```python
import torch

def _softmax(x, axis=-1):
    return torch.softmax(x, dim=axis)

def _gelu(x):
    return torch.nn.functional.gelu(x, approximate='tanh')

def _silu(x):
    return torch.nn.functional.silu(x)

def _sigmoid(x):
    return torch.sigmoid(x)

def _layernorm(x, axis=-1, eps=1e-05):
    m = x.mean(dim=axis, keepdim=True)
    v = x.var(dim=axis, keepdim=True, unbiased=False)
    return (x - m) / torch.sqrt(v + eps)

def _scatter_add(tgt, idx, src, axis=0):
    return tgt.clone().index_add_(axis, idx, src)

def _segment_sum(src, seg, n):
    out = torch.zeros((n,) + src.shape[1:], dtype=src.dtype)
    return out.index_add_(0, seg, src)

def _pad(x, pw):
    flat = tuple((v for pair in reversed(pw) for v in pair))
    return torch.nn.functional.pad(x, flat)
kernel_name = 'recurrent_scan__memory_aug_recurrent_mem_tr__glu_gated_reglu__prompt'

def setup_inputs():

    _w = lambda a: (lambda t: t.to(torch.bfloat16) if t.is_floating_point() else t)(torch.as_tensor(a))

    def _A_setup():
        B, S, Dm = (1, 2048, 448)
        H, Dh = (16, 256)
        M, seg = (8, 32)
        seg = min(seg, S)
        S = S // seg * seg
        return {'x': _w((lambda *s: torch.randn(*s, dtype=torch.bfloat16) * 0.1)(B, S, Dm)), 'mem0': _w((lambda *s: torch.randn(*s, dtype=torch.bfloat16) * 1.6)(B, M, Dm)), 'Wq': _w((lambda *s: torch.randn(*s, dtype=torch.bfloat16) * 0.8)(Dm, H, Dh) * Dm ** (-0.5)), 'Wk': _w((lambda *s: torch.randn(*s, dtype=torch.bfloat16) * 0.8)(Dm, H, Dh) * Dm ** (-0.5)), 'Wv': _w((lambda *s: torch.randn(*s, dtype=torch.bfloat16) * 1.6)(Dm, H, Dh) * Dm ** (-0.5)), 'Wo': _w((lambda *s: torch.randn(*s, dtype=torch.bfloat16) * 1.6)(H, Dh, Dm) * (H * Dh) ** (-0.5)), 'seg_len': seg}
    _A_in = _A_setup()

    def _B_setup():
        B, S, D, F = (1, 2048, 448, 1792)
        return {'x': _w((lambda *s: torch.randn(*s, dtype=torch.bfloat16) * 0.1)(B, S, D)), 'W_gate': _w((lambda *s: torch.randn(*s, dtype=torch.bfloat16) * 0.4)(D, F) * (2.0 / D) ** 0.5), 'W_up': _w((lambda *s: torch.randn(*s, dtype=torch.bfloat16) * 0.4)(D, F) * (2.0 / D) ** 0.5), 'W_down': _w((lambda *s: torch.randn(*s, dtype=torch.bfloat16) * 0.4)(F, D) * (1.0 / F) ** 0.5)}
    _B_in = _B_setup()
    return {'A_x': _A_in['x'], 'A_mem0': _A_in['mem0'], 'A_Wq': _A_in['Wq'], 'A_Wk': _A_in['Wk'], 'A_Wv': _A_in['Wv'], 'A_Wo': _A_in['Wo'], 'A_seg_len': _A_in['seg_len'], 'B_x': _B_in['x'], 'B_W_gate': _B_in['W_gate'], 'B_W_up': _B_in['W_up'], 'B_W_down': _B_in['W_down']}

def reference(A_x, A_mem0, A_Wq, A_Wk, A_Wv, A_Wo, A_seg_len, B_x, B_W_gate, B_W_up, B_W_down):

    def _A_ref(x, mem0, Wq, Wk, Wv, Wo, seg_len):
        B, S, Dm = x.shape
        H, Dh = (Wq.shape[1], Wq.shape[2])
        M = mem0.shape[1]
        scale = Dh ** (-0.5)
        n_seg = S // seg_len
        L = M + seg_len
        idx = torch.arange(L)
        mask = (idx[:, None] < M) | (idx[:, None] >= idx[None, :])
        mem = mem0
        outs = []
        for s in range(n_seg):
            xs = x[:, s * seg_len:(s + 1) * seg_len, :].clone()
            h = torch.concatenate([mem, xs], axis=1)
            q = torch.einsum('btd,dhe->bhte', h, Wq)
            k = torch.einsum('btd,dhe->bhte', h, Wk)
            v = torch.einsum('btd,dhe->bhte', h, Wv)
            scores = torch.einsum('bhqe,bhke->bhqk', q, k) * scale
            scores = torch.where(mask[None, None], scores, -1000000000.0)
            p = _softmax(scores, axis=-1)
            o = torch.einsum('bhqk,bhke->bhqe', p, v)
            o = torch.einsum('bhte,hed->btd', o, Wo)
            mem = o[:, :M, :].clone()
            outs.append(o[:, M:, :])
        return torch.concatenate(outs, axis=1)

    def _B_ref(x, W_gate, W_up, W_down):
        gate = torch.einsum('bsd,df->bsf', x, W_gate)
        up = torch.einsum('bsd,df->bsf', x, W_up)
        gate = gate * (lambda x, dt: x.to(dt))(gate > 0, gate.dtype)
        h = gate * up
        return torch.einsum('bsf,fd->bsd', h, W_down)
    x = A_x
    xn = _layernorm(x, axis=-1)
    s = _A_ref(xn, A_mem0, A_Wq, A_Wk, A_Wv, A_Wo, A_seg_len)
    g = _silu(_B_ref(xn, B_W_gate, B_W_up, B_W_down))
    return x + s * g
```

```asm
; @launch grid=(256,1,1) block=(256,1,1) lds=151552
.amdgcn_target "amdgcn-amd-amdhsa--gfx950"
.text
.globl recurrent_scan__memory_aug_recurrent_mem_tr__glu_gated_reglu__prompt_kernel
.p2align 8
.type recurrent_scan__memory_aug_recurrent_mem_tr__glu_gated_reglu__prompt_kernel,@function
recurrent_scan__memory_aug_recurrent_mem_tr__glu_gated_reglu__prompt_kernel:
s_cmp_ge_u32 s2, 256
s_cbranch_scc1 M_exit
s_getpc_b64 s[6:7]
M_pc:
s_lshr_b32 s14, s2, 3
s_and_b32 s14, s14, 31
s_mul_i32 s14, s14, (((M_code_end-recurrent_scan__memory_aug_recurrent_mem_tr__glu_gated_reglu__prompt_kernel)+4095)/4096)*128
s_sub_u32 s6, s6, M_pc-recurrent_scan__memory_aug_recurrent_mem_tr__glu_gated_reglu__prompt_kernel
s_subb_u32 s7, s7, 0
v_lshlrev_b32 v255, 7, v0
v_add_u32 v255, s14, v255
v_cmp_gt_u32 vcc, (((M_code_end-recurrent_scan__memory_aug_recurrent_mem_tr__glu_gated_reglu__prompt_kernel)+4095)/4096), v0
s_and_saveexec_b64 s[20:21], vcc
s_cbranch_execz M_pf_done
global_load_dword v255, v255, s[6:7]
M_pf_done:
s_mov_b64 exec, s[20:21]
s_load_dwordx2 s[8:9], s[0:1], 104
s_mov_b32 s10, 268435456
s_mov_b32 s11, 0x20000
s_load_dwordx2 s[4:5], s[0:1], 96
s_getreg_b32 s3, hwreg(HW_REG_XCC_ID)
s_and_b32 s3, s3, 15
s_mov_b32 s19, 200000
v_lshrrev_b32 v3, 6, v0
s_nop 0
v_readfirstlane_b32 s13, v3
s_waitcnt lgkmcnt(0)
s_load_dwordx8 s[60:67], s[0:1], 16
s_waitcnt lgkmcnt(0)
s_cmp_ge_u32 s13, 2
s_cselect_b32 s68, s62, s60
s_cselect_b32 s69, s63, s61
s_cselect_b32 s70, s66, s64
s_cselect_b32 s71, s67, s65
v_and_b32 v5, 127, v0
s_mul_i32 s72, s2, 112
v_add_u32 v6, s72, v5
v_lshlrev_b32 v6, 7, v6
v_cmp_gt_u32 vcc, 0x70, v5
s_and_saveexec_b64 s[20:21], vcc
s_cbranch_execz M_wt_done
global_load_dword v253, v6, s[68:69]
global_load_dword v254, v6, s[70:71]
M_wt_done:
s_mov_b64 exec, s[20:21]
s_and_b32 s3, s3, 7
s_lshl_b32 s17, s3, 5
v_mov_b32 v1, 0
v_mov_b32 v2, 1
v_mov_b32 v4, s17
v_cmp_eq_u32 vcc, 0, v0
s_and_saveexec_b64 s[20:21], vcc
s_cbranch_execz M_reg_done
global_atomic_add v2, v4, v2, s[4:5] sc0 sc1
s_waitcnt vmcnt(0)
ds_write_b32 v1, v2
s_waitcnt lgkmcnt(0)
M_reg_done:
s_mov_b64 exec, s[20:21]
s_barrier
ds_read_b32 v3, v1
s_waitcnt lgkmcnt(0)
s_nop 0
v_readfirstlane_b32 s12, v3
s_barrier
s_cmp_lt_u32 s12, 32
s_cbranch_scc0 M_overflow
s_lshl_b32 s17, s3, 5
s_add_u32 s12, s12, s17
M_dispatch:
s_cmp_ge_u32 s12, 32
s_cbranch_scc1 M_worker
s_lshl_b32 s56, s12, 1
s_load_dwordx2 s[36:37], s[0:1], 0
s_mov_b32 s38, 1835008
s_mov_b32 s39, 0x20000
v_and_b32 v1, 63, v0
v_lshrrev_b32 v2, 3, v1
s_lshl_b32 s21, s13, 3
v_add_u32 v2, s21, v2
v_and_b32 v3, 7, v1
v_mul_u32_u24 v4, 896, v2
v_lshl_add_u32 v4, v3, 4, v4
s_mul_i32 s21, s56, 28672
s_add_u32 s22, s21, 28672
s_waitcnt lgkmcnt(0)
buffer_load_dwordx4 v[112:115], v4, s[36:39], s21 offen offset:0
buffer_load_dwordx4 v[116:119], v4, s[36:39], s21 offen offset:128
buffer_load_dwordx4 v[120:123], v4, s[36:39], s21 offen offset:256
buffer_load_dwordx4 v[124:127], v4, s[36:39], s21 offen offset:384
buffer_load_dwordx4 v[128:131], v4, s[36:39], s21 offen offset:512
buffer_load_dwordx4 v[132:135], v4, s[36:39], s21 offen offset:640
buffer_load_dwordx4 v[136:139], v4, s[36:39], s21 offen offset:768
buffer_load_dwordx4 v[144:147], v4, s[36:39], s22 offen offset:0
buffer_load_dwordx4 v[148:151], v4, s[36:39], s22 offen offset:128
buffer_load_dwordx4 v[152:155], v4, s[36:39], s22 offen offset:256
buffer_load_dwordx4 v[156:159], v4, s[36:39], s22 offen offset:384
buffer_load_dwordx4 v[160:163], v4, s[36:39], s22 offen offset:512
buffer_load_dwordx4 v[164:167], v4, s[36:39], s22 offen offset:640
buffer_load_dwordx4 v[168:171], v4, s[36:39], s22 offen offset:768
s_load_dwordx2 s[40:41], s[0:1], 8
s_mov_b32 s42, 7168
s_mov_b32 s43, 0x20000
v_mov_b32 v16, -1
v_mov_b32 v20, 0
v_mov_b32 v17, -1
v_mov_b32 v21, 0
v_mov_b32 v18, -1
v_mov_b32 v22, 0
v_mov_b32 v19, -1
v_mov_b32 v23, 0
v_lshlrev_b32 v24, 4, v0
s_mul_i32 s23, s12, 1952
s_add_u32 s23, s23, 44047360
v_cmp_gt_u32 vcc, 122, v0
s_and_saveexec_b64 s[24:25], vcc
buffer_store_dwordx4 v[16:19], v24, s[8:11], s23 offen sc1
s_mov_b64 exec, s[24:25]
s_mul_i32 s23, s12, 50
v_add_u32 v25, s23, v0
s_mul_i32 s23, s23, 16
s_add_u32 s23, s23, 44109824
v_cmp_gt_u32 vcc, 50, v0
s_mov_b32 s28, 1576
v_cmp_gt_u32 s[26:27], s28, v25
s_and_b64 vcc, vcc, s[26:27]
s_and_saveexec_b64 s[24:25], vcc
buffer_store_dwordx4 v[20:23], v24, s[8:11], s23 offen sc1
s_mov_b64 exec, s[24:25]
s_lshl_b32 s23, s12, 1
s_add_u32 s23, s23, 0
s_cmp_eq_u32 s23, 0
s_cbranch_scc1 I_nos_1
s_mul_i32 s23, s23, 7168
s_add_u32 s23, s23, 44135040
buffer_store_dwordx4 v[16:19], v24, s[8:11], s23 offen sc1
v_cmp_gt_u32 vcc, 192, v0
s_and_saveexec_b64 s[24:25], vcc
s_add_u32 s23, s23, 4096
buffer_store_dwordx4 v[16:19], v24, s[8:11], s23 offen sc1
s_mov_b64 exec, s[24:25]
I_nos_1:
s_lshl_b32 s23, s12, 1
s_add_u32 s23, s23, 1
s_cmp_eq_u32 s23, 0
s_cbranch_scc1 I_nos_2
s_mul_i32 s23, s23, 7168
s_add_u32 s23, s23, 44135040
buffer_store_dwordx4 v[16:19], v24, s[8:11], s23 offen sc1
v_cmp_gt_u32 vcc, 192, v0
s_and_saveexec_b64 s[24:25], vcc
s_add_u32 s23, s23, 4096
buffer_store_dwordx4 v[16:19], v24, s[8:11], s23 offen sc1
s_mov_b64 exec, s[24:25]
I_nos_2:
s_cmp_lg_u32 s12, 31
s_cbranch_scc1 I_nm_3
s_waitcnt lgkmcnt(0)
v_add_u32 v25, 0, v0
v_and_b32 v26, 7, v25
v_mul_u32_u24 v26, 896, v26
v_lshrrev_b32 v27, 6, v25
v_lshl_add_u32 v26, v27, 7, v26
v_bfe_u32 v27, v25, 4, 2
v_lshl_add_u32 v26, v27, 5, v26
v_bfe_u32 v27, v25, 3, 1
v_lshl_add_u32 v26, v27, 4, v26
v_lshlrev_b32 v27, 4, v25
buffer_load_dwordx4 v[28:31], v26, s[40:43], 0 offen
s_waitcnt vmcnt(0)
s_mov_b32 s23, 44040192
buffer_store_dwordx4 v[28:31], v27, s[8:11], s23 offen sc1
s_mov_b32 s23, 44135040
buffer_store_dwordx4 v[28:31], v27, s[8:11], s23 offen sc1
s_nop 1
v_add_u32 v25, 256, v0
v_and_b32 v26, 7, v25
v_mul_u32_u24 v26, 896, v26
v_lshrrev_b32 v27, 6, v25
v_lshl_add_u32 v26, v27, 7, v26
v_bfe_u32 v27, v25, 4, 2
v_lshl_add_u32 v26, v27, 5, v26
v_bfe_u32 v27, v25, 3, 1
v_lshl_add_u32 v26, v27, 4, v26
v_lshlrev_b32 v27, 4, v25
v_cmp_gt_u32 vcc, 448, v25
s_and_saveexec_b64 s[24:25], vcc
buffer_load_dwordx4 v[28:31], v26, s[40:43], 0 offen
s_waitcnt vmcnt(0)
s_mov_b32 s23, 44040192
buffer_store_dwordx4 v[28:31], v27, s[8:11], s23 offen sc1
s_mov_b32 s23, 44135040
buffer_store_dwordx4 v[28:31], v27, s[8:11], s23 offen sc1
s_mov_b64 exec, s[24:25]
s_nop 1
I_nm_3:
s_waitcnt vmcnt(0) lgkmcnt(0)
s_barrier
s_cmp_lg_u32 s13, 0
s_cbranch_scc1 I_ns_4
v_mov_b32 v16, 0
v_mov_b32 v17, 1
s_mov_b64 exec, 1
global_atomic_add v16, v17, s[4:5] offset:16 sc1
s_mov_b64 exec, -1
I_ns_4:
v_and_b32 v1, 63, v0
v_lshrrev_b32 v2, 3, v1
s_lshl_b32 s21, s13, 3
v_add_u32 v2, s21, v2
v_and_b32 v3, 7, v1
v_mul_u32_u24 v4, 896, v2
v_lshl_add_u32 v4, v3, 4, v4
s_mul_i32 s21, s56, 28672
s_waitcnt lgkmcnt(0)
s_barrier
v_lshlrev_b32 v48, 16, v112
v_and_b32 v49, 0xffff0000, v112
v_lshlrev_b32 v50, 16, v113
v_and_b32 v51, 0xffff0000, v113
v_lshlrev_b32 v52, 16, v114
v_and_b32 v53, 0xffff0000, v114
v_lshlrev_b32 v54, 16, v115
v_and_b32 v55, 0xffff0000, v115
v_lshlrev_b32 v56, 16, v116
v_and_b32 v57, 0xffff0000, v116
v_lshlrev_b32 v58, 16, v117
v_and_b32 v59, 0xffff0000, v117
v_lshlrev_b32 v60, 16, v118
v_and_b32 v61, 0xffff0000, v118
v_lshlrev_b32 v62, 16, v119
v_and_b32 v63, 0xffff0000, v119
v_lshlrev_b32 v64, 16, v120
v_and_b32 v65, 0xffff0000, v120
v_lshlrev_b32 v66, 16, v121
v_and_b32 v67, 0xffff0000, v121
v_lshlrev_b32 v68, 16, v122
v_and_b32 v69, 0xffff0000, v122
v_lshlrev_b32 v70, 16, v123
v_and_b32 v71, 0xffff0000, v123
v_lshlrev_b32 v72, 16, v124
v_and_b32 v73, 0xffff0000, v124
v_lshlrev_b32 v74, 16, v125
v_and_b32 v75, 0xffff0000, v125
v_lshlrev_b32 v76, 16, v126
v_and_b32 v77, 0xffff0000, v126
v_lshlrev_b32 v78, 16, v127
v_and_b32 v79, 0xffff0000, v127
v_lshlrev_b32 v80, 16, v128
v_and_b32 v81, 0xffff0000, v128
v_lshlrev_b32 v82, 16, v129
v_and_b32 v83, 0xffff0000, v129
v_lshlrev_b32 v84, 16, v130
v_and_b32 v85, 0xffff0000, v130
v_lshlrev_b32 v86, 16, v131
v_and_b32 v87, 0xffff0000, v131
v_lshlrev_b32 v88, 16, v132
v_and_b32 v89, 0xffff0000, v132
v_lshlrev_b32 v90, 16, v133
v_and_b32 v91, 0xffff0000, v133
v_lshlrev_b32 v92, 16, v134
v_and_b32 v93, 0xffff0000, v134
v_lshlrev_b32 v94, 16, v135
v_and_b32 v95, 0xffff0000, v135
v_lshlrev_b32 v96, 16, v136
v_and_b32 v97, 0xffff0000, v136
v_lshlrev_b32 v98, 16, v137
v_and_b32 v99, 0xffff0000, v137
v_lshlrev_b32 v100, 16, v138
v_and_b32 v101, 0xffff0000, v138
v_lshlrev_b32 v102, 16, v139
v_and_b32 v103, 0xffff0000, v139
v_pk_add_f32 v[6:7], v[48:49], v[50:51]
v_pk_add_f32 v[6:7], v[6:7], v[52:53]
v_pk_add_f32 v[6:7], v[6:7], v[54:55]
v_pk_add_f32 v[6:7], v[6:7], v[56:57]
v_pk_add_f32 v[6:7], v[6:7], v[58:59]
v_pk_add_f32 v[6:7], v[6:7], v[60:61]
v_pk_add_f32 v[6:7], v[6:7], v[62:63]
v_pk_add_f32 v[6:7], v[6:7], v[64:65]
v_pk_add_f32 v[6:7], v[6:7], v[66:67]
v_pk_add_f32 v[6:7], v[6:7], v[68:69]
v_pk_add_f32 v[6:7], v[6:7], v[70:71]
v_pk_add_f32 v[6:7], v[6:7], v[72:73]
v_pk_add_f32 v[6:7], v[6:7], v[74:75]
v_pk_add_f32 v[6:7], v[6:7], v[76:77]
v_pk_add_f32 v[6:7], v[6:7], v[78:79]
v_pk_add_f32 v[6:7], v[6:7], v[80:81]
v_pk_add_f32 v[6:7], v[6:7], v[82:83]
v_pk_add_f32 v[6:7], v[6:7], v[84:85]
v_pk_add_f32 v[6:7], v[6:7], v[86:87]
v_pk_add_f32 v[6:7], v[6:7], v[88:89]
v_pk_add_f32 v[6:7], v[6:7], v[90:91]
v_pk_add_f32 v[6:7], v[6:7], v[92:93]
v_pk_add_f32 v[6:7], v[6:7], v[94:95]
v_pk_add_f32 v[6:7], v[6:7], v[96:97]
v_pk_add_f32 v[6:7], v[6:7], v[98:99]
v_pk_add_f32 v[6:7], v[6:7], v[100:101]
v_pk_add_f32 v[6:7], v[6:7], v[102:103]
v_add_f32 v6, v6, v7
s_nop 1
v_add_f32_dpp v6, v6, v6 quad_perm:[1,0,3,2] row_mask:0xf bank_mask:0xf
s_nop 1
v_add_f32_dpp v6, v6, v6 quad_perm:[2,3,0,1] row_mask:0xf bank_mask:0xf
s_nop 1
v_add_f32_dpp v6, v6, v6 row_half_mirror row_mask:0xf bank_mask:0xf
v_mul_f32 v6, 0x3b124925, v6
v_mov_b32 v7, v6
v_pk_add_f32 v[48:49], v[48:49], v[6:7] neg_lo:[0,1] neg_hi:[0,1]
v_pk_add_f32 v[50:51], v[50:51], v[6:7] neg_lo:[0,1] neg_hi:[0,1]
v_pk_add_f32 v[52:53], v[52:53], v[6:7] neg_lo:[0,1] neg_hi:[0,1]
v_pk_add_f32 v[54:55], v[54:55], v[6:7] neg_lo:[0,1] neg_hi:[0,1]
v_pk_add_f32 v[56:57], v[56:57], v[6:7] neg_lo:[0,1] neg_hi:[0,1]
v_pk_add_f32 v[58:59], v[58:59], v[6:7] neg_lo:[0,1] neg_hi:[0,1]
v_pk_add_f32 v[60:61], v[60:61], v[6:7] neg_lo:[0,1] neg_hi:[0,1]
v_pk_add_f32 v[62:63], v[62:63], v[6:7] neg_lo:[0,1] neg_hi:[0,1]
v_pk_add_f32 v[64:65], v[64:65], v[6:7] neg_lo:[0,1] neg_hi:[0,1]
v_pk_add_f32 v[66:67], v[66:67], v[6:7] neg_lo:[0,1] neg_hi:[0,1]
v_pk_add_f32 v[68:69], v[68:69], v[6:7] neg_lo:[0,1] neg_hi:[0,1]
v_pk_add_f32 v[70:71], v[70:71], v[6:7] neg_lo:[0,1] neg_hi:[0,1]
v_pk_add_f32 v[72:73], v[72:73], v[6:7] neg_lo:[0,1] neg_hi:[0,1]
v_pk_add_f32 v[74:75], v[74:75], v[6:7] neg_lo:[0,1] neg_hi:[0,1]
v_pk_add_f32 v[76:77], v[76:77], v[6:7] neg_lo:[0,1] neg_hi:[0,1]
v_pk_add_f32 v[78:79], v[78:79], v[6:7] neg_lo:[0,1] neg_hi:[0,1]
v_pk_add_f32 v[80:81], v[80:81], v[6:7] neg_lo:[0,1] neg_hi:[0,1]
v_pk_add_f32 v[82:83], v[82:83], v[6:7] neg_lo:[0,1] neg_hi:[0,1]
v_pk_add_f32 v[84:85], v[84:85], v[6:7] neg_lo:[0,1] neg_hi:[0,1]
v_pk_add_f32 v[86:87], v[86:87], v[6:7] neg_lo:[0,1] neg_hi:[0,1]
v_pk_add_f32 v[88:89], v[88:89], v[6:7] neg_lo:[0,1] neg_hi:[0,1]
v_pk_add_f32 v[90:91], v[90:91], v[6:7] neg_lo:[0,1] neg_hi:[0,1]
v_pk_add_f32 v[92:93], v[92:93], v[6:7] neg_lo:[0,1] neg_hi:[0,1]
v_pk_add_f32 v[94:95], v[94:95], v[6:7] neg_lo:[0,1] neg_hi:[0,1]
v_pk_add_f32 v[96:97], v[96:97], v[6:7] neg_lo:[0,1] neg_hi:[0,1]
v_pk_add_f32 v[98:99], v[98:99], v[6:7] neg_lo:[0,1] neg_hi:[0,1]
v_pk_add_f32 v[100:101], v[100:101], v[6:7] neg_lo:[0,1] neg_hi:[0,1]
v_pk_add_f32 v[102:103], v[102:103], v[6:7] neg_lo:[0,1] neg_hi:[0,1]
v_pk_mul_f32 v[8:9], v[48:49], v[48:49]
v_pk_fma_f32 v[8:9], v[50:51], v[50:51], v[8:9]
v_pk_fma_f32 v[8:9], v[52:53], v[52:53], v[8:9]
v_pk_fma_f32 v[8:9], v[54:55], v[54:55], v[8:9]
v_pk_fma_f32 v[8:9], v[56:57], v[56:57], v[8:9]
v_pk_fma_f32 v[8:9], v[58:59], v[58:59], v[8:9]
v_pk_fma_f32 v[8:9], v[60:61], v[60:61], v[8:9]
v_pk_fma_f32 v[8:9], v[62:63], v[62:63], v[8:9]
v_pk_fma_f32 v[8:9], v[64:65], v[64:65], v[8:9]
v_pk_fma_f32 v[8:9], v[66:67], v[66:67], v[8:9]
v_pk_fma_f32 v[8:9], v[68:69], v[68:69], v[8:9]
v_pk_fma_f32 v[8:9], v[70:71], v[70:71], v[8:9]
v_pk_fma_f32 v[8:9], v[72:73], v[72:73], v[8:9]
v_pk_fma_f32 v[8:9], v[74:75], v[74:75], v[8:9]
v_pk_fma_f32 v[8:9], v[76:77], v[76:77], v[8:9]
v_pk_fma_f32 v[8:9], v[78:79], v[78:79], v[8:9]
v_pk_fma_f32 v[8:9], v[80:81], v[80:81], v[8:9]
v_pk_fma_f32 v[8:9], v[82:83], v[82:83], v[8:9]
v_pk_fma_f32 v[8:9], v[84:85], v[84:85], v[8:9]
v_pk_fma_f32 v[8:9], v[86:87], v[86:87], v[8:9]
v_pk_fma_f32 v[8:9], v[88:89], v[88:89], v[8:9]
v_pk_fma_f32 v[8:9], v[90:91], v[90:91], v[8:9]
v_pk_fma_f32 v[8:9], v[92:93], v[92:93], v[8:9]
v_pk_fma_f32 v[8:9], v[94:95], v[94:95], v[8:9]
v_pk_fma_f32 v[8:9], v[96:97], v[96:97], v[8:9]
v_pk_fma_f32 v[8:9], v[98:99], v[98:99], v[8:9]
v_pk_fma_f32 v[8:9], v[100:101], v[100:101], v[8:9]
v_pk_fma_f32 v[8:9], v[102:103], v[102:103], v[8:9]
v_add_f32 v8, v8, v9
s_nop 1
v_add_f32_dpp v8, v8, v8 quad_perm:[1,0,3,2] row_mask:0xf bank_mask:0xf
s_nop 1
v_add_f32_dpp v8, v8, v8 quad_perm:[2,3,0,1] row_mask:0xf bank_mask:0xf
s_nop 1
v_add_f32_dpp v8, v8, v8 row_half_mirror row_mask:0xf bank_mask:0xf
v_mov_b32 v9, 0x3727c5ac
v_mov_b32 v10, 0x3b124925
v_fma_f32 v8, v8, v10, v9
v_rsq_f32 v8, v8
s_nop 0
v_mov_b32 v9, v8
v_pk_mul_f32 v[48:49], v[48:49], v[8:9]
v_cvt_pk_bf16_f32 v16, v48, v49
v_pk_mul_f32 v[50:51], v[50:51], v[8:9]
v_cvt_pk_bf16_f32 v17, v50, v51
v_pk_mul_f32 v[52:53], v[52:53], v[8:9]
v_cvt_pk_bf16_f32 v18, v52, v53
v_pk_mul_f32 v[54:55], v[54:55], v[8:9]
v_cvt_pk_bf16_f32 v19, v54, v55
v_pk_mul_f32 v[56:57], v[56:57], v[8:9]
v_cvt_pk_bf16_f32 v20, v56, v57
v_pk_mul_f32 v[58:59], v[58:59], v[8:9]
v_cvt_pk_bf16_f32 v21, v58, v59
v_pk_mul_f32 v[60:61], v[60:61], v[8:9]
v_cvt_pk_bf16_f32 v22, v60, v61
v_pk_mul_f32 v[62:63], v[62:63], v[8:9]
v_cvt_pk_bf16_f32 v23, v62, v63
v_pk_mul_f32 v[64:65], v[64:65], v[8:9]
v_cvt_pk_bf16_f32 v24, v64, v65
v_pk_mul_f32 v[66:67], v[66:67], v[8:9]
v_cvt_pk_bf16_f32 v25, v66, v67
v_pk_mul_f32 v[68:69], v[68:69], v[8:9]
v_cvt_pk_bf16_f32 v26, v68, v69
v_pk_mul_f32 v[70:71], v[70:71], v[8:9]
v_cvt_pk_bf16_f32 v27, v70, v71
v_pk_mul_f32 v[72:73], v[72:73], v[8:9]
v_cvt_pk_bf16_f32 v28, v72, v73
v_pk_mul_f32 v[74:75], v[74:75], v[8:9]
v_cvt_pk_bf16_f32 v29, v74, v75
v_pk_mul_f32 v[76:77], v[76:77], v[8:9]
v_cvt_pk_bf16_f32 v30, v76, v77
v_pk_mul_f32 v[78:79], v[78:79], v[8:9]
v_cvt_pk_bf16_f32 v31, v78, v79
v_pk_mul_f32 v[80:81], v[80:81], v[8:9]
v_cvt_pk_bf16_f32 v32, v80, v81
v_pk_mul_f32 v[82:83], v[82:83], v[8:9]
v_cvt_pk_bf16_f32 v33, v82, v83
v_pk_mul_f32 v[84:85], v[84:85], v[8:9]
v_cvt_pk_bf16_f32 v34, v84, v85
v_pk_mul_f32 v[86:87], v[86:87], v[8:9]
v_cvt_pk_bf16_f32 v35, v86, v87
v_pk_mul_f32 v[88:89], v[88:89], v[8:9]
v_cvt_pk_bf16_f32 v36, v88, v89
v_pk_mul_f32 v[90:91], v[90:91], v[8:9]
v_cvt_pk_bf16_f32 v37, v90, v91
v_pk_mul_f32 v[92:93], v[92:93], v[8:9]
v_cvt_pk_bf16_f32 v38, v92, v93
v_pk_mul_f32 v[94:95], v[94:95], v[8:9]
v_cvt_pk_bf16_f32 v39, v94, v95
v_pk_mul_f32 v[96:97], v[96:97], v[8:9]
v_cvt_pk_bf16_f32 v40, v96, v97
v_pk_mul_f32 v[98:99], v[98:99], v[8:9]
v_cvt_pk_bf16_f32 v41, v98, v99
v_pk_mul_f32 v[100:101], v[100:101], v[8:9]
v_cvt_pk_bf16_f32 v42, v100, v101
v_pk_mul_f32 v[102:103], v[102:103], v[8:9]
v_cvt_pk_bf16_f32 v43, v102, v103
v_mul_u32_u24 v4, 912, v2
v_lshl_add_u32 v4, v3, 4, v4
ds_write_b128 v4, v[16:19] offset:0
ds_write_b128 v4, v[20:23] offset:128
ds_write_b128 v4, v[24:27] offset:256
ds_write_b128 v4, v[28:31] offset:384
ds_write_b128 v4, v[32:35] offset:512
ds_write_b128 v4, v[36:39] offset:640
ds_write_b128 v4, v[40:43] offset:768
s_waitcnt lgkmcnt(0)
s_barrier
v_and_b32 v2, 15, v1
v_lshrrev_b32 v3, 4, v1
v_lshlrev_b32 v5, 4, v1
v_lshlrev_b32 v12, 3, v1
v_bfe_u32 v8, v2, 3, 1
v_lshlrev_b32 v4, 4, v8
v_bfe_u32 v8, v2, 1, 1
v_lshl_add_u32 v4, v8, 3, v4
v_bfe_u32 v8, v2, 2, 1
v_lshl_add_u32 v4, v8, 2, v4
v_and_b32 v8, 1, v2
v_add_u32 v4, v4, v8
s_lshr_b32 s21, s13, 1
s_lshl_b32 s22, s21, 1
v_add_u32 v13, s22, v4
v_mul_u32_u24 v13, 912, v13
v_lshrrev_b32 v8, 1, v3
v_lshl_add_u32 v13, v8, 5, v13
v_and_b32 v8, 1, v3
v_lshl_add_u32 v13, v8, 3, v13
s_and_b32 s22, s13, 1
s_mul_i32 s22, s22, 448
v_add_u32 v13, s22, v13
ds_read2_b32 v[16:17], v13 offset0:0 offset1:4
ds_read2_b32 v[18:19], v13 offset0:1 offset1:5
ds_read2_b32 v[20:21], v13 offset0:16 offset1:20
ds_read2_b32 v[22:23], v13 offset0:17 offset1:21
ds_read2_b32 v[24:25], v13 offset0:32 offset1:36
ds_read2_b32 v[26:27], v13 offset0:33 offset1:37
ds_read2_b32 v[28:29], v13 offset0:48 offset1:52
ds_read2_b32 v[30:31], v13 offset0:49 offset1:53
ds_read2_b32 v[32:33], v13 offset0:64 offset1:68
ds_read2_b32 v[34:35], v13 offset0:65 offset1:69
ds_read2_b32 v[36:37], v13 offset0:80 offset1:84
ds_read2_b32 v[38:39], v13 offset0:81 offset1:85
ds_read2_b32 v[40:41], v13 offset0:96 offset1:100
ds_read2_b32 v[42:43], v13 offset0:97 offset1:101
s_mul_i32 s22, s56, 28672
s_mul_i32 s23, s13, 7168
s_add_u32 s22, s22, s23
s_add_u32 s24, s22, 46428800
s_waitcnt lgkmcnt(0)
buffer_store_dwordx4 v[16:19], v5, s[8:11], s24 offen offset:0 sc1
buffer_store_dwordx4 v[20:23], v5, s[8:11], s24 offen offset:1024 sc1
buffer_store_dwordx4 v[24:27], v5, s[8:11], s24 offen offset:2048 sc1
buffer_store_dwordx4 v[28:31], v5, s[8:11], s24 offen offset:3072 sc1
s_add_u32 s24, s24, 4096
buffer_store_dwordx4 v[32:35], v5, s[8:11], s24 offen offset:0 sc1
buffer_store_dwordx4 v[36:39], v5, s[8:11], s24 offen offset:1024 sc1
buffer_store_dwordx4 v[40:43], v5, s[8:11], s24 offen offset:2048 sc1
v_add_u32 v13, 0, v2
v_mul_u32_u24 v13, 912, v13
v_lshl_add_u32 v13, v3, 3, v13
s_mul_i32 s23, s13, 224
v_add_u32 v13, s23, v13
ds_read2_b64 v[48:51], v13 offset0:0 offset1:4
ds_read2_b64 v[52:55], v13 offset0:8 offset1:12
ds_read2_b64 v[56:59], v13 offset0:16 offset1:20
ds_read_b64 v[60:61], v13 offset:192
v_add_u32 v13, 16, v2
v_mul_u32_u24 v13, 912, v13
v_lshl_add_u32 v13, v3, 3, v13
s_mul_i32 s23, s13, 224
v_add_u32 v13, s23, v13
ds_read2_b64 v[62:65], v13 offset0:0 offset1:4
ds_read2_b64 v[66:69], v13 offset0:8 offset1:12
ds_read2_b64 v[70:73], v13 offset0:16 offset1:20
ds_read_b64 v[74:75], v13 offset:192
s_waitcnt lgkmcnt(0)
s_add_u32 s24, s22, 42205184
s_add_u32 s25, s24, 4096
buffer_store_dwordx4 v[48:51], v5, s[8:11], s24 offen offset:0 sc1
buffer_store_dwordx4 v[52:55], v5, s[8:11], s24 offen offset:1024 sc1
buffer_store_dwordx4 v[56:59], v5, s[8:11], s24 offen offset:2048 sc1
buffer_store_dwordx2 v[60:61], v12, s[8:11], s24 offen offset:3072 sc1
buffer_store_dwordx4 v[62:65], v5, s[8:11], s24 offen offset:3584 sc1
buffer_store_dwordx4 v[66:69], v5, s[8:11], s25 offen offset:512 sc1
buffer_store_dwordx4 v[70:73], v5, s[8:11], s25 offen offset:1536 sc1
buffer_store_dwordx2 v[74:75], v12, s[8:11], s25 offen offset:2560 sc1
v_add_u32 v13, 0, v4
v_mul_u32_u24 v13, 912, v13
v_lshl_add_u32 v13, v3, 3, v13
s_mul_i32 s23, s13, 224
v_add_u32 v13, s23, v13
ds_read2_b64 v[76:79], v13 offset0:0 offset1:4
ds_read2_b64 v[80:83], v13 offset0:8 offset1:12
ds_read2_b64 v[84:87], v13 offset0:16 offset1:20
ds_read_b64 v[88:89], v13 offset:192
v_add_u32 v13, 2, v4
v_mul_u32_u24 v13, 912, v13
v_lshl_add_u32 v13, v3, 3, v13
s_mul_i32 s23, s13, 224
v_add_u32 v13, s23, v13
ds_read2_b64 v[90:93], v13 offset0:0 offset1:4
ds_read2_b64 v[94:97], v13 offset0:8 offset1:12
ds_read2_b64 v[98:101], v13 offset0:16 offset1:20
ds_read_b64 v[102:103], v13 offset:192
s_waitcnt lgkmcnt(0)
s_add_u32 s24, s22, 44593792
s_add_u32 s25, s24, 4096
buffer_store_dwordx4 v[76:79], v5, s[8:11], s24 offen offset:0 sc1
buffer_store_dwordx4 v[80:83], v5, s[8:11], s24 offen offset:1024 sc1
buffer_store_dwordx4 v[84:87], v5, s[8:11], s24 offen offset:2048 sc1
buffer_store_dwordx2 v[88:89], v12, s[8:11], s24 offen offset:3072 sc1
buffer_store_dwordx4 v[90:93], v5, s[8:11], s24 offen offset:3584 sc1
buffer_store_dwordx4 v[94:97], v5, s[8:11], s25 offen offset:512 sc1
buffer_store_dwordx4 v[98:101], v5, s[8:11], s25 offen offset:1536 sc1
buffer_store_dwordx2 v[102:103], v12, s[8:11], s25 offen offset:2560 sc1
s_add_u32 s56, s56, 1
v_and_b32 v1, 63, v0
v_lshrrev_b32 v2, 3, v1
s_lshl_b32 s21, s13, 3
v_add_u32 v2, s21, v2
v_and_b32 v3, 7, v1
v_mul_u32_u24 v4, 896, v2
v_lshl_add_u32 v4, v3, 4, v4
s_mul_i32 s21, s56, 28672
s_waitcnt lgkmcnt(0)
s_barrier
v_lshlrev_b32 v48, 16, v144
v_and_b32 v49, 0xffff0000, v144
v_lshlrev_b32 v50, 16, v145
v_and_b32 v51, 0xffff0000, v145
v_lshlrev_b32 v52, 16, v146
v_and_b32 v53, 0xffff0000, v146
v_lshlrev_b32 v54, 16, v147
v_and_b32 v55, 0xffff0000, v147
v_lshlrev_b32 v56, 16, v148
v_and_b32 v57, 0xffff0000, v148
v_lshlrev_b32 v58, 16, v149
v_and_b32 v59, 0xffff0000, v149
v_lshlrev_b32 v60, 16, v150
v_and_b32 v61, 0xffff0000, v150
v_lshlrev_b32 v62, 16, v151
v_and_b32 v63, 0xffff0000, v151
v_lshlrev_b32 v64, 16, v152
v_and_b32 v65, 0xffff0000, v152
v_lshlrev_b32 v66, 16, v153
v_and_b32 v67, 0xffff0000, v153
v_lshlrev_b32 v68, 16, v154
v_and_b32 v69, 0xffff0000, v154
v_lshlrev_b32 v70, 16, v155
v_and_b32 v71, 0xffff0000, v155
v_lshlrev_b32 v72, 16, v156
v_and_b32 v73, 0xffff0000, v156
v_lshlrev_b32 v74, 16, v157
v_and_b32 v75, 0xffff0000, v157
v_lshlrev_b32 v76, 16, v158
v_and_b32 v77, 0xffff0000, v158
v_lshlrev_b32 v78, 16, v159
v_and_b32 v79, 0xffff0000, v159
v_lshlrev_b32 v80, 16, v160
v_and_b32 v81, 0xffff0000, v160
v_lshlrev_b32 v82, 16, v161
v_and_b32 v83, 0xffff0000, v161
v_lshlrev_b32 v84, 16, v162
v_and_b32 v85, 0xffff0000, v162
v_lshlrev_b32 v86, 16, v163
v_and_b32 v87, 0xffff0000, v163
v_lshlrev_b32 v88, 16, v164
v_and_b32 v89, 0xffff0000, v164
v_lshlrev_b32 v90, 16, v165
v_and_b32 v91, 0xffff0000, v165
v_lshlrev_b32 v92, 16, v166
v_and_b32 v93, 0xffff0000, v166
v_lshlrev_b32 v94, 16, v167
v_and_b32 v95, 0xffff0000, v167
v_lshlrev_b32 v96, 16, v168
v_and_b32 v97, 0xffff0000, v168
v_lshlrev_b32 v98, 16, v169
v_and_b32 v99, 0xffff0000, v169
v_lshlrev_b32 v100, 16, v170
v_and_b32 v101, 0xffff0000, v170
v_lshlrev_b32 v102, 16, v171
v_and_b32 v103, 0xffff0000, v171
v_pk_add_f32 v[6:7], v[48:49], v[50:51]
v_pk_add_f32 v[6:7], v[6:7], v[52:53]
v_pk_add_f32 v[6:7], v[6:7], v[54:55]
v_pk_add_f32 v[6:7], v[6:7], v[56:57]
v_pk_add_f32 v[6:7], v[6:7], v[58:59]
v_pk_add_f32 v[6:7], v[6:7], v[60:61]
v_pk_add_f32 v[6:7], v[6:7], v[62:63]
v_pk_add_f32 v[6:7], v[6:7], v[64:65]
v_pk_add_f32 v[6:7], v[6:7], v[66:67]
v_pk_add_f32 v[6:7], v[6:7], v[68:69]
v_pk_add_f32 v[6:7], v[6:7], v[70:71]
v_pk_add_f32 v[6:7], v[6:7], v[72:73]
v_pk_add_f32 v[6:7], v[6:7], v[74:75]
v_pk_add_f32 v[6:7], v[6:7], v[76:77]
v_pk_add_f32 v[6:7], v[6:7], v[78:79]
v_pk_add_f32 v[6:7], v[6:7], v[80:81]
v_pk_add_f32 v[6:7], v[6:7], v[82:83]
v_pk_add_f32 v[6:7], v[6:7], v[84:85]
v_pk_add_f32 v[6:7], v[6:7], v[86:87]
v_pk_add_f32 v[6:7], v[6:7], v[88:89]
v_pk_add_f32 v[6:7], v[6:7], v[90:91]
v_pk_add_f32 v[6:7], v[6:7], v[92:93]
v_pk_add_f32 v[6:7], v[6:7], v[94:95]
v_pk_add_f32 v[6:7], v[6:7], v[96:97]
v_pk_add_f32 v[6:7], v[6:7], v[98:99]
v_pk_add_f32 v[6:7], v[6:7], v[100:101]
v_pk_add_f32 v[6:7], v[6:7], v[102:103]
v_add_f32 v6, v6, v7
s_nop 1
v_add_f32_dpp v6, v6, v6 quad_perm:[1,0,3,2] row_mask:0xf bank_mask:0xf
s_nop 1
v_add_f32_dpp v6, v6, v6 quad_perm:[2,3,0,1] row_mask:0xf bank_mask:0xf
s_nop 1
v_add_f32_dpp v6, v6, v6 row_half_mirror row_mask:0xf bank_mask:0xf
v_mul_f32 v6, 0x3b124925, v6
v_mov_b32 v7, v6
v_pk_add_f32 v[48:49], v[48:49], v[6:7] neg_lo:[0,1] neg_hi:[0,1]
v_pk_add_f32 v[50:51], v[50:51], v[6:7] neg_lo:[0,1] neg_hi:[0,1]
v_pk_add_f32 v[52:53], v[52:53], v[6:7] neg_lo:[0,1] neg_hi:[0,1]
v_pk_add_f32 v[54:55], v[54:55], v[6:7] neg_lo:[0,1] neg_hi:[0,1]
v_pk_add_f32 v[56:57], v[56:57], v[6:7] neg_lo:[0,1] neg_hi:[0,1]
v_pk_add_f32 v[58:59], v[58:59], v[6:7] neg_lo:[0,1] neg_hi:[0,1]
v_pk_add_f32 v[60:61], v[60:61], v[6:7] neg_lo:[0,1] neg_hi:[0,1]
v_pk_add_f32 v[62:63], v[62:63], v[6:7] neg_lo:[0,1] neg_hi:[0,1]
v_pk_add_f32 v[64:65], v[64:65], v[6:7] neg_lo:[0,1] neg_hi:[0,1]
v_pk_add_f32 v[66:67], v[66:67], v[6:7] neg_lo:[0,1] neg_hi:[0,1]
v_pk_add_f32 v[68:69], v[68:69], v[6:7] neg_lo:[0,1] neg_hi:[0,1]
v_pk_add_f32 v[70:71], v[70:71], v[6:7] neg_lo:[0,1] neg_hi:[0,1]
v_pk_add_f32 v[72:73], v[72:73], v[6:7] neg_lo:[0,1] neg_hi:[0,1]
v_pk_add_f32 v[74:75], v[74:75], v[6:7] neg_lo:[0,1] neg_hi:[0,1]
v_pk_add_f32 v[76:77], v[76:77], v[6:7] neg_lo:[0,1] neg_hi:[0,1]
v_pk_add_f32 v[78:79], v[78:79], v[6:7] neg_lo:[0,1] neg_hi:[0,1]
v_pk_add_f32 v[80:81], v[80:81], v[6:7] neg_lo:[0,1] neg_hi:[0,1]
v_pk_add_f32 v[82:83], v[82:83], v[6:7] neg_lo:[0,1] neg_hi:[0,1]
v_pk_add_f32 v[84:85], v[84:85], v[6:7] neg_lo:[0,1] neg_hi:[0,1]
v_pk_add_f32 v[86:87], v[86:87], v[6:7] neg_lo:[0,1] neg_hi:[0,1]
v_pk_add_f32 v[88:89], v[88:89], v[6:7] neg_lo:[0,1] neg_hi:[0,1]
v_pk_add_f32 v[90:91], v[90:91], v[6:7] neg_lo:[0,1] neg_hi:[0,1]
v_pk_add_f32 v[92:93], v[92:93], v[6:7] neg_lo:[0,1] neg_hi:[0,1]
v_pk_add_f32 v[94:95], v[94:95], v[6:7] neg_lo:[0,1] neg_hi:[0,1]
v_pk_add_f32 v[96:97], v[96:97], v[6:7] neg_lo:[0,1] neg_hi:[0,1]
v_pk_add_f32 v[98:99], v[98:99], v[6:7] neg_lo:[0,1] neg_hi:[0,1]
v_pk_add_f32 v[100:101], v[100:101], v[6:7] neg_lo:[0,1] neg_hi:[0,1]
v_pk_add_f32 v[102:103], v[102:103], v[6:7] neg_lo:[0,1] neg_hi:[0,1]
v_pk_mul_f32 v[8:9], v[48:49], v[48:49]
v_pk_fma_f32 v[8:9], v[50:51], v[50:51], v[8:9]
v_pk_fma_f32 v[8:9], v[52:53], v[52:53], v[8:9]
v_pk_fma_f32 v[8:9], v[54:55], v[54:55], v[8:9]
v_pk_fma_f32 v[8:9], v[56:57], v[56:57], v[8:9]
v_pk_fma_f32 v[8:9], v[58:59], v[58:59], v[8:9]
v_pk_fma_f32 v[8:9], v[60:61], v[60:61], v[8:9]
v_pk_fma_f32 v[8:9], v[62:63], v[62:63], v[8:9]
v_pk_fma_f32 v[8:9], v[64:65], v[64:65], v[8:9]
v_pk_fma_f32 v[8:9], v[66:67], v[66:67], v[8:9]
v_pk_fma_f32 v[8:9], v[68:69], v[68:69], v[8:9]
v_pk_fma_f32 v[8:9], v[70:71], v[70:71], v[8:9]
v_pk_fma_f32 v[8:9], v[72:73], v[72:73], v[8:9]
v_pk_fma_f32 v[8:9], v[74:75], v[74:75], v[8:9]
v_pk_fma_f32 v[8:9], v[76:77], v[76:77], v[8:9]
v_pk_fma_f32 v[8:9], v[78:79], v[78:79], v[8:9]
v_pk_fma_f32 v[8:9], v[80:81], v[80:81], v[8:9]
v_pk_fma_f32 v[8:9], v[82:83], v[82:83], v[8:9]
v_pk_fma_f32 v[8:9], v[84:85], v[84:85], v[8:9]
v_pk_fma_f32 v[8:9], v[86:87], v[86:87], v[8:9]
v_pk_fma_f32 v[8:9], v[88:89], v[88:89], v[8:9]
v_pk_fma_f32 v[8:9], v[90:91], v[90:91], v[8:9]
v_pk_fma_f32 v[8:9], v[92:93], v[92:93], v[8:9]
v_pk_fma_f32 v[8:9], v[94:95], v[94:95], v[8:9]
v_pk_fma_f32 v[8:9], v[96:97], v[96:97], v[8:9]
v_pk_fma_f32 v[8:9], v[98:99], v[98:99], v[8:9]
v_pk_fma_f32 v[8:9], v[100:101], v[100:101], v[8:9]
v_pk_fma_f32 v[8:9], v[102:103], v[102:103], v[8:9]
v_add_f32 v8, v8, v9
s_nop 1
v_add_f32_dpp v8, v8, v8 quad_perm:[1,0,3,2] row_mask:0xf bank_mask:0xf
s_nop 1
v_add_f32_dpp v8, v8, v8 quad_perm:[2,3,0,1] row_mask:0xf bank_mask:0xf
s_nop 1
v_add_f32_dpp v8, v8, v8 row_half_mirror row_mask:0xf bank_mask:0xf
v_mov_b32 v9, 0x3727c5ac
v_mov_b32 v10, 0x3b124925
v_fma_f32 v8, v8, v10, v9
v_rsq_f32 v8, v8
s_nop 0
v_mov_b32 v9, v8
v_pk_mul_f32 v[48:49], v[48:49], v[8:9]
v_cvt_pk_bf16_f32 v16, v48, v49
v_pk_mul_f32 v[50:51], v[50:51], v[8:9]
v_cvt_pk_bf16_f32 v17, v50, v51
v_pk_mul_f32 v[52:53], v[52:53], v[8:9]
v_cvt_pk_bf16_f32 v18, v52, v53
v_pk_mul_f32 v[54:55], v[54:55], v[8:9]
v_cvt_pk_bf16_f32 v19, v54, v55
v_pk_mul_f32 v[56:57], v[56:57], v[8:9]
v_cvt_pk_bf16_f32 v20, v56, v57
v_pk_mul_f32 v[58:59], v[58:59], v[8:9]
v_cvt_pk_bf16_f32 v21, v58, v59
v_pk_mul_f32 v[60:61], v[60:61], v[8:9]
v_cvt_pk_bf16_f32 v22, v60, v61
v_pk_mul_f32 v[62:63], v[62:63], v[8:9]
v_cvt_pk_bf16_f32 v23, v62, v63
v_pk_mul_f32 v[64:65], v[64:65], v[8:9]
v_cvt_pk_bf16_f32 v24, v64, v65
v_pk_mul_f32 v[66:67], v[66:67], v[8:9]
v_cvt_pk_bf16_f32 v25, v66, v67
v_pk_mul_f32 v[68:69], v[68:69], v[8:9]
v_cvt_pk_bf16_f32 v26, v68, v69
v_pk_mul_f32 v[70:71], v[70:71], v[8:9]
v_cvt_pk_bf16_f32 v27, v70, v71
v_pk_mul_f32 v[72:73], v[72:73], v[8:9]
v_cvt_pk_bf16_f32 v28, v72, v73
v_pk_mul_f32 v[74:75], v[74:75], v[8:9]
v_cvt_pk_bf16_f32 v29, v74, v75
v_pk_mul_f32 v[76:77], v[76:77], v[8:9]
v_cvt_pk_bf16_f32 v30, v76, v77
v_pk_mul_f32 v[78:79], v[78:79], v[8:9]
v_cvt_pk_bf16_f32 v31, v78, v79
v_pk_mul_f32 v[80:81], v[80:81], v[8:9]
v_cvt_pk_bf16_f32 v32, v80, v81
v_pk_mul_f32 v[82:83], v[82:83], v[8:9]
v_cvt_pk_bf16_f32 v33, v82, v83
v_pk_mul_f32 v[84:85], v[84:85], v[8:9]
v_cvt_pk_bf16_f32 v34, v84, v85
v_pk_mul_f32 v[86:87], v[86:87], v[8:9]
v_cvt_pk_bf16_f32 v35, v86, v87
v_pk_mul_f32 v[88:89], v[88:89], v[8:9]
v_cvt_pk_bf16_f32 v36, v88, v89
v_pk_mul_f32 v[90:91], v[90:91], v[8:9]
v_cvt_pk_bf16_f32 v37, v90, v91
v_pk_mul_f32 v[92:93], v[92:93], v[8:9]
v_cvt_pk_bf16_f32 v38, v92, v93
v_pk_mul_f32 v[94:95], v[94:95], v[8:9]
v_cvt_pk_bf16_f32 v39, v94, v95
v_pk_mul_f32 v[96:97], v[96:97], v[8:9]
v_cvt_pk_bf16_f32 v40, v96, v97
v_pk_mul_f32 v[98:99], v[98:99], v[8:9]
v_cvt_pk_bf16_f32 v41, v98, v99
v_pk_mul_f32 v[100:101], v[100:101], v[8:9]
v_cvt_pk_bf16_f32 v42, v100, v101
v_pk_mul_f32 v[102:103], v[102:103], v[8:9]
v_cvt_pk_bf16_f32 v43, v102, v103
v_mul_u32_u24 v4, 912, v2
v_lshl_add_u32 v4, v3, 4, v4
ds_write_b128 v4, v[16:19] offset:0
ds_write_b128 v4, v[20:23] offset:128
ds_write_b128 v4, v[24:27] offset:256
ds_write_b128 v4, v[28:31] offset:384
ds_write_b128 v4, v[32:35] offset:512
ds_write_b128 v4, v[36:39] offset:640
ds_write_b128 v4, v[40:43] offset:768
s_waitcnt lgkmcnt(0)
s_barrier
v_and_b32 v2, 15, v1
v_lshrrev_b32 v3, 4, v1
v_lshlrev_b32 v5, 4, v1
v_lshlrev_b32 v12, 3, v1
v_bfe_u32 v8, v2, 3, 1
v_lshlrev_b32 v4, 4, v8
v_bfe_u32 v8, v2, 1, 1
v_lshl_add_u32 v4, v8, 3, v4
v_bfe_u32 v8, v2, 2, 1
v_lshl_add_u32 v4, v8, 2, v4
v_and_b32 v8, 1, v2
v_add_u32 v4, v4, v8
s_lshr_b32 s21, s13, 1
s_lshl_b32 s22, s21, 1
v_add_u32 v13, s22, v4
v_mul_u32_u24 v13, 912, v13
v_lshrrev_b32 v8, 1, v3
v_lshl_add_u32 v13, v8, 5, v13
v_and_b32 v8, 1, v3
v_lshl_add_u32 v13, v8, 3, v13
s_and_b32 s22, s13, 1
s_mul_i32 s22, s22, 448
v_add_u32 v13, s22, v13
ds_read2_b32 v[16:17], v13 offset0:0 offset1:4
ds_read2_b32 v[18:19], v13 offset0:1 offset1:5
ds_read2_b32 v[20:21], v13 offset0:16 offset1:20
ds_read2_b32 v[22:23], v13 offset0:17 offset1:21
ds_read2_b32 v[24:25], v13 offset0:32 offset1:36
ds_read2_b32 v[26:27], v13 offset0:33 offset1:37
ds_read2_b32 v[28:29], v13 offset0:48 offset1:52
ds_read2_b32 v[30:31], v13 offset0:49 offset1:53
ds_read2_b32 v[32:33], v13 offset0:64 offset1:68
ds_read2_b32 v[34:35], v13 offset0:65 offset1:69
ds_read2_b32 v[36:37], v13 offset0:80 offset1:84
ds_read2_b32 v[38:39], v13 offset0:81 offset1:85
ds_read2_b32 v[40:41], v13 offset0:96 offset1:100
ds_read2_b32 v[42:43], v13 offset0:97 offset1:101
s_mul_i32 s22, s56, 28672
s_mul_i32 s23, s13, 7168
s_add_u32 s22, s22, s23
s_add_u32 s24, s22, 46428800
s_waitcnt lgkmcnt(0)
buffer_store_dwordx4 v[16:19], v5, s[8:11], s24 offen offset:0 sc1
buffer_store_dwordx4 v[20:23], v5, s[8:11], s24 offen offset:1024 sc1
buffer_store_dwordx4 v[24:27], v5, s[8:11], s24 offen offset:2048 sc1
buffer_store_dwordx4 v[28:31], v5, s[8:11], s24 offen offset:3072 sc1
s_add_u32 s24, s24, 4096
buffer_store_dwordx4 v[32:35], v5, s[8:11], s24 offen offset:0 sc1
buffer_store_dwordx4 v[36:39], v5, s[8:11], s24 offen offset:1024 sc1
buffer_store_dwordx4 v[40:43], v5, s[8:11], s24 offen offset:2048 sc1
v_add_u32 v13, 0, v2
v_mul_u32_u24 v13, 912, v13
v_lshl_add_u32 v13, v3, 3, v13
s_mul_i32 s23, s13, 224
v_add_u32 v13, s23, v13
ds_read2_b64 v[48:51], v13 offset0:0 offset1:4
ds_read2_b64 v[52:55], v13 offset0:8 offset1:12
ds_read2_b64 v[56:59], v13 offset0:16 offset1:20
ds_read_b64 v[60:61], v13 offset:192
v_add_u32 v13, 16, v2
v_mul_u32_u24 v13, 912, v13
v_lshl_add_u32 v13, v3, 3, v13
s_mul_i32 s23, s13, 224
v_add_u32 v13, s23, v13
ds_read2_b64 v[62:65], v13 offset0:0 offset1:4
ds_read2_b64 v[66:69], v13 offset0:8 offset1:12
ds_read2_b64 v[70:73], v13 offset0:16 offset1:20
ds_read_b64 v[74:75], v13 offset:192
s_waitcnt lgkmcnt(0)
s_add_u32 s24, s22, 42205184
s_add_u32 s25, s24, 4096
buffer_store_dwordx4 v[48:51], v5, s[8:11], s24 offen offset:0 sc1
buffer_store_dwordx4 v[52:55], v5, s[8:11], s24 offen offset:1024 sc1
buffer_store_dwordx4 v[56:59], v5, s[8:11], s24 offen offset:2048 sc1
buffer_store_dwordx2 v[60:61], v12, s[8:11], s24 offen offset:3072 sc1
buffer_store_dwordx4 v[62:65], v5, s[8:11], s24 offen offset:3584 sc1
buffer_store_dwordx4 v[66:69], v5, s[8:11], s25 offen offset:512 sc1
buffer_store_dwordx4 v[70:73], v5, s[8:11], s25 offen offset:1536 sc1
buffer_store_dwordx2 v[74:75], v12, s[8:11], s25 offen offset:2560 sc1
v_add_u32 v13, 0, v4
v_mul_u32_u24 v13, 912, v13
v_lshl_add_u32 v13, v3, 3, v13
s_mul_i32 s23, s13, 224
v_add_u32 v13, s23, v13
ds_read2_b64 v[76:79], v13 offset0:0 offset1:4
ds_read2_b64 v[80:83], v13 offset0:8 offset1:12
ds_read2_b64 v[84:87], v13 offset0:16 offset1:20
ds_read_b64 v[88:89], v13 offset:192
v_add_u32 v13, 2, v4
v_mul_u32_u24 v13, 912, v13
v_lshl_add_u32 v13, v3, 3, v13
s_mul_i32 s23, s13, 224
v_add_u32 v13, s23, v13
ds_read2_b64 v[90:93], v13 offset0:0 offset1:4
ds_read2_b64 v[94:97], v13 offset0:8 offset1:12
ds_read2_b64 v[98:101], v13 offset0:16 offset1:20
ds_read_b64 v[102:103], v13 offset:192
s_waitcnt lgkmcnt(0)
s_add_u32 s24, s22, 44593792
s_add_u32 s25, s24, 4096
buffer_store_dwordx4 v[76:79], v5, s[8:11], s24 offen offset:0 sc1
buffer_store_dwordx4 v[80:83], v5, s[8:11], s24 offen offset:1024 sc1
buffer_store_dwordx4 v[84:87], v5, s[8:11], s24 offen offset:2048 sc1
buffer_store_dwordx2 v[88:89], v12, s[8:11], s24 offen offset:3072 sc1
buffer_store_dwordx4 v[90:93], v5, s[8:11], s24 offen offset:3584 sc1
buffer_store_dwordx4 v[94:97], v5, s[8:11], s25 offen offset:512 sc1
buffer_store_dwordx4 v[98:101], v5, s[8:11], s25 offen offset:1536 sc1
buffer_store_dwordx2 v[102:103], v12, s[8:11], s25 offen offset:2560 sc1
s_waitcnt vmcnt(0)
s_barrier
s_cmp_lg_u32 s13, 0
s_cbranch_scc1 LN_ns_5
v_mov_b32 v14, 0
global_load_dword v15, v14, s[4:5] offset:16 sc1
s_waitcnt vmcnt(0)
WI_6:
v_cmp_gt_u32 vcc, 32, v15
s_cbranch_vccz WID_7
s_sleep 8
global_load_dword v15, v14, s[4:5] offset:16 sc1
s_waitcnt vmcnt(0)
s_sub_u32 s19, s19, 1
s_cbranch_scc0 WI_6
s_branch M_abort
WID_7:
v_mov_b32 v10, 0
v_mov_b32 v11, 2
s_mov_b32 s23, 44111616
s_mov_b64 exec, 1
buffer_atomic_add v11, v10, s[8:11], s23 offen sc1
s_mov_b64 exec, -1
LN_ns_5:
s_cmp_lg_u32 s13, 0
s_cbranch_scc1 WIW_8
v_mov_b32 v16, 0
global_load_dword v17, v16, s[4:5] offset:16 sc1
s_waitcnt vmcnt(0)
WI_9:
v_cmp_gt_u32 vcc, 32, v17
s_cbranch_vccz WID_10
s_sleep 8
global_load_dword v17, v16, s[4:5] offset:16 sc1
s_waitcnt vmcnt(0)
s_sub_u32 s19, s19, 1
s_cbranch_scc0 WI_9
s_branch M_abort
WID_10:
WIW_8:
s_barrier
s_cmp_lt_u32 s12, 30
s_cbranch_scc1 M_chain
s_branch M_helper
M_worker:
s_sub_u32 s12, s12, 32
s_mul_i32 s21, s12, 9363
s_lshr_b32 s21, s21, 16
s_mul_i32 s22, s21, 7
s_sub_u32 s22, s12, s22
s_and_b32 s20, s21, 1
s_lshr_b32 s21, s21, 1
v_and_b32 v1, 63, v0
v_and_b32 v2, 15, v1
v_lshrrev_b32 v3, 4, v1
v_lshlrev_b32 v7, 4, v1
v_lshrrev_b32 v6, 5, v1
v_and_b32 v4, 31, v1
v_xor_b32 v4, v4, v6
v_lshlrev_b32 v4, 4, v4
v_lshl_add_u32 v4, v6, 13, v4
v_xor_b32 v5, v3, v2
v_lshlrev_b32 v5, 4, v5
v_lshl_add_u32 v5, v2, 9, v5
s_cmp_eq_u32 s20, 1
s_cbranch_scc1 G_wb_11
s_load_dwordx2 s[36:37], s[0:1], 16
s_mov_b32 s38, 3670016
s_mov_b32 s39, 0x20000
s_load_dwordx2 s[40:41], s[0:1], 24
s_mov_b32 s42, 3670016
s_mov_b32 s43, 0x20000
s_mov_b32 s44, 0x3db8aa3b
s_mov_b32 s45, 0x3db8aa3b
s_mul_i32 s32, s13, 917504
s_lshl_b32 s23, s21, 9
s_add_u32 s32, s32, s23
s_mul_i32 s50, s13, 16384
s_add_u32 s50, s50, 32768
s_lshl_b32 s54, s21, 2
s_add_u32 s54, s54, s13
s_lshl_b32 s54, s54, 7
s_add_u32 s54, s54, 44118656
s_waitcnt lgkmcnt(0)
v_lshrrev_b32 v10, 2, v0
v_lshlrev_b32 v10, 13, v10
v_and_b32 v11, 3, v0
v_lshl_add_u32 v10, v11, 7, v10
s_lshl_b32 s23, s22, 19
s_lshl_b32 s24, s21, 9
s_add_u32 s23, s23, s24
buffer_load_dword v11, v10, s[40:43], s23 offen
s_lshr_b32 s23, s13, 1
s_lshl_b32 s23, s23, 5
s_and_b32 s24, s13, 1
s_lshl_b32 s24, s24, 1
s_add_u32 s23, s23, s24
s_lshl_b32 s28, s22, 6
s_add_u32 s28, s28, s23
s_lshl_b32 s28, s28, 13
s_lshl_b32 s23, s21, 9
s_add_u32 s28, s28, s23
v_xor_b32 v8, 0, v4
s_add_u32 s23, s28, 0
buffer_load_dwordx4 v[208:211], v8, s[36:39], s23 offen
v_xor_b32 v8, 32, v4
s_add_u32 s23, s28, 65536
buffer_load_dwordx4 v[212:215], v8, s[36:39], s23 offen
v_xor_b32 v8, 64, v4
s_add_u32 s23, s28, 32768
buffer_load_dwordx4 v[216:219], v8, s[36:39], s23 offen
v_xor_b32 v8, 96, v4
s_add_u32 s23, s28, 98304
buffer_load_dwordx4 v[220:223], v8, s[36:39], s23 offen
v_xor_b32 v8, 128, v4
s_add_u32 s23, s28, 131072
buffer_load_dwordx4 v[224:227], v8, s[36:39], s23 offen
v_xor_b32 v8, 160, v4
s_add_u32 s23, s28, 196608
buffer_load_dwordx4 v[228:231], v8, s[36:39], s23 offen
v_xor_b32 v8, 192, v4
s_add_u32 s23, s28, 163840
buffer_load_dwordx4 v[232:235], v8, s[36:39], s23 offen
v_xor_b32 v8, 224, v4
s_add_u32 s23, s28, 229376
buffer_load_dwordx4 v[236:239], v8, s[36:39], s23 offen
s_waitcnt vmcnt(0)
v_xor_b32 v8, 0, v4
s_add_u32 s23, s32, 0
buffer_load_dwordx4 a[128:131], v8, s[40:43], s23 offen
v_xor_b32 v8, 32, v4
s_add_u32 s23, s32, 16384
buffer_load_dwordx4 a[132:135], v8, s[40:43], s23 offen
v_xor_b32 v8, 64, v4
s_add_u32 s23, s32, 32768
buffer_load_dwordx4 a[136:139], v8, s[40:43], s23 offen
v_xor_b32 v8, 96, v4
s_add_u32 s23, s32, 49152
buffer_load_dwordx4 a[140:143], v8, s[40:43], s23 offen
v_xor_b32 v8, 128, v4
s_add_u32 s23, s32, 65536
buffer_load_dwordx4 a[144:147], v8, s[40:43], s23 offen
v_xor_b32 v8, 160, v4
s_add_u32 s23, s32, 81920
buffer_load_dwordx4 a[148:151], v8, s[40:43], s23 offen
v_xor_b32 v8, 192, v4
s_add_u32 s23, s32, 98304
buffer_load_dwordx4 a[152:155], v8, s[40:43], s23 offen
v_xor_b32 v8, 224, v4
s_add_u32 s23, s32, 114688
buffer_load_dwordx4 a[156:159], v8, s[40:43], s23 offen
v_xor_b32 v8, 0, v4
s_add_u32 s23, s32, 131072
buffer_load_dwordx4 a[160:163], v8, s[40:43], s23 offen
v_xor_b32 v8, 32, v4
s_add_u32 s23, s32, 147456
buffer_load_dwordx4 a[164:167], v8, s[40:43], s23 offen
v_xor_b32 v8, 64, v4
s_add_u32 s23, s32, 163840
buffer_load_dwordx4 a[168:171], v8, s[40:43], s23 offen
v_xor_b32 v8, 96, v4
s_add_u32 s23, s32, 180224
buffer_load_dwordx4 a[172:175], v8, s[40:43], s23 offen
v_xor_b32 v8, 128, v4
s_add_u32 s23, s32, 196608
buffer_load_dwordx4 a[176:179], v8, s[40:43], s23 offen
v_xor_b32 v8, 160, v4
s_add_u32 s23, s32, 212992
buffer_load_dwordx4 a[180:183], v8, s[40:43], s23 offen
v_xor_b32 v8, 192, v4
s_add_u32 s23, s32, 229376
buffer_load_dwordx4 a[184:187], v8, s[40:43], s23 offen
v_xor_b32 v8, 224, v4
s_add_u32 s23, s32, 245760
buffer_load_dwordx4 a[188:191], v8, s[40:43], s23 offen
s_lshl_b32 s52, s13, 13
v_add_u32 v8, s52, v7
ds_write_b128 v8, v[208:211] offset:0
ds_write_b128 v8, v[212:215] offset:1024
ds_write_b128 v8, v[216:219] offset:2048
ds_write_b128 v8, v[220:223] offset:3072
ds_write_b128 v8, v[224:227] offset:4096
ds_write_b128 v8, v[228:231] offset:5120
ds_write_b128 v8, v[232:235] offset:6144
ds_write_b128 v8, v[236:239] offset:7168
s_waitcnt lgkmcnt(0)
s_barrier
v_xor_b32 v8, 0, v5
ds_read_b128 a[0:3], v8 offset:0
ds_read_b128 a[4:7], v8 offset:8192
ds_read_b128 a[8:11], v8 offset:16384
ds_read_b128 a[12:15], v8 offset:24576
v_xor_b32 v8, 64, v5
ds_read_b128 a[16:19], v8 offset:0
ds_read_b128 a[20:23], v8 offset:8192
ds_read_b128 a[24:27], v8 offset:16384
ds_read_b128 a[28:31], v8 offset:24576
s_waitcnt lgkmcnt(0)
v_xor_b32 v8, 128, v5
ds_read_b128 a[32:35], v8 offset:0
ds_read_b128 a[36:39], v8 offset:8192
ds_read_b128 a[40:43], v8 offset:16384
ds_read_b128 a[44:47], v8 offset:24576
v_xor_b32 v8, 192, v5
ds_read_b128 a[48:51], v8 offset:0
ds_read_b128 a[52:55], v8 offset:8192
ds_read_b128 a[56:59], v8 offset:16384
ds_read_b128 a[60:63], v8 offset:24576
s_waitcnt lgkmcnt(0)
v_xor_b32 v8, 256, v5
ds_read_b128 a[64:67], v8 offset:0
ds_read_b128 a[68:71], v8 offset:8192
ds_read_b128 a[72:75], v8 offset:16384
ds_read_b128 a[76:79], v8 offset:24576
v_xor_b32 v8, 320, v5
ds_read_b128 a[80:83], v8 offset:0
ds_read_b128 a[84:87], v8 offset:8192
ds_read_b128 a[88:91], v8 offset:16384
ds_read_b128 a[92:95], v8 offset:24576
s_waitcnt lgkmcnt(0)
v_xor_b32 v8, 384, v5
ds_read_b128 a[96:99], v8 offset:0
ds_read_b128 a[100:103], v8 offset:8192
ds_read_b128 a[104:107], v8 offset:16384
ds_read_b128 a[108:111], v8 offset:24576
v_xor_b32 v8, 448, v5
ds_read_b128 a[112:115], v8 offset:0
ds_read_b128 a[116:119], v8 offset:8192
ds_read_b128 a[120:123], v8 offset:16384
ds_read_b128 a[124:127], v8 offset:24576
s_waitcnt lgkmcnt(0)
v_xor_b32 v8, 0, v4
s_add_u32 s23, s32, 262144
buffer_load_dwordx4 a[192:195], v8, s[40:43], s23 offen
v_xor_b32 v8, 32, v4
s_add_u32 s23, s32, 278528
buffer_load_dwordx4 a[196:199], v8, s[40:43], s23 offen
v_xor_b32 v8, 64, v4
s_add_u32 s23, s32, 294912
buffer_load_dwordx4 a[200:203], v8, s[40:43], s23 offen
v_xor_b32 v8, 96, v4
s_add_u32 s23, s32, 311296
buffer_load_dwordx4 a[204:207], v8, s[40:43], s23 offen
v_xor_b32 v8, 128, v4
s_add_u32 s23, s32, 327680
buffer_load_dwordx4 a[208:211], v8, s[40:43], s23 offen
v_xor_b32 v8, 160, v4
s_add_u32 s23, s32, 344064
buffer_load_dwordx4 a[212:215], v8, s[40:43], s23 offen
v_xor_b32 v8, 192, v4
s_add_u32 s23, s32, 360448
buffer_load_dwordx4 a[216:219], v8, s[40:43], s23 offen
v_xor_b32 v8, 224, v4
s_add_u32 s23, s32, 376832
buffer_load_dwordx4 a[220:223], v8, s[40:43], s23 offen
v_xor_b32 v8, 0, v4
s_add_u32 s23, s32, 393216
buffer_load_dwordx4 a[224:227], v8, s[40:43], s23 offen
v_xor_b32 v8, 32, v4
s_add_u32 s23, s32, 409600
buffer_load_dwordx4 a[228:231], v8, s[40:43], s23 offen
v_xor_b32 v8, 64, v4
s_add_u32 s23, s32, 425984
buffer_load_dwordx4 a[232:235], v8, s[40:43], s23 offen
v_xor_b32 v8, 96, v4
s_add_u32 s23, s32, 442368
buffer_load_dwordx4 a[236:239], v8, s[40:43], s23 offen
v_xor_b32 v8, 128, v4
s_add_u32 s23, s32, 458752
buffer_load_dwordx4 a[240:243], v8, s[40:43], s23 offen
v_xor_b32 v8, 160, v4
s_add_u32 s23, s32, 475136
buffer_load_dwordx4 a[244:247], v8, s[40:43], s23 offen
v_xor_b32 v8, 192, v4
s_add_u32 s23, s32, 491520
buffer_load_dwordx4 a[248:251], v8, s[40:43], s23 offen
v_xor_b32 v8, 224, v4
s_add_u32 s23, s32, 507904
buffer_load_dwordx4 a[252:255], v8, s[40:43], s23 offen
v_xor_b32 v8, 0, v4
s_add_u32 s23, s32, 524288
buffer_load_dwordx4 v[16:19], v8, s[40:43], s23 offen
v_xor_b32 v8, 32, v4
s_add_u32 s23, s32, 540672
buffer_load_dwordx4 v[20:23], v8, s[40:43], s23 offen
v_xor_b32 v8, 64, v4
s_add_u32 s23, s32, 557056
buffer_load_dwordx4 v[24:27], v8, s[40:43], s23 offen
v_xor_b32 v8, 96, v4
s_add_u32 s23, s32, 573440
buffer_load_dwordx4 v[28:31], v8, s[40:43], s23 offen
v_xor_b32 v8, 128, v4
s_add_u32 s23, s32, 589824
buffer_load_dwordx4 v[32:35], v8, s[40:43], s23 offen
v_xor_b32 v8, 160, v4
s_add_u32 s23, s32, 606208
buffer_load_dwordx4 v[36:39], v8, s[40:43], s23 offen
v_xor_b32 v8, 192, v4
s_add_u32 s23, s32, 622592
buffer_load_dwordx4 v[40:43], v8, s[40:43], s23 offen
v_xor_b32 v8, 224, v4
s_add_u32 s23, s32, 638976
buffer_load_dwordx4 v[44:47], v8, s[40:43], s23 offen
v_xor_b32 v8, 0, v4
s_add_u32 s23, s32, 655360
buffer_load_dwordx4 v[48:51], v8, s[40:43], s23 offen
v_xor_b32 v8, 32, v4
s_add_u32 s23, s32, 671744
buffer_load_dwordx4 v[52:55], v8, s[40:43], s23 offen
v_xor_b32 v8, 64, v4
s_add_u32 s23, s32, 688128
buffer_load_dwordx4 v[56:59], v8, s[40:43], s23 offen
v_xor_b32 v8, 96, v4
s_add_u32 s23, s32, 704512
buffer_load_dwordx4 v[60:63], v8, s[40:43], s23 offen
v_xor_b32 v8, 128, v4
s_add_u32 s23, s32, 720896
buffer_load_dwordx4 v[64:67], v8, s[40:43], s23 offen
v_xor_b32 v8, 160, v4
s_add_u32 s23, s32, 737280
buffer_load_dwordx4 v[68:71], v8, s[40:43], s23 offen
v_xor_b32 v8, 192, v4
s_add_u32 s23, s32, 753664
buffer_load_dwordx4 v[72:75], v8, s[40:43], s23 offen
v_xor_b32 v8, 224, v4
s_add_u32 s23, s32, 770048
buffer_load_dwordx4 v[76:79], v8, s[40:43], s23 offen
v_xor_b32 v8, 0, v4
s_add_u32 s23, s32, 786432
buffer_load_dwordx4 v[80:83], v8, s[40:43], s23 offen
v_xor_b32 v8, 32, v4
s_add_u32 s23, s32, 802816
buffer_load_dwordx4 v[84:87], v8, s[40:43], s23 offen
v_xor_b32 v8, 64, v4
s_add_u32 s23, s32, 819200
buffer_load_dwordx4 v[88:91], v8, s[40:43], s23 offen
v_xor_b32 v8, 96, v4
s_add_u32 s23, s32, 835584
buffer_load_dwordx4 v[92:95], v8, s[40:43], s23 offen
v_xor_b32 v8, 128, v4
s_add_u32 s23, s32, 851968
buffer_load_dwordx4 v[96:99], v8, s[40:43], s23 offen
v_xor_b32 v8, 160, v4
s_add_u32 s23, s32, 868352
buffer_load_dwordx4 v[100:103], v8, s[40:43], s23 offen
v_xor_b32 v8, 192, v4
s_add_u32 s23, s32, 884736
buffer_load_dwordx4 v[104:107], v8, s[40:43], s23 offen
v_xor_b32 v8, 224, v4
s_add_u32 s23, s32, 901120
buffer_load_dwordx4 v[108:111], v8, s[40:43], s23 offen
v_add_u32 v9, s50, v5
v_add_u32 v14, s50, v7
v_mov_b32 v10, 0
v_mov_b32 v11, 1
s_waitcnt vmcnt(48)
ds_write_b128 v14, a[128:131] offset:0
ds_write_b128 v14, a[132:135] offset:1024
ds_write_b128 v14, a[136:139] offset:2048
ds_write_b128 v14, a[140:143] offset:3072
ds_write_b128 v14, a[144:147] offset:4096
ds_write_b128 v14, a[148:151] offset:5120
ds_write_b128 v14, a[152:155] offset:6144
ds_write_b128 v14, a[156:159] offset:7168
v_xor_b32 v8, 0, v9
ds_read_b128 v[144:147], v8 offset:0
v_xor_b32 v8, 64, v9
ds_read_b128 v[148:151], v8 offset:0
v_xor_b32 v8, 128, v9
ds_read_b128 v[152:155], v8 offset:0
v_xor_b32 v8, 192, v9
ds_read_b128 v[156:159], v8 offset:0
v_xor_b32 v8, 256, v9
ds_read_b128 v[160:163], v8 offset:0
v_xor_b32 v8, 320, v9
ds_read_b128 v[164:167], v8 offset:0
v_xor_b32 v8, 384, v9
ds_read_b128 v[168:171], v8 offset:0
v_xor_b32 v8, 448, v9
ds_read_b128 v[172:175], v8 offset:0
s_waitcnt vmcnt(40)
s_waitcnt lgkmcnt(0)
v_mfma_f32_16x16x32_bf16 v[112:115], a[0:3], v[144:147], 0
ds_write_b128 v14, a[160:163] offset:8192
v_mfma_f32_16x16x32_bf16 v[116:119], a[4:7], v[144:147], 0
v_mfma_f32_16x16x32_bf16 v[120:123], a[8:11], v[144:147], 0
ds_write_b128 v14, a[164:167] offset:9216
v_mfma_f32_16x16x32_bf16 v[124:127], a[12:15], v[144:147], 0
v_mfma_f32_16x16x32_bf16 v[112:115], a[16:19], v[148:151], v[112:115]
ds_write_b128 v14, a[168:171] offset:10240
v_mfma_f32_16x16x32_bf16 v[116:119], a[20:23], v[148:151], v[116:119]
v_mfma_f32_16x16x32_bf16 v[120:123], a[24:27], v[148:151], v[120:123]
ds_write_b128 v14, a[172:175] offset:11264
v_mfma_f32_16x16x32_bf16 v[124:127], a[28:31], v[148:151], v[124:127]
v_mfma_f32_16x16x32_bf16 v[112:115], a[32:35], v[152:155], v[112:115]
ds_write_b128 v14, a[176:179] offset:12288
v_mfma_f32_16x16x32_bf16 v[116:119], a[36:39], v[152:155], v[116:119]
v_mfma_f32_16x16x32_bf16 v[120:123], a[40:43], v[152:155], v[120:123]
ds_write_b128 v14, a[180:183] offset:13312
v_mfma_f32_16x16x32_bf16 v[124:127], a[44:47], v[152:155], v[124:127]
v_mfma_f32_16x16x32_bf16 v[112:115], a[48:51], v[156:159], v[112:115]
ds_write_b128 v14, a[184:187] offset:14336
v_mfma_f32_16x16x32_bf16 v[116:119], a[52:55], v[156:159], v[116:119]
v_mfma_f32_16x16x32_bf16 v[120:123], a[56:59], v[156:159], v[120:123]
ds_write_b128 v14, a[188:191] offset:15360
v_mfma_f32_16x16x32_bf16 v[124:127], a[60:63], v[156:159], v[124:127]
v_mfma_f32_16x16x32_bf16 v[112:115], a[64:67], v[160:163], v[112:115]
v_xor_b32 v8, 0, v9
ds_read_b128 v[176:179], v8 offset:8192
v_mfma_f32_16x16x32_bf16 v[116:119], a[68:71], v[160:163], v[116:119]
v_mfma_f32_16x16x32_bf16 v[120:123], a[72:75], v[160:163], v[120:123]
v_xor_b32 v8, 64, v9
ds_read_b128 v[180:183], v8 offset:8192
v_mfma_f32_16x16x32_bf16 v[124:127], a[76:79], v[160:163], v[124:127]
v_mfma_f32_16x16x32_bf16 v[112:115], a[80:83], v[164:167], v[112:115]
v_xor_b32 v8, 128, v9
ds_read_b128 v[184:187], v8 offset:8192
v_mfma_f32_16x16x32_bf16 v[116:119], a[84:87], v[164:167], v[116:119]
v_mfma_f32_16x16x32_bf16 v[120:123], a[88:91], v[164:167], v[120:123]
v_xor_b32 v8, 192, v9
ds_read_b128 v[188:191], v8 offset:8192
v_mfma_f32_16x16x32_bf16 v[124:127], a[92:95], v[164:167], v[124:127]
v_mfma_f32_16x16x32_bf16 v[112:115], a[96:99], v[168:171], v[112:115]
v_xor_b32 v8, 256, v9
ds_read_b128 v[192:195], v8 offset:8192
v_mfma_f32_16x16x32_bf16 v[116:119], a[100:103], v[168:171], v[116:119]
v_mfma_f32_16x16x32_bf16 v[120:123], a[104:107], v[168:171], v[120:123]
v_xor_b32 v8, 320, v9
ds_read_b128 v[196:199], v8 offset:8192
v_mfma_f32_16x16x32_bf16 v[124:127], a[108:111], v[168:171], v[124:127]
v_mfma_f32_16x16x32_bf16 v[112:115], a[112:115], v[172:175], v[112:115]
v_xor_b32 v8, 384, v9
ds_read_b128 v[200:203], v8 offset:8192
v_mfma_f32_16x16x32_bf16 v[116:119], a[116:119], v[172:175], v[116:119]
v_mfma_f32_16x16x32_bf16 v[120:123], a[120:123], v[172:175], v[120:123]
v_xor_b32 v8, 448, v9
ds_read_b128 v[204:207], v8 offset:8192
v_mfma_f32_16x16x32_bf16 v[124:127], a[124:127], v[172:175], v[124:127]
v_mov_b32 v12, 0
global_load_dword v13, v12, s[4:5] offset:16 sc1
s_waitcnt vmcnt(33)
s_waitcnt lgkmcnt(0)
v_mfma_f32_16x16x32_bf16 v[128:131], a[0:3], v[176:179], 0
ds_write_b128 v14, a[192:195] offset:0
v_mfma_f32_16x16x32_bf16 v[132:135], a[4:7], v[176:179], 0
v_mfma_f32_16x16x32_bf16 v[136:139], a[8:11], v[176:179], 0
ds_write_b128 v14, a[196:199] offset:1024
v_mfma_f32_16x16x32_bf16 v[140:143], a[12:15], v[176:179], 0
v_pk_mul_f32 v[112:113], v[112:113], s[44:45]
v_mfma_f32_16x16x32_bf16 v[128:131], a[16:19], v[180:183], v[128:131]
ds_write_b128 v14, a[200:203] offset:2048
v_mfma_f32_16x16x32_bf16 v[132:135], a[20:23], v[180:183], v[132:135]
v_pk_mul_f32 v[114:115], v[114:115], s[44:45]
v_mfma_f32_16x16x32_bf16 v[136:139], a[24:27], v[180:183], v[136:139]
ds_write_b128 v14, a[204:207] offset:3072
v_mfma_f32_16x16x32_bf16 v[140:143], a[28:31], v[180:183], v[140:143]
v_pk_mul_f32 v[116:117], v[116:117], s[44:45]
v_mfma_f32_16x16x32_bf16 v[128:131], a[32:35], v[184:187], v[128:131]
ds_write_b128 v14, a[208:211] offset:4096
v_mfma_f32_16x16x32_bf16 v[132:135], a[36:39], v[184:187], v[132:135]
v_pk_mul_f32 v[118:119], v[118:119], s[44:45]
v_mfma_f32_16x16x32_bf16 v[136:139], a[40:43], v[184:187], v[136:139]
ds_write_b128 v14, a[212:215] offset:5120
v_mfma_f32_16x16x32_bf16 v[140:143], a[44:47], v[184:187], v[140:143]
v_pk_mul_f32 v[120:121], v[120:121], s[44:45]
v_mfma_f32_16x16x32_bf16 v[128:131], a[48:51], v[188:191], v[128:131]
ds_write_b128 v14, a[216:219] offset:6144
v_mfma_f32_16x16x32_bf16 v[132:135], a[52:55], v[188:191], v[132:135]
v_pk_mul_f32 v[122:123], v[122:123], s[44:45]
v_mfma_f32_16x16x32_bf16 v[136:139], a[56:59], v[188:191], v[136:139]
ds_write_b128 v14, a[220:223] offset:7168
v_mfma_f32_16x16x32_bf16 v[140:143], a[60:63], v[188:191], v[140:143]
v_pk_mul_f32 v[124:125], v[124:125], s[44:45]
v_mfma_f32_16x16x32_bf16 v[128:131], a[64:67], v[192:195], v[128:131]
v_xor_b32 v8, 0, v9
ds_read_b128 v[144:147], v8 offset:0
v_mfma_f32_16x16x32_bf16 v[132:135], a[68:71], v[192:195], v[132:135]
v_pk_mul_f32 v[126:127], v[126:127], s[44:45]
v_mfma_f32_16x16x32_bf16 v[136:139], a[72:75], v[192:195], v[136:139]
v_xor_b32 v8, 64, v9
ds_read_b128 v[148:151], v8 offset:0
v_mfma_f32_16x16x32_bf16 v[140:143], a[76:79], v[192:195], v[140:143]
v_cvt_pk_bf16_f32 v112, v112, v113
v_mfma_f32_16x16x32_bf16 v[128:131], a[80:83], v[196:199], v[128:131]
v_xor_b32 v8, 128, v9
ds_read_b128 v[152:155], v8 offset:0
v_mfma_f32_16x16x32_bf16 v[132:135], a[84:87], v[196:199], v[132:135]
v_cvt_pk_bf16_f32 v113, v114, v115
v_mfma_f32_16x16x32_bf16 v[136:139], a[88:91], v[196:199], v[136:139]
v_xor_b32 v8, 192, v9
ds_read_b128 v[156:159], v8 offset:0
v_mfma_f32_16x16x32_bf16 v[140:143], a[92:95], v[196:199], v[140:143]
v_cvt_pk_bf16_f32 v114, v116, v117
v_mfma_f32_16x16x32_bf16 v[128:131], a[96:99], v[200:203], v[128:131]
v_xor_b32 v8, 256, v9
ds_read_b128 v[160:163], v8 offset:0
v_mfma_f32_16x16x32_bf16 v[132:135], a[100:103], v[200:203], v[132:135]
v_cvt_pk_bf16_f32 v115, v118, v119
v_mfma_f32_16x16x32_bf16 v[136:139], a[104:107], v[200:203], v[136:139]
v_xor_b32 v8, 320, v9
ds_read_b128 v[164:167], v8 offset:0
v_mfma_f32_16x16x32_bf16 v[140:143], a[108:111], v[200:203], v[140:143]
v_cvt_pk_bf16_f32 v116, v120, v121
v_mfma_f32_16x16x32_bf16 v[128:131], a[112:115], v[204:207], v[128:131]
v_xor_b32 v8, 384, v9
ds_read_b128 v[168:171], v8 offset:0
v_mfma_f32_16x16x32_bf16 v[132:135], a[116:119], v[204:207], v[132:135]
v_cvt_pk_bf16_f32 v117, v122, v123
v_mfma_f32_16x16x32_bf16 v[136:139], a[120:123], v[204:207], v[136:139]
v_xor_b32 v8, 448, v9
ds_read_b128 v[172:175], v8 offset:0
v_mfma_f32_16x16x32_bf16 v[140:143], a[124:127], v[204:207], v[140:143]
v_cvt_pk_bf16_f32 v118, v124, v125
v_cvt_pk_bf16_f32 v119, v126, v127
s_mul_i32 s49, s21, 401408
s_mul_i32 s24, s13, 100352
s_add_u32 s49, s49, s24
s_add_u32 s24, s22, 0
s_lshl_b32 s24, s24, 11
s_add_u32 s49, s49, s24
buffer_store_dwordx4 v[112:115], v7, s[8:11], s49 offen offset:0 sc1
buffer_store_dwordx4 v[116:119], v7, s[8:11], s49 offen offset:1024 sc1
s_waitcnt vmcnt(2)
WI_12:
v_cmp_gt_u32 vcc, 32, v13
s_cbranch_vccz WID_13
s_sleep 8
global_load_dword v13, v12, s[4:5] offset:16 sc1
s_waitcnt vmcnt(0)
s_sub_u32 s19, s19, 1
s_cbranch_scc0 WI_12
s_branch M_abort
WID_13:
s_waitcnt vmcnt(27)
s_waitcnt lgkmcnt(0)
v_mfma_f32_16x16x32_bf16 v[112:115], a[0:3], v[144:147], 0
ds_write_b128 v14, a[224:227] offset:8192
v_mfma_f32_16x16x32_bf16 v[116:119], a[4:7], v[144:147], 0
v_mfma_f32_16x16x32_bf16 v[120:123], a[8:11], v[144:147], 0
ds_write_b128 v14, a[228:231] offset:9216
v_mfma_f32_16x16x32_bf16 v[124:127], a[12:15], v[144:147], 0
v_pk_mul_f32 v[128:129], v[128:129], s[44:45]
v_mfma_f32_16x16x32_bf16 v[112:115], a[16:19], v[148:151], v[112:115]
ds_write_b128 v14, a[232:235] offset:10240
v_mfma_f32_16x16x32_bf16 v[116:119], a[20:23], v[148:151], v[116:119]
v_pk_mul_f32 v[130:131], v[130:131], s[44:45]
v_mfma_f32_16x16x32_bf16 v[120:123], a[24:27], v[148:151], v[120:123]
ds_write_b128 v14, a[236:239] offset:11264
v_mfma_f32_16x16x32_bf16 v[124:127], a[28:31], v[148:151], v[124:127]
v_pk_mul_f32 v[132:133], v[132:133], s[44:45]
v_mfma_f32_16x16x32_bf16 v[112:115], a[32:35], v[152:155], v[112:115]
ds_write_b128 v14, a[240:243] offset:12288
v_mfma_f32_16x16x32_bf16 v[116:119], a[36:39], v[152:155], v[116:119]
v_pk_mul_f32 v[134:135], v[134:135], s[44:45]
v_mfma_f32_16x16x32_bf16 v[120:123], a[40:43], v[152:155], v[120:123]
ds_write_b128 v14, a[244:247] offset:13312
v_mfma_f32_16x16x32_bf16 v[124:127], a[44:47], v[152:155], v[124:127]
v_pk_mul_f32 v[136:137], v[136:137], s[44:45]
v_mfma_f32_16x16x32_bf16 v[112:115], a[48:51], v[156:159], v[112:115]
ds_write_b128 v14, a[248:251] offset:14336
v_mfma_f32_16x16x32_bf16 v[116:119], a[52:55], v[156:159], v[116:119]
v_pk_mul_f32 v[138:139], v[138:139], s[44:45]
v_mfma_f32_16x16x32_bf16 v[120:123], a[56:59], v[156:159], v[120:123]
ds_write_b128 v14, a[252:255] offset:15360
v_mfma_f32_16x16x32_bf16 v[124:127], a[60:63], v[156:159], v[124:127]
v_pk_mul_f32 v[140:141], v[140:141], s[44:45]
v_mfma_f32_16x16x32_bf16 v[112:115], a[64:67], v[160:163], v[112:115]
v_xor_b32 v8, 0, v9
ds_read_b128 v[176:179], v8 offset:8192
v_mfma_f32_16x16x32_bf16 v[116:119], a[68:71], v[160:163], v[116:119]
v_pk_mul_f32 v[142:143], v[142:143], s[44:45]
v_mfma_f32_16x16x32_bf16 v[120:123], a[72:75], v[160:163], v[120:123]
v_xor_b32 v8, 64, v9
ds_read_b128 v[180:183], v8 offset:8192
v_mfma_f32_16x16x32_bf16 v[124:127], a[76:79], v[160:163], v[124:127]
v_cvt_pk_bf16_f32 v128, v128, v129
v_mfma_f32_16x16x32_bf16 v[112:115], a[80:83], v[164:167], v[112:115]
v_xor_b32 v8, 128, v9
ds_read_b128 v[184:187], v8 offset:8192
v_mfma_f32_16x16x32_bf16 v[116:119], a[84:87], v[164:167], v[116:119]
v_cvt_pk_bf16_f32 v129, v130, v131
v_mfma_f32_16x16x32_bf16 v[120:123], a[88:91], v[164:167], v[120:123]
v_xor_b32 v8, 192, v9
ds_read_b128 v[188:191], v8 offset:8192
v_mfma_f32_16x16x32_bf16 v[124:127], a[92:95], v[164:167], v[124:127]
v_cvt_pk_bf16_f32 v130, v132, v133
v_mfma_f32_16x16x32_bf16 v[112:115], a[96:99], v[168:171], v[112:115]
v_xor_b32 v8, 256, v9
ds_read_b128 v[192:195], v8 offset:8192
v_mfma_f32_16x16x32_bf16 v[116:119], a[100:103], v[168:171], v[116:119]
v_cvt_pk_bf16_f32 v131, v134, v135
v_mfma_f32_16x16x32_bf16 v[120:123], a[104:107], v[168:171], v[120:123]
v_xor_b32 v8, 320, v9
ds_read_b128 v[196:199], v8 offset:8192
v_mfma_f32_16x16x32_bf16 v[124:127], a[108:111], v[168:171], v[124:127]
v_cvt_pk_bf16_f32 v132, v136, v137
v_mfma_f32_16x16x32_bf16 v[112:115], a[112:115], v[172:175], v[112:115]
v_xor_b32 v8, 384, v9
ds_read_b128 v[200:203], v8 offset:8192
v_mfma_f32_16x16x32_bf16 v[116:119], a[116:119], v[172:175], v[116:119]
v_cvt_pk_bf16_f32 v133, v138, v139
v_mfma_f32_16x16x32_bf16 v[120:123], a[120:123], v[172:175], v[120:123]
v_xor_b32 v8, 448, v9
ds_read_b128 v[204:207], v8 offset:8192
v_mfma_f32_16x16x32_bf16 v[124:127], a[124:127], v[172:175], v[124:127]
v_cvt_pk_bf16_f32 v134, v140, v141
v_cvt_pk_bf16_f32 v135, v142, v143
s_mul_i32 s49, s21, 401408
s_mul_i32 s24, s13, 100352
s_add_u32 s49, s49, s24
s_add_u32 s24, s22, 7
s_lshl_b32 s24, s24, 11
s_add_u32 s49, s49, s24
buffer_store_dwordx4 v[128:131], v7, s[8:11], s49 offen offset:0 sc1
buffer_store_dwordx4 v[132:135], v7, s[8:11], s49 offen offset:1024 sc1
s_waitcnt vmcnt(2)
s_mov_b64 exec, 1
buffer_atomic_add v11, v10, s[8:11], s54 offen offset:0 sc1
s_mov_b64 exec, -1
s_waitcnt vmcnt(22)
s_waitcnt lgkmcnt(0)
v_mfma_f32_16x16x32_bf16 v[128:131], a[0:3], v[176:179], 0
ds_write_b128 v14, v[16:19] offset:0
v_mfma_f32_16x16x32_bf16 v[132:135], a[4:7], v[176:179], 0
v_mfma_f32_16x16x32_bf16 v[136:139], a[8:11], v[176:179], 0
ds_write_b128 v14, v[20:23] offset:1024
v_mfma_f32_16x16x32_bf16 v[140:143], a[12:15], v[176:179], 0
v_pk_mul_f32 v[112:113], v[112:113], s[44:45]
v_mfma_f32_16x16x32_bf16 v[128:131], a[16:19], v[180:183], v[128:131]
ds_write_b128 v14, v[24:27] offset:2048
v_mfma_f32_16x16x32_bf16 v[132:135], a[20:23], v[180:183], v[132:135]
v_pk_mul_f32 v[114:115], v[114:115], s[44:45]
v_mfma_f32_16x16x32_bf16 v[136:139], a[24:27], v[180:183], v[136:139]
ds_write_b128 v14, v[28:31] offset:3072
v_mfma_f32_16x16x32_bf16 v[140:143], a[28:31], v[180:183], v[140:143]
v_pk_mul_f32 v[116:117], v[116:117], s[44:45]
v_mfma_f32_16x16x32_bf16 v[128:131], a[32:35], v[184:187], v[128:131]
ds_write_b128 v14, v[32:35] offset:4096
v_mfma_f32_16x16x32_bf16 v[132:135], a[36:39], v[184:187], v[132:135]
v_pk_mul_f32 v[118:119], v[118:119], s[44:45]
v_mfma_f32_16x16x32_bf16 v[136:139], a[40:43], v[184:187], v[136:139]
ds_write_b128 v14, v[36:39] offset:5120
v_mfma_f32_16x16x32_bf16 v[140:143], a[44:47], v[184:187], v[140:143]
v_pk_mul_f32 v[120:121], v[120:121], s[44:45]
v_mfma_f32_16x16x32_bf16 v[128:131], a[48:51], v[188:191], v[128:131]
ds_write_b128 v14, v[40:43] offset:6144
v_mfma_f32_16x16x32_bf16 v[132:135], a[52:55], v[188:191], v[132:135]
v_pk_mul_f32 v[122:123], v[122:123], s[44:45]
v_mfma_f32_16x16x32_bf16 v[136:139], a[56:59], v[188:191], v[136:139]
ds_write_b128 v14, v[44:47] offset:7168
v_mfma_f32_16x16x32_bf16 v[140:143], a[60:63], v[188:191], v[140:143]
v_pk_mul_f32 v[124:125], v[124:125], s[44:45]
v_mfma_f32_16x16x32_bf16 v[128:131], a[64:67], v[192:195], v[128:131]
v_xor_b32 v8, 0, v9
ds_read_b128 v[144:147], v8 offset:0
v_mfma_f32_16x16x32_bf16 v[132:135], a[68:71], v[192:195], v[132:135]
v_pk_mul_f32 v[126:127], v[126:127], s[44:45]
v_mfma_f32_16x16x32_bf16 v[136:139], a[72:75], v[192:195], v[136:139]
v_xor_b32 v8, 64, v9
ds_read_b128 v[148:151], v8 offset:0
v_mfma_f32_16x16x32_bf16 v[140:143], a[76:79], v[192:195], v[140:143]
v_cvt_pk_bf16_f32 v112, v112, v113
v_mfma_f32_16x16x32_bf16 v[128:131], a[80:83], v[196:199], v[128:131]
v_xor_b32 v8, 128, v9
ds_read_b128 v[152:155], v8 offset:0
v_mfma_f32_16x16x32_bf16 v[132:135], a[84:87], v[196:199], v[132:135]
v_cvt_pk_bf16_f32 v113, v114, v115
v_mfma_f32_16x16x32_bf16 v[136:139], a[88:91], v[196:199], v[136:139]
v_xor_b32 v8, 192, v9
ds_read_b128 v[156:159], v8 offset:0
v_mfma_f32_16x16x32_bf16 v[140:143], a[92:95], v[196:199], v[140:143]
v_cvt_pk_bf16_f32 v114, v116, v117
v_mfma_f32_16x16x32_bf16 v[128:131], a[96:99], v[200:203], v[128:131]
v_xor_b32 v8, 256, v9
ds_read_b128 v[160:163], v8 offset:0
v_mfma_f32_16x16x32_bf16 v[132:135], a[100:103], v[200:203], v[132:135]
v_cvt_pk_bf16_f32 v115, v118, v119
v_mfma_f32_16x16x32_bf16 v[136:139], a[104:107], v[200:203], v[136:139]
v_xor_b32 v8, 320, v9
ds_read_b128 v[164:167], v8 offset:0
v_mfma_f32_16x16x32_bf16 v[140:143], a[108:111], v[200:203], v[140:143]
v_cvt_pk_bf16_f32 v116, v120, v121
v_mfma_f32_16x16x32_bf16 v[128:131], a[112:115], v[204:207], v[128:131]
v_xor_b32 v8, 384, v9
ds_read_b128 v[168:171], v8 offset:0
v_mfma_f32_16x16x32_bf16 v[132:135], a[116:119], v[204:207], v[132:135]
v_cvt_pk_bf16_f32 v117, v122, v123
v_mfma_f32_16x16x32_bf16 v[136:139], a[120:123], v[204:207], v[136:139]
v_xor_b32 v8, 448, v9
ds_read_b128 v[172:175], v8 offset:0
v_mfma_f32_16x16x32_bf16 v[140:143], a[124:127], v[204:207], v[140:143]
v_cvt_pk_bf16_f32 v118, v124, v125
v_cvt_pk_bf16_f32 v119, v126, v127
s_mul_i32 s49, s21, 401408
s_mul_i32 s24, s13, 100352
s_add_u32 s49, s49, s24
s_add_u32 s24, s22, 14
s_lshl_b32 s24, s24, 11
s_add_u32 s49, s49, s24
buffer_store_dwordx4 v[112:115], v7, s[8:11], s49 offen offset:0 sc1
buffer_store_dwordx4 v[116:119], v7, s[8:11], s49 offen offset:1024 sc1
s_waitcnt vmcnt(3)
s_mov_b64 exec, 1
buffer_atomic_add v11, v10, s[8:11], s54 offen offset:4 sc1
s_mov_b64 exec, -1
s_waitcnt vmcnt(17)
s_waitcnt lgkmcnt(0)
v_mfma_f32_16x16x32_bf16 v[112:115], a[0:3], v[144:147], 0
ds_write_b128 v14, v[48:51] offset:8192
v_mfma_f32_16x16x32_bf16 v[116:119], a[4:7], v[144:147], 0
v_mfma_f32_16x16x32_bf16 v[120:123], a[8:11], v[144:147], 0
ds_write_b128 v14, v[52:55] offset:9216
v_mfma_f32_16x16x32_bf16 v[124:127], a[12:15], v[144:147], 0
v_pk_mul_f32 v[128:129], v[128:129], s[44:45]
v_mfma_f32_16x16x32_bf16 v[112:115], a[16:19], v[148:151], v[112:115]
ds_write_b128 v14, v[56:59] offset:10240
v_mfma_f32_16x16x32_bf16 v[116:119], a[20:23], v[148:151], v[116:119]
v_pk_mul_f32 v[130:131], v[130:131], s[44:45]
v_mfma_f32_16x16x32_bf16 v[120:123], a[24:27], v[148:151], v[120:123]
ds_write_b128 v14, v[60:63] offset:11264
v_mfma_f32_16x16x32_bf16 v[124:127], a[28:31], v[148:151], v[124:127]
v_pk_mul_f32 v[132:133], v[132:133], s[44:45]
v_mfma_f32_16x16x32_bf16 v[112:115], a[32:35], v[152:155], v[112:115]
ds_write_b128 v14, v[64:67] offset:12288
v_mfma_f32_16x16x32_bf16 v[116:119], a[36:39], v[152:155], v[116:119]
v_pk_mul_f32 v[134:135], v[134:135], s[44:45]
v_mfma_f32_16x16x32_bf16 v[120:123], a[40:43], v[152:155], v[120:123]
ds_write_b128 v14, v[68:71] offset:13312
v_mfma_f32_16x16x32_bf16 v[124:127], a[44:47], v[152:155], v[124:127]
v_pk_mul_f32 v[136:137], v[136:137], s[44:45]
v_mfma_f32_16x16x32_bf16 v[112:115], a[48:51], v[156:159], v[112:115]
ds_write_b128 v14, v[72:75] offset:14336
v_mfma_f32_16x16x32_bf16 v[116:119], a[52:55], v[156:159], v[116:119]
v_pk_mul_f32 v[138:139], v[138:139], s[44:45]
v_mfma_f32_16x16x32_bf16 v[120:123], a[56:59], v[156:159], v[120:123]
ds_write_b128 v14, v[76:79] offset:15360
v_mfma_f32_16x16x32_bf16 v[124:127], a[60:63], v[156:159], v[124:127]
v_pk_mul_f32 v[140:141], v[140:141], s[44:45]
v_mfma_f32_16x16x32_bf16 v[112:115], a[64:67], v[160:163], v[112:115]
v_xor_b32 v8, 0, v9
ds_read_b128 v[176:179], v8 offset:8192
v_mfma_f32_16x16x32_bf16 v[116:119], a[68:71], v[160:163], v[116:119]
v_pk_mul_f32 v[142:143], v[142:143], s[44:45]
v_mfma_f32_16x16x32_bf16 v[120:123], a[72:75], v[160:163], v[120:123]
v_xor_b32 v8, 64, v9
ds_read_b128 v[180:183], v8 offset:8192
v_mfma_f32_16x16x32_bf16 v[124:127], a[76:79], v[160:163], v[124:127]
v_cvt_pk_bf16_f32 v128, v128, v129
v_mfma_f32_16x16x32_bf16 v[112:115], a[80:83], v[164:167], v[112:115]
v_xor_b32 v8, 128, v9
ds_read_b128 v[184:187], v8 offset:8192
v_mfma_f32_16x16x32_bf16 v[116:119], a[84:87], v[164:167], v[116:119]
v_cvt_pk_bf16_f32 v129, v130, v131
v_mfma_f32_16x16x32_bf16 v[120:123], a[88:91], v[164:167], v[120:123]
v_xor_b32 v8, 192, v9
ds_read_b128 v[188:191], v8 offset:8192
v_mfma_f32_16x16x32_bf16 v[124:127], a[92:95], v[164:167], v[124:127]
v_cvt_pk_bf16_f32 v130, v132, v133
v_mfma_f32_16x16x32_bf16 v[112:115], a[96:99], v[168:171], v[112:115]
v_xor_b32 v8, 256, v9
ds_read_b128 v[192:195], v8 offset:8192
v_mfma_f32_16x16x32_bf16 v[116:119], a[100:103], v[168:171], v[116:119]
v_cvt_pk_bf16_f32 v131, v134, v135
v_mfma_f32_16x16x32_bf16 v[120:123], a[104:107], v[168:171], v[120:123]
v_xor_b32 v8, 320, v9
ds_read_b128 v[196:199], v8 offset:8192
v_mfma_f32_16x16x32_bf16 v[124:127], a[108:111], v[168:171], v[124:127]
v_cvt_pk_bf16_f32 v132, v136, v137
v_mfma_f32_16x16x32_bf16 v[112:115], a[112:115], v[172:175], v[112:115]
v_xor_b32 v8, 384, v9
ds_read_b128 v[200:203], v8 offset:8192
v_mfma_f32_16x16x32_bf16 v[116:119], a[116:119], v[172:175], v[116:119]
v_cvt_pk_bf16_f32 v133, v138, v139
v_mfma_f32_16x16x32_bf16 v[120:123], a[120:123], v[172:175], v[120:123]
v_xor_b32 v8, 448, v9
ds_read_b128 v[204:207], v8 offset:8192
v_mfma_f32_16x16x32_bf16 v[124:127], a[124:127], v[172:175], v[124:127]
v_cvt_pk_bf16_f32 v134, v140, v141
v_cvt_pk_bf16_f32 v135, v142, v143
s_mul_i32 s49, s21, 401408
s_mul_i32 s24, s13, 100352
s_add_u32 s49, s49, s24
s_add_u32 s24, s22, 21
s_lshl_b32 s24, s24, 11
s_add_u32 s49, s49, s24
buffer_store_dwordx4 v[128:131], v7, s[8:11], s49 offen offset:0 sc1
buffer_store_dwordx4 v[132:135], v7, s[8:11], s49 offen offset:1024 sc1
s_waitcnt vmcnt(3)
s_mov_b64 exec, 1
buffer_atomic_add v11, v10, s[8:11], s54 offen offset:8 sc1
s_mov_b64 exec, -1
s_waitcnt vmcnt(12)
s_waitcnt lgkmcnt(0)
v_mfma_f32_16x16x32_bf16 v[128:131], a[0:3], v[176:179], 0
ds_write_b128 v14, v[80:83] offset:0
v_mfma_f32_16x16x32_bf16 v[132:135], a[4:7], v[176:179], 0
v_mfma_f32_16x16x32_bf16 v[136:139], a[8:11], v[176:179], 0
ds_write_b128 v14, v[84:87] offset:1024
v_mfma_f32_16x16x32_bf16 v[140:143], a[12:15], v[176:179], 0
v_pk_mul_f32 v[112:113], v[112:113], s[44:45]
v_mfma_f32_16x16x32_bf16 v[128:131], a[16:19], v[180:183], v[128:131]
ds_write_b128 v14, v[88:91] offset:2048
v_mfma_f32_16x16x32_bf16 v[132:135], a[20:23], v[180:183], v[132:135]
v_pk_mul_f32 v[114:115], v[114:115], s[44:45]
v_mfma_f32_16x16x32_bf16 v[136:139], a[24:27], v[180:183], v[136:139]
ds_write_b128 v14, v[92:95] offset:3072
v_mfma_f32_16x16x32_bf16 v[140:143], a[28:31], v[180:183], v[140:143]
v_pk_mul_f32 v[116:117], v[116:117], s[44:45]
v_mfma_f32_16x16x32_bf16 v[128:131], a[32:35], v[184:187], v[128:131]
ds_write_b128 v14, v[96:99] offset:4096
v_mfma_f32_16x16x32_bf16 v[132:135], a[36:39], v[184:187], v[132:135]
v_pk_mul_f32 v[118:119], v[118:119], s[44:45]
v_mfma_f32_16x16x32_bf16 v[136:139], a[40:43], v[184:187], v[136:139]
ds_write_b128 v14, v[100:103] offset:5120
v_mfma_f32_16x16x32_bf16 v[140:143], a[44:47], v[184:187], v[140:143]
v_pk_mul_f32 v[120:121], v[120:121], s[44:45]
v_mfma_f32_16x16x32_bf16 v[128:131], a[48:51], v[188:191], v[128:131]
ds_write_b128 v14, v[104:107] offset:6144
v_mfma_f32_16x16x32_bf16 v[132:135], a[52:55], v[188:191], v[132:135]
v_pk_mul_f32 v[122:123], v[122:123], s[44:45]
v_mfma_f32_16x16x32_bf16 v[136:139], a[56:59], v[188:191], v[136:139]
ds_write_b128 v14, v[108:111] offset:7168
v_mfma_f32_16x16x32_bf16 v[140:143], a[60:63], v[188:191], v[140:143]
v_pk_mul_f32 v[124:125], v[124:125], s[44:45]
v_mfma_f32_16x16x32_bf16 v[128:131], a[64:67], v[192:195], v[128:131]
v_xor_b32 v8, 0, v9
ds_read_b128 v[144:147], v8 offset:0
v_mfma_f32_16x16x32_bf16 v[132:135], a[68:71], v[192:195], v[132:135]
v_pk_mul_f32 v[126:127], v[126:127], s[44:45]
v_mfma_f32_16x16x32_bf16 v[136:139], a[72:75], v[192:195], v[136:139]
v_xor_b32 v8, 64, v9
ds_read_b128 v[148:151], v8 offset:0
v_mfma_f32_16x16x32_bf16 v[140:143], a[76:79], v[192:195], v[140:143]
v_cvt_pk_bf16_f32 v112, v112, v113
v_mfma_f32_16x16x32_bf16 v[128:131], a[80:83], v[196:199], v[128:131]
v_xor_b32 v8, 128, v9
ds_read_b128 v[152:155], v8 offset:0
v_mfma_f32_16x16x32_bf16 v[132:135], a[84:87], v[196:199], v[132:135]
v_cvt_pk_bf16_f32 v113, v114, v115
v_mfma_f32_16x16x32_bf16 v[136:139], a[88:91], v[196:199], v[136:139]
v_xor_b32 v8, 192, v9
ds_read_b128 v[156:159], v8 offset:0
v_mfma_f32_16x16x32_bf16 v[140:143], a[92:95], v[196:199], v[140:143]
v_cvt_pk_bf16_f32 v114, v116, v117
v_mfma_f32_16x16x32_bf16 v[128:131], a[96:99], v[200:203], v[128:131]
v_xor_b32 v8, 256, v9
ds_read_b128 v[160:163], v8 offset:0
v_mfma_f32_16x16x32_bf16 v[132:135], a[100:103], v[200:203], v[132:135]
v_cvt_pk_bf16_f32 v115, v118, v119
v_mfma_f32_16x16x32_bf16 v[136:139], a[104:107], v[200:203], v[136:139]
v_xor_b32 v8, 320, v9
ds_read_b128 v[164:167], v8 offset:0
v_mfma_f32_16x16x32_bf16 v[140:143], a[108:111], v[200:203], v[140:143]
v_cvt_pk_bf16_f32 v116, v120, v121
v_mfma_f32_16x16x32_bf16 v[128:131], a[112:115], v[204:207], v[128:131]
v_xor_b32 v8, 384, v9
ds_read_b128 v[168:171], v8 offset:0
v_mfma_f32_16x16x32_bf16 v[132:135], a[116:119], v[204:207], v[132:135]
v_cvt_pk_bf16_f32 v117, v122, v123
v_mfma_f32_16x16x32_bf16 v[136:139], a[120:123], v[204:207], v[136:139]
v_xor_b32 v8, 448, v9
ds_read_b128 v[172:175], v8 offset:0
v_mfma_f32_16x16x32_bf16 v[140:143], a[124:127], v[204:207], v[140:143]
v_cvt_pk_bf16_f32 v118, v124, v125
v_cvt_pk_bf16_f32 v119, v126, v127
s_mul_i32 s49, s21, 401408
s_mul_i32 s24, s13, 100352
s_add_u32 s49, s49, s24
s_add_u32 s24, s22, 28
s_lshl_b32 s24, s24, 11
s_add_u32 s49, s49, s24
buffer_store_dwordx4 v[112:115], v7, s[8:11], s49 offen offset:0 sc1
buffer_store_dwordx4 v[116:119], v7, s[8:11], s49 offen offset:1024 sc1
s_waitcnt vmcnt(3)
s_mov_b64 exec, 1
buffer_atomic_add v11, v10, s[8:11], s54 offen offset:12 sc1
s_mov_b64 exec, -1
s_waitcnt lgkmcnt(0)
v_mfma_f32_16x16x32_bf16 v[112:115], a[0:3], v[144:147], 0
v_mfma_f32_16x16x32_bf16 v[116:119], a[4:7], v[144:147], 0
v_mfma_f32_16x16x32_bf16 v[120:123], a[8:11], v[144:147], 0
v_mfma_f32_16x16x32_bf16 v[124:127], a[12:15], v[144:147], 0
v_pk_mul_f32 v[128:129], v[128:129], s[44:45]
v_mfma_f32_16x16x32_bf16 v[112:115], a[16:19], v[148:151], v[112:115]
v_pk_mul_f32 v[130:131], v[130:131], s[44:45]
v_mfma_f32_16x16x32_bf16 v[116:119], a[20:23], v[148:151], v[116:119]
v_pk_mul_f32 v[132:133], v[132:133], s[44:45]
v_mfma_f32_16x16x32_bf16 v[120:123], a[24:27], v[148:151], v[120:123]
v_pk_mul_f32 v[134:135], v[134:135], s[44:45]
v_mfma_f32_16x16x32_bf16 v[124:127], a[28:31], v[148:151], v[124:127]
v_pk_mul_f32 v[136:137], v[136:137], s[44:45]
v_mfma_f32_16x16x32_bf16 v[112:115], a[32:35], v[152:155], v[112:115]
v_pk_mul_f32 v[138:139], v[138:139], s[44:45]
v_mfma_f32_16x16x32_bf16 v[116:119], a[36:39], v[152:155], v[116:119]
v_pk_mul_f32 v[140:141], v[140:141], s[44:45]
v_mfma_f32_16x16x32_bf16 v[120:123], a[40:43], v[152:155], v[120:123]
v_pk_mul_f32 v[142:143], v[142:143], s[44:45]
v_mfma_f32_16x16x32_bf16 v[124:127], a[44:47], v[152:155], v[124:127]
v_cvt_pk_bf16_f32 v128, v128, v129
v_mfma_f32_16x16x32_bf16 v[112:115], a[48:51], v[156:159], v[112:115]
v_cvt_pk_bf16_f32 v129, v130, v131
v_mfma_f32_16x16x32_bf16 v[116:119], a[52:55], v[156:159], v[116:119]
v_cvt_pk_bf16_f32 v130, v132, v133
v_mfma_f32_16x16x32_bf16 v[120:123], a[56:59], v[156:159], v[120:123]
v_cvt_pk_bf16_f32 v131, v134, v135
v_mfma_f32_16x16x32_bf16 v[124:127], a[60:63], v[156:159], v[124:127]
v_cvt_pk_bf16_f32 v132, v136, v137
v_mfma_f32_16x16x32_bf16 v[112:115], a[64:67], v[160:163], v[112:115]
v_cvt_pk_bf16_f32 v133, v138, v139
v_mfma_f32_16x16x32_bf16 v[116:119], a[68:71], v[160:163], v[116:119]
v_cvt_pk_bf16_f32 v134, v140, v141
v_mfma_f32_16x16x32_bf16 v[120:123], a[72:75], v[160:163], v[120:123]
v_cvt_pk_bf16_f32 v135, v142, v143
v_mfma_f32_16x16x32_bf16 v[124:127], a[76:79], v[160:163], v[124:127]
s_mul_i32 s49, s21, 401408
s_mul_i32 s24, s13, 100352
s_add_u32 s49, s49, s24
s_add_u32 s24, s22, 35
s_lshl_b32 s24, s24, 11
s_add_u32 s49, s49, s24
v_mfma_f32_16x16x32_bf16 v[112:115], a[80:83], v[164:167], v[112:115]
buffer_store_dwordx4 v[128:131], v7, s[8:11], s49 offen offset:0 sc1
v_mfma_f32_16x16x32_bf16 v[116:119], a[84:87], v[164:167], v[116:119]
buffer_store_dwordx4 v[132:135], v7, s[8:11], s49 offen offset:1024 sc1
v_mfma_f32_16x16x32_bf16 v[120:123], a[88:91], v[164:167], v[120:123]
v_mfma_f32_16x16x32_bf16 v[124:127], a[92:95], v[164:167], v[124:127]
v_mfma_f32_16x16x32_bf16 v[112:115], a[96:99], v[168:171], v[112:115]
v_mfma_f32_16x16x32_bf16 v[116:119], a[100:103], v[168:171], v[116:119]
v_mfma_f32_16x16x32_bf16 v[120:123], a[104:107], v[168:171], v[120:123]
v_mfma_f32_16x16x32_bf16 v[124:127], a[108:111], v[168:171], v[124:127]
v_mfma_f32_16x16x32_bf16 v[112:115], a[112:115], v[172:175], v[112:115]
v_mfma_f32_16x16x32_bf16 v[116:119], a[116:119], v[172:175], v[116:119]
v_mfma_f32_16x16x32_bf16 v[120:123], a[120:123], v[172:175], v[120:123]
v_mfma_f32_16x16x32_bf16 v[124:127], a[124:127], v[172:175], v[124:127]
s_waitcnt vmcnt(3)
s_mov_b64 exec, 1
buffer_atomic_add v11, v10, s[8:11], s54 offen offset:16 sc1
s_mov_b64 exec, -1
s_nop 7
v_pk_mul_f32 v[112:113], v[112:113], s[44:45]
v_pk_mul_f32 v[114:115], v[114:115], s[44:45]
v_pk_mul_f32 v[116:117], v[116:117], s[44:45]
v_pk_mul_f32 v[118:119], v[118:119], s[44:45]
v_pk_mul_f32 v[120:121], v[120:121], s[44:45]
v_pk_mul_f32 v[122:123], v[122:123], s[44:45]
v_pk_mul_f32 v[124:125], v[124:125], s[44:45]
v_pk_mul_f32 v[126:127], v[126:127], s[44:45]
v_cvt_pk_bf16_f32 v112, v112, v113
v_cvt_pk_bf16_f32 v113, v114, v115
v_cvt_pk_bf16_f32 v114, v116, v117
v_cvt_pk_bf16_f32 v115, v118, v119
v_cvt_pk_bf16_f32 v116, v120, v121
v_cvt_pk_bf16_f32 v117, v122, v123
v_cvt_pk_bf16_f32 v118, v124, v125
v_cvt_pk_bf16_f32 v119, v126, v127
s_mul_i32 s49, s21, 401408
s_mul_i32 s24, s13, 100352
s_add_u32 s49, s49, s24
s_add_u32 s24, s22, 42
s_lshl_b32 s24, s24, 11
s_add_u32 s49, s49, s24
buffer_store_dwordx4 v[112:115], v7, s[8:11], s49 offen offset:0 sc1
buffer_store_dwordx4 v[116:119], v7, s[8:11], s49 offen offset:1024 sc1
s_waitcnt vmcnt(3)
s_mov_b64 exec, 1
buffer_atomic_add v11, v10, s[8:11], s54 offen offset:20 sc1
s_mov_b64 exec, -1
s_waitcnt vmcnt(1)
s_mov_b64 exec, 1
buffer_atomic_add v11, v10, s[8:11], s54 offen offset:24 sc1
s_mov_b64 exec, -1
s_branch M_phase0_done
G_wb_11:
s_load_dwordx2 s[36:37], s[0:1], 32
s_mov_b32 s38, 3670016
s_mov_b32 s39, 0x20000
s_load_dwordx2 s[40:41], s[0:1], 40
s_mov_b32 s42, 3670016
s_mov_b32 s43, 0x20000
s_mul_i32 s46, s21, 229376
v_lshlrev_b32 v8, 4, v0
s_lshl_b32 s54, s21, 7
s_add_u32 s54, s54, 44114560
s_waitcnt lgkmcnt(0)
v_lshlrev_b32 v10, 7, v0
s_lshl_b32 s24, s22, 15
s_add_u32 s23, s46, s24
buffer_load_dword v11, v10, s[40:43], s23 offen
s_lshr_b32 s23, s13, 1
s_lshl_b32 s23, s23, 5
s_and_b32 s24, s13, 1
s_lshl_b32 s24, s24, 1
s_add_u32 s23, s23, s24
s_lshl_b32 s28, s22, 6
s_add_u32 s28, s28, s23
s_lshl_b32 s28, s28, 13
s_lshl_b32 s23, s21, 9
s_add_u32 s28, s28, s23
v_xor_b32 v8, 0, v4
s_add_u32 s23, s28, 0
buffer_load_dwordx4 v[112:115], v8, s[36:39], s23 offen
v_xor_b32 v8, 32, v4
s_add_u32 s23, s28, 65536
buffer_load_dwordx4 v[116:119], v8, s[36:39], s23 offen
v_xor_b32 v8, 64, v4
s_add_u32 s23, s28, 32768
buffer_load_dwordx4 v[120:123], v8, s[36:39], s23 offen
v_xor_b32 v8, 96, v4
s_add_u32 s23, s28, 98304
buffer_load_dwordx4 v[124:127], v8, s[36:39], s23 offen
v_xor_b32 v8, 128, v4
s_add_u32 s23, s28, 131072
buffer_load_dwordx4 v[128:131], v8, s[36:39], s23 offen
v_xor_b32 v8, 160, v4
s_add_u32 s23, s28, 196608
buffer_load_dwordx4 v[132:135], v8, s[36:39], s23 offen
v_xor_b32 v8, 192, v4
s_add_u32 s23, s28, 163840
buffer_load_dwordx4 v[136:139], v8, s[36:39], s23 offen
v_xor_b32 v8, 224, v4
s_add_u32 s23, s28, 229376
buffer_load_dwordx4 v[140:143], v8, s[36:39], s23 offen
s_waitcnt vmcnt(0)
v_lshlrev_b32 v9, 4, v0
s_add_u32 s23, s46, 0
buffer_load_dwordx4 a[128:131], v9, s[40:43], s23 offen
s_add_u32 s23, s46, 4096
buffer_load_dwordx4 a[132:135], v9, s[40:43], s23 offen
s_add_u32 s23, s46, 8192
buffer_load_dwordx4 a[136:139], v9, s[40:43], s23 offen
s_add_u32 s23, s46, 12288
buffer_load_dwordx4 a[140:143], v9, s[40:43], s23 offen
s_add_u32 s23, s46, 16384
buffer_load_dwordx4 a[144:147], v9, s[40:43], s23 offen
s_add_u32 s23, s46, 20480
buffer_load_dwordx4 a[148:151], v9, s[40:43], s23 offen
s_add_u32 s23, s46, 24576
buffer_load_dwordx4 a[152:155], v9, s[40:43], s23 offen
s_add_u32 s23, s46, 28672
buffer_load_dwordx4 a[156:159], v9, s[40:43], s23 offen
s_add_u32 s23, s46, 32768
buffer_load_dwordx4 a[160:163], v9, s[40:43], s23 offen
s_add_u32 s23, s46, 36864
buffer_load_dwordx4 a[164:167], v9, s[40:43], s23 offen
s_add_u32 s23, s46, 40960
buffer_load_dwordx4 a[168:171], v9, s[40:43], s23 offen
s_add_u32 s23, s46, 45056
buffer_load_dwordx4 a[172:175], v9, s[40:43], s23 offen
s_add_u32 s23, s46, 49152
buffer_load_dwordx4 a[176:179], v9, s[40:43], s23 offen
s_add_u32 s23, s46, 53248
buffer_load_dwordx4 a[180:183], v9, s[40:43], s23 offen
s_add_u32 s23, s46, 57344
buffer_load_dwordx4 a[184:187], v9, s[40:43], s23 offen
s_add_u32 s23, s46, 61440
buffer_load_dwordx4 a[188:191], v9, s[40:43], s23 offen
s_add_u32 s23, s46, 65536
buffer_load_dwordx4 a[192:195], v9, s[40:43], s23 offen
s_add_u32 s23, s46, 69632
buffer_load_dwordx4 a[196:199], v9, s[40:43], s23 offen
s_add_u32 s23, s46, 73728
buffer_load_dwordx4 a[200:203], v9, s[40:43], s23 offen
s_add_u32 s23, s46, 77824
buffer_load_dwordx4 a[204:207], v9, s[40:43], s23 offen
s_add_u32 s23, s46, 81920
buffer_load_dwordx4 a[208:211], v9, s[40:43], s23 offen
s_add_u32 s23, s46, 86016
buffer_load_dwordx4 a[212:215], v9, s[40:43], s23 offen
s_add_u32 s23, s46, 90112
buffer_load_dwordx4 a[216:219], v9, s[40:43], s23 offen
s_add_u32 s23, s46, 94208
buffer_load_dwordx4 a[220:223], v9, s[40:43], s23 offen
s_add_u32 s23, s46, 98304
buffer_load_dwordx4 a[224:227], v9, s[40:43], s23 offen
s_add_u32 s23, s46, 102400
buffer_load_dwordx4 a[228:231], v9, s[40:43], s23 offen
s_add_u32 s23, s46, 106496
buffer_load_dwordx4 a[232:235], v9, s[40:43], s23 offen
s_add_u32 s23, s46, 110592
buffer_load_dwordx4 a[236:239], v9, s[40:43], s23 offen
s_add_u32 s23, s46, 114688
buffer_load_dwordx4 a[240:243], v9, s[40:43], s23 offen
s_add_u32 s23, s46, 118784
buffer_load_dwordx4 a[244:247], v9, s[40:43], s23 offen
s_add_u32 s23, s46, 122880
buffer_load_dwordx4 a[248:251], v9, s[40:43], s23 offen
s_add_u32 s23, s46, 126976
buffer_load_dwordx4 a[252:255], v9, s[40:43], s23 offen
s_add_u32 s23, s46, 131072
buffer_load_dwordx4 v[16:19], v9, s[40:43], s23 offen
s_add_u32 s23, s46, 135168
buffer_load_dwordx4 v[20:23], v9, s[40:43], s23 offen
s_add_u32 s23, s46, 139264
buffer_load_dwordx4 v[24:27], v9, s[40:43], s23 offen
s_add_u32 s23, s46, 143360
buffer_load_dwordx4 v[28:31], v9, s[40:43], s23 offen
s_add_u32 s23, s46, 147456
buffer_load_dwordx4 v[32:35], v9, s[40:43], s23 offen
s_add_u32 s23, s46, 151552
buffer_load_dwordx4 v[36:39], v9, s[40:43], s23 offen
s_add_u32 s23, s46, 155648
buffer_load_dwordx4 v[40:43], v9, s[40:43], s23 offen
s_add_u32 s23, s46, 159744
buffer_load_dwordx4 v[44:47], v9, s[40:43], s23 offen
s_add_u32 s23, s46, 163840
buffer_load_dwordx4 v[48:51], v9, s[40:43], s23 offen
s_add_u32 s23, s46, 167936
buffer_load_dwordx4 v[52:55], v9, s[40:43], s23 offen
s_add_u32 s23, s46, 172032
buffer_load_dwordx4 v[56:59], v9, s[40:43], s23 offen
s_add_u32 s23, s46, 176128
buffer_load_dwordx4 v[60:63], v9, s[40:43], s23 offen
s_add_u32 s23, s46, 180224
buffer_load_dwordx4 v[64:67], v9, s[40:43], s23 offen
s_add_u32 s23, s46, 184320
buffer_load_dwordx4 v[68:71], v9, s[40:43], s23 offen
s_add_u32 s23, s46, 188416
buffer_load_dwordx4 v[72:75], v9, s[40:43], s23 offen
s_add_u32 s23, s46, 192512
buffer_load_dwordx4 v[76:79], v9, s[40:43], s23 offen
s_add_u32 s23, s46, 196608
buffer_load_dwordx4 v[80:83], v9, s[40:43], s23 offen
s_add_u32 s23, s46, 200704
buffer_load_dwordx4 v[84:87], v9, s[40:43], s23 offen
s_add_u32 s23, s46, 204800
buffer_load_dwordx4 v[88:91], v9, s[40:43], s23 offen
s_add_u32 s23, s46, 208896
buffer_load_dwordx4 v[92:95], v9, s[40:43], s23 offen
s_add_u32 s23, s46, 212992
buffer_load_dwordx4 v[96:99], v9, s[40:43], s23 offen
s_add_u32 s23, s46, 217088
buffer_load_dwordx4 v[100:103], v9, s[40:43], s23 offen
s_add_u32 s23, s46, 221184
buffer_load_dwordx4 v[104:107], v9, s[40:43], s23 offen
s_add_u32 s23, s46, 225280
buffer_load_dwordx4 v[108:111], v9, s[40:43], s23 offen
v_add_u32 v8, 0, v0
v_mul_u32_u24 v4, 2341, v8
v_lshrrev_b32 v4, 17, v4
v_mul_u32_u24 v10, 56, v4
v_sub_u32 v10, v8, v10
v_lshlrev_b32 v10, 4, v10
v_mul_u32_u24 v4, 928, v4
v_add_u32 v10, v10, v4
v_add_u32 v10, 32768, v10
v_add_u32 v8, 256, v0
v_mul_u32_u24 v4, 2341, v8
v_lshrrev_b32 v4, 17, v4
v_mul_u32_u24 v11, 56, v4
v_sub_u32 v11, v8, v11
v_lshlrev_b32 v11, 4, v11
v_mul_u32_u24 v4, 928, v4
v_add_u32 v11, v11, v4
v_add_u32 v11, 32768, v11
v_add_u32 v8, 512, v0
v_mul_u32_u24 v4, 2341, v8
v_lshrrev_b32 v4, 17, v4
v_mul_u32_u24 v12, 56, v4
v_sub_u32 v12, v8, v12
v_lshlrev_b32 v12, 4, v12
v_mul_u32_u24 v4, 928, v4
v_add_u32 v12, v12, v4
v_add_u32 v12, 32768, v12
v_add_u32 v8, 768, v0
v_mul_u32_u24 v4, 2341, v8
v_lshrrev_b32 v4, 17, v4
v_mul_u32_u24 v13, 56, v4
v_sub_u32 v13, v8, v13
v_lshlrev_b32 v13, 4, v13
v_mul_u32_u24 v4, 928, v4
v_add_u32 v13, v13, v4
v_add_u32 v13, 32768, v13
v_add_u32 v8, 1024, v0
v_mul_u32_u24 v4, 2341, v8
v_lshrrev_b32 v4, 17, v4
v_mul_u32_u24 v14, 56, v4
v_sub_u32 v14, v8, v14
v_lshlrev_b32 v14, 4, v14
v_mul_u32_u24 v4, 928, v4
v_add_u32 v14, v14, v4
v_add_u32 v14, 32768, v14
v_add_u32 v8, 1280, v0
v_mul_u32_u24 v4, 2341, v8
v_lshrrev_b32 v4, 17, v4
v_mul_u32_u24 v15, 56, v4
v_sub_u32 v15, v8, v15
v_lshlrev_b32 v15, 4, v15
v_mul_u32_u24 v4, 928, v4
v_add_u32 v15, v15, v4
v_add_u32 v15, 32768, v15
v_add_u32 v8, 1536, v0
v_mul_u32_u24 v4, 2341, v8
v_lshrrev_b32 v4, 17, v4
v_mul_u32_u24 v6, 56, v4
v_sub_u32 v6, v8, v6
v_lshlrev_b32 v6, 4, v6
v_mul_u32_u24 v4, 928, v4
v_add_u32 v6, v6, v4
v_add_u32 v6, 32768, v6
v_bfe_u32 v8, v1, 2, 2
v_lshl_add_u32 v8, v3, 3, v8
v_mul_u32_u24 v9, 928, v8
v_and_b32 v8, 3, v1
v_lshl_add_u32 v9, v8, 3, v9
s_mul_i32 s23, s13, 224
s_add_u32 s23, s23, 32768
v_add_u32 v9, s23, v9
s_lshl_b32 s52, s13, 13
v_add_u32 v8, s52, v7
ds_write_b128 v8, v[112:115] offset:0
ds_write_b128 v8, v[116:119] offset:1024
ds_write_b128 v8, v[120:123] offset:2048
ds_write_b128 v8, v[124:127] offset:3072
ds_write_b128 v8, v[128:131] offset:4096
ds_write_b128 v8, v[132:135] offset:5120
ds_write_b128 v8, v[136:139] offset:6144
ds_write_b128 v8, v[140:143] offset:7168
s_waitcnt lgkmcnt(0)
s_barrier
v_xor_b32 v8, 0, v5
ds_read_b128 a[0:3], v8 offset:0
ds_read_b128 a[4:7], v8 offset:8192
ds_read_b128 a[8:11], v8 offset:16384
ds_read_b128 a[12:15], v8 offset:24576
v_xor_b32 v8, 64, v5
ds_read_b128 a[16:19], v8 offset:0
ds_read_b128 a[20:23], v8 offset:8192
ds_read_b128 a[24:27], v8 offset:16384
ds_read_b128 a[28:31], v8 offset:24576
s_waitcnt lgkmcnt(0)
v_xor_b32 v8, 128, v5
ds_read_b128 a[32:35], v8 offset:0
ds_read_b128 a[36:39], v8 offset:8192
ds_read_b128 a[40:43], v8 offset:16384
ds_read_b128 a[44:47], v8 offset:24576
v_xor_b32 v8, 192, v5
ds_read_b128 a[48:51], v8 offset:0
ds_read_b128 a[52:55], v8 offset:8192
ds_read_b128 a[56:59], v8 offset:16384
ds_read_b128 a[60:63], v8 offset:24576
s_waitcnt lgkmcnt(0)
v_xor_b32 v8, 256, v5
ds_read_b128 a[64:67], v8 offset:0
ds_read_b128 a[68:71], v8 offset:8192
ds_read_b128 a[72:75], v8 offset:16384
ds_read_b128 a[76:79], v8 offset:24576
v_xor_b32 v8, 320, v5
ds_read_b128 a[80:83], v8 offset:0
ds_read_b128 a[84:87], v8 offset:8192
ds_read_b128 a[88:91], v8 offset:16384
ds_read_b128 a[92:95], v8 offset:24576
s_waitcnt lgkmcnt(0)
v_xor_b32 v8, 384, v5
ds_read_b128 a[96:99], v8 offset:0
ds_read_b128 a[100:103], v8 offset:8192
ds_read_b128 a[104:107], v8 offset:16384
ds_read_b128 a[108:111], v8 offset:24576
v_xor_b32 v8, 448, v5
ds_read_b128 a[112:115], v8 offset:0
ds_read_b128 a[116:119], v8 offset:8192
ds_read_b128 a[120:123], v8 offset:16384
ds_read_b128 a[124:127], v8 offset:24576
s_waitcnt lgkmcnt(0)
s_waitcnt vmcnt(49)
ds_write_b128 v10, a[128:131] offset:0
ds_write_b128 v11, a[132:135] offset:0
ds_write_b128 v12, a[136:139] offset:0
ds_write_b128 v13, a[140:143] offset:0
ds_write_b128 v14, a[144:147] offset:0
ds_write_b128 v15, a[148:151] offset:0
ds_write_b128 v6, a[152:155] offset:0
s_waitcnt lgkmcnt(0)
s_barrier
ds_read_b64_tr_b16 v[224:225], v9 offset:0
ds_read_b64_tr_b16 v[226:227], v9 offset:3712
ds_read_b64_tr_b16 v[228:229], v9 offset:32
ds_read_b64_tr_b16 v[230:231], v9 offset:3744
ds_read_b64_tr_b16 v[232:233], v9 offset:64
ds_read_b64_tr_b16 v[234:235], v9 offset:3776
ds_read_b64_tr_b16 v[236:237], v9 offset:96
ds_read_b64_tr_b16 v[238:239], v9 offset:3808
ds_read_b64_tr_b16 v[240:241], v9 offset:128
ds_read_b64_tr_b16 v[242:243], v9 offset:3840
ds_read_b64_tr_b16 v[244:245], v9 offset:160
ds_read_b64_tr_b16 v[246:247], v9 offset:3872
ds_read_b64_tr_b16 v[248:249], v9 offset:192
ds_read_b64_tr_b16 v[250:251], v9 offset:3904
s_waitcnt vmcnt(42)
s_waitcnt lgkmcnt(12)
v_mfma_f32_16x16x32_bf16 v[112:115], a[0:3], v[224:227], 0
v_mfma_f32_16x16x32_bf16 v[116:119], a[4:7], v[224:227], 0
ds_write_b128 v10, a[156:159] offset:29696
v_mfma_f32_16x16x32_bf16 v[120:123], a[8:11], v[224:227], 0
v_mfma_f32_16x16x32_bf16 v[124:127], a[12:15], v[224:227], 0
s_waitcnt lgkmcnt(11)
v_mfma_f32_16x16x32_bf16 v[128:131], a[0:3], v[228:231], 0
v_mfma_f32_16x16x32_bf16 v[132:135], a[4:7], v[228:231], 0
ds_write_b128 v11, a[160:163] offset:29696
v_mfma_f32_16x16x32_bf16 v[136:139], a[8:11], v[228:231], 0
v_mfma_f32_16x16x32_bf16 v[140:143], a[12:15], v[228:231], 0
s_waitcnt lgkmcnt(10)
v_mfma_f32_16x16x32_bf16 v[144:147], a[0:3], v[232:235], 0
v_mfma_f32_16x16x32_bf16 v[148:151], a[4:7], v[232:235], 0
ds_write_b128 v12, a[164:167] offset:29696
v_mfma_f32_16x16x32_bf16 v[152:155], a[8:11], v[232:235], 0
v_mfma_f32_16x16x32_bf16 v[156:159], a[12:15], v[232:235], 0
s_waitcnt lgkmcnt(9)
v_mfma_f32_16x16x32_bf16 v[160:163], a[0:3], v[236:239], 0
v_mfma_f32_16x16x32_bf16 v[164:167], a[4:7], v[236:239], 0
ds_write_b128 v13, a[168:171] offset:29696
v_mfma_f32_16x16x32_bf16 v[168:171], a[8:11], v[236:239], 0
v_mfma_f32_16x16x32_bf16 v[172:175], a[12:15], v[236:239], 0
s_waitcnt lgkmcnt(8)
v_mfma_f32_16x16x32_bf16 v[176:179], a[0:3], v[240:243], 0
v_mfma_f32_16x16x32_bf16 v[180:183], a[4:7], v[240:243], 0
ds_write_b128 v14, a[172:175] offset:29696
v_mfma_f32_16x16x32_bf16 v[184:187], a[8:11], v[240:243], 0
v_mfma_f32_16x16x32_bf16 v[188:191], a[12:15], v[240:243], 0
s_waitcnt lgkmcnt(7)
v_mfma_f32_16x16x32_bf16 v[192:195], a[0:3], v[244:247], 0
v_mfma_f32_16x16x32_bf16 v[196:199], a[4:7], v[244:247], 0
ds_write_b128 v15, a[176:179] offset:29696
v_mfma_f32_16x16x32_bf16 v[200:203], a[8:11], v[244:247], 0
v_mfma_f32_16x16x32_bf16 v[204:207], a[12:15], v[244:247], 0
s_waitcnt lgkmcnt(6)
v_mfma_f32_16x16x32_bf16 v[208:211], a[0:3], v[248:251], 0
v_mfma_f32_16x16x32_bf16 v[212:215], a[4:7], v[248:251], 0
ds_write_b128 v6, a[180:183] offset:29696
v_mfma_f32_16x16x32_bf16 v[216:219], a[8:11], v[248:251], 0
v_mfma_f32_16x16x32_bf16 v[220:223], a[12:15], v[248:251], 0
s_waitcnt lgkmcnt(0)
s_barrier
ds_read_b64_tr_b16 v[224:225], v9 offset:29696
ds_read_b64_tr_b16 v[226:227], v9 offset:33408
ds_read_b64_tr_b16 v[228:229], v9 offset:29728
ds_read_b64_tr_b16 v[230:231], v9 offset:33440
ds_read_b64_tr_b16 v[232:233], v9 offset:29760
ds_read_b64_tr_b16 v[234:235], v9 offset:33472
ds_read_b64_tr_b16 v[236:237], v9 offset:29792
ds_read_b64_tr_b16 v[238:239], v9 offset:33504
ds_read_b64_tr_b16 v[240:241], v9 offset:29824
ds_read_b64_tr_b16 v[242:243], v9 offset:33536
ds_read_b64_tr_b16 v[244:245], v9 offset:29856
ds_read_b64_tr_b16 v[246:247], v9 offset:33568
ds_read_b64_tr_b16 v[248:249], v9 offset:29888
ds_read_b64_tr_b16 v[250:251], v9 offset:33600
s_waitcnt vmcnt(35)
s_waitcnt lgkmcnt(12)
v_mfma_f32_16x16x32_bf16 v[112:115], a[16:19], v[224:227], v[112:115]
v_mfma_f32_16x16x32_bf16 v[116:119], a[20:23], v[224:227], v[116:119]
ds_write_b128 v10, a[184:187] offset:0
v_mfma_f32_16x16x32_bf16 v[120:123], a[24:27], v[224:227], v[120:123]
v_mfma_f32_16x16x32_bf16 v[124:127], a[28:31], v[224:227], v[124:127]
s_waitcnt lgkmcnt(11)
v_mfma_f32_16x16x32_bf16 v[128:131], a[16:19], v[228:231], v[128:131]
v_mfma_f32_16x16x32_bf16 v[132:135], a[20:23], v[228:231], v[132:135]
ds_write_b128 v11, a[188:191] offset:0
v_mfma_f32_16x16x32_bf16 v[136:139], a[24:27], v[228:231], v[136:139]
v_mfma_f32_16x16x32_bf16 v[140:143], a[28:31], v[228:231], v[140:143]
s_waitcnt lgkmcnt(10)
v_mfma_f32_16x16x32_bf16 v[144:147], a[16:19], v[232:235], v[144:147]
v_mfma_f32_16x16x32_bf16 v[148:151], a[20:23], v[232:235], v[148:151]
ds_write_b128 v12, a[192:195] offset:0
v_mfma_f32_16x16x32_bf16 v[152:155], a[24:27], v[232:235], v[152:155]
v_mfma_f32_16x16x32_bf16 v[156:159], a[28:31], v[232:235], v[156:159]
s_waitcnt lgkmcnt(9)
v_mfma_f32_16x16x32_bf16 v[160:163], a[16:19], v[236:239], v[160:163]
v_mfma_f32_16x16x32_bf16 v[164:167], a[20:23], v[236:239], v[164:167]
ds_write_b128 v13, a[196:199] offset:0
v_mfma_f32_16x16x32_bf16 v[168:171], a[24:27], v[236:239], v[168:171]
v_mfma_f32_16x16x32_bf16 v[172:175], a[28:31], v[236:239], v[172:175]
s_waitcnt lgkmcnt(8)
v_mfma_f32_16x16x32_bf16 v[176:179], a[16:19], v[240:243], v[176:179]
v_mfma_f32_16x16x32_bf16 v[180:183], a[20:23], v[240:243], v[180:183]
ds_write_b128 v14, a[200:203] offset:0
v_mfma_f32_16x16x32_bf16 v[184:187], a[24:27], v[240:243], v[184:187]
v_mfma_f32_16x16x32_bf16 v[188:191], a[28:31], v[240:243], v[188:191]
s_waitcnt lgkmcnt(7)
v_mfma_f32_16x16x32_bf16 v[192:195], a[16:19], v[244:247], v[192:195]
v_mfma_f32_16x16x32_bf16 v[196:199], a[20:23], v[244:247], v[196:199]
ds_write_b128 v15, a[204:207] offset:0
v_mfma_f32_16x16x32_bf16 v[200:203], a[24:27], v[244:247], v[200:203]
v_mfma_f32_16x16x32_bf16 v[204:207], a[28:31], v[244:247], v[204:207]
s_waitcnt lgkmcnt(6)
v_mfma_f32_16x16x32_bf16 v[208:211], a[16:19], v[248:251], v[208:211]
v_mfma_f32_16x16x32_bf16 v[212:215], a[20:23], v[248:251], v[212:215]
ds_write_b128 v6, a[208:211] offset:0
v_mfma_f32_16x16x32_bf16 v[216:219], a[24:27], v[248:251], v[216:219]
v_mfma_f32_16x16x32_bf16 v[220:223], a[28:31], v[248:251], v[220:223]
s_waitcnt lgkmcnt(0)
s_barrier
ds_read_b64_tr_b16 v[224:225], v9 offset:0
ds_read_b64_tr_b16 v[226:227], v9 offset:3712
ds_read_b64_tr_b16 v[228:229], v9 offset:32
ds_read_b64_tr_b16 v[230:231], v9 offset:3744
ds_read_b64_tr_b16 v[232:233], v9 offset:64
ds_read_b64_tr_b16 v[234:235], v9 offset:3776
ds_read_b64_tr_b16 v[236:237], v9 offset:96
ds_read_b64_tr_b16 v[238:239], v9 offset:3808
ds_read_b64_tr_b16 v[240:241], v9 offset:128
ds_read_b64_tr_b16 v[242:243], v9 offset:3840
ds_read_b64_tr_b16 v[244:245], v9 offset:160
ds_read_b64_tr_b16 v[246:247], v9 offset:3872
ds_read_b64_tr_b16 v[248:249], v9 offset:192
ds_read_b64_tr_b16 v[250:251], v9 offset:3904
s_waitcnt vmcnt(28)
s_waitcnt lgkmcnt(12)
v_mfma_f32_16x16x32_bf16 v[112:115], a[32:35], v[224:227], v[112:115]
v_mfma_f32_16x16x32_bf16 v[116:119], a[36:39], v[224:227], v[116:119]
ds_write_b128 v10, a[212:215] offset:29696
v_mfma_f32_16x16x32_bf16 v[120:123], a[40:43], v[224:227], v[120:123]
v_mfma_f32_16x16x32_bf16 v[124:127], a[44:47], v[224:227], v[124:127]
s_waitcnt lgkmcnt(11)
v_mfma_f32_16x16x32_bf16 v[128:131], a[32:35], v[228:231], v[128:131]
v_mfma_f32_16x16x32_bf16 v[132:135], a[36:39], v[228:231], v[132:135]
ds_write_b128 v11, a[216:219] offset:29696
v_mfma_f32_16x16x32_bf16 v[136:139], a[40:43], v[228:231], v[136:139]
v_mfma_f32_16x16x32_bf16 v[140:143], a[44:47], v[228:231], v[140:143]
s_waitcnt lgkmcnt(10)
v_mfma_f32_16x16x32_bf16 v[144:147], a[32:35], v[232:235], v[144:147]
v_mfma_f32_16x16x32_bf16 v[148:151], a[36:39], v[232:235], v[148:151]
ds_write_b128 v12, a[220:223] offset:29696
v_mfma_f32_16x16x32_bf16 v[152:155], a[40:43], v[232:235], v[152:155]
v_mfma_f32_16x16x32_bf16 v[156:159], a[44:47], v[232:235], v[156:159]
s_waitcnt lgkmcnt(9)
v_mfma_f32_16x16x32_bf16 v[160:163], a[32:35], v[236:239], v[160:163]
v_mfma_f32_16x16x32_bf16 v[164:167], a[36:39], v[236:239], v[164:167]
ds_write_b128 v13, a[224:227] offset:29696
v_mfma_f32_16x16x32_bf16 v[168:171], a[40:43], v[236:239], v[168:171]
v_mfma_f32_16x16x32_bf16 v[172:175], a[44:47], v[236:239], v[172:175]
s_waitcnt lgkmcnt(8)
v_mfma_f32_16x16x32_bf16 v[176:179], a[32:35], v[240:243], v[176:179]
v_mfma_f32_16x16x32_bf16 v[180:183], a[36:39], v[240:243], v[180:183]
ds_write_b128 v14, a[228:231] offset:29696
v_mfma_f32_16x16x32_bf16 v[184:187], a[40:43], v[240:243], v[184:187]
v_mfma_f32_16x16x32_bf16 v[188:191], a[44:47], v[240:243], v[188:191]
s_waitcnt lgkmcnt(7)
v_mfma_f32_16x16x32_bf16 v[192:195], a[32:35], v[244:247], v[192:195]
v_mfma_f32_16x16x32_bf16 v[196:199], a[36:39], v[244:247], v[196:199]
ds_write_b128 v15, a[232:235] offset:29696
v_mfma_f32_16x16x32_bf16 v[200:203], a[40:43], v[244:247], v[200:203]
v_mfma_f32_16x16x32_bf16 v[204:207], a[44:47], v[244:247], v[204:207]
s_waitcnt lgkmcnt(6)
v_mfma_f32_16x16x32_bf16 v[208:211], a[32:35], v[248:251], v[208:211]
v_mfma_f32_16x16x32_bf16 v[212:215], a[36:39], v[248:251], v[212:215]
ds_write_b128 v6, a[236:239] offset:29696
v_mfma_f32_16x16x32_bf16 v[216:219], a[40:43], v[248:251], v[216:219]
v_mfma_f32_16x16x32_bf16 v[220:223], a[44:47], v[248:251], v[220:223]
s_waitcnt lgkmcnt(0)
s_barrier
ds_read_b64_tr_b16 v[224:225], v9 offset:29696
ds_read_b64_tr_b16 v[226:227], v9 offset:33408
ds_read_b64_tr_b16 v[228:229], v9 offset:29728
ds_read_b64_tr_b16 v[230:231], v9 offset:33440
ds_read_b64_tr_b16 v[232:233], v9 offset:29760
ds_read_b64_tr_b16 v[234:235], v9 offset:33472
ds_read_b64_tr_b16 v[236:237], v9 offset:29792
ds_read_b64_tr_b16 v[238:239], v9 offset:33504
ds_read_b64_tr_b16 v[240:241], v9 offset:29824
ds_read_b64_tr_b16 v[242:243], v9 offset:33536
ds_read_b64_tr_b16 v[244:245], v9 offset:29856
ds_read_b64_tr_b16 v[246:247], v9 offset:33568
ds_read_b64_tr_b16 v[248:249], v9 offset:29888
ds_read_b64_tr_b16 v[250:251], v9 offset:33600
s_waitcnt vmcnt(21)
s_waitcnt lgkmcnt(12)
v_mfma_f32_16x16x32_bf16 v[112:115], a[48:51], v[224:227], v[112:115]
v_mfma_f32_16x16x32_bf16 v[116:119], a[52:55], v[224:227], v[116:119]
ds_write_b128 v10, a[240:243] offset:0
v_mfma_f32_16x16x32_bf16 v[120:123], a[56:59], v[224:227], v[120:123]
v_mfma_f32_16x16x32_bf16 v[124:127], a[60:63], v[224:227], v[124:127]
s_waitcnt lgkmcnt(11)
v_mfma_f32_16x16x32_bf16 v[128:131], a[48:51], v[228:231], v[128:131]
v_mfma_f32_16x16x32_bf16 v[132:135], a[52:55], v[228:231], v[132:135]
ds_write_b128 v11, a[244:247] offset:0
v_mfma_f32_16x16x32_bf16 v[136:139], a[56:59], v[228:231], v[136:139]
v_mfma_f32_16x16x32_bf16 v[140:143], a[60:63], v[228:231], v[140:143]
s_waitcnt lgkmcnt(10)
v_mfma_f32_16x16x32_bf16 v[144:147], a[48:51], v[232:235], v[144:147]
v_mfma_f32_16x16x32_bf16 v[148:151], a[52:55], v[232:235], v[148:151]
ds_write_b128 v12, a[248:251] offset:0
v_mfma_f32_16x16x32_bf16 v[152:155], a[56:59], v[232:235], v[152:155]
v_mfma_f32_16x16x32_bf16 v[156:159], a[60:63], v[232:235], v[156:159]
s_waitcnt lgkmcnt(9)
v_mfma_f32_16x16x32_bf16 v[160:163], a[48:51], v[236:239], v[160:163]
v_mfma_f32_16x16x32_bf16 v[164:167], a[52:55], v[236:239], v[164:167]
ds_write_b128 v13, a[252:255] offset:0
v_mfma_f32_16x16x32_bf16 v[168:171], a[56:59], v[236:239], v[168:171]
v_mfma_f32_16x16x32_bf16 v[172:175], a[60:63], v[236:239], v[172:175]
s_waitcnt lgkmcnt(8)
v_mfma_f32_16x16x32_bf16 v[176:179], a[48:51], v[240:243], v[176:179]
v_mfma_f32_16x16x32_bf16 v[180:183], a[52:55], v[240:243], v[180:183]
ds_write_b128 v14, v[16:19] offset:0
v_mfma_f32_16x16x32_bf16 v[184:187], a[56:59], v[240:243], v[184:187]
v_mfma_f32_16x16x32_bf16 v[188:191], a[60:63], v[240:243], v[188:191]
s_waitcnt lgkmcnt(7)
v_mfma_f32_16x16x32_bf16 v[192:195], a[48:51], v[244:247], v[192:195]
v_mfma_f32_16x16x32_bf16 v[196:199], a[52:55], v[244:247], v[196:199]
ds_write_b128 v15, v[20:23] offset:0
v_mfma_f32_16x16x32_bf16 v[200:203], a[56:59], v[244:247], v[200:203]
v_mfma_f32_16x16x32_bf16 v[204:207], a[60:63], v[244:247], v[204:207]
s_waitcnt lgkmcnt(6)
v_mfma_f32_16x16x32_bf16 v[208:211], a[48:51], v[248:251], v[208:211]
v_mfma_f32_16x16x32_bf16 v[212:215], a[52:55], v[248:251], v[212:215]
ds_write_b128 v6, v[24:27] offset:0
v_mfma_f32_16x16x32_bf16 v[216:219], a[56:59], v[248:251], v[216:219]
v_mfma_f32_16x16x32_bf16 v[220:223], a[60:63], v[248:251], v[220:223]
s_waitcnt lgkmcnt(0)
s_barrier
ds_read_b64_tr_b16 v[224:225], v9 offset:0
ds_read_b64_tr_b16 v[226:227], v9 offset:3712
ds_read_b64_tr_b16 v[228:229], v9 offset:32
ds_read_b64_tr_b16 v[230:231], v9 offset:3744
ds_read_b64_tr_b16 v[232:233], v9 offset:64
ds_read_b64_tr_b16 v[234:235], v9 offset:3776
ds_read_b64_tr_b16 v[236:237], v9 offset:96
ds_read_b64_tr_b16 v[238:239], v9 offset:3808
ds_read_b64_tr_b16 v[240:241], v9 offset:128
ds_read_b64_tr_b16 v[242:243], v9 offset:3840
ds_read_b64_tr_b16 v[244:245], v9 offset:160
ds_read_b64_tr_b16 v[246:247], v9 offset:3872
ds_read_b64_tr_b16 v[248:249], v9 offset:192
ds_read_b64_tr_b16 v[250:251], v9 offset:3904
s_waitcnt vmcnt(14)
s_waitcnt lgkmcnt(12)
v_mfma_f32_16x16x32_bf16 v[112:115], a[64:67], v[224:227], v[112:115]
v_mfma_f32_16x16x32_bf16 v[116:119], a[68:71], v[224:227], v[116:119]
ds_write_b128 v10, v[28:31] offset:29696
v_mfma_f32_16x16x32_bf16 v[120:123], a[72:75], v[224:227], v[120:123]
v_mfma_f32_16x16x32_bf16 v[124:127], a[76:79], v[224:227], v[124:127]
s_waitcnt lgkmcnt(11)
v_mfma_f32_16x16x32_bf16 v[128:131], a[64:67], v[228:231], v[128:131]
v_mfma_f32_16x16x32_bf16 v[132:135], a[68:71], v[228:231], v[132:135]
ds_write_b128 v11, v[32:35] offset:29696
v_mfma_f32_16x16x32_bf16 v[136:139], a[72:75], v[228:231], v[136:139]
v_mfma_f32_16x16x32_bf16 v[140:143], a[76:79], v[228:231], v[140:143]
s_waitcnt lgkmcnt(10)
v_mfma_f32_16x16x32_bf16 v[144:147], a[64:67], v[232:235], v[144:147]
v_mfma_f32_16x16x32_bf16 v[148:151], a[68:71], v[232:235], v[148:151]
ds_write_b128 v12, v[36:39] offset:29696
v_mfma_f32_16x16x32_bf16 v[152:155], a[72:75], v[232:235], v[152:155]
v_mfma_f32_16x16x32_bf16 v[156:159], a[76:79], v[232:235], v[156:159]
s_waitcnt lgkmcnt(9)
v_mfma_f32_16x16x32_bf16 v[160:163], a[64:67], v[236:239], v[160:163]
v_mfma_f32_16x16x32_bf16 v[164:167], a[68:71], v[236:239], v[164:167]
ds_write_b128 v13, v[40:43] offset:29696
v_mfma_f32_16x16x32_bf16 v[168:171], a[72:75], v[236:239], v[168:171]
v_mfma_f32_16x16x32_bf16 v[172:175], a[76:79], v[236:239], v[172:175]
s_waitcnt lgkmcnt(8)
v_mfma_f32_16x16x32_bf16 v[176:179], a[64:67], v[240:243], v[176:179]
v_mfma_f32_16x16x32_bf16 v[180:183], a[68:71], v[240:243], v[180:183]
ds_write_b128 v14, v[44:47] offset:29696
v_mfma_f32_16x16x32_bf16 v[184:187], a[72:75], v[240:243], v[184:187]
v_mfma_f32_16x16x32_bf16 v[188:191], a[76:79], v[240:243], v[188:191]
s_waitcnt lgkmcnt(7)
v_mfma_f32_16x16x32_bf16 v[192:195], a[64:67], v[244:247], v[192:195]
v_mfma_f32_16x16x32_bf16 v[196:199], a[68:71], v[244:247], v[196:199]
ds_write_b128 v15, v[48:51] offset:29696
v_mfma_f32_16x16x32_bf16 v[200:203], a[72:75], v[244:247], v[200:203]
v_mfma_f32_16x16x32_bf16 v[204:207], a[76:79], v[244:247], v[204:207]
s_waitcnt lgkmcnt(6)
v_mfma_f32_16x16x32_bf16 v[208:211], a[64:67], v[248:251], v[208:211]
v_mfma_f32_16x16x32_bf16 v[212:215], a[68:71], v[248:251], v[212:215]
ds_write_b128 v6, v[52:55] offset:29696
v_mfma_f32_16x16x32_bf16 v[216:219], a[72:75], v[248:251], v[216:219]
v_mfma_f32_16x16x32_bf16 v[220:223], a[76:79], v[248:251], v[220:223]
s_waitcnt lgkmcnt(0)
s_barrier
ds_read_b64_tr_b16 v[224:225], v9 offset:29696
ds_read_b64_tr_b16 v[226:227], v9 offset:33408
ds_read_b64_tr_b16 v[228:229], v9 offset:29728
ds_read_b64_tr_b16 v[230:231], v9 offset:33440
ds_read_b64_tr_b16 v[232:233], v9 offset:29760
ds_read_b64_tr_b16 v[234:235], v9 offset:33472
ds_read_b64_tr_b16 v[236:237], v9 offset:29792
ds_read_b64_tr_b16 v[238:239], v9 offset:33504
ds_read_b64_tr_b16 v[240:241], v9 offset:29824
ds_read_b64_tr_b16 v[242:243], v9 offset:33536
ds_read_b64_tr_b16 v[244:245], v9 offset:29856
ds_read_b64_tr_b16 v[246:247], v9 offset:33568
ds_read_b64_tr_b16 v[248:249], v9 offset:29888
ds_read_b64_tr_b16 v[250:251], v9 offset:33600
s_waitcnt vmcnt(7)
s_waitcnt lgkmcnt(12)
v_mfma_f32_16x16x32_bf16 v[112:115], a[80:83], v[224:227], v[112:115]
v_mfma_f32_16x16x32_bf16 v[116:119], a[84:87], v[224:227], v[116:119]
ds_write_b128 v10, v[56:59] offset:0
v_mfma_f32_16x16x32_bf16 v[120:123], a[88:91], v[224:227], v[120:123]
v_mfma_f32_16x16x32_bf16 v[124:127], a[92:95], v[224:227], v[124:127]
s_waitcnt lgkmcnt(11)
v_mfma_f32_16x16x32_bf16 v[128:131], a[80:83], v[228:231], v[128:131]
v_mfma_f32_16x16x32_bf16 v[132:135], a[84:87], v[228:231], v[132:135]
ds_write_b128 v11, v[60:63] offset:0
v_mfma_f32_16x16x32_bf16 v[136:139], a[88:91], v[228:231], v[136:139]
v_mfma_f32_16x16x32_bf16 v[140:143], a[92:95], v[228:231], v[140:143]
s_waitcnt lgkmcnt(10)
v_mfma_f32_16x16x32_bf16 v[144:147], a[80:83], v[232:235], v[144:147]
v_mfma_f32_16x16x32_bf16 v[148:151], a[84:87], v[232:235], v[148:151]
ds_write_b128 v12, v[64:67] offset:0
v_mfma_f32_16x16x32_bf16 v[152:155], a[88:91], v[232:235], v[152:155]
v_mfma_f32_16x16x32_bf16 v[156:159], a[92:95], v[232:235], v[156:159]
s_waitcnt lgkmcnt(9)
v_mfma_f32_16x16x32_bf16 v[160:163], a[80:83], v[236:239], v[160:163]
v_mfma_f32_16x16x32_bf16 v[164:167], a[84:87], v[236:239], v[164:167]
ds_write_b128 v13, v[68:71] offset:0
v_mfma_f32_16x16x32_bf16 v[168:171], a[88:91], v[236:239], v[168:171]
v_mfma_f32_16x16x32_bf16 v[172:175], a[92:95], v[236:239], v[172:175]
s_waitcnt lgkmcnt(8)
v_mfma_f32_16x16x32_bf16 v[176:179], a[80:83], v[240:243], v[176:179]
v_mfma_f32_16x16x32_bf16 v[180:183], a[84:87], v[240:243], v[180:183]
ds_write_b128 v14, v[72:75] offset:0
v_mfma_f32_16x16x32_bf16 v[184:187], a[88:91], v[240:243], v[184:187]
v_mfma_f32_16x16x32_bf16 v[188:191], a[92:95], v[240:243], v[188:191]
s_waitcnt lgkmcnt(7)
v_mfma_f32_16x16x32_bf16 v[192:195], a[80:83], v[244:247], v[192:195]
v_mfma_f32_16x16x32_bf16 v[196:199], a[84:87], v[244:247], v[196:199]
ds_write_b128 v15, v[76:79] offset:0
v_mfma_f32_16x16x32_bf16 v[200:203], a[88:91], v[244:247], v[200:203]
v_mfma_f32_16x16x32_bf16 v[204:207], a[92:95], v[244:247], v[204:207]
s_waitcnt lgkmcnt(6)
v_mfma_f32_16x16x32_bf16 v[208:211], a[80:83], v[248:251], v[208:211]
v_mfma_f32_16x16x32_bf16 v[212:215], a[84:87], v[248:251], v[212:215]
ds_write_b128 v6, v[80:83] offset:0
v_mfma_f32_16x16x32_bf16 v[216:219], a[88:91], v[248:251], v[216:219]
v_mfma_f32_16x16x32_bf16 v[220:223], a[92:95], v[248:251], v[220:223]
s_waitcnt lgkmcnt(0)
s_barrier
ds_read_b64_tr_b16 v[224:225], v9 offset:0
ds_read_b64_tr_b16 v[226:227], v9 offset:3712
ds_read_b64_tr_b16 v[228:229], v9 offset:32
ds_read_b64_tr_b16 v[230:231], v9 offset:3744
ds_read_b64_tr_b16 v[232:233], v9 offset:64
ds_read_b64_tr_b16 v[234:235], v9 offset:3776
ds_read_b64_tr_b16 v[236:237], v9 offset:96
ds_read_b64_tr_b16 v[238:239], v9 offset:3808
ds_read_b64_tr_b16 v[240:241], v9 offset:128
ds_read_b64_tr_b16 v[242:243], v9 offset:3840
ds_read_b64_tr_b16 v[244:245], v9 offset:160
ds_read_b64_tr_b16 v[246:247], v9 offset:3872
ds_read_b64_tr_b16 v[248:249], v9 offset:192
ds_read_b64_tr_b16 v[250:251], v9 offset:3904
s_waitcnt vmcnt(0)
s_waitcnt lgkmcnt(12)
v_mfma_f32_16x16x32_bf16 v[112:115], a[96:99], v[224:227], v[112:115]
v_mfma_f32_16x16x32_bf16 v[116:119], a[100:103], v[224:227], v[116:119]
ds_write_b128 v10, v[84:87] offset:29696
v_mfma_f32_16x16x32_bf16 v[120:123], a[104:107], v[224:227], v[120:123]
v_mfma_f32_16x16x32_bf16 v[124:127], a[108:111], v[224:227], v[124:127]
s_waitcnt lgkmcnt(11)
v_mfma_f32_16x16x32_bf16 v[128:131], a[96:99], v[228:231], v[128:131]
v_mfma_f32_16x16x32_bf16 v[132:135], a[100:103], v[228:231], v[132:135]
ds_write_b128 v11, v[88:91] offset:29696
v_mfma_f32_16x16x32_bf16 v[136:139], a[104:107], v[228:231], v[136:139]
v_mfma_f32_16x16x32_bf16 v[140:143], a[108:111], v[228:231], v[140:143]
s_waitcnt lgkmcnt(10)
v_mfma_f32_16x16x32_bf16 v[144:147], a[96:99], v[232:235], v[144:147]
v_mfma_f32_16x16x32_bf16 v[148:151], a[100:103], v[232:235], v[148:151]
ds_write_b128 v12, v[92:95] offset:29696
v_mfma_f32_16x16x32_bf16 v[152:155], a[104:107], v[232:235], v[152:155]
v_mfma_f32_16x16x32_bf16 v[156:159], a[108:111], v[232:235], v[156:159]
s_waitcnt lgkmcnt(9)
v_mfma_f32_16x16x32_bf16 v[160:163], a[96:99], v[236:239], v[160:163]
v_mfma_f32_16x16x32_bf16 v[164:167], a[100:103], v[236:239], v[164:167]
ds_write_b128 v13, v[96:99] offset:29696
v_mfma_f32_16x16x32_bf16 v[168:171], a[104:107], v[236:239], v[168:171]
v_mfma_f32_16x16x32_bf16 v[172:175], a[108:111], v[236:239], v[172:175]
s_waitcnt lgkmcnt(8)
v_mfma_f32_16x16x32_bf16 v[176:179], a[96:99], v[240:243], v[176:179]
v_mfma_f32_16x16x32_bf16 v[180:183], a[100:103], v[240:243], v[180:183]
ds_write_b128 v14, v[100:103] offset:29696
v_mfma_f32_16x16x32_bf16 v[184:187], a[104:107], v[240:243], v[184:187]
v_mfma_f32_16x16x32_bf16 v[188:191], a[108:111], v[240:243], v[188:191]
s_waitcnt lgkmcnt(7)
v_mfma_f32_16x16x32_bf16 v[192:195], a[96:99], v[244:247], v[192:195]
v_mfma_f32_16x16x32_bf16 v[196:199], a[100:103], v[244:247], v[196:199]
ds_write_b128 v15, v[104:107] offset:29696
v_mfma_f32_16x16x32_bf16 v[200:203], a[104:107], v[244:247], v[200:203]
v_mfma_f32_16x16x32_bf16 v[204:207], a[108:111], v[244:247], v[204:207]
s_waitcnt lgkmcnt(6)
v_mfma_f32_16x16x32_bf16 v[208:211], a[96:99], v[248:251], v[208:211]
v_mfma_f32_16x16x32_bf16 v[212:215], a[100:103], v[248:251], v[212:215]
ds_write_b128 v6, v[108:111] offset:29696
v_mfma_f32_16x16x32_bf16 v[216:219], a[104:107], v[248:251], v[216:219]
v_mfma_f32_16x16x32_bf16 v[220:223], a[108:111], v[248:251], v[220:223]
s_waitcnt lgkmcnt(0)
s_barrier
ds_read_b64_tr_b16 v[224:225], v9 offset:29696
ds_read_b64_tr_b16 v[226:227], v9 offset:33408
ds_read_b64_tr_b16 v[228:229], v9 offset:29728
ds_read_b64_tr_b16 v[230:231], v9 offset:33440
ds_read_b64_tr_b16 v[232:233], v9 offset:29760
ds_read_b64_tr_b16 v[234:235], v9 offset:33472
ds_read_b64_tr_b16 v[236:237], v9 offset:29792
ds_read_b64_tr_b16 v[238:239], v9 offset:33504
ds_read_b64_tr_b16 v[240:241], v9 offset:29824
ds_read_b64_tr_b16 v[242:243], v9 offset:33536
ds_read_b64_tr_b16 v[244:245], v9 offset:29856
ds_read_b64_tr_b16 v[246:247], v9 offset:33568
ds_read_b64_tr_b16 v[248:249], v9 offset:29888
ds_read_b64_tr_b16 v[250:251], v9 offset:33600
s_waitcnt lgkmcnt(12)
v_mfma_f32_16x16x32_bf16 v[112:115], a[112:115], v[224:227], v[112:115]
v_mfma_f32_16x16x32_bf16 v[116:119], a[116:119], v[224:227], v[116:119]
v_mfma_f32_16x16x32_bf16 v[120:123], a[120:123], v[224:227], v[120:123]
v_mfma_f32_16x16x32_bf16 v[124:127], a[124:127], v[224:227], v[124:127]
s_waitcnt lgkmcnt(10)
v_mfma_f32_16x16x32_bf16 v[128:131], a[112:115], v[228:231], v[128:131]
v_mfma_f32_16x16x32_bf16 v[132:135], a[116:119], v[228:231], v[132:135]
v_mfma_f32_16x16x32_bf16 v[136:139], a[120:123], v[228:231], v[136:139]
v_mfma_f32_16x16x32_bf16 v[140:143], a[124:127], v[228:231], v[140:143]
s_waitcnt lgkmcnt(8)
v_mfma_f32_16x16x32_bf16 v[144:147], a[112:115], v[232:235], v[144:147]
v_mfma_f32_16x16x32_bf16 v[148:151], a[116:119], v[232:235], v[148:151]
v_mfma_f32_16x16x32_bf16 v[152:155], a[120:123], v[232:235], v[152:155]
v_mfma_f32_16x16x32_bf16 v[156:159], a[124:127], v[232:235], v[156:159]
s_waitcnt lgkmcnt(6)
v_mfma_f32_16x16x32_bf16 v[160:163], a[112:115], v[236:239], v[160:163]
v_mfma_f32_16x16x32_bf16 v[164:167], a[116:119], v[236:239], v[164:167]
v_mfma_f32_16x16x32_bf16 v[168:171], a[120:123], v[236:239], v[168:171]
v_mfma_f32_16x16x32_bf16 v[172:175], a[124:127], v[236:239], v[172:175]
s_waitcnt lgkmcnt(4)
v_mfma_f32_16x16x32_bf16 v[176:179], a[112:115], v[240:243], v[176:179]
v_mfma_f32_16x16x32_bf16 v[180:183], a[116:119], v[240:243], v[180:183]
v_mfma_f32_16x16x32_bf16 v[184:187], a[120:123], v[240:243], v[184:187]
v_mfma_f32_16x16x32_bf16 v[188:191], a[124:127], v[240:243], v[188:191]
s_waitcnt lgkmcnt(2)
v_mfma_f32_16x16x32_bf16 v[192:195], a[112:115], v[244:247], v[192:195]
v_mfma_f32_16x16x32_bf16 v[196:199], a[116:119], v[244:247], v[196:199]
v_mfma_f32_16x16x32_bf16 v[200:203], a[120:123], v[244:247], v[200:203]
v_mfma_f32_16x16x32_bf16 v[204:207], a[124:127], v[244:247], v[204:207]
s_waitcnt lgkmcnt(0)
v_mfma_f32_16x16x32_bf16 v[208:211], a[112:115], v[248:251], v[208:211]
v_mfma_f32_16x16x32_bf16 v[212:215], a[116:119], v[248:251], v[212:215]
v_mfma_f32_16x16x32_bf16 v[216:219], a[120:123], v[248:251], v[216:219]
v_mfma_f32_16x16x32_bf16 v[220:223], a[124:127], v[248:251], v[220:223]
s_nop 7
v_mov_b32 v8, 0
global_load_dword v9, v8, s[4:5] offset:16 sc1
v_cvt_pk_bf16_f32 v112, v112, v113
v_cvt_pk_bf16_f32 v113, v114, v115
v_cvt_pk_bf16_f32 v114, v116, v117
v_cvt_pk_bf16_f32 v115, v118, v119
v_cvt_pk_bf16_f32 v116, v120, v121
v_cvt_pk_bf16_f32 v117, v122, v123
v_cvt_pk_bf16_f32 v118, v124, v125
v_cvt_pk_bf16_f32 v119, v126, v127
s_mul_i32 s23, s13, 7
s_add_u32 s23, s23, 0
s_lshr_b32 s49, s23, 1
s_mul_i32 s49, s49, 458752
s_and_b32 s23, s23, 1
s_and_b32 s24, s21, 3
s_lshl_b32 s24, s24, 1
s_add_u32 s23, s23, s24
s_mul_i32 s23, s23, 7
s_add_u32 s23, s23, s22
s_lshl_b32 s23, s23, 11
s_add_u32 s49, s49, s23
s_lshr_b32 s23, s21, 2
s_mul_i32 s23, s23, 114688
s_add_u32 s49, s49, s23
s_add_u32 s49, s49, 6422528
buffer_store_dwordx4 v[112:115], v7, s[8:11], s49 offen offset:0 sc1
buffer_store_dwordx4 v[116:119], v7, s[8:11], s49 offen offset:1024 sc1
v_cvt_pk_bf16_f32 v128, v128, v129
v_cvt_pk_bf16_f32 v129, v130, v131
v_cvt_pk_bf16_f32 v130, v132, v133
v_cvt_pk_bf16_f32 v131, v134, v135
v_cvt_pk_bf16_f32 v132, v136, v137
v_cvt_pk_bf16_f32 v133, v138, v139
v_cvt_pk_bf16_f32 v134, v140, v141
v_cvt_pk_bf16_f32 v135, v142, v143
s_mul_i32 s23, s13, 7
s_add_u32 s23, s23, 1
s_lshr_b32 s49, s23, 1
s_mul_i32 s49, s49, 458752
s_and_b32 s23, s23, 1
s_and_b32 s24, s21, 3
s_lshl_b32 s24, s24, 1
s_add_u32 s23, s23, s24
s_mul_i32 s23, s23, 7
s_add_u32 s23, s23, s22
s_lshl_b32 s23, s23, 11
s_add_u32 s49, s49, s23
s_lshr_b32 s23, s21, 2
s_mul_i32 s23, s23, 114688
s_add_u32 s49, s49, s23
s_add_u32 s49, s49, 6422528
buffer_store_dwordx4 v[128:131], v7, s[8:11], s49 offen offset:0 sc1
buffer_store_dwordx4 v[132:135], v7, s[8:11], s49 offen offset:1024 sc1
v_cvt_pk_bf16_f32 v144, v144, v145
v_cvt_pk_bf16_f32 v145, v146, v147
v_cvt_pk_bf16_f32 v146, v148, v149
v_cvt_pk_bf16_f32 v147, v150, v151
v_cvt_pk_bf16_f32 v148, v152, v153
v_cvt_pk_bf16_f32 v149, v154, v155
v_cvt_pk_bf16_f32 v150, v156, v157
v_cvt_pk_bf16_f32 v151, v158, v159
s_mul_i32 s23, s13, 7
s_add_u32 s23, s23, 2
s_lshr_b32 s49, s23, 1
s_mul_i32 s49, s49, 458752
s_and_b32 s23, s23, 1
s_and_b32 s24, s21, 3
s_lshl_b32 s24, s24, 1
s_add_u32 s23, s23, s24
s_mul_i32 s23, s23, 7
s_add_u32 s23, s23, s22
s_lshl_b32 s23, s23, 11
s_add_u32 s49, s49, s23
s_lshr_b32 s23, s21, 2
s_mul_i32 s23, s23, 114688
s_add_u32 s49, s49, s23
s_add_u32 s49, s49, 6422528
buffer_store_dwordx4 v[144:147], v7, s[8:11], s49 offen offset:0 sc1
buffer_store_dwordx4 v[148:151], v7, s[8:11], s49 offen offset:1024 sc1
v_cvt_pk_bf16_f32 v160, v160, v161
v_cvt_pk_bf16_f32 v161, v162, v163
v_cvt_pk_bf16_f32 v162, v164, v165
v_cvt_pk_bf16_f32 v163, v166, v167
v_cvt_pk_bf16_f32 v164, v168, v169
v_cvt_pk_bf16_f32 v165, v170, v171
v_cvt_pk_bf16_f32 v166, v172, v173
v_cvt_pk_bf16_f32 v167, v174, v175
s_mul_i32 s23, s13, 7
s_add_u32 s23, s23, 3
s_lshr_b32 s49, s23, 1
s_mul_i32 s49, s49, 458752
s_and_b32 s23, s23, 1
s_and_b32 s24, s21, 3
s_lshl_b32 s24, s24, 1
s_add_u32 s23, s23, s24
s_mul_i32 s23, s23, 7
s_add_u32 s23, s23, s22
s_lshl_b32 s23, s23, 11
s_add_u32 s49, s49, s23
s_lshr_b32 s23, s21, 2
s_mul_i32 s23, s23, 114688
s_add_u32 s49, s49, s23
s_add_u32 s49, s49, 6422528
buffer_store_dwordx4 v[160:163], v7, s[8:11], s49 offen offset:0 sc1
buffer_store_dwordx4 v[164:167], v7, s[8:11], s49 offen offset:1024 sc1
v_cvt_pk_bf16_f32 v176, v176, v177
v_cvt_pk_bf16_f32 v177, v178, v179
v_cvt_pk_bf16_f32 v178, v180, v181
v_cvt_pk_bf16_f32 v179, v182, v183
v_cvt_pk_bf16_f32 v180, v184, v185
v_cvt_pk_bf16_f32 v181, v186, v187
v_cvt_pk_bf16_f32 v182, v188, v189
v_cvt_pk_bf16_f32 v183, v190, v191
s_mul_i32 s23, s13, 7
s_add_u32 s23, s23, 4
s_lshr_b32 s49, s23, 1
s_mul_i32 s49, s49, 458752
s_and_b32 s23, s23, 1
s_and_b32 s24, s21, 3
s_lshl_b32 s24, s24, 1
s_add_u32 s23, s23, s24
s_mul_i32 s23, s23, 7
s_add_u32 s23, s23, s22
s_lshl_b32 s23, s23, 11
s_add_u32 s49, s49, s23
s_lshr_b32 s23, s21, 2
s_mul_i32 s23, s23, 114688
s_add_u32 s49, s49, s23
s_add_u32 s49, s49, 6422528
buffer_store_dwordx4 v[176:179], v7, s[8:11], s49 offen offset:0 sc1
buffer_store_dwordx4 v[180:183], v7, s[8:11], s49 offen offset:1024 sc1
v_cvt_pk_bf16_f32 v192, v192, v193
v_cvt_pk_bf16_f32 v193, v194, v195
v_cvt_pk_bf16_f32 v194, v196, v197
v_cvt_pk_bf16_f32 v195, v198, v199
v_cvt_pk_bf16_f32 v196, v200, v201
v_cvt_pk_bf16_f32 v197, v202, v203
v_cvt_pk_bf16_f32 v198, v204, v205
v_cvt_pk_bf16_f32 v199, v206, v207
s_mul_i32 s23, s13, 7
s_add_u32 s23, s23, 5
s_lshr_b32 s49, s23, 1
s_mul_i32 s49, s49, 458752
s_and_b32 s23, s23, 1
s_and_b32 s24, s21, 3
s_lshl_b32 s24, s24, 1
s_add_u32 s23, s23, s24
s_mul_i32 s23, s23, 7
s_add_u32 s23, s23, s22
s_lshl_b32 s23, s23, 11
s_add_u32 s49, s49, s23
s_lshr_b32 s23, s21, 2
s_mul_i32 s23, s23, 114688
s_add_u32 s49, s49, s23
s_add_u32 s49, s49, 6422528
buffer_store_dwordx4 v[192:195], v7, s[8:11], s49 offen offset:0 sc1
buffer_store_dwordx4 v[196:199], v7, s[8:11], s49 offen offset:1024 sc1
v_cvt_pk_bf16_f32 v208, v208, v209
v_cvt_pk_bf16_f32 v209, v210, v211
v_cvt_pk_bf16_f32 v210, v212, v213
v_cvt_pk_bf16_f32 v211, v214, v215
v_cvt_pk_bf16_f32 v212, v216, v217
v_cvt_pk_bf16_f32 v213, v218, v219
v_cvt_pk_bf16_f32 v214, v220, v221
v_cvt_pk_bf16_f32 v215, v222, v223
s_mul_i32 s23, s13, 7
s_add_u32 s23, s23, 6
s_lshr_b32 s49, s23, 1
s_mul_i32 s49, s49, 458752
s_and_b32 s23, s23, 1
s_and_b32 s24, s21, 3
s_lshl_b32 s24, s24, 1
s_add_u32 s23, s23, s24
s_mul_i32 s23, s23, 7
s_add_u32 s23, s23, s22
s_lshl_b32 s23, s23, 11
s_add_u32 s49, s49, s23
s_lshr_b32 s23, s21, 2
s_mul_i32 s23, s23, 114688
s_add_u32 s49, s49, s23
s_add_u32 s49, s49, 6422528
buffer_store_dwordx4 v[208:211], v7, s[8:11], s49 offen offset:0 sc1
buffer_store_dwordx4 v[212:215], v7, s[8:11], s49 offen offset:1024 sc1
s_waitcnt vmcnt(0)
WI_14:
v_cmp_gt_u32 vcc, 32, v9
s_cbranch_vccz WID_15
s_sleep 8
global_load_dword v9, v8, s[4:5] offset:16 sc1
s_waitcnt vmcnt(0)
s_sub_u32 s19, s19, 1
s_cbranch_scc0 WI_14
s_branch M_abort
WID_15:
s_barrier
s_cmp_lg_u32 s13, 0
s_cbranch_scc1 G_ns_16
v_mov_b32 v10, 0
v_mov_b32 v11, 1
s_mov_b64 exec, 1
buffer_atomic_add v11, v10, s[8:11], s54 offen sc1
s_mov_b64 exec, -1
G_ns_16:
s_branch M_phase0_done
M_phase0_done:
s_cmp_lt_u32 s12, 56
s_cbranch_scc1 M_vx
s_cmp_lt_u32 s12, 104
s_cbranch_scc1 M_xa
s_cmp_lt_u32 s12, 132
s_cbranch_scc1 M_pv
s_cmp_lt_u32 s12, 196
s_cbranch_scc1 M_ff
s_cmp_lt_u32 s12, 224
s_cbranch_scc1 M_vm
s_branch M_exit
M_overflow:
M_wa_17:
v_mbcnt_lo_u32_b32 v8, -1, 0
v_mbcnt_hi_u32_b32 v8, -1, v8
v_and_b32 v8, 7, v8
v_lshlrev_b32 v8, 5, v8
global_load_dword v9, v8, s[4:5] sc1
s_waitcnt vmcnt(0)
v_readlane_b32 s18, v9, 0
v_readlane_b32 s17, v9, 1
s_add_u32 s18, s18, s17
v_readlane_b32 s17, v9, 2
s_add_u32 s18, s18, s17
v_readlane_b32 s17, v9, 3
s_add_u32 s18, s18, s17
v_readlane_b32 s17, v9, 4
s_add_u32 s18, s18, s17
v_readlane_b32 s17, v9, 5
s_add_u32 s18, s18, s17
v_readlane_b32 s17, v9, 6
s_add_u32 s18, s18, s17
v_readlane_b32 s17, v9, 7
s_add_u32 s18, s18, s17
s_cmp_ge_u32 s18, 256
s_cbranch_scc1 M_wad_18
s_sleep 4
s_sub_u32 s19, s19, 1
s_cbranch_scc0 M_wa_17
s_branch M_abort
M_wad_18:
s_sub_u32 s20, s12, 32
v_readlane_b32 s17, v9, 0
s_max_u32 s17, s17, 32
s_sub_u32 s17, s17, 32
s_cmp_gt_u32 s3, 0
s_cselect_b32 s17, s17, 0
s_add_u32 s20, s20, s17
v_readlane_b32 s17, v9, 1
s_max_u32 s17, s17, 32
s_sub_u32 s17, s17, 32
s_cmp_gt_u32 s3, 1
s_cselect_b32 s17, s17, 0
s_add_u32 s20, s20, s17
v_readlane_b32 s17, v9, 2
s_max_u32 s17, s17, 32
s_sub_u32 s17, s17, 32
s_cmp_gt_u32 s3, 2
s_cselect_b32 s17, s17, 0
s_add_u32 s20, s20, s17
v_readlane_b32 s17, v9, 3
s_max_u32 s17, s17, 32
s_sub_u32 s17, s17, 32
s_cmp_gt_u32 s3, 3
s_cselect_b32 s17, s17, 0
s_add_u32 s20, s20, s17
v_readlane_b32 s17, v9, 4
s_max_u32 s17, s17, 32
s_sub_u32 s17, s17, 32
s_cmp_gt_u32 s3, 4
s_cselect_b32 s17, s17, 0
s_add_u32 s20, s20, s17
v_readlane_b32 s17, v9, 5
s_max_u32 s17, s17, 32
s_sub_u32 s17, s17, 32
s_cmp_gt_u32 s3, 5
s_cselect_b32 s17, s17, 0
s_add_u32 s20, s20, s17
v_readlane_b32 s17, v9, 6
s_max_u32 s17, s17, 32
s_sub_u32 s17, s17, 32
s_cmp_gt_u32 s3, 6
s_cselect_b32 s17, s17, 0
s_add_u32 s20, s20, s17
v_readlane_b32 s17, v9, 0
s_min_u32 s17, s17, 32
s_sub_u32 s21, 32, s17
s_cmp_lt_u32 s20, s21
s_cbranch_scc0 M_es_19
s_add_u32 s12, s20, s17
s_add_u32 s12, s12, 0
s_branch M_dispatch
M_es_19:
s_sub_u32 s20, s20, s21
v_readlane_b32 s17, v9, 1
s_min_u32 s17, s17, 32
s_sub_u32 s21, 32, s17
s_cmp_lt_u32 s20, s21
s_cbranch_scc0 M_es_20
s_add_u32 s12, s20, s17
s_add_u32 s12, s12, 32
s_branch M_dispatch
M_es_20:
s_sub_u32 s20, s20, s21
v_readlane_b32 s17, v9, 2
s_min_u32 s17, s17, 32
s_sub_u32 s21, 32, s17
s_cmp_lt_u32 s20, s21
s_cbranch_scc0 M_es_21
s_add_u32 s12, s20, s17
s_add_u32 s12, s12, 64
s_branch M_dispatch
M_es_21:
s_sub_u32 s20, s20, s21
v_readlane_b32 s17, v9, 3
s_min_u32 s17, s17, 32
s_sub_u32 s21, 32, s17
s_cmp_lt_u32 s20, s21
s_cbranch_scc0 M_es_22
s_add_u32 s12, s20, s17
s_add_u32 s12, s12, 96
s_branch M_dispatch
M_es_22:
s_sub_u32 s20, s20, s21
v_readlane_b32 s17, v9, 4
s_min_u32 s17, s17, 32
s_sub_u32 s21, 32, s17
s_cmp_lt_u32 s20, s21
s_cbranch_scc0 M_es_23
s_add_u32 s12, s20, s17
s_add_u32 s12, s12, 128
s_branch M_dispatch
M_es_23:
s_sub_u32 s20, s20, s21
v_readlane_b32 s17, v9, 5
s_min_u32 s17, s17, 32
s_sub_u32 s21, 32, s17
s_cmp_lt_u32 s20, s21
s_cbranch_scc0 M_es_24
s_add_u32 s12, s20, s17
s_add_u32 s12, s12, 160
s_branch M_dispatch
M_es_24:
s_sub_u32 s20, s20, s21
v_readlane_b32 s17, v9, 6
s_min_u32 s17, s17, 32
s_sub_u32 s21, 32, s17
s_cmp_lt_u32 s20, s21
s_cbranch_scc0 M_es_25
s_add_u32 s12, s20, s17
s_add_u32 s12, s12, 192
s_branch M_dispatch
M_es_25:
s_sub_u32 s20, s20, s21
v_readlane_b32 s17, v9, 7
s_min_u32 s17, s17, 32
s_sub_u32 s21, 32, s17
s_cmp_lt_u32 s20, s21
s_cbranch_scc0 M_es_26
s_add_u32 s12, s20, s17
s_add_u32 s12, s12, 224
s_branch M_dispatch
M_es_26:
s_sub_u32 s20, s20, s21
s_branch M_exit
M_chain:
s_cmp_ge_u32 s12, 16
s_cbranch_scc1 M_chainB
v_and_b32 v0, 63, v0
v_lshlrev_b32 v1, 4, v0
v_lshlrev_b32 v2, 3, v0
v_and_b32 v10, 15, v0
v_lshrrev_b32 v11, 4, v0
v_min_u32 v12, 13, v10
v_lshlrev_b32 v12, 2, v12
s_mul_i32 s18, s13, 3584
s_add_u32 s18, s18, 12800
s_add_u32 s17, s18, 0
v_lshrrev_b32 v7, 3, v10
v_lshlrev_b32 v7, 9, v7
v_lshl_add_u32 v7, v11, 7, v7
v_and_b32 v16, 7, v10
v_lshl_add_u32 v7, v16, 4, v7
v_add_u32 v7, s18, v7
v_lshrrev_b32 v15, 1, v11
v_lshlrev_b32 v15, 9, v15
v_and_b32 v16, 3, v0
v_lshl_add_u32 v15, v16, 7, v15
v_and_b32 v16, 1, v11
v_lshl_add_u32 v15, v16, 6, v15
v_bfe_u32 v16, v0, 2, 2
v_lshl_add_u32 v15, v16, 4, v15
v_add_u32 v15, s18, v15
v_lshrrev_b32 v3, 3, v10
v_lshlrev_b32 v3, 8, v3
v_lshl_add_u32 v3, v11, 6, v3
v_and_b32 v16, 7, v10
v_lshl_add_u32 v3, v16, 3, v3
v_add_u32 v3, s17, v3
v_lshrrev_b32 v4, 1, v11
v_lshlrev_b32 v4, 8, v4
v_and_b32 v16, 3, v0
v_lshl_add_u32 v4, v16, 6, v4
v_and_b32 v16, 1, v11
v_lshl_add_u32 v4, v16, 5, v4
v_bfe_u32 v16, v0, 2, 2
v_lshl_add_u32 v4, v16, 3, v4
v_add_u32 v4, s17, v4
v_lshrrev_b32 v5, 1, v11
v_lshlrev_b32 v5, 7, v5
v_and_b32 v16, 7, v0
v_lshl_add_u32 v5, v16, 4, v5
v_and_b32 v17, 1, v11
v_lshl_add_u32 v5, v17, 3, v5
s_mul_i32 s18, s13, 3200
s_add_u32 s18, s18, 0
v_add_u32 v16, v10, v11
v_and_b32 v17, 15, v16
v_lshlrev_b32 v13, 4, v17
v_lshl_add_u32 v13, v11, 8, v13
v_add_u32 v13, s18, v13
v_add_u32 v16, 4, v16
v_and_b32 v17, 15, v16
v_lshlrev_b32 v14, 4, v17
v_lshl_add_u32 v14, v11, 8, v14
v_add_u32 v14, s18, v14
v_add_u32 v14, 1024, v14
s_lshl_b32 s18, s13, 2
v_add_u32 v16, s18, v11
v_add_u32 v17, 2, v10
v_and_b32 v17, 3, v17
v_cmp_gt_u32 vcc, 2, v10
s_nop 1
v_cndmask_b32 v17, v17, v10, vcc
v_add_u32 v18, v16, v17
v_add_u32 v19, 4, v18
v_cndmask_b32 v18, v18, v19, vcc
v_lshlrev_b32 v6, 8, v17
v_add_u32 v19, 1024, v6
v_cndmask_b32 v6, v6, v19, vcc
v_cmp_le_u32 vcc, 6, v10
v_add_u32 v19, 8, v18
s_nop 0
v_cndmask_b32 v18, v18, v19, vcc
v_and_b32 v18, 15, v18
v_lshl_add_u32 v6, v18, 4, v6
v_add_u32 v6, 0, v6
v_cmp_gt_u32 vcc, 10, v10
v_mov_b32 v19, 3072
s_nop 0
v_cndmask_b32 v6, v19, v6, vcc
v_cmp_gt_u32 s[20:21], 10, v10
v_cmp_gt_u32 s[22:23], 40, v0
v_mov_b32 v9, 0x44444444
v_mov_b32 v18, 0xeeeeeeee
v_and_b32 v17, 8, v0
v_cmp_ne_u32 vcc, 0, v17
s_nop 1
v_cndmask_b32 v9, v9, v18, vcc
s_lshr_b32 s17, s12, 2
s_mul_i32 s17, s17, 2560
s_bfe_u32 s18, s12, 0x10001
s_lshl_b32 s15, s18, 10
s_lshl_b32 s16, s18, 8
s_and_b32 s18, s12, 1
s_lshl_b32 s25, s18, 9
s_add_u32 s15, s15, s25
s_lshl_b32 s25, s18, 7
s_add_u32 s16, s16, s25
s_add_u32 s16, s16, 2048
s_add_u32 s15, s15, s17
s_add_u32 s16, s16, s17
v_subrev_u32 v17, 2, v10
v_lshrrev_b32 v17, 1, v17
v_lshrrev_b32 v18, 1, v17
v_lshlrev_b32 v18, 8, v18
v_and_b32 v17, 1, v17
v_lshl_add_u32 v18, v17, 7, v18
v_add_u32 v18, s15, v18
v_mov_b32 v17, s16
v_cmp_gt_u32 vcc, 2, v10
s_nop 1
v_cndmask_b32 v18, v18, v17, vcc
v_lshl_add_u32 v8, v16, 4, v18
v_and_b32 v17, 1, v10
v_lshl_add_u32 v8, v17, 3, v8
v_add_u32 v17, s15, v1
v_add_u32 v18, s16, v1
v_subrev_u32 v18, 512, v18
v_cmp_gt_u32 vcc, 32, v0
s_nop 1
v_cndmask_b32 v0, v18, v17, vcc
s_lshr_b32 s17, s12, 2
s_lshl_b32 s17, s17, 7
s_and_b32 s18, s12, 3
s_lshl_b32 s18, s18, 2
s_add_u32 s50, s17, s18
s_add_u32 s50, s50, 44109952
s_mul_i32 s17, s12, 401408
s_mul_i32 s18, s13, 100352
s_add_u32 s17, s17, s18
s_lshl_b32 s15, s12, 2
s_add_u32 s15, s15, s13
s_lshl_b32 s15, s15, 7
s_add_u32 s15, s15, 44118656
v_min_u32 v16, 6, v0
v_lshlrev_b32 v16, 2, v16
buffer_load_dword v17, v16, s[8:11], s15 offen sc1
s_waitcnt vmcnt(0)
A_wp_27:
v_cmp_gt_u32 vcc, 7, v17
s_and_b32 vcc_lo, vcc_lo, 3
s_mov_b32 vcc_hi, 0
s_cbranch_vccz A_wpo_28
s_sleep 1
buffer_load_dword v17, v16, s[8:11], s15 offen sc1
s_waitcnt vmcnt(0)
s_sub_u32 s19, s19, 1
s_cbranch_scc0 A_wp_27
s_branch M_abort
A_wpo_28:
buffer_load_dwordx4 a[0:3], v1, s[8:11], s17 offen offset:0 sc1
buffer_load_dwordx4 a[4:7], v1, s[8:11], s17 offen offset:1024 sc1
buffer_load_dwordx4 a[8:11], v1, s[8:11], s17 offen offset:2048 sc1
buffer_load_dwordx4 a[12:15], v1, s[8:11], s17 offen offset:3072 sc1
s_add_u32 s17, s17, 4096
buffer_load_dwordx4 a[16:19], v1, s[8:11], s17 offen offset:0 sc1
buffer_load_dwordx4 a[20:23], v1, s[8:11], s17 offen offset:1024 sc1
buffer_load_dwordx4 a[24:27], v1, s[8:11], s17 offen offset:2048 sc1
buffer_load_dwordx4 a[28:31], v1, s[8:11], s17 offen offset:3072 sc1
s_add_u32 s17, s17, 4096
buffer_load_dwordx4 a[32:35], v1, s[8:11], s17 offen offset:0 sc1
buffer_load_dwordx4 a[36:39], v1, s[8:11], s17 offen offset:1024 sc1
buffer_load_dwordx4 a[40:43], v1, s[8:11], s17 offen offset:2048 sc1
buffer_load_dwordx4 a[44:47], v1, s[8:11], s17 offen offset:3072 sc1
s_add_u32 s17, s17, 4096
buffer_load_dwordx4 a[48:51], v1, s[8:11], s17 offen offset:0 sc1
buffer_load_dwordx4 a[52:55], v1, s[8:11], s17 offen offset:1024 sc1
buffer_load_dwordx4 a[56:59], v1, s[8:11], s17 offen offset:2048 sc1
buffer_load_dwordx4 a[60:63], v1, s[8:11], s17 offen offset:3072 sc1
s_add_u32 s17, s17, 4096
buffer_load_dwordx4 a[64:67], v1, s[8:11], s17 offen offset:0 sc1
buffer_load_dwordx4 a[68:71], v1, s[8:11], s17 offen offset:1024 sc1
buffer_load_dwordx4 a[72:75], v1, s[8:11], s17 offen offset:2048 sc1
buffer_load_dwordx4 a[76:79], v1, s[8:11], s17 offen offset:3072 sc1
buffer_load_dword v17, v16, s[8:11], s15 offen sc1
s_add_u32 s17, s17, 4096
buffer_load_dwordx4 a[80:83], v1, s[8:11], s17 offen offset:0 sc1
buffer_load_dwordx4 a[84:87], v1, s[8:11], s17 offen offset:1024 sc1
buffer_load_dwordx4 a[88:91], v1, s[8:11], s17 offen offset:2048 sc1
buffer_load_dwordx4 a[92:95], v1, s[8:11], s17 offen offset:3072 sc1
s_add_u32 s17, s17, 4096
buffer_load_dwordx4 a[96:99], v1, s[8:11], s17 offen offset:0 sc1
buffer_load_dwordx4 a[100:103], v1, s[8:11], s17 offen offset:1024 sc1
buffer_load_dwordx4 a[104:107], v1, s[8:11], s17 offen offset:2048 sc1
buffer_load_dwordx4 a[108:111], v1, s[8:11], s17 offen offset:3072 sc1
s_waitcnt vmcnt(8)
A_wp_29:
v_cmp_gt_u32 vcc, 7, v17
s_and_b32 vcc_lo, vcc_lo, 15
s_mov_b32 vcc_hi, 0
s_cbranch_vccz A_wpo_30
s_sleep 1
buffer_load_dword v17, v16, s[8:11], s15 offen sc1
s_waitcnt vmcnt(0)
s_sub_u32 s19, s19, 1
s_cbranch_scc0 A_wp_29
s_branch M_abort
A_wpo_30:
s_add_u32 s17, s17, 4096
buffer_load_dwordx4 a[112:115], v1, s[8:11], s17 offen offset:0 sc1
buffer_load_dwordx4 a[116:119], v1, s[8:11], s17 offen offset:1024 sc1
buffer_load_dwordx4 a[120:123], v1, s[8:11], s17 offen offset:2048 sc1
buffer_load_dwordx4 a[124:127], v1, s[8:11], s17 offen offset:3072 sc1
s_add_u32 s17, s17, 4096
buffer_load_dwordx4 a[128:131], v1, s[8:11], s17 offen offset:0 sc1
buffer_load_dwordx4 a[132:135], v1, s[8:11], s17 offen offset:1024 sc1
buffer_load_dwordx4 a[136:139], v1, s[8:11], s17 offen offset:2048 sc1
buffer_load_dwordx4 a[140:143], v1, s[8:11], s17 offen offset:3072 sc1
s_add_u32 s17, s17, 4096
buffer_load_dwordx4 a[144:147], v1, s[8:11], s17 offen offset:0 sc1
buffer_load_dwordx4 a[148:151], v1, s[8:11], s17 offen offset:1024 sc1
buffer_load_dwordx4 a[152:155], v1, s[8:11], s17 offen offset:2048 sc1
buffer_load_dwordx4 a[156:159], v1, s[8:11], s17 offen offset:3072 sc1
s_add_u32 s17, s17, 4096
buffer_load_dwordx4 a[160:163], v1, s[8:11], s17 offen offset:0 sc1
buffer_load_dwordx4 a[164:167], v1, s[8:11], s17 offen offset:1024 sc1
buffer_load_dwordx4 a[168:171], v1, s[8:11], s17 offen offset:2048 sc1
buffer_load_dwordx4 a[172:175], v1, s[8:11], s17 offen offset:3072 sc1
s_add_u32 s17, s17, 4096
buffer_load_dwordx4 a[176:179], v1, s[8:11], s17 offen offset:0 sc1
buffer_load_dwordx4 a[180:183], v1, s[8:11], s17 offen offset:1024 sc1
buffer_load_dwordx4 a[184:187], v1, s[8:11], s17 offen offset:2048 sc1
buffer_load_dwordx4 a[188:191], v1, s[8:11], s17 offen offset:3072 sc1
buffer_load_dword v17, v16, s[8:11], s15 offen sc1
s_add_u32 s17, s17, 4096
buffer_load_dwordx4 a[192:195], v1, s[8:11], s17 offen offset:0 sc1
buffer_load_dwordx4 a[196:199], v1, s[8:11], s17 offen offset:1024 sc1
buffer_load_dwordx4 a[200:203], v1, s[8:11], s17 offen offset:2048 sc1
buffer_load_dwordx4 a[204:207], v1, s[8:11], s17 offen offset:3072 sc1
s_add_u32 s17, s17, 4096
buffer_load_dwordx4 a[208:211], v1, s[8:11], s17 offen offset:0 sc1
buffer_load_dwordx4 a[212:215], v1, s[8:11], s17 offen offset:1024 sc1
buffer_load_dwordx4 a[216:219], v1, s[8:11], s17 offen offset:2048 sc1
buffer_load_dwordx4 a[220:223], v1, s[8:11], s17 offen offset:3072 sc1
s_waitcnt vmcnt(8)
A_wp_31:
v_cmp_gt_u32 vcc, 7, v17
s_and_b32 vcc_lo, vcc_lo, 127
s_mov_b32 vcc_hi, 0
s_cbranch_vccz A_wpo_32
s_sleep 1
buffer_load_dword v17, v16, s[8:11], s15 offen sc1
s_waitcnt vmcnt(0)
s_sub_u32 s19, s19, 1
s_cbranch_scc0 A_wp_31
s_branch M_abort
A_wpo_32:
s_add_u32 s17, s17, 4096
buffer_load_dwordx4 v[88:91], v1, s[8:11], s17 offen offset:0 sc1
buffer_load_dwordx4 v[92:95], v1, s[8:11], s17 offen offset:1024 sc1
buffer_load_dwordx4 v[96:99], v1, s[8:11], s17 offen offset:2048 sc1
buffer_load_dwordx4 v[100:103], v1, s[8:11], s17 offen offset:3072 sc1
s_add_u32 s17, s17, 4096
buffer_load_dwordx4 v[104:107], v1, s[8:11], s17 offen offset:0 sc1
buffer_load_dwordx4 v[108:111], v1, s[8:11], s17 offen offset:1024 sc1
buffer_load_dwordx4 v[112:115], v1, s[8:11], s17 offen offset:2048 sc1
buffer_load_dwordx4 v[116:119], v1, s[8:11], s17 offen offset:3072 sc1
s_add_u32 s17, s17, 4096
buffer_load_dwordx4 v[120:123], v1, s[8:11], s17 offen offset:0 sc1
buffer_load_dwordx4 v[124:127], v1, s[8:11], s17 offen offset:1024 sc1
buffer_load_dwordx4 v[128:131], v1, s[8:11], s17 offen offset:2048 sc1
buffer_load_dwordx4 v[132:135], v1, s[8:11], s17 offen offset:3072 sc1
s_add_u32 s17, s17, 4096
buffer_load_dwordx4 v[136:139], v1, s[8:11], s17 offen offset:0 sc1
buffer_load_dwordx4 v[140:143], v1, s[8:11], s17 offen offset:1024 sc1
buffer_load_dwordx4 v[144:147], v1, s[8:11], s17 offen offset:2048 sc1
buffer_load_dwordx4 v[148:151], v1, s[8:11], s17 offen offset:3072 sc1
s_add_u32 s17, s17, 4096
buffer_load_dwordx4 v[152:155], v1, s[8:11], s17 offen offset:0 sc1
buffer_load_dwordx4 v[156:159], v1, s[8:11], s17 offen offset:1024 sc1
buffer_load_dwordx4 v[160:163], v1, s[8:11], s17 offen offset:2048 sc1
buffer_load_dwordx4 v[164:167], v1, s[8:11], s17 offen offset:3072 sc1
s_add_u32 s17, s17, 4096
buffer_load_dwordx4 v[168:171], v1, s[8:11], s17 offen offset:0 sc1
buffer_load_dwordx4 v[172:175], v1, s[8:11], s17 offen offset:1024 sc1
buffer_load_dwordx4 v[176:179], v1, s[8:11], s17 offen offset:2048 sc1
buffer_load_dwordx4 v[180:183], v1, s[8:11], s17 offen offset:3072 sc1
s_add_u32 s17, s17, 4096
buffer_load_dwordx4 v[184:187], v1, s[8:11], s17 offen offset:0 sc1
buffer_load_dwordx4 v[188:191], v1, s[8:11], s17 offen offset:1024 sc1
buffer_load_dwordx4 v[192:195], v1, s[8:11], s17 offen offset:2048 sc1
buffer_load_dwordx4 v[196:199], v1, s[8:11], s17 offen offset:3072 sc1
s_add_u32 s17, s17, 4096
buffer_load_dwordx4 v[200:203], v1, s[8:11], s17 offen offset:0 sc1
buffer_load_dwordx4 v[204:207], v1, s[8:11], s17 offen offset:1024 sc1
buffer_load_dwordx4 v[208:211], v1, s[8:11], s17 offen offset:2048 sc1
buffer_load_dwordx4 v[212:215], v1, s[8:11], s17 offen offset:3072 sc1
s_add_u32 s17, s17, 4096
buffer_load_dwordx4 v[216:219], v1, s[8:11], s17 offen offset:0 sc1
buffer_load_dwordx4 v[220:223], v1, s[8:11], s17 offen offset:1024 sc1
buffer_load_dwordx4 v[224:227], v1, s[8:11], s17 offen offset:2048 sc1
buffer_load_dwordx4 v[228:231], v1, s[8:11], s17 offen offset:3072 sc1
s_add_u32 s17, s17, 4096
buffer_load_dwordx4 v[232:235], v1, s[8:11], s17 offen offset:0 sc1
buffer_load_dwordx4 v[236:239], v1, s[8:11], s17 offen offset:1024 sc1
buffer_load_dwordx4 v[240:243], v1, s[8:11], s17 offen offset:2048 sc1
buffer_load_dwordx4 v[244:247], v1, s[8:11], s17 offen offset:3072 sc1
s_add_u32 s17, s17, 4096
buffer_load_dwordx4 v[248:251], v1, s[8:11], s17 offen offset:0 sc1
buffer_load_dwordx4 v[252:255], v1, s[8:11], s17 offen offset:1024 sc1
s_mov_b32 s15, 44111616
v_mov_b32 v16, 0
A_ln_33:
buffer_load_dword v17, v16, s[8:11], s15 offen sc1
s_waitcnt vmcnt(0)
v_cmp_gt_u32 vcc, 64, v17
s_cbranch_vccz A_lno_34
s_sleep 1
s_sub_u32 s19, s19, 1
s_cbranch_scc0 A_ln_33
s_branch M_abort
A_lno_34:
s_mul_i32 s24, s13, 7168
s_add_u32 s24, s24, 42205184
buffer_load_dwordx4 a[224:227], v1, s[8:11], s24 offen offset:0 sc1
buffer_load_dwordx4 a[228:231], v1, s[8:11], s24 offen offset:1024 sc1
buffer_load_dwordx4 a[232:235], v1, s[8:11], s24 offen offset:2048 sc1
buffer_load_dwordx2 a[236:237], v2, s[8:11], s24 offen offset:3072 sc1
buffer_load_dwordx4 a[238:241], v1, s[8:11], s24 offen offset:3584 sc1
s_add_u32 s18, s24, 4096
buffer_load_dwordx4 a[242:245], v1, s[8:11], s18 offen offset:512 sc1
buffer_load_dwordx4 a[246:249], v1, s[8:11], s18 offen offset:1536 sc1
buffer_load_dwordx2 a[250:251], v2, s[8:11], s18 offen offset:2560 sc1
v_mov_b64 v[20:21], 0
v_mov_b64 v[22:23], 0
v_mov_b64 v[24:25], 0
v_mov_b64 v[26:27], 0
v_mov_b64 v[28:29], 0
v_mov_b64 v[30:31], 0
v_mov_b64 v[32:33], 0
v_mov_b64 v[34:35], 0
v_mov_b64 v[36:37], 0
v_mov_b64 v[38:39], 0
v_mov_b64 v[40:41], 0
v_mov_b64 v[42:43], 0
v_mov_b64 v[44:45], 0
v_mov_b64 v[46:47], 0
v_mov_b32 v48, 0xff800000
v_mov_b32 v49, 0xff800000
v_mov_b32 v50, 0xff800000
v_mov_b32 v51, 0xff800000
s_mul_i32 s18, s13, 3200
s_add_u32 s18, s18, 3072
v_mov_b32 v16, s18
ds_write_b128 v16, v[48:51]
s_waitcnt vmcnt(0) lgkmcnt(0)
s_mov_b32 s14, 0
s_mov_b32 s15, 44040192
s_mov_b32 s16, 44068864
M_md_35:
v_mbcnt_lo_u32_b32 v48, -1, 0
v_mbcnt_hi_u32_b32 v48, -1, v48
v_and_b32 v48, 7, v48
v_lshlrev_b32 v48, 5, v48
global_load_dword v49, v48, s[4:5] sc1
s_waitcnt vmcnt(0)
v_readlane_b32 s18, v49, 0
v_readlane_b32 s17, v49, 1
s_add_u32 s18, s18, s17
v_readlane_b32 s17, v49, 2
s_add_u32 s18, s18, s17
v_readlane_b32 s17, v49, 3
s_add_u32 s18, s18, s17
v_readlane_b32 s17, v49, 4
s_add_u32 s18, s18, s17
v_readlane_b32 s17, v49, 5
s_add_u32 s18, s18, s17
v_readlane_b32 s17, v49, 6
s_add_u32 s18, s18, s17
v_readlane_b32 s17, v49, 7
s_add_u32 s18, s18, s17
v_readlane_b32 s17, v49, 0
s_mov_b32 s51, 0
s_cmp_ge_u32 s17, 32
s_cbranch_scc1 M_mdd_36
s_mov_b32 s51, 1
s_cmp_ge_u32 s18, 256
s_cbranch_scc1 M_mdd_36
s_sleep 4
s_sub_u32 s19, s19, 1
s_cbranch_scc0 M_md_35
s_branch M_abort
M_mdd_36:
s_cmp_eq_u32 s51, 1
s_cbranch_scc1 A_m_38
A_m_37:
s_cmp_eq_u32 s13, 1
s_cbranch_scc1 A_w_40
s_cmp_eq_u32 s13, 2
s_cbranch_scc1 A_w_41
s_cmp_eq_u32 s13, 3
s_cbranch_scc1 A_w_42
A_w_39:
A_loop_43:
s_barrier
buffer_load_dwordx4 v[60:63], v1, s[8:11], s15 offen offset:0 sc1
s_add_u32 s25, s15, 4096
v_mov_b64 v[20:21], 0
v_mov_b64 v[22:23], 0
v_mov_b64 v[24:25], 0
v_mov_b64 v[26:27], 0
v_mov_b64 v[28:29], 0
v_mov_b64 v[30:31], 0
v_mov_b64 v[32:33], 0
s_nop 0
s_nop 0
s_nop 0
buffer_load_dwordx4 v[64:67], v1, s[8:11], s15 offen offset:1024 sc1
v_mov_b64 v[34:35], 0
v_mov_b64 v[36:37], 0
v_mov_b64 v[38:39], 0
v_mov_b64 v[40:41], 0
v_mov_b64 v[42:43], 0
v_mov_b64 v[44:45], 0
v_mov_b64 v[46:47], 0
s_nop 0
s_nop 0
s_nop 0
buffer_load_dwordx4 v[68:71], v1, s[8:11], s15 offen offset:2048 sc1
s_nop 10
buffer_load_dwordx4 v[72:75], v1, s[8:11], s15 offen offset:3072 sc1
s_nop 10
buffer_load_dwordx4 v[76:79], v1, s[8:11], s25 offen offset:0 sc1
s_waitcnt vmcnt(4)
v_smfmac_f32_16x16x64_bf16 v[20:23], v[60:63], a[0:7], v9
buffer_load_dwordx4 v[80:83], v1, s[8:11], s25 offen offset:1024 sc1
v_smfmac_f32_16x16x64_bf16 v[24:27], v[60:63], a[56:63], v9
v_max_u32 v10, v60, v61
v_smfmac_f32_16x16x64_bf16 v[28:31], v[60:63], a[112:119], v9
v_max3_u32 v10, v10, v62, v63
v_smfmac_f32_16x16x64_bf16 v[32:35], v[60:63], a[168:175], v9
ds_write_b128 v1, v[60:63] offset:27136
s_waitcnt vmcnt(4)
v_smfmac_f32_16x16x64_bf16 v[20:23], v[64:67], a[8:15], v9
buffer_load_dwordx4 v[84:87], v1, s[8:11], s25 offen offset:2048 sc1
v_smfmac_f32_16x16x64_bf16 v[24:27], v[64:67], a[64:71], v9
v_max3_u32 v10, v10, v64, v65
v_smfmac_f32_16x16x64_bf16 v[28:31], v[64:67], a[120:127], v9
v_max3_u32 v10, v10, v66, v67
v_smfmac_f32_16x16x64_bf16 v[32:35], v[64:67], a[176:183], v9
ds_write_b128 v1, v[64:67] offset:28160
s_waitcnt vmcnt(4)
v_smfmac_f32_16x16x64_bf16 v[20:23], v[68:71], a[16:23], v9
v_max3_u32 v10, v10, v68, v69
v_smfmac_f32_16x16x64_bf16 v[24:27], v[68:71], a[72:79], v9
v_max3_u32 v10, v10, v70, v71
v_smfmac_f32_16x16x64_bf16 v[28:31], v[68:71], a[128:135], v9
v_smfmac_f32_16x16x64_bf16 v[32:35], v[68:71], a[184:191], v9
s_waitcnt vmcnt(3)
v_smfmac_f32_16x16x64_bf16 v[20:23], v[72:75], a[24:31], v9
v_max3_u32 v10, v10, v72, v73
v_smfmac_f32_16x16x64_bf16 v[24:27], v[72:75], a[80:87], v9
v_max3_u32 v10, v10, v74, v75
v_smfmac_f32_16x16x64_bf16 v[28:31], v[72:75], a[136:143], v9
v_smfmac_f32_16x16x64_bf16 v[32:35], v[72:75], a[192:199], v9
s_waitcnt vmcnt(2)
v_smfmac_f32_16x16x64_bf16 v[20:23], v[76:79], a[32:39], v9
v_max3_u32 v10, v10, v76, v77
v_smfmac_f32_16x16x64_bf16 v[24:27], v[76:79], a[88:95], v9
v_max3_u32 v10, v10, v78, v79
v_smfmac_f32_16x16x64_bf16 v[28:31], v[76:79], a[144:151], v9
v_smfmac_f32_16x16x64_bf16 v[32:35], v[76:79], a[200:207], v9
s_waitcnt vmcnt(1)
v_smfmac_f32_16x16x64_bf16 v[20:23], v[80:83], a[40:47], v9
v_max3_u32 v10, v10, v80, v81
v_smfmac_f32_16x16x64_bf16 v[24:27], v[80:83], a[96:103], v9
v_max3_u32 v10, v10, v82, v83
v_smfmac_f32_16x16x64_bf16 v[28:31], v[80:83], a[152:159], v9
v_smfmac_f32_16x16x64_bf16 v[32:35], v[80:83], a[208:215], v9
s_waitcnt vmcnt(0)
v_smfmac_f32_16x16x64_bf16 v[20:23], v[84:87], a[48:55], v9
v_max3_u32 v10, v10, v84, v85
v_smfmac_f32_16x16x64_bf16 v[24:27], v[84:87], a[104:111], v9
v_max3_u32 v10, v10, v86, v87
v_smfmac_f32_16x16x64_bf16 v[28:31], v[84:87], a[160:167], v9
v_cmp_eq_u32 vcc, -1, v10
v_smfmac_f32_16x16x64_bf16 v[32:35], v[84:87], a[216:223], v9
v_cvt_pk_bf16_f32 v16, v20, v21
s_cbranch_vccnz A_retry_45
A_again_44:
v_smfmac_f32_16x16x64_bf16 v[36:39], v[60:63], v[88:95], v9
v_cvt_pk_bf16_f32 v17, v22, v23
v_smfmac_f32_16x16x64_bf16 v[36:39], v[64:67], v[96:103], v9
ds_write_b64 v3, v[16:17] offset:0
v_smfmac_f32_16x16x64_bf16 v[36:39], v[68:71], v[104:111], v9
ds_read_b64_tr_b16 v[48:49], v4 offset:0
v_smfmac_f32_16x16x64_bf16 v[36:39], v[72:75], v[112:119], v9
v_cvt_pk_bf16_f32 v18, v24, v25
v_smfmac_f32_16x16x64_bf16 v[36:39], v[76:79], v[120:127], v9
v_cvt_pk_bf16_f32 v19, v26, v27
v_smfmac_f32_16x16x64_bf16 v[36:39], v[80:83], v[128:135], v9
ds_write_b64 v3, v[18:19] offset:512
v_smfmac_f32_16x16x64_bf16 v[36:39], v[84:87], v[136:143], v9
ds_read_b64_tr_b16 v[50:51], v4 offset:512
v_smfmac_f32_16x16x64_bf16 v[40:43], v[60:63], v[144:151], v9
v_cvt_pk_bf16_f32 v16, v28, v29
v_smfmac_f32_16x16x64_bf16 v[40:43], v[64:67], v[152:159], v9
v_cvt_pk_bf16_f32 v17, v30, v31
v_smfmac_f32_16x16x64_bf16 v[40:43], v[68:71], v[160:167], v9
ds_write_b64 v3, v[16:17] offset:1024
v_smfmac_f32_16x16x64_bf16 v[40:43], v[72:75], v[168:175], v9
ds_read_b64_tr_b16 v[52:53], v4 offset:1024
v_smfmac_f32_16x16x64_bf16 v[40:43], v[76:79], v[176:183], v9
v_cvt_pk_bf16_f32 v18, v32, v33
v_smfmac_f32_16x16x64_bf16 v[40:43], v[80:83], v[184:191], v9
v_cvt_pk_bf16_f32 v19, v34, v35
v_smfmac_f32_16x16x64_bf16 v[40:43], v[84:87], v[192:199], v9
ds_write_b64 v3, v[18:19] offset:1536
v_smfmac_f32_16x16x64_bf16 v[44:47], v[60:63], v[200:207], v9
ds_read_b64_tr_b16 v[54:55], v4 offset:1536
v_smfmac_f32_16x16x64_bf16 v[44:47], v[64:67], v[208:215], v9
v_cvt_pk_bf16_f32 v16, v36, v37
v_smfmac_f32_16x16x64_bf16 v[44:47], v[68:71], v[216:223], v9
v_cvt_pk_bf16_f32 v17, v38, v39
v_smfmac_f32_16x16x64_bf16 v[44:47], v[72:75], v[224:231], v9
ds_write_b64 v3, v[16:17] offset:2048
v_smfmac_f32_16x16x64_bf16 v[44:47], v[76:79], v[232:239], v9
ds_read_b64_tr_b16 v[56:57], v4 offset:2048
v_smfmac_f32_16x16x64_bf16 v[44:47], v[80:83], v[240:247], v9
v_cvt_pk_bf16_f32 v18, v40, v41
v_smfmac_f32_16x16x64_bf16 v[44:47], v[84:87], v[248:255], v9
v_cvt_pk_bf16_f32 v19, v42, v43
ds_write_b64 v3, v[18:19] offset:2560
ds_read_b64_tr_b16 v[58:59], v4 offset:2560
s_waitcnt lgkmcnt(4)
v_mfma_f32_16x16x32_bf16 v[20:23], a[224:227], v[48:51], 0
ds_read_b64 v[60:61], v5 offset:27136
ds_read_b64 v[62:63], v5 offset:27392
v_mfma_f32_16x16x32_bf16 v[24:27], a[238:241], v[48:51], 0
ds_read_b64 v[64:65], v5 offset:27648
ds_read_b64 v[66:67], v5 offset:27904
v_mfma_f32_16x16x32_bf16 v[20:23], a[228:231], v[52:55], v[20:23]
v_cvt_pk_bf16_f32 v16, v44, v45
v_cvt_pk_bf16_f32 v17, v46, v47
v_mfma_f32_16x16x32_bf16 v[24:27], a[242:245], v[52:55], v[24:27]
ds_write_b64 v3, v[16:17] offset:3072
ds_read_b64_tr_b16 a[252:253], v4 offset:3072
s_waitcnt lgkmcnt(6)
v_mfma_f32_16x16x32_bf16 v[20:23], a[232:235], v[56:59], v[20:23]
ds_read_b64 v[68:69], v5 offset:28160
ds_read_b64 v[70:71], v5 offset:28416
v_mfma_f32_16x16x32_bf16 v[24:27], a[246:249], v[56:59], v[24:27]
ds_read_b64 v[72:73], v5 offset:28672
s_waitcnt lgkmcnt(5)
v_mfma_f32_16x16x32_bf16 v[28:31], v[60:63], v[48:51], 0
v_mfma_f32_16x16x32_bf16 v[28:31], v[64:67], v[52:55], v[28:31]
s_waitcnt lgkmcnt(1)
v_mfma_f32_16x16x32_bf16 v[28:31], v[68:71], v[56:59], v[28:31]
v_mfma_f32_16x16x16_bf16 v[20:23], a[236:237], a[252:253], v[20:23]
v_mfma_f32_16x16x16_bf16 v[24:27], a[250:251], a[252:253], v[24:27]
s_waitcnt lgkmcnt(0)
v_mfma_f32_16x16x16_bf16 v[28:31], v[72:73], a[252:253], v[28:31]
s_add_u32 s24, s24, 28672
s_nop 3
v_add_f32_dpp v20, v20, v20 row_ror:8 row_mask:0xf bank_mask:0x3
v_add_f32_dpp v21, v21, v21 row_ror:8 row_mask:0xf bank_mask:0x3
v_add_f32_dpp v22, v22, v22 row_ror:8 row_mask:0xf bank_mask:0x3
v_add_f32_dpp v23, v23, v23 row_ror:8 row_mask:0xf bank_mask:0x3
v_add_f32_dpp v20, v24, v24 row_ror:8 row_mask:0xf bank_mask:0xc
v_add_f32_dpp v21, v25, v25 row_ror:8 row_mask:0xf bank_mask:0xc
v_add_f32_dpp v22, v26, v26 row_ror:8 row_mask:0xf bank_mask:0xc
v_add_f32_dpp v23, v27, v27 row_ror:8 row_mask:0xf bank_mask:0xc
ds_write_b128 v13, v[20:23]
v_add_f32_dpp v28, v28, v28 row_ror:8 row_mask:0xf bank_mask:0xf
v_add_f32_dpp v29, v29, v29 row_ror:8 row_mask:0xf bank_mask:0xf
v_add_f32_dpp v30, v30, v30 row_ror:8 row_mask:0xf bank_mask:0xf
v_add_f32_dpp v31, v31, v31 row_ror:8 row_mask:0xf bank_mask:0xf
ds_write_b128 v14, v[28:31]
s_waitcnt lgkmcnt(0)
s_barrier
ds_read_b128 v[48:51], v6 offset:0
ds_read_b128 v[60:63], v6 offset:3200
ds_read_b128 v[64:67], v6 offset:6400
ds_read_b128 v[68:71], v6 offset:9600
s_waitcnt lgkmcnt(2)
v_pk_add_f32 v[48:49], v[48:49], v[60:61]
v_pk_add_f32 v[50:51], v[50:51], v[62:63]
s_waitcnt lgkmcnt(0)
v_pk_add_f32 v[64:65], v[64:65], v[68:69]
v_pk_add_f32 v[66:67], v[66:67], v[70:71]
v_pk_add_f32 v[48:49], v[48:49], v[64:65]
v_pk_add_f32 v[50:51], v[50:51], v[66:67]
v_max3_f32 v10, v48, v49, v50
v_max_f32 v10, v10, v51
s_nop 1
v_max_f32_dpp v10, v10, v10 row_ror:8 row_mask:0xf bank_mask:0xf
s_nop 1
v_max_f32_dpp v10, v10, v10 row_ror:4 row_mask:0xf bank_mask:0xf
s_nop 1
v_max_f32_dpp v10, v10, v10 row_ror:2 row_mask:0xf bank_mask:0xf
s_nop 1
v_max_f32_dpp v10, v10, v10 row_ror:1 row_mask:0xf bank_mask:0xf
s_add_u32 s17, s14, 1
v_mov_b32 v16, s17
v_mov_b32 v17, 0
s_mov_b64 exec, 1
buffer_store_dword v16, v17, s[8:11], s50 offen
s_mov_b64 exec, -1
v_pk_add_f32 v[48:49], v[48:49], v[10:11] op_sel_hi:[1,0] neg_lo:[0,1] neg_hi:[0,1]
v_pk_add_f32 v[50:51], v[50:51], v[10:11] op_sel_hi:[1,0] neg_lo:[0,1] neg_hi:[0,1]
v_exp_f32 v48, v48
v_exp_f32 v49, v49
v_exp_f32 v50, v50
v_exp_f32 v51, v51
s_nop 0
v_pk_add_f32 v[18:19], v[48:49], v[50:51]
v_add_f32 v72, v18, v19
s_nop 1
v_add_f32_dpp v72, v72, v72 row_ror:8 row_mask:0xf bank_mask:0xf
s_nop 1
v_add_f32_dpp v72, v72, v72 row_ror:4 row_mask:0xf bank_mask:0xf
s_nop 1
v_add_f32_dpp v72, v72, v72 row_ror:2 row_mask:0xf bank_mask:0xf
s_nop 1
v_add_f32_dpp v72, v72, v72 row_ror:1 row_mask:0xf bank_mask:0xf
v_rcp_f32 v72, v72
s_nop 0
v_pk_mul_f32 v[48:49], v[48:49], v[72:73] op_sel_hi:[1,0]
v_pk_mul_f32 v[50:51], v[50:51], v[72:73] op_sel_hi:[1,0]
v_cvt_pk_bf16_f32 v48, v48, v49
v_cvt_pk_bf16_f32 v49, v50, v51
v_min_u32 v48, -2, v48
v_min_u32 v49, -2, v49
s_mov_b64 exec, s[20:21]
buffer_store_dwordx2 v[48:49], v8, s[8:11], s16 offen
s_mov_b64 exec, -1
s_barrier
buffer_load_dwordx4 a[224:227], v1, s[8:11], s24 offen offset:0 sc1
buffer_load_dwordx4 a[228:231], v1, s[8:11], s24 offen offset:1024 sc1
buffer_load_dwordx4 a[232:235], v1, s[8:11], s24 offen offset:2048 sc1
buffer_load_dwordx2 a[236:237], v2, s[8:11], s24 offen offset:3072 sc1
buffer_load_dwordx4 a[238:241], v1, s[8:11], s24 offen offset:3584 sc1
s_add_u32 s18, s24, 4096
buffer_load_dwordx4 a[242:245], v1, s[8:11], s18 offen offset:512 sc1
buffer_load_dwordx4 a[246:249], v1, s[8:11], s18 offen offset:1536 sc1
buffer_load_dwordx2 a[250:251], v2, s[8:11], s18 offen offset:2560 sc1
s_add_u32 s14, s14, 1
s_and_b32 s17, s14, 3
s_mul_i32 s15, s17, 7168
s_add_u32 s15, s15, 44040192
s_mul_i32 s16, s17, 10240
s_add_u32 s16, s16, 44068864
s_waitcnt vmcnt(0)
s_cmp_lt_u32 s14, 63
s_cbranch_scc1 A_loop_43
s_endpgm
A_w_40:
A_loop_48:
s_barrier
buffer_load_dwordx4 v[68:71], v1, s[8:11], s15 offen offset:2048 sc1
s_add_u32 s25, s15, 4096
v_mov_b64 v[20:21], 0
v_mov_b64 v[22:23], 0
v_mov_b64 v[24:25], 0
v_mov_b64 v[26:27], 0
v_mov_b64 v[28:29], 0
v_mov_b64 v[30:31], 0
v_mov_b64 v[32:33], 0
s_nop 0
s_nop 0
s_nop 0
buffer_load_dwordx4 v[72:75], v1, s[8:11], s15 offen offset:3072 sc1
v_mov_b64 v[34:35], 0
v_mov_b64 v[36:37], 0
v_mov_b64 v[38:39], 0
v_mov_b64 v[40:41], 0
v_mov_b64 v[42:43], 0
v_mov_b64 v[44:45], 0
v_mov_b64 v[46:47], 0
s_nop 0
s_nop 0
s_nop 0
buffer_load_dwordx4 v[76:79], v1, s[8:11], s25 offen offset:0 sc1
s_nop 10
buffer_load_dwordx4 v[80:83], v1, s[8:11], s25 offen offset:1024 sc1
s_nop 10
buffer_load_dwordx4 v[84:87], v1, s[8:11], s25 offen offset:2048 sc1
s_waitcnt vmcnt(4)
v_smfmac_f32_16x16x64_bf16 v[20:23], v[68:71], a[16:23], v9
buffer_load_dwordx4 v[60:63], v1, s[8:11], s15 offen offset:0 sc1
v_smfmac_f32_16x16x64_bf16 v[24:27], v[68:71], a[72:79], v9
v_max_u32 v10, v68, v69
v_smfmac_f32_16x16x64_bf16 v[28:31], v[68:71], a[128:135], v9
v_max3_u32 v10, v10, v70, v71
v_smfmac_f32_16x16x64_bf16 v[32:35], v[68:71], a[184:191], v9
ds_write_b128 v1, v[68:71] offset:31232
s_waitcnt vmcnt(4)
v_smfmac_f32_16x16x64_bf16 v[20:23], v[72:75], a[24:31], v9
buffer_load_dwordx4 v[64:67], v1, s[8:11], s15 offen offset:1024 sc1
v_smfmac_f32_16x16x64_bf16 v[24:27], v[72:75], a[80:87], v9
v_max3_u32 v10, v10, v72, v73
v_smfmac_f32_16x16x64_bf16 v[28:31], v[72:75], a[136:143], v9
v_max3_u32 v10, v10, v74, v75
v_smfmac_f32_16x16x64_bf16 v[32:35], v[72:75], a[192:199], v9
ds_write_b128 v1, v[72:75] offset:32256
s_waitcnt vmcnt(4)
v_smfmac_f32_16x16x64_bf16 v[20:23], v[76:79], a[32:39], v9
v_max3_u32 v10, v10, v76, v77
v_smfmac_f32_16x16x64_bf16 v[24:27], v[76:79], a[88:95], v9
v_max3_u32 v10, v10, v78, v79
v_smfmac_f32_16x16x64_bf16 v[28:31], v[76:79], a[144:151], v9
v_smfmac_f32_16x16x64_bf16 v[32:35], v[76:79], a[200:207], v9
s_waitcnt vmcnt(3)
v_smfmac_f32_16x16x64_bf16 v[20:23], v[80:83], a[40:47], v9
v_max3_u32 v10, v10, v80, v81
v_smfmac_f32_16x16x64_bf16 v[24:27], v[80:83], a[96:103], v9
v_max3_u32 v10, v10, v82, v83
v_smfmac_f32_16x16x64_bf16 v[28:31], v[80:83], a[152:159], v9
v_smfmac_f32_16x16x64_bf16 v[32:35], v[80:83], a[208:215], v9
s_waitcnt vmcnt(2)
v_smfmac_f32_16x16x64_bf16 v[20:23], v[84:87], a[48:55], v9
v_max3_u32 v10, v10, v84, v85
v_smfmac_f32_16x16x64_bf16 v[24:27], v[84:87], a[104:111], v9
v_max3_u32 v10, v10, v86, v87
v_smfmac_f32_16x16x64_bf16 v[28:31], v[84:87], a[160:167], v9
v_smfmac_f32_16x16x64_bf16 v[32:35], v[84:87], a[216:223], v9
s_waitcnt vmcnt(1)
v_smfmac_f32_16x16x64_bf16 v[20:23], v[60:63], a[0:7], v9
v_max3_u32 v10, v10, v60, v61
v_smfmac_f32_16x16x64_bf16 v[24:27], v[60:63], a[56:63], v9
v_max3_u32 v10, v10, v62, v63
v_smfmac_f32_16x16x64_bf16 v[28:31], v[60:63], a[112:119], v9
v_smfmac_f32_16x16x64_bf16 v[32:35], v[60:63], a[168:175], v9
s_waitcnt vmcnt(0)
v_smfmac_f32_16x16x64_bf16 v[20:23], v[64:67], a[8:15], v9
v_max3_u32 v10, v10, v64, v65
v_smfmac_f32_16x16x64_bf16 v[24:27], v[64:67], a[64:71], v9
v_max3_u32 v10, v10, v66, v67
v_smfmac_f32_16x16x64_bf16 v[28:31], v[64:67], a[120:127], v9
v_cmp_eq_u32 vcc, -1, v10
v_smfmac_f32_16x16x64_bf16 v[32:35], v[64:67], a[176:183], v9
ds_write_b128 v1, v[64:67] offset:30208
v_cvt_pk_bf16_f32 v16, v20, v21
s_cbranch_vccnz A_retry_50
A_again_49:
v_smfmac_f32_16x16x64_bf16 v[36:39], v[60:63], v[88:95], v9
v_cvt_pk_bf16_f32 v17, v22, v23
v_smfmac_f32_16x16x64_bf16 v[36:39], v[64:67], v[96:103], v9
ds_write_b64 v3, v[16:17] offset:0
v_smfmac_f32_16x16x64_bf16 v[36:39], v[68:71], v[104:111], v9
ds_read_b64_tr_b16 v[48:49], v4 offset:0
v_smfmac_f32_16x16x64_bf16 v[36:39], v[72:75], v[112:119], v9
v_cvt_pk_bf16_f32 v18, v24, v25
v_smfmac_f32_16x16x64_bf16 v[36:39], v[76:79], v[120:127], v9
v_cvt_pk_bf16_f32 v19, v26, v27
v_smfmac_f32_16x16x64_bf16 v[36:39], v[80:83], v[128:135], v9
ds_write_b64 v3, v[18:19] offset:512
v_smfmac_f32_16x16x64_bf16 v[36:39], v[84:87], v[136:143], v9
ds_read_b64_tr_b16 v[50:51], v4 offset:512
v_smfmac_f32_16x16x64_bf16 v[40:43], v[60:63], v[144:151], v9
v_cvt_pk_bf16_f32 v16, v28, v29
v_smfmac_f32_16x16x64_bf16 v[40:43], v[64:67], v[152:159], v9
v_cvt_pk_bf16_f32 v17, v30, v31
v_smfmac_f32_16x16x64_bf16 v[40:43], v[68:71], v[160:167], v9
ds_write_b64 v3, v[16:17] offset:1024
v_smfmac_f32_16x16x64_bf16 v[40:43], v[72:75], v[168:175], v9
ds_read_b64_tr_b16 v[52:53], v4 offset:1024
v_smfmac_f32_16x16x64_bf16 v[40:43], v[76:79], v[176:183], v9
v_cvt_pk_bf16_f32 v18, v32, v33
v_smfmac_f32_16x16x64_bf16 v[40:43], v[80:83], v[184:191], v9
v_cvt_pk_bf16_f32 v19, v34, v35
v_smfmac_f32_16x16x64_bf16 v[40:43], v[84:87], v[192:199], v9
ds_write_b64 v3, v[18:19] offset:1536
v_smfmac_f32_16x16x64_bf16 v[44:47], v[60:63], v[200:207], v9
ds_read_b64_tr_b16 v[54:55], v4 offset:1536
v_smfmac_f32_16x16x64_bf16 v[44:47], v[64:67], v[208:215], v9
v_cvt_pk_bf16_f32 v16, v36, v37
v_smfmac_f32_16x16x64_bf16 v[44:47], v[68:71], v[216:223], v9
v_cvt_pk_bf16_f32 v17, v38, v39
v_smfmac_f32_16x16x64_bf16 v[44:47], v[72:75], v[224:231], v9
ds_write_b64 v3, v[16:17] offset:2048
v_smfmac_f32_16x16x64_bf16 v[44:47], v[76:79], v[232:239], v9
ds_read_b64_tr_b16 v[56:57], v4 offset:2048
v_smfmac_f32_16x16x64_bf16 v[44:47], v[80:83], v[240:247], v9
v_cvt_pk_bf16_f32 v18, v40, v41
v_smfmac_f32_16x16x64_bf16 v[44:47], v[84:87], v[248:255], v9
v_cvt_pk_bf16_f32 v19, v42, v43
ds_write_b64 v3, v[18:19] offset:2560
ds_read_b64_tr_b16 v[58:59], v4 offset:2560
s_waitcnt lgkmcnt(4)
v_mfma_f32_16x16x32_bf16 v[20:23], a[224:227], v[48:51], 0
ds_read_b64 v[60:61], v5 offset:30976
ds_read_b64 v[62:63], v5 offset:31232
v_mfma_f32_16x16x32_bf16 v[24:27], a[238:241], v[48:51], 0
ds_read_b64 v[64:65], v5 offset:31488
ds_read_b64 v[66:67], v5 offset:31744
v_mfma_f32_16x16x32_bf16 v[20:23], a[228:231], v[52:55], v[20:23]
v_cvt_pk_bf16_f32 v16, v44, v45
v_cvt_pk_bf16_f32 v17, v46, v47
v_mfma_f32_16x16x32_bf16 v[24:27], a[242:245], v[52:55], v[24:27]
ds_write_b64 v3, v[16:17] offset:3072
ds_read_b64_tr_b16 a[252:253], v4 offset:3072
s_waitcnt lgkmcnt(6)
v_mfma_f32_16x16x32_bf16 v[20:23], a[232:235], v[56:59], v[20:23]
ds_read_b64 v[68:69], v5 offset:32000
ds_read_b64 v[70:71], v5 offset:32256
v_mfma_f32_16x16x32_bf16 v[24:27], a[246:249], v[56:59], v[24:27]
ds_read_b64 v[72:73], v5 offset:32512
s_waitcnt lgkmcnt(5)
v_mfma_f32_16x16x32_bf16 v[28:31], v[60:63], v[48:51], 0
v_mfma_f32_16x16x32_bf16 v[28:31], v[64:67], v[52:55], v[28:31]
s_waitcnt lgkmcnt(1)
v_mfma_f32_16x16x32_bf16 v[28:31], v[68:71], v[56:59], v[28:31]
v_mfma_f32_16x16x16_bf16 v[20:23], a[236:237], a[252:253], v[20:23]
v_mfma_f32_16x16x16_bf16 v[24:27], a[250:251], a[252:253], v[24:27]
s_waitcnt lgkmcnt(0)
v_mfma_f32_16x16x16_bf16 v[28:31], v[72:73], a[252:253], v[28:31]
s_add_u32 s24, s24, 28672
s_nop 3
v_add_f32_dpp v20, v20, v20 row_ror:8 row_mask:0xf bank_mask:0x3
v_add_f32_dpp v21, v21, v21 row_ror:8 row_mask:0xf bank_mask:0x3
v_add_f32_dpp v22, v22, v22 row_ror:8 row_mask:0xf bank_mask:0x3
v_add_f32_dpp v23, v23, v23 row_ror:8 row_mask:0xf bank_mask:0x3
v_add_f32_dpp v20, v24, v24 row_ror:8 row_mask:0xf bank_mask:0xc
v_add_f32_dpp v21, v25, v25 row_ror:8 row_mask:0xf bank_mask:0xc
v_add_f32_dpp v22, v26, v26 row_ror:8 row_mask:0xf bank_mask:0xc
v_add_f32_dpp v23, v27, v27 row_ror:8 row_mask:0xf bank_mask:0xc
ds_write_b128 v13, v[20:23]
v_add_f32_dpp v28, v28, v28 row_ror:8 row_mask:0xf bank_mask:0xf
v_add_f32_dpp v29, v29, v29 row_ror:8 row_mask:0xf bank_mask:0xf
v_add_f32_dpp v30, v30, v30 row_ror:8 row_mask:0xf bank_mask:0xf
v_add_f32_dpp v31, v31, v31 row_ror:8 row_mask:0xf bank_mask:0xf
ds_write_b128 v14, v[28:31]
s_waitcnt lgkmcnt(0)
s_barrier
ds_read_b128 v[48:51], v6 offset:0
ds_read_b128 v[60:63], v6 offset:3200
ds_read_b128 v[64:67], v6 offset:6400
ds_read_b128 v[68:71], v6 offset:9600
s_waitcnt lgkmcnt(2)
v_pk_add_f32 v[48:49], v[48:49], v[60:61]
v_pk_add_f32 v[50:51], v[50:51], v[62:63]
s_waitcnt lgkmcnt(0)
v_pk_add_f32 v[64:65], v[64:65], v[68:69]
v_pk_add_f32 v[66:67], v[66:67], v[70:71]
v_pk_add_f32 v[48:49], v[48:49], v[64:65]
v_pk_add_f32 v[50:51], v[50:51], v[66:67]
v_max3_f32 v10, v48, v49, v50
v_max_f32 v10, v10, v51
s_nop 1
v_max_f32_dpp v10, v10, v10 row_ror:8 row_mask:0xf bank_mask:0xf
s_nop 1
v_max_f32_dpp v10, v10, v10 row_ror:4 row_mask:0xf bank_mask:0xf
s_nop 1
v_max_f32_dpp v10, v10, v10 row_ror:2 row_mask:0xf bank_mask:0xf
s_nop 1
v_max_f32_dpp v10, v10, v10 row_ror:1 row_mask:0xf bank_mask:0xf
v_pk_add_f32 v[48:49], v[48:49], v[10:11] op_sel_hi:[1,0] neg_lo:[0,1] neg_hi:[0,1]
v_pk_add_f32 v[50:51], v[50:51], v[10:11] op_sel_hi:[1,0] neg_lo:[0,1] neg_hi:[0,1]
v_exp_f32 v48, v48
v_exp_f32 v49, v49
v_exp_f32 v50, v50
v_exp_f32 v51, v51
s_nop 0
v_pk_add_f32 v[18:19], v[48:49], v[50:51]
v_add_f32 v72, v18, v19
s_nop 1
v_add_f32_dpp v72, v72, v72 row_ror:8 row_mask:0xf bank_mask:0xf
s_nop 1
v_add_f32_dpp v72, v72, v72 row_ror:4 row_mask:0xf bank_mask:0xf
s_nop 1
v_add_f32_dpp v72, v72, v72 row_ror:2 row_mask:0xf bank_mask:0xf
s_nop 1
v_add_f32_dpp v72, v72, v72 row_ror:1 row_mask:0xf bank_mask:0xf
v_rcp_f32 v72, v72
s_nop 0
v_pk_mul_f32 v[48:49], v[48:49], v[72:73] op_sel_hi:[1,0]
v_pk_mul_f32 v[50:51], v[50:51], v[72:73] op_sel_hi:[1,0]
v_cvt_pk_bf16_f32 v48, v48, v49
v_cvt_pk_bf16_f32 v49, v50, v51
v_min_u32 v48, -2, v48
v_min_u32 v49, -2, v49
s_mov_b64 exec, s[20:21]
buffer_store_dwordx2 v[48:49], v8, s[8:11], s16 offen
s_mov_b64 exec, -1
s_barrier
buffer_load_dwordx4 a[224:227], v1, s[8:11], s24 offen offset:0 sc1
buffer_load_dwordx4 a[228:231], v1, s[8:11], s24 offen offset:1024 sc1
buffer_load_dwordx4 a[232:235], v1, s[8:11], s24 offen offset:2048 sc1
buffer_load_dwordx2 a[236:237], v2, s[8:11], s24 offen offset:3072 sc1
buffer_load_dwordx4 a[238:241], v1, s[8:11], s24 offen offset:3584 sc1
s_add_u32 s18, s24, 4096
buffer_load_dwordx4 a[242:245], v1, s[8:11], s18 offen offset:512 sc1
buffer_load_dwordx4 a[246:249], v1, s[8:11], s18 offen offset:1536 sc1
buffer_load_dwordx2 a[250:251], v2, s[8:11], s18 offen offset:2560 sc1
s_add_u32 s14, s14, 1
s_and_b32 s17, s14, 3
s_mul_i32 s15, s17, 7168
s_add_u32 s15, s15, 44040192
s_mul_i32 s16, s17, 10240
s_add_u32 s16, s16, 44068864
s_waitcnt vmcnt(0)
s_cmp_lt_u32 s14, 63
s_cbranch_scc1 A_loop_48
s_endpgm
A_w_41:
A_loop_53:
s_mov_b32 s17, 44109824
buffer_load_dword v16, v12, s[8:11], s17 offen sc1
FP_54:
buffer_load_dword v17, v12, s[8:11], s17 offen sc1
s_waitcnt vmcnt(1)
v_cmp_gt_u32 vcc, s14, v16
s_cbranch_vccz FPD_55
buffer_load_dword v16, v12, s[8:11], s17 offen sc1
s_waitcnt vmcnt(1)
v_cmp_gt_u32 vcc, s14, v17
s_cbranch_vccz FPD_55
s_sub_u32 s19, s19, 1
s_cbranch_scc0 FP_54
s_branch M_abort
FPD_55:
s_barrier
s_add_u32 s25, s15, 4096
buffer_load_dwordx4 v[76:79], v1, s[8:11], s25 offen offset:0 sc1
v_mov_b64 v[20:21], 0
v_mov_b64 v[22:23], 0
v_mov_b64 v[24:25], 0
v_mov_b64 v[26:27], 0
v_mov_b64 v[28:29], 0
v_mov_b64 v[30:31], 0
v_mov_b64 v[32:33], 0
s_nop 0
s_nop 0
s_nop 0
buffer_load_dwordx4 v[80:83], v1, s[8:11], s25 offen offset:1024 sc1
v_mov_b64 v[34:35], 0
v_mov_b64 v[36:37], 0
v_mov_b64 v[38:39], 0
v_mov_b64 v[40:41], 0
v_mov_b64 v[42:43], 0
v_mov_b64 v[44:45], 0
v_mov_b64 v[46:47], 0
s_nop 0
s_nop 0
s_nop 0
buffer_load_dwordx4 v[84:87], v1, s[8:11], s25 offen offset:2048 sc1
s_nop 10
buffer_load_dwordx4 v[60:63], v1, s[8:11], s15 offen offset:0 sc1
s_nop 10
buffer_load_dwordx4 v[64:67], v1, s[8:11], s15 offen offset:1024 sc1
s_waitcnt vmcnt(4)
v_smfmac_f32_16x16x64_bf16 v[20:23], v[76:79], a[32:39], v9
buffer_load_dwordx4 v[68:71], v1, s[8:11], s15 offen offset:2048 sc1
v_smfmac_f32_16x16x64_bf16 v[24:27], v[76:79], a[88:95], v9
v_max_u32 v10, v76, v77
v_smfmac_f32_16x16x64_bf16 v[28:31], v[76:79], a[144:151], v9
v_max3_u32 v10, v10, v78, v79
v_smfmac_f32_16x16x64_bf16 v[32:35], v[76:79], a[200:207], v9
ds_write_b128 v1, v[76:79] offset:34304
s_waitcnt vmcnt(4)
v_smfmac_f32_16x16x64_bf16 v[20:23], v[80:83], a[40:47], v9
buffer_load_dwordx4 v[72:75], v1, s[8:11], s15 offen offset:3072 sc1
v_smfmac_f32_16x16x64_bf16 v[24:27], v[80:83], a[96:103], v9
v_max3_u32 v10, v10, v80, v81
v_smfmac_f32_16x16x64_bf16 v[28:31], v[80:83], a[152:159], v9
v_max3_u32 v10, v10, v82, v83
v_smfmac_f32_16x16x64_bf16 v[32:35], v[80:83], a[208:215], v9
ds_write_b128 v1, v[80:83] offset:35328
s_waitcnt vmcnt(4)
v_smfmac_f32_16x16x64_bf16 v[20:23], v[84:87], a[48:55], v9
v_max3_u32 v10, v10, v84, v85
v_smfmac_f32_16x16x64_bf16 v[24:27], v[84:87], a[104:111], v9
v_max3_u32 v10, v10, v86, v87
v_smfmac_f32_16x16x64_bf16 v[28:31], v[84:87], a[160:167], v9
v_smfmac_f32_16x16x64_bf16 v[32:35], v[84:87], a[216:223], v9
s_waitcnt vmcnt(3)
v_smfmac_f32_16x16x64_bf16 v[20:23], v[60:63], a[0:7], v9
v_max3_u32 v10, v10, v60, v61
v_smfmac_f32_16x16x64_bf16 v[24:27], v[60:63], a[56:63], v9
v_max3_u32 v10, v10, v62, v63
v_smfmac_f32_16x16x64_bf16 v[28:31], v[60:63], a[112:119], v9
v_smfmac_f32_16x16x64_bf16 v[32:35], v[60:63], a[168:175], v9
s_waitcnt vmcnt(2)
v_smfmac_f32_16x16x64_bf16 v[20:23], v[64:67], a[8:15], v9
v_max3_u32 v10, v10, v64, v65
v_smfmac_f32_16x16x64_bf16 v[24:27], v[64:67], a[64:71], v9
v_max3_u32 v10, v10, v66, v67
v_smfmac_f32_16x16x64_bf16 v[28:31], v[64:67], a[120:127], v9
v_smfmac_f32_16x16x64_bf16 v[32:35], v[64:67], a[176:183], v9
s_waitcnt vmcnt(1)
v_smfmac_f32_16x16x64_bf16 v[20:23], v[68:71], a[16:23], v9
v_max3_u32 v10, v10, v68, v69
v_smfmac_f32_16x16x64_bf16 v[24:27], v[68:71], a[72:79], v9
v_max3_u32 v10, v10, v70, v71
v_smfmac_f32_16x16x64_bf16 v[28:31], v[68:71], a[128:135], v9
v_smfmac_f32_16x16x64_bf16 v[32:35], v[68:71], a[184:191], v9
s_waitcnt vmcnt(0)
v_smfmac_f32_16x16x64_bf16 v[20:23], v[72:75], a[24:31], v9
v_max3_u32 v10, v10, v72, v73
v_smfmac_f32_16x16x64_bf16 v[24:27], v[72:75], a[80:87], v9
v_max3_u32 v10, v10, v74, v75
v_smfmac_f32_16x16x64_bf16 v[28:31], v[72:75], a[136:143], v9
v_cmp_eq_u32 vcc, -1, v10
v_smfmac_f32_16x16x64_bf16 v[32:35], v[72:75], a[192:199], v9
ds_write_b128 v1, v[72:75] offset:33280
v_cvt_pk_bf16_f32 v16, v20, v21
s_cbranch_vccnz A_retry_57
A_again_56:
v_smfmac_f32_16x16x64_bf16 v[36:39], v[60:63], v[88:95], v9
v_cvt_pk_bf16_f32 v17, v22, v23
v_smfmac_f32_16x16x64_bf16 v[36:39], v[64:67], v[96:103], v9
ds_write_b64 v3, v[16:17] offset:0
v_smfmac_f32_16x16x64_bf16 v[36:39], v[68:71], v[104:111], v9
ds_read_b64_tr_b16 v[48:49], v4 offset:0
v_smfmac_f32_16x16x64_bf16 v[36:39], v[72:75], v[112:119], v9
v_cvt_pk_bf16_f32 v18, v24, v25
v_smfmac_f32_16x16x64_bf16 v[36:39], v[76:79], v[120:127], v9
v_cvt_pk_bf16_f32 v19, v26, v27
v_smfmac_f32_16x16x64_bf16 v[36:39], v[80:83], v[128:135], v9
ds_write_b64 v3, v[18:19] offset:512
v_smfmac_f32_16x16x64_bf16 v[36:39], v[84:87], v[136:143], v9
ds_read_b64_tr_b16 v[50:51], v4 offset:512
v_smfmac_f32_16x16x64_bf16 v[40:43], v[60:63], v[144:151], v9
v_cvt_pk_bf16_f32 v16, v28, v29
v_smfmac_f32_16x16x64_bf16 v[40:43], v[64:67], v[152:159], v9
v_cvt_pk_bf16_f32 v17, v30, v31
v_smfmac_f32_16x16x64_bf16 v[40:43], v[68:71], v[160:167], v9
ds_write_b64 v3, v[16:17] offset:1024
v_smfmac_f32_16x16x64_bf16 v[40:43], v[72:75], v[168:175], v9
ds_read_b64_tr_b16 v[52:53], v4 offset:1024
v_smfmac_f32_16x16x64_bf16 v[40:43], v[76:79], v[176:183], v9
v_cvt_pk_bf16_f32 v18, v32, v33
v_smfmac_f32_16x16x64_bf16 v[40:43], v[80:83], v[184:191], v9
v_cvt_pk_bf16_f32 v19, v34, v35
v_smfmac_f32_16x16x64_bf16 v[40:43], v[84:87], v[192:199], v9
ds_write_b64 v3, v[18:19] offset:1536
v_smfmac_f32_16x16x64_bf16 v[44:47], v[60:63], v[200:207], v9
ds_read_b64_tr_b16 v[54:55], v4 offset:1536
v_smfmac_f32_16x16x64_bf16 v[44:47], v[64:67], v[208:215], v9
v_cvt_pk_bf16_f32 v16, v36, v37
v_smfmac_f32_16x16x64_bf16 v[44:47], v[68:71], v[216:223], v9
v_cvt_pk_bf16_f32 v17, v38, v39
v_smfmac_f32_16x16x64_bf16 v[44:47], v[72:75], v[224:231], v9
ds_write_b64 v3, v[16:17] offset:2048
v_smfmac_f32_16x16x64_bf16 v[44:47], v[76:79], v[232:239], v9
ds_read_b64_tr_b16 v[56:57], v4 offset:2048
v_smfmac_f32_16x16x64_bf16 v[44:47], v[80:83], v[240:247], v9
v_cvt_pk_bf16_f32 v18, v40, v41
v_smfmac_f32_16x16x64_bf16 v[44:47], v[84:87], v[248:255], v9
v_cvt_pk_bf16_f32 v19, v42, v43
ds_write_b64 v3, v[18:19] offset:2560
ds_read_b64_tr_b16 v[58:59], v4 offset:2560
s_waitcnt lgkmcnt(4)
v_mfma_f32_16x16x32_bf16 v[20:23], a[224:227], v[48:51], 0
ds_read_b64 v[60:61], v5 offset:33792
ds_read_b64 v[62:63], v5 offset:34048
v_mfma_f32_16x16x32_bf16 v[24:27], a[238:241], v[48:51], 0
ds_read_b64 v[64:65], v5 offset:34304
ds_read_b64 v[66:67], v5 offset:34560
v_mfma_f32_16x16x32_bf16 v[20:23], a[228:231], v[52:55], v[20:23]
v_cvt_pk_bf16_f32 v16, v44, v45
v_cvt_pk_bf16_f32 v17, v46, v47
v_mfma_f32_16x16x32_bf16 v[24:27], a[242:245], v[52:55], v[24:27]
ds_write_b64 v3, v[16:17] offset:3072
ds_read_b64_tr_b16 a[252:253], v4 offset:3072
s_waitcnt lgkmcnt(6)
v_mfma_f32_16x16x32_bf16 v[20:23], a[232:235], v[56:59], v[20:23]
ds_read_b64 v[68:69], v5 offset:34816
ds_read_b64 v[70:71], v5 offset:35072
v_mfma_f32_16x16x32_bf16 v[24:27], a[246:249], v[56:59], v[24:27]
ds_read_b64 v[72:73], v5 offset:35328
s_waitcnt lgkmcnt(5)
v_mfma_f32_16x16x32_bf16 v[28:31], v[60:63], v[48:51], 0
v_mfma_f32_16x16x32_bf16 v[28:31], v[64:67], v[52:55], v[28:31]
s_waitcnt lgkmcnt(1)
v_mfma_f32_16x16x32_bf16 v[28:31], v[68:71], v[56:59], v[28:31]
v_mfma_f32_16x16x16_bf16 v[20:23], a[236:237], a[252:253], v[20:23]
v_mfma_f32_16x16x16_bf16 v[24:27], a[250:251], a[252:253], v[24:27]
s_waitcnt lgkmcnt(0)
v_mfma_f32_16x16x16_bf16 v[28:31], v[72:73], a[252:253], v[28:31]
s_add_u32 s24, s24, 28672
s_nop 3
v_add_f32_dpp v20, v20, v20 row_ror:8 row_mask:0xf bank_mask:0x3
v_add_f32_dpp v21, v21, v21 row_ror:8 row_mask:0xf bank_mask:0x3
v_add_f32_dpp v22, v22, v22 row_ror:8 row_mask:0xf bank_mask:0x3
v_add_f32_dpp v23, v23, v23 row_ror:8 row_mask:0xf bank_mask:0x3
v_add_f32_dpp v20, v24, v24 row_ror:8 row_mask:0xf bank_mask:0xc
v_add_f32_dpp v21, v25, v25 row_ror:8 row_mask:0xf bank_mask:0xc
v_add_f32_dpp v22, v26, v26 row_ror:8 row_mask:0xf bank_mask:0xc
v_add_f32_dpp v23, v27, v27 row_ror:8 row_mask:0xf bank_mask:0xc
ds_write_b128 v13, v[20:23]
v_add_f32_dpp v28, v28, v28 row_ror:8 row_mask:0xf bank_mask:0xf
v_add_f32_dpp v29, v29, v29 row_ror:8 row_mask:0xf bank_mask:0xf
v_add_f32_dpp v30, v30, v30 row_ror:8 row_mask:0xf bank_mask:0xf
v_add_f32_dpp v31, v31, v31 row_ror:8 row_mask:0xf bank_mask:0xf
ds_write_b128 v14, v[28:31]
s_waitcnt lgkmcnt(0)
s_barrier
s_barrier
buffer_load_dwordx4 a[224:227], v1, s[8:11], s24 offen offset:0 sc1
buffer_load_dwordx4 a[228:231], v1, s[8:11], s24 offen offset:1024 sc1
buffer_load_dwordx4 a[232:235], v1, s[8:11], s24 offen offset:2048 sc1
buffer_load_dwordx2 a[236:237], v2, s[8:11], s24 offen offset:3072 sc1
buffer_load_dwordx4 a[238:241], v1, s[8:11], s24 offen offset:3584 sc1
s_add_u32 s18, s24, 4096
buffer_load_dwordx4 a[242:245], v1, s[8:11], s18 offen offset:512 sc1
buffer_load_dwordx4 a[246:249], v1, s[8:11], s18 offen offset:1536 sc1
buffer_load_dwordx2 a[250:251], v2, s[8:11], s18 offen offset:2560 sc1
s_add_u32 s14, s14, 1
s_and_b32 s17, s14, 3
s_mul_i32 s15, s17, 7168
s_add_u32 s15, s15, 44040192
s_mul_i32 s16, s17, 10240
s_add_u32 s16, s16, 44068864
s_waitcnt vmcnt(0)
s_cmp_lt_u32 s14, 63
s_cbranch_scc1 A_loop_53
s_endpgm
A_w_42:
A_loop_60:
s_barrier
s_add_u32 s25, s15, 4096
buffer_load_dwordx4 v[84:87], v1, s[8:11], s25 offen offset:2048 sc1
v_mov_b64 v[20:21], 0
v_mov_b64 v[22:23], 0
v_mov_b64 v[24:25], 0
v_mov_b64 v[26:27], 0
v_mov_b64 v[28:29], 0
v_mov_b64 v[30:31], 0
v_mov_b64 v[32:33], 0
s_nop 0
s_nop 0
s_nop 0
buffer_load_dwordx4 v[60:63], v1, s[8:11], s15 offen offset:0 sc1
v_mov_b64 v[34:35], 0
v_mov_b64 v[36:37], 0
v_mov_b64 v[38:39], 0
v_mov_b64 v[40:41], 0
v_mov_b64 v[42:43], 0
v_mov_b64 v[44:45], 0
v_mov_b64 v[46:47], 0
s_nop 0
s_nop 0
s_nop 0
buffer_load_dwordx4 v[64:67], v1, s[8:11], s15 offen offset:1024 sc1
s_nop 10
buffer_load_dwordx4 v[68:71], v1, s[8:11], s15 offen offset:2048 sc1
s_nop 10
buffer_load_dwordx4 v[72:75], v1, s[8:11], s15 offen offset:3072 sc1
s_waitcnt vmcnt(4)
v_smfmac_f32_16x16x64_bf16 v[20:23], v[84:87], a[48:55], v9
buffer_load_dwordx4 v[76:79], v1, s[8:11], s25 offen offset:0 sc1
v_smfmac_f32_16x16x64_bf16 v[24:27], v[84:87], a[104:111], v9
v_max_u32 v10, v84, v85
v_smfmac_f32_16x16x64_bf16 v[28:31], v[84:87], a[160:167], v9
v_max3_u32 v10, v10, v86, v87
v_smfmac_f32_16x16x64_bf16 v[32:35], v[84:87], a[216:223], v9
ds_write_b128 v1, v[84:87] offset:37376
s_waitcnt vmcnt(4)
v_smfmac_f32_16x16x64_bf16 v[20:23], v[60:63], a[0:7], v9
buffer_load_dwordx4 v[80:83], v1, s[8:11], s25 offen offset:1024 sc1
v_smfmac_f32_16x16x64_bf16 v[24:27], v[60:63], a[56:63], v9
v_max3_u32 v10, v10, v60, v61
v_smfmac_f32_16x16x64_bf16 v[28:31], v[60:63], a[112:119], v9
v_max3_u32 v10, v10, v62, v63
v_smfmac_f32_16x16x64_bf16 v[32:35], v[60:63], a[168:175], v9
s_waitcnt vmcnt(4)
v_smfmac_f32_16x16x64_bf16 v[20:23], v[64:67], a[8:15], v9
v_max3_u32 v10, v10, v64, v65
v_smfmac_f32_16x16x64_bf16 v[24:27], v[64:67], a[64:71], v9
v_max3_u32 v10, v10, v66, v67
v_smfmac_f32_16x16x64_bf16 v[28:31], v[64:67], a[120:127], v9
v_smfmac_f32_16x16x64_bf16 v[32:35], v[64:67], a[176:183], v9
s_waitcnt vmcnt(3)
v_smfmac_f32_16x16x64_bf16 v[20:23], v[68:71], a[16:23], v9
v_max3_u32 v10, v10, v68, v69
v_smfmac_f32_16x16x64_bf16 v[24:27], v[68:71], a[72:79], v9
v_max3_u32 v10, v10, v70, v71
v_smfmac_f32_16x16x64_bf16 v[28:31], v[68:71], a[128:135], v9
v_smfmac_f32_16x16x64_bf16 v[32:35], v[68:71], a[184:191], v9
s_waitcnt vmcnt(2)
v_smfmac_f32_16x16x64_bf16 v[20:23], v[72:75], a[24:31], v9
v_max3_u32 v10, v10, v72, v73
v_smfmac_f32_16x16x64_bf16 v[24:27], v[72:75], a[80:87], v9
v_max3_u32 v10, v10, v74, v75
v_smfmac_f32_16x16x64_bf16 v[28:31], v[72:75], a[136:143], v9
v_smfmac_f32_16x16x64_bf16 v[32:35], v[72:75], a[192:199], v9
s_waitcnt vmcnt(1)
v_smfmac_f32_16x16x64_bf16 v[20:23], v[76:79], a[32:39], v9
v_max3_u32 v10, v10, v76, v77
v_smfmac_f32_16x16x64_bf16 v[24:27], v[76:79], a[88:95], v9
v_max3_u32 v10, v10, v78, v79
v_smfmac_f32_16x16x64_bf16 v[28:31], v[76:79], a[144:151], v9
v_smfmac_f32_16x16x64_bf16 v[32:35], v[76:79], a[200:207], v9
s_waitcnt vmcnt(0)
v_smfmac_f32_16x16x64_bf16 v[20:23], v[80:83], a[40:47], v9
v_max3_u32 v10, v10, v80, v81
v_smfmac_f32_16x16x64_bf16 v[24:27], v[80:83], a[96:103], v9
v_max3_u32 v10, v10, v82, v83
v_smfmac_f32_16x16x64_bf16 v[28:31], v[80:83], a[152:159], v9
v_cmp_eq_u32 vcc, -1, v10
v_smfmac_f32_16x16x64_bf16 v[32:35], v[80:83], a[208:215], v9
ds_write_b128 v1, v[80:83] offset:36352
v_cvt_pk_bf16_f32 v16, v20, v21
s_cbranch_vccnz A_retry_62
A_again_61:
v_smfmac_f32_16x16x64_bf16 v[36:39], v[60:63], v[88:95], v9
v_cvt_pk_bf16_f32 v17, v22, v23
v_smfmac_f32_16x16x64_bf16 v[36:39], v[64:67], v[96:103], v9
ds_write_b64 v3, v[16:17] offset:0
v_smfmac_f32_16x16x64_bf16 v[36:39], v[68:71], v[104:111], v9
ds_read_b64_tr_b16 v[48:49], v4 offset:0
v_smfmac_f32_16x16x64_bf16 v[36:39], v[72:75], v[112:119], v9
v_cvt_pk_bf16_f32 v18, v24, v25
v_smfmac_f32_16x16x64_bf16 v[36:39], v[76:79], v[120:127], v9
v_cvt_pk_bf16_f32 v19, v26, v27
v_smfmac_f32_16x16x64_bf16 v[36:39], v[80:83], v[128:135], v9
ds_write_b64 v3, v[18:19] offset:512
v_smfmac_f32_16x16x64_bf16 v[36:39], v[84:87], v[136:143], v9
ds_read_b64_tr_b16 v[50:51], v4 offset:512
v_smfmac_f32_16x16x64_bf16 v[40:43], v[60:63], v[144:151], v9
v_cvt_pk_bf16_f32 v16, v28, v29
v_smfmac_f32_16x16x64_bf16 v[40:43], v[64:67], v[152:159], v9
v_cvt_pk_bf16_f32 v17, v30, v31
v_smfmac_f32_16x16x64_bf16 v[40:43], v[68:71], v[160:167], v9
ds_write_b64 v3, v[16:17] offset:1024
v_smfmac_f32_16x16x64_bf16 v[40:43], v[72:75], v[168:175], v9
ds_read_b64_tr_b16 v[52:53], v4 offset:1024
v_smfmac_f32_16x16x64_bf16 v[40:43], v[76:79], v[176:183], v9
v_cvt_pk_bf16_f32 v18, v32, v33
v_smfmac_f32_16x16x64_bf16 v[40:43], v[80:83], v[184:191], v9
v_cvt_pk_bf16_f32 v19, v34, v35
v_smfmac_f32_16x16x64_bf16 v[40:43], v[84:87], v[192:199], v9
ds_write_b64 v3, v[18:19] offset:1536
v_smfmac_f32_16x16x64_bf16 v[44:47], v[60:63], v[200:207], v9
ds_read_b64_tr_b16 v[54:55], v4 offset:1536
v_smfmac_f32_16x16x64_bf16 v[44:47], v[64:67], v[208:215], v9
v_cvt_pk_bf16_f32 v16, v36, v37
v_smfmac_f32_16x16x64_bf16 v[44:47], v[68:71], v[216:223], v9
v_cvt_pk_bf16_f32 v17, v38, v39
v_smfmac_f32_16x16x64_bf16 v[44:47], v[72:75], v[224:231], v9
ds_write_b64 v3, v[16:17] offset:2048
v_smfmac_f32_16x16x64_bf16 v[44:47], v[76:79], v[232:239], v9
ds_read_b64_tr_b16 v[56:57], v4 offset:2048
v_smfmac_f32_16x16x64_bf16 v[44:47], v[80:83], v[240:247], v9
v_cvt_pk_bf16_f32 v18, v40, v41
v_smfmac_f32_16x16x64_bf16 v[44:47], v[84:87], v[248:255], v9
v_cvt_pk_bf16_f32 v19, v42, v43
ds_write_b64 v3, v[18:19] offset:2560
ds_read_b64_tr_b16 v[58:59], v4 offset:2560
s_waitcnt lgkmcnt(4)
v_mfma_f32_16x16x32_bf16 v[20:23], a[224:227], v[48:51], 0
ds_read_b64 v[60:61], v5 offset:36608
ds_read_b64 v[62:63], v5 offset:36864
v_mfma_f32_16x16x32_bf16 v[24:27], a[238:241], v[48:51], 0
ds_read_b64 v[64:65], v5 offset:37120
ds_read_b64 v[66:67], v5 offset:37376
v_mfma_f32_16x16x32_bf16 v[20:23], a[228:231], v[52:55], v[20:23]
v_cvt_pk_bf16_f32 v16, v44, v45
v_cvt_pk_bf16_f32 v17, v46, v47
v_mfma_f32_16x16x32_bf16 v[24:27], a[242:245], v[52:55], v[24:27]
ds_write_b64 v3, v[16:17] offset:3072
ds_read_b64_tr_b16 a[252:253], v4 offset:3072
s_waitcnt lgkmcnt(6)
v_mfma_f32_16x16x32_bf16 v[20:23], a[232:235], v[56:59], v[20:23]
ds_read_b64 v[68:69], v5 offset:37632
ds_read_b64 v[70:71], v5 offset:37888
v_mfma_f32_16x16x32_bf16 v[24:27], a[246:249], v[56:59], v[24:27]
ds_read_b64 v[72:73], v5 offset:38144
s_waitcnt lgkmcnt(5)
v_mfma_f32_16x16x32_bf16 v[28:31], v[60:63], v[48:51], 0
v_mfma_f32_16x16x32_bf16 v[28:31], v[64:67], v[52:55], v[28:31]
s_waitcnt lgkmcnt(1)
v_mfma_f32_16x16x32_bf16 v[28:31], v[68:71], v[56:59], v[28:31]
v_mfma_f32_16x16x16_bf16 v[20:23], a[236:237], a[252:253], v[20:23]
v_mfma_f32_16x16x16_bf16 v[24:27], a[250:251], a[252:253], v[24:27]
s_waitcnt lgkmcnt(0)
v_mfma_f32_16x16x16_bf16 v[28:31], v[72:73], a[252:253], v[28:31]
s_add_u32 s24, s24, 28672
s_nop 3
v_add_f32_dpp v20, v20, v20 row_ror:8 row_mask:0xf bank_mask:0x3
v_add_f32_dpp v21, v21, v21 row_ror:8 row_mask:0xf bank_mask:0x3
v_add_f32_dpp v22, v22, v22 row_ror:8 row_mask:0xf bank_mask:0x3
v_add_f32_dpp v23, v23, v23 row_ror:8 row_mask:0xf bank_mask:0x3
v_add_f32_dpp v20, v24, v24 row_ror:8 row_mask:0xf bank_mask:0xc
v_add_f32_dpp v21, v25, v25 row_ror:8 row_mask:0xf bank_mask:0xc
v_add_f32_dpp v22, v26, v26 row_ror:8 row_mask:0xf bank_mask:0xc
v_add_f32_dpp v23, v27, v27 row_ror:8 row_mask:0xf bank_mask:0xc
ds_write_b128 v13, v[20:23]
v_add_f32_dpp v28, v28, v28 row_ror:8 row_mask:0xf bank_mask:0xf
v_add_f32_dpp v29, v29, v29 row_ror:8 row_mask:0xf bank_mask:0xf
v_add_f32_dpp v30, v30, v30 row_ror:8 row_mask:0xf bank_mask:0xf
v_add_f32_dpp v31, v31, v31 row_ror:8 row_mask:0xf bank_mask:0xf
ds_write_b128 v14, v[28:31]
s_waitcnt lgkmcnt(0)
s_barrier
s_barrier
s_add_u32 s26, s14, 2
s_and_b32 s26, s26, 3
s_mul_i32 s26, s26, 10240
s_add_u32 s26, s26, 44068864
v_mov_b32 v48, -1
v_mov_b32 v49, -1
v_mov_b32 v50, -1
v_mov_b32 v51, -1
s_mov_b64 exec, s[22:23]
buffer_store_dwordx4 v[48:51], v0, s[8:11], s26 offen
s_mov_b64 exec, -1
buffer_load_dwordx4 a[224:227], v1, s[8:11], s24 offen offset:0 sc1
buffer_load_dwordx4 a[228:231], v1, s[8:11], s24 offen offset:1024 sc1
buffer_load_dwordx4 a[232:235], v1, s[8:11], s24 offen offset:2048 sc1
buffer_load_dwordx2 a[236:237], v2, s[8:11], s24 offen offset:3072 sc1
buffer_load_dwordx4 a[238:241], v1, s[8:11], s24 offen offset:3584 sc1
s_add_u32 s18, s24, 4096
buffer_load_dwordx4 a[242:245], v1, s[8:11], s18 offen offset:512 sc1
buffer_load_dwordx4 a[246:249], v1, s[8:11], s18 offen offset:1536 sc1
buffer_load_dwordx2 a[250:251], v2, s[8:11], s18 offen offset:2560 sc1
s_add_u32 s14, s14, 1
s_and_b32 s17, s14, 3
s_mul_i32 s15, s17, 7168
s_add_u32 s15, s15, 44040192
s_mul_i32 s16, s17, 10240
s_add_u32 s16, s16, 44068864
s_waitcnt vmcnt(0)
s_cmp_lt_u32 s14, 63
s_cbranch_scc1 A_loop_60
s_endpgm
A_m_38:
s_cmp_eq_u32 s13, 1
s_cbranch_scc1 A_w_66
s_cmp_eq_u32 s13, 2
s_cbranch_scc1 A_w_67
s_cmp_eq_u32 s13, 3
s_cbranch_scc1 A_w_68
A_w_65:
A_loop_69:
s_barrier
buffer_load_dwordx4 v[60:63], v1, s[8:11], s15 offen offset:0 sc1
s_add_u32 s25, s15, 4096
v_mov_b64 v[20:21], 0
v_mov_b64 v[22:23], 0
v_mov_b64 v[24:25], 0
v_mov_b64 v[26:27], 0
v_mov_b64 v[28:29], 0
v_mov_b64 v[30:31], 0
v_mov_b64 v[32:33], 0
s_nop 0
s_nop 0
s_nop 0
buffer_load_dwordx4 v[64:67], v1, s[8:11], s15 offen offset:1024 sc1
v_mov_b64 v[34:35], 0
v_mov_b64 v[36:37], 0
v_mov_b64 v[38:39], 0
v_mov_b64 v[40:41], 0
v_mov_b64 v[42:43], 0
v_mov_b64 v[44:45], 0
v_mov_b64 v[46:47], 0
s_nop 0
s_nop 0
s_nop 0
buffer_load_dwordx4 v[68:71], v1, s[8:11], s15 offen offset:2048 sc1
s_nop 10
buffer_load_dwordx4 v[72:75], v1, s[8:11], s15 offen offset:3072 sc1
s_nop 10
buffer_load_dwordx4 v[76:79], v1, s[8:11], s25 offen offset:0 sc1
s_waitcnt vmcnt(4)
v_smfmac_f32_16x16x64_bf16 v[20:23], v[60:63], a[0:7], v9
buffer_load_dwordx4 v[80:83], v1, s[8:11], s25 offen offset:1024 sc1
v_smfmac_f32_16x16x64_bf16 v[24:27], v[60:63], a[56:63], v9
v_max_u32 v10, v60, v61
v_smfmac_f32_16x16x64_bf16 v[28:31], v[60:63], a[112:119], v9
v_max3_u32 v10, v10, v62, v63
v_smfmac_f32_16x16x64_bf16 v[32:35], v[60:63], a[168:175], v9
ds_write_b128 v1, v[60:63] offset:27136
s_waitcnt vmcnt(4)
v_smfmac_f32_16x16x64_bf16 v[20:23], v[64:67], a[8:15], v9
buffer_load_dwordx4 v[84:87], v1, s[8:11], s25 offen offset:2048 sc1
v_smfmac_f32_16x16x64_bf16 v[24:27], v[64:67], a[64:71], v9
v_max3_u32 v10, v10, v64, v65
v_smfmac_f32_16x16x64_bf16 v[28:31], v[64:67], a[120:127], v9
v_max3_u32 v10, v10, v66, v67
v_smfmac_f32_16x16x64_bf16 v[32:35], v[64:67], a[176:183], v9
ds_write_b128 v1, v[64:67] offset:28160
s_waitcnt vmcnt(4)
v_smfmac_f32_16x16x64_bf16 v[20:23], v[68:71], a[16:23], v9
v_max3_u32 v10, v10, v68, v69
v_smfmac_f32_16x16x64_bf16 v[24:27], v[68:71], a[72:79], v9
v_max3_u32 v10, v10, v70, v71
v_smfmac_f32_16x16x64_bf16 v[28:31], v[68:71], a[128:135], v9
v_smfmac_f32_16x16x64_bf16 v[32:35], v[68:71], a[184:191], v9
s_waitcnt vmcnt(3)
v_smfmac_f32_16x16x64_bf16 v[20:23], v[72:75], a[24:31], v9
v_max3_u32 v10, v10, v72, v73
v_smfmac_f32_16x16x64_bf16 v[24:27], v[72:75], a[80:87], v9
v_max3_u32 v10, v10, v74, v75
v_smfmac_f32_16x16x64_bf16 v[28:31], v[72:75], a[136:143], v9
v_smfmac_f32_16x16x64_bf16 v[32:35], v[72:75], a[192:199], v9
s_waitcnt vmcnt(2)
v_smfmac_f32_16x16x64_bf16 v[20:23], v[76:79], a[32:39], v9
v_max3_u32 v10, v10, v76, v77
v_smfmac_f32_16x16x64_bf16 v[24:27], v[76:79], a[88:95], v9
v_max3_u32 v10, v10, v78, v79
v_smfmac_f32_16x16x64_bf16 v[28:31], v[76:79], a[144:151], v9
v_smfmac_f32_16x16x64_bf16 v[32:35], v[76:79], a[200:207], v9
s_waitcnt vmcnt(1)
v_smfmac_f32_16x16x64_bf16 v[20:23], v[80:83], a[40:47], v9
v_max3_u32 v10, v10, v80, v81
v_smfmac_f32_16x16x64_bf16 v[24:27], v[80:83], a[96:103], v9
v_max3_u32 v10, v10, v82, v83
v_smfmac_f32_16x16x64_bf16 v[28:31], v[80:83], a[152:159], v9
v_smfmac_f32_16x16x64_bf16 v[32:35], v[80:83], a[208:215], v9
s_waitcnt vmcnt(0)
v_smfmac_f32_16x16x64_bf16 v[20:23], v[84:87], a[48:55], v9
v_max3_u32 v10, v10, v84, v85
v_smfmac_f32_16x16x64_bf16 v[24:27], v[84:87], a[104:111], v9
v_max3_u32 v10, v10, v86, v87
v_smfmac_f32_16x16x64_bf16 v[28:31], v[84:87], a[160:167], v9
v_cmp_eq_u32 vcc, -1, v10
v_smfmac_f32_16x16x64_bf16 v[32:35], v[84:87], a[216:223], v9
v_cvt_pk_bf16_f32 v16, v20, v21
s_cbranch_vccnz A_retry_71
A_again_70:
v_smfmac_f32_16x16x64_bf16 v[36:39], v[60:63], v[88:95], v9
v_cvt_pk_bf16_f32 v17, v22, v23
v_smfmac_f32_16x16x64_bf16 v[36:39], v[64:67], v[96:103], v9
ds_write_b64 v3, v[16:17] offset:0
v_smfmac_f32_16x16x64_bf16 v[36:39], v[68:71], v[104:111], v9
ds_read_b64_tr_b16 v[48:49], v4 offset:0
v_smfmac_f32_16x16x64_bf16 v[36:39], v[72:75], v[112:119], v9
v_cvt_pk_bf16_f32 v18, v24, v25
v_smfmac_f32_16x16x64_bf16 v[36:39], v[76:79], v[120:127], v9
v_cvt_pk_bf16_f32 v19, v26, v27
v_smfmac_f32_16x16x64_bf16 v[36:39], v[80:83], v[128:135], v9
ds_write_b64 v3, v[18:19] offset:512
v_smfmac_f32_16x16x64_bf16 v[36:39], v[84:87], v[136:143], v9
ds_read_b64_tr_b16 v[50:51], v4 offset:512
v_smfmac_f32_16x16x64_bf16 v[40:43], v[60:63], v[144:151], v9
v_cvt_pk_bf16_f32 v16, v28, v29
v_smfmac_f32_16x16x64_bf16 v[40:43], v[64:67], v[152:159], v9
v_cvt_pk_bf16_f32 v17, v30, v31
v_smfmac_f32_16x16x64_bf16 v[40:43], v[68:71], v[160:167], v9
ds_write_b64 v3, v[16:17] offset:1024
v_smfmac_f32_16x16x64_bf16 v[40:43], v[72:75], v[168:175], v9
ds_read_b64_tr_b16 v[52:53], v4 offset:1024
v_smfmac_f32_16x16x64_bf16 v[40:43], v[76:79], v[176:183], v9
v_cvt_pk_bf16_f32 v18, v32, v33
v_smfmac_f32_16x16x64_bf16 v[40:43], v[80:83], v[184:191], v9
v_cvt_pk_bf16_f32 v19, v34, v35
v_smfmac_f32_16x16x64_bf16 v[40:43], v[84:87], v[192:199], v9
ds_write_b64 v3, v[18:19] offset:1536
v_smfmac_f32_16x16x64_bf16 v[44:47], v[60:63], v[200:207], v9
ds_read_b64_tr_b16 v[54:55], v4 offset:1536
v_smfmac_f32_16x16x64_bf16 v[44:47], v[64:67], v[208:215], v9
v_cvt_pk_bf16_f32 v16, v36, v37
v_smfmac_f32_16x16x64_bf16 v[44:47], v[68:71], v[216:223], v9
v_cvt_pk_bf16_f32 v17, v38, v39
v_smfmac_f32_16x16x64_bf16 v[44:47], v[72:75], v[224:231], v9
ds_write_b64 v3, v[16:17] offset:2048
v_smfmac_f32_16x16x64_bf16 v[44:47], v[76:79], v[232:239], v9
ds_read_b64_tr_b16 v[56:57], v4 offset:2048
v_smfmac_f32_16x16x64_bf16 v[44:47], v[80:83], v[240:247], v9
v_cvt_pk_bf16_f32 v18, v40, v41
v_smfmac_f32_16x16x64_bf16 v[44:47], v[84:87], v[248:255], v9
v_cvt_pk_bf16_f32 v19, v42, v43
ds_write_b64 v3, v[18:19] offset:2560
ds_read_b64_tr_b16 v[58:59], v4 offset:2560
s_waitcnt lgkmcnt(4)
v_mfma_f32_16x16x32_bf16 v[20:23], a[224:227], v[48:51], 0
ds_read_b64 v[60:61], v5 offset:27136
ds_read_b64 v[62:63], v5 offset:27392
v_mfma_f32_16x16x32_bf16 v[24:27], a[238:241], v[48:51], 0
ds_read_b64 v[64:65], v5 offset:27648
ds_read_b64 v[66:67], v5 offset:27904
v_mfma_f32_16x16x32_bf16 v[20:23], a[228:231], v[52:55], v[20:23]
v_cvt_pk_bf16_f32 v16, v44, v45
v_cvt_pk_bf16_f32 v17, v46, v47
v_mfma_f32_16x16x32_bf16 v[24:27], a[242:245], v[52:55], v[24:27]
ds_write_b64 v3, v[16:17] offset:3072
ds_read_b64_tr_b16 a[252:253], v4 offset:3072
s_waitcnt lgkmcnt(6)
v_mfma_f32_16x16x32_bf16 v[20:23], a[232:235], v[56:59], v[20:23]
ds_read_b64 v[68:69], v5 offset:28160
ds_read_b64 v[70:71], v5 offset:28416
v_mfma_f32_16x16x32_bf16 v[24:27], a[246:249], v[56:59], v[24:27]
ds_read_b64 v[72:73], v5 offset:28672
s_waitcnt lgkmcnt(5)
v_mfma_f32_16x16x32_bf16 v[28:31], v[60:63], v[48:51], 0
v_mfma_f32_16x16x32_bf16 v[28:31], v[64:67], v[52:55], v[28:31]
s_waitcnt lgkmcnt(1)
v_mfma_f32_16x16x32_bf16 v[28:31], v[68:71], v[56:59], v[28:31]
v_mfma_f32_16x16x16_bf16 v[20:23], a[236:237], a[252:253], v[20:23]
v_mfma_f32_16x16x16_bf16 v[24:27], a[250:251], a[252:253], v[24:27]
s_waitcnt lgkmcnt(0)
v_mfma_f32_16x16x16_bf16 v[28:31], v[72:73], a[252:253], v[28:31]
s_add_u32 s24, s24, 28672
s_nop 3
v_add_f32_dpp v20, v20, v20 row_ror:8 row_mask:0xf bank_mask:0x3
v_add_f32_dpp v21, v21, v21 row_ror:8 row_mask:0xf bank_mask:0x3
v_add_f32_dpp v22, v22, v22 row_ror:8 row_mask:0xf bank_mask:0x3
v_add_f32_dpp v23, v23, v23 row_ror:8 row_mask:0xf bank_mask:0x3
v_add_f32_dpp v20, v24, v24 row_ror:8 row_mask:0xf bank_mask:0xc
v_add_f32_dpp v21, v25, v25 row_ror:8 row_mask:0xf bank_mask:0xc
v_add_f32_dpp v22, v26, v26 row_ror:8 row_mask:0xf bank_mask:0xc
v_add_f32_dpp v23, v27, v27 row_ror:8 row_mask:0xf bank_mask:0xc
ds_write_b128 v13, v[20:23]
v_add_f32_dpp v28, v28, v28 row_ror:8 row_mask:0xf bank_mask:0xf
v_add_f32_dpp v29, v29, v29 row_ror:8 row_mask:0xf bank_mask:0xf
v_add_f32_dpp v30, v30, v30 row_ror:8 row_mask:0xf bank_mask:0xf
v_add_f32_dpp v31, v31, v31 row_ror:8 row_mask:0xf bank_mask:0xf
ds_write_b128 v14, v[28:31]
s_waitcnt lgkmcnt(0)
s_barrier
ds_read_b128 v[48:51], v6 offset:0
ds_read_b128 v[60:63], v6 offset:3200
ds_read_b128 v[64:67], v6 offset:6400
ds_read_b128 v[68:71], v6 offset:9600
s_waitcnt lgkmcnt(2)
v_pk_add_f32 v[48:49], v[48:49], v[60:61]
v_pk_add_f32 v[50:51], v[50:51], v[62:63]
s_waitcnt lgkmcnt(0)
v_pk_add_f32 v[64:65], v[64:65], v[68:69]
v_pk_add_f32 v[66:67], v[66:67], v[70:71]
v_pk_add_f32 v[48:49], v[48:49], v[64:65]
v_pk_add_f32 v[50:51], v[50:51], v[66:67]
v_max3_f32 v10, v48, v49, v50
v_max_f32 v10, v10, v51
s_nop 1
v_max_f32_dpp v10, v10, v10 row_ror:8 row_mask:0xf bank_mask:0xf
s_nop 1
v_max_f32_dpp v10, v10, v10 row_ror:4 row_mask:0xf bank_mask:0xf
s_nop 1
v_max_f32_dpp v10, v10, v10 row_ror:2 row_mask:0xf bank_mask:0xf
s_nop 1
v_max_f32_dpp v10, v10, v10 row_ror:1 row_mask:0xf bank_mask:0xf
s_add_u32 s17, s14, 1
v_mov_b32 v16, s17
v_mov_b32 v17, 0
s_mov_b64 exec, 1
buffer_store_dword v16, v17, s[8:11], s50 offen sc1
s_mov_b64 exec, -1
v_pk_add_f32 v[48:49], v[48:49], v[10:11] op_sel_hi:[1,0] neg_lo:[0,1] neg_hi:[0,1]
v_pk_add_f32 v[50:51], v[50:51], v[10:11] op_sel_hi:[1,0] neg_lo:[0,1] neg_hi:[0,1]
v_exp_f32 v48, v48
v_exp_f32 v49, v49
v_exp_f32 v50, v50
v_exp_f32 v51, v51
s_nop 0
v_pk_add_f32 v[18:19], v[48:49], v[50:51]
v_add_f32 v72, v18, v19
s_nop 1
v_add_f32_dpp v72, v72, v72 row_ror:8 row_mask:0xf bank_mask:0xf
s_nop 1
v_add_f32_dpp v72, v72, v72 row_ror:4 row_mask:0xf bank_mask:0xf
s_nop 1
v_add_f32_dpp v72, v72, v72 row_ror:2 row_mask:0xf bank_mask:0xf
s_nop 1
v_add_f32_dpp v72, v72, v72 row_ror:1 row_mask:0xf bank_mask:0xf
v_rcp_f32 v72, v72
s_nop 0
v_pk_mul_f32 v[48:49], v[48:49], v[72:73] op_sel_hi:[1,0]
v_pk_mul_f32 v[50:51], v[50:51], v[72:73] op_sel_hi:[1,0]
v_cvt_pk_bf16_f32 v48, v48, v49
v_cvt_pk_bf16_f32 v49, v50, v51
v_min_u32 v48, -2, v48
v_min_u32 v49, -2, v49
s_mov_b64 exec, s[20:21]
buffer_store_dwordx2 v[48:49], v8, s[8:11], s16 offen sc1
s_mov_b64 exec, -1
s_barrier
buffer_load_dwordx4 a[224:227], v1, s[8:11], s24 offen offset:0 sc1
buffer_load_dwordx4 a[228:231], v1, s[8:11], s24 offen offset:1024 sc1
buffer_load_dwordx4 a[232:235], v1, s[8:11], s24 offen offset:2048 sc1
buffer_load_dwordx2 a[236:237], v2, s[8:11], s24 offen offset:3072 sc1
buffer_load_dwordx4 a[238:241], v1, s[8:11], s24 offen offset:3584 sc1
s_add_u32 s18, s24, 4096
buffer_load_dwordx4 a[242:245], v1, s[8:11], s18 offen offset:512 sc1
buffer_load_dwordx4 a[246:249], v1, s[8:11], s18 offen offset:1536 sc1
buffer_load_dwordx2 a[250:251], v2, s[8:11], s18 offen offset:2560 sc1
s_add_u32 s14, s14, 1
s_and_b32 s17, s14, 3
s_mul_i32 s15, s17, 7168
s_add_u32 s15, s15, 44040192
s_mul_i32 s16, s17, 10240
s_add_u32 s16, s16, 44068864
s_waitcnt vmcnt(0)
s_cmp_lt_u32 s14, 63
s_cbranch_scc1 A_loop_69
s_endpgm
A_w_66:
A_loop_74:
s_barrier
buffer_load_dwordx4 v[68:71], v1, s[8:11], s15 offen offset:2048 sc1
s_add_u32 s25, s15, 4096
v_mov_b64 v[20:21], 0
v_mov_b64 v[22:23], 0
v_mov_b64 v[24:25], 0
v_mov_b64 v[26:27], 0
v_mov_b64 v[28:29], 0
v_mov_b64 v[30:31], 0
v_mov_b64 v[32:33], 0
s_nop 0
s_nop 0
s_nop 0
buffer_load_dwordx4 v[72:75], v1, s[8:11], s15 offen offset:3072 sc1
v_mov_b64 v[34:35], 0
v_mov_b64 v[36:37], 0
v_mov_b64 v[38:39], 0
v_mov_b64 v[40:41], 0
v_mov_b64 v[42:43], 0
v_mov_b64 v[44:45], 0
v_mov_b64 v[46:47], 0
s_nop 0
s_nop 0
s_nop 0
buffer_load_dwordx4 v[76:79], v1, s[8:11], s25 offen offset:0 sc1
s_nop 10
buffer_load_dwordx4 v[80:83], v1, s[8:11], s25 offen offset:1024 sc1
s_nop 10
buffer_load_dwordx4 v[84:87], v1, s[8:11], s25 offen offset:2048 sc1
s_waitcnt vmcnt(4)
v_smfmac_f32_16x16x64_bf16 v[20:23], v[68:71], a[16:23], v9
buffer_load_dwordx4 v[60:63], v1, s[8:11], s15 offen offset:0 sc1
v_smfmac_f32_16x16x64_bf16 v[24:27], v[68:71], a[72:79], v9
v_max_u32 v10, v68, v69
v_smfmac_f32_16x16x64_bf16 v[28:31], v[68:71], a[128:135], v9
v_max3_u32 v10, v10, v70, v71
v_smfmac_f32_16x16x64_bf16 v[32:35], v[68:71], a[184:191], v9
ds_write_b128 v1, v[68:71] offset:31232
s_waitcnt vmcnt(4)
v_smfmac_f32_16x16x64_bf16 v[20:23], v[72:75], a[24:31], v9
buffer_load_dwordx4 v[64:67], v1, s[8:11], s15 offen offset:1024 sc1
v_smfmac_f32_16x16x64_bf16 v[24:27], v[72:75], a[80:87], v9
v_max3_u32 v10, v10, v72, v73
v_smfmac_f32_16x16x64_bf16 v[28:31], v[72:75], a[136:143], v9
v_max3_u32 v10, v10, v74, v75
v_smfmac_f32_16x16x64_bf16 v[32:35], v[72:75], a[192:199], v9
ds_write_b128 v1, v[72:75] offset:32256
s_waitcnt vmcnt(4)
v_smfmac_f32_16x16x64_bf16 v[20:23], v[76:79], a[32:39], v9
v_max3_u32 v10, v10, v76, v77
v_smfmac_f32_16x16x64_bf16 v[24:27], v[76:79], a[88:95], v9
v_max3_u32 v10, v10, v78, v79
v_smfmac_f32_16x16x64_bf16 v[28:31], v[76:79], a[144:151], v9
v_smfmac_f32_16x16x64_bf16 v[32:35], v[76:79], a[200:207], v9
s_waitcnt vmcnt(3)
v_smfmac_f32_16x16x64_bf16 v[20:23], v[80:83], a[40:47], v9
v_max3_u32 v10, v10, v80, v81
v_smfmac_f32_16x16x64_bf16 v[24:27], v[80:83], a[96:103], v9
v_max3_u32 v10, v10, v82, v83
v_smfmac_f32_16x16x64_bf16 v[28:31], v[80:83], a[152:159], v9
v_smfmac_f32_16x16x64_bf16 v[32:35], v[80:83], a[208:215], v9
s_waitcnt vmcnt(2)
v_smfmac_f32_16x16x64_bf16 v[20:23], v[84:87], a[48:55], v9
v_max3_u32 v10, v10, v84, v85
v_smfmac_f32_16x16x64_bf16 v[24:27], v[84:87], a[104:111], v9
v_max3_u32 v10, v10, v86, v87
v_smfmac_f32_16x16x64_bf16 v[28:31], v[84:87], a[160:167], v9
v_smfmac_f32_16x16x64_bf16 v[32:35], v[84:87], a[216:223], v9
s_waitcnt vmcnt(1)
v_smfmac_f32_16x16x64_bf16 v[20:23], v[60:63], a[0:7], v9
v_max3_u32 v10, v10, v60, v61
v_smfmac_f32_16x16x64_bf16 v[24:27], v[60:63], a[56:63], v9
v_max3_u32 v10, v10, v62, v63
v_smfmac_f32_16x16x64_bf16 v[28:31], v[60:63], a[112:119], v9
v_smfmac_f32_16x16x64_bf16 v[32:35], v[60:63], a[168:175], v9
s_waitcnt vmcnt(0)
v_smfmac_f32_16x16x64_bf16 v[20:23], v[64:67], a[8:15], v9
v_max3_u32 v10, v10, v64, v65
v_smfmac_f32_16x16x64_bf16 v[24:27], v[64:67], a[64:71], v9
v_max3_u32 v10, v10, v66, v67
v_smfmac_f32_16x16x64_bf16 v[28:31], v[64:67], a[120:127], v9
v_cmp_eq_u32 vcc, -1, v10
v_smfmac_f32_16x16x64_bf16 v[32:35], v[64:67], a[176:183], v9
ds_write_b128 v1, v[64:67] offset:30208
v_cvt_pk_bf16_f32 v16, v20, v21
s_cbranch_vccnz A_retry_76
A_again_75:
v_smfmac_f32_16x16x64_bf16 v[36:39], v[60:63], v[88:95], v9
v_cvt_pk_bf16_f32 v17, v22, v23
v_smfmac_f32_16x16x64_bf16 v[36:39], v[64:67], v[96:103], v9
ds_write_b64 v3, v[16:17] offset:0
v_smfmac_f32_16x16x64_bf16 v[36:39], v[68:71], v[104:111], v9
ds_read_b64_tr_b16 v[48:49], v4 offset:0
v_smfmac_f32_16x16x64_bf16 v[36:39], v[72:75], v[112:119], v9
v_cvt_pk_bf16_f32 v18, v24, v25
v_smfmac_f32_16x16x64_bf16 v[36:39], v[76:79], v[120:127], v9
v_cvt_pk_bf16_f32 v19, v26, v27
v_smfmac_f32_16x16x64_bf16 v[36:39], v[80:83], v[128:135], v9
ds_write_b64 v3, v[18:19] offset:512
v_smfmac_f32_16x16x64_bf16 v[36:39], v[84:87], v[136:143], v9
ds_read_b64_tr_b16 v[50:51], v4 offset:512
v_smfmac_f32_16x16x64_bf16 v[40:43], v[60:63], v[144:151], v9
v_cvt_pk_bf16_f32 v16, v28, v29
v_smfmac_f32_16x16x64_bf16 v[40:43], v[64:67], v[152:159], v9
v_cvt_pk_bf16_f32 v17, v30, v31
v_smfmac_f32_16x16x64_bf16 v[40:43], v[68:71], v[160:167], v9
ds_write_b64 v3, v[16:17] offset:1024
v_smfmac_f32_16x16x64_bf16 v[40:43], v[72:75], v[168:175], v9
ds_read_b64_tr_b16 v[52:53], v4 offset:1024
v_smfmac_f32_16x16x64_bf16 v[40:43], v[76:79], v[176:183], v9
v_cvt_pk_bf16_f32 v18, v32, v33
v_smfmac_f32_16x16x64_bf16 v[40:43], v[80:83], v[184:191], v9
v_cvt_pk_bf16_f32 v19, v34, v35
v_smfmac_f32_16x16x64_bf16 v[40:43], v[84:87], v[192:199], v9
ds_write_b64 v3, v[18:19] offset:1536
v_smfmac_f32_16x16x64_bf16 v[44:47], v[60:63], v[200:207], v9
ds_read_b64_tr_b16 v[54:55], v4 offset:1536
v_smfmac_f32_16x16x64_bf16 v[44:47], v[64:67], v[208:215], v9
v_cvt_pk_bf16_f32 v16, v36, v37
v_smfmac_f32_16x16x64_bf16 v[44:47], v[68:71], v[216:223], v9
v_cvt_pk_bf16_f32 v17, v38, v39
v_smfmac_f32_16x16x64_bf16 v[44:47], v[72:75], v[224:231], v9
ds_write_b64 v3, v[16:17] offset:2048
v_smfmac_f32_16x16x64_bf16 v[44:47], v[76:79], v[232:239], v9
ds_read_b64_tr_b16 v[56:57], v4 offset:2048
v_smfmac_f32_16x16x64_bf16 v[44:47], v[80:83], v[240:247], v9
v_cvt_pk_bf16_f32 v18, v40, v41
v_smfmac_f32_16x16x64_bf16 v[44:47], v[84:87], v[248:255], v9
v_cvt_pk_bf16_f32 v19, v42, v43
ds_write_b64 v3, v[18:19] offset:2560
ds_read_b64_tr_b16 v[58:59], v4 offset:2560
s_waitcnt lgkmcnt(4)
v_mfma_f32_16x16x32_bf16 v[20:23], a[224:227], v[48:51], 0
ds_read_b64 v[60:61], v5 offset:30976
ds_read_b64 v[62:63], v5 offset:31232
v_mfma_f32_16x16x32_bf16 v[24:27], a[238:241], v[48:51], 0
ds_read_b64 v[64:65], v5 offset:31488
ds_read_b64 v[66:67], v5 offset:31744
v_mfma_f32_16x16x32_bf16 v[20:23], a[228:231], v[52:55], v[20:23]
v_cvt_pk_bf16_f32 v16, v44, v45
v_cvt_pk_bf16_f32 v17, v46, v47
v_mfma_f32_16x16x32_bf16 v[24:27], a[242:245], v[52:55], v[24:27]
ds_write_b64 v3, v[16:17] offset:3072
ds_read_b64_tr_b16 a[252:253], v4 offset:3072
s_waitcnt lgkmcnt(6)
v_mfma_f32_16x16x32_bf16 v[20:23], a[232:235], v[56:59], v[20:23]
ds_read_b64 v[68:69], v5 offset:32000
ds_read_b64 v[70:71], v5 offset:32256
v_mfma_f32_16x16x32_bf16 v[24:27], a[246:249], v[56:59], v[24:27]
ds_read_b64 v[72:73], v5 offset:32512
s_waitcnt lgkmcnt(5)
v_mfma_f32_16x16x32_bf16 v[28:31], v[60:63], v[48:51], 0
v_mfma_f32_16x16x32_bf16 v[28:31], v[64:67], v[52:55], v[28:31]
s_waitcnt lgkmcnt(1)
v_mfma_f32_16x16x32_bf16 v[28:31], v[68:71], v[56:59], v[28:31]
v_mfma_f32_16x16x16_bf16 v[20:23], a[236:237], a[252:253], v[20:23]
v_mfma_f32_16x16x16_bf16 v[24:27], a[250:251], a[252:253], v[24:27]
s_waitcnt lgkmcnt(0)
v_mfma_f32_16x16x16_bf16 v[28:31], v[72:73], a[252:253], v[28:31]
s_add_u32 s24, s24, 28672
s_nop 3
v_add_f32_dpp v20, v20, v20 row_ror:8 row_mask:0xf bank_mask:0x3
v_add_f32_dpp v21, v21, v21 row_ror:8 row_mask:0xf bank_mask:0x3
v_add_f32_dpp v22, v22, v22 row_ror:8 row_mask:0xf bank_mask:0x3
v_add_f32_dpp v23, v23, v23 row_ror:8 row_mask:0xf bank_mask:0x3
v_add_f32_dpp v20, v24, v24 row_ror:8 row_mask:0xf bank_mask:0xc
v_add_f32_dpp v21, v25, v25 row_ror:8 row_mask:0xf bank_mask:0xc
v_add_f32_dpp v22, v26, v26 row_ror:8 row_mask:0xf bank_mask:0xc
v_add_f32_dpp v23, v27, v27 row_ror:8 row_mask:0xf bank_mask:0xc
ds_write_b128 v13, v[20:23]
v_add_f32_dpp v28, v28, v28 row_ror:8 row_mask:0xf bank_mask:0xf
v_add_f32_dpp v29, v29, v29 row_ror:8 row_mask:0xf bank_mask:0xf
v_add_f32_dpp v30, v30, v30 row_ror:8 row_mask:0xf bank_mask:0xf
v_add_f32_dpp v31, v31, v31 row_ror:8 row_mask:0xf bank_mask:0xf
ds_write_b128 v14, v[28:31]
s_waitcnt lgkmcnt(0)
s_barrier
ds_read_b128 v[48:51], v6 offset:0
ds_read_b128 v[60:63], v6 offset:3200
ds_read_b128 v[64:67], v6 offset:6400
ds_read_b128 v[68:71], v6 offset:9600
s_waitcnt lgkmcnt(2)
v_pk_add_f32 v[48:49], v[48:49], v[60:61]
v_pk_add_f32 v[50:51], v[50:51], v[62:63]
s_waitcnt lgkmcnt(0)
v_pk_add_f32 v[64:65], v[64:65], v[68:69]
v_pk_add_f32 v[66:67], v[66:67], v[70:71]
v_pk_add_f32 v[48:49], v[48:49], v[64:65]
v_pk_add_f32 v[50:51], v[50:51], v[66:67]
v_max3_f32 v10, v48, v49, v50
v_max_f32 v10, v10, v51
s_nop 1
v_max_f32_dpp v10, v10, v10 row_ror:8 row_mask:0xf bank_mask:0xf
s_nop 1
v_max_f32_dpp v10, v10, v10 row_ror:4 row_mask:0xf bank_mask:0xf
s_nop 1
v_max_f32_dpp v10, v10, v10 row_ror:2 row_mask:0xf bank_mask:0xf
s_nop 1
v_max_f32_dpp v10, v10, v10 row_ror:1 row_mask:0xf bank_mask:0xf
v_pk_add_f32 v[48:49], v[48:49], v[10:11] op_sel_hi:[1,0] neg_lo:[0,1] neg_hi:[0,1]
v_pk_add_f32 v[50:51], v[50:51], v[10:11] op_sel_hi:[1,0] neg_lo:[0,1] neg_hi:[0,1]
v_exp_f32 v48, v48
v_exp_f32 v49, v49
v_exp_f32 v50, v50
v_exp_f32 v51, v51
s_nop 0
v_pk_add_f32 v[18:19], v[48:49], v[50:51]
v_add_f32 v72, v18, v19
s_nop 1
v_add_f32_dpp v72, v72, v72 row_ror:8 row_mask:0xf bank_mask:0xf
s_nop 1
v_add_f32_dpp v72, v72, v72 row_ror:4 row_mask:0xf bank_mask:0xf
s_nop 1
v_add_f32_dpp v72, v72, v72 row_ror:2 row_mask:0xf bank_mask:0xf
s_nop 1
v_add_f32_dpp v72, v72, v72 row_ror:1 row_mask:0xf bank_mask:0xf
v_rcp_f32 v72, v72
s_nop 0
v_pk_mul_f32 v[48:49], v[48:49], v[72:73] op_sel_hi:[1,0]
v_pk_mul_f32 v[50:51], v[50:51], v[72:73] op_sel_hi:[1,0]
v_cvt_pk_bf16_f32 v48, v48, v49
v_cvt_pk_bf16_f32 v49, v50, v51
v_min_u32 v48, -2, v48
v_min_u32 v49, -2, v49
s_mov_b64 exec, s[20:21]
buffer_store_dwordx2 v[48:49], v8, s[8:11], s16 offen sc1
s_mov_b64 exec, -1
s_barrier
buffer_load_dwordx4 a[224:227], v1, s[8:11], s24 offen offset:0 sc1
buffer_load_dwordx4 a[228:231], v1, s[8:11], s24 offen offset:1024 sc1
buffer_load_dwordx4 a[232:235], v1, s[8:11], s24 offen offset:2048 sc1
buffer_load_dwordx2 a[236:237], v2, s[8:11], s24 offen offset:3072 sc1
buffer_load_dwordx4 a[238:241], v1, s[8:11], s24 offen offset:3584 sc1
s_add_u32 s18, s24, 4096
buffer_load_dwordx4 a[242:245], v1, s[8:11], s18 offen offset:512 sc1
buffer_load_dwordx4 a[246:249], v1, s[8:11], s18 offen offset:1536 sc1
buffer_load_dwordx2 a[250:251], v2, s[8:11], s18 offen offset:2560 sc1
s_add_u32 s14, s14, 1
s_and_b32 s17, s14, 3
s_mul_i32 s15, s17, 7168
s_add_u32 s15, s15, 44040192
s_mul_i32 s16, s17, 10240
s_add_u32 s16, s16, 44068864
s_waitcnt vmcnt(0)
s_cmp_lt_u32 s14, 63
s_cbranch_scc1 A_loop_74
s_endpgm
A_w_67:
A_loop_79:
s_mov_b32 s17, 44109824
buffer_load_dword v16, v12, s[8:11], s17 offen sc1
FP_80:
buffer_load_dword v17, v12, s[8:11], s17 offen sc1
s_waitcnt vmcnt(1)
v_cmp_gt_u32 vcc, s14, v16
s_cbranch_vccz FPD_81
buffer_load_dword v16, v12, s[8:11], s17 offen sc1
s_waitcnt vmcnt(1)
v_cmp_gt_u32 vcc, s14, v17
s_cbranch_vccz FPD_81
s_sub_u32 s19, s19, 1
s_cbranch_scc0 FP_80
s_branch M_abort
FPD_81:
s_barrier
s_add_u32 s25, s15, 4096
buffer_load_dwordx4 v[76:79], v1, s[8:11], s25 offen offset:0 sc1
v_mov_b64 v[20:21], 0
v_mov_b64 v[22:23], 0
v_mov_b64 v[24:25], 0
v_mov_b64 v[26:27], 0
v_mov_b64 v[28:29], 0
v_mov_b64 v[30:31], 0
v_mov_b64 v[32:33], 0
s_nop 0
s_nop 0
s_nop 0
buffer_load_dwordx4 v[80:83], v1, s[8:11], s25 offen offset:1024 sc1
v_mov_b64 v[34:35], 0
v_mov_b64 v[36:37], 0
v_mov_b64 v[38:39], 0
v_mov_b64 v[40:41], 0
v_mov_b64 v[42:43], 0
v_mov_b64 v[44:45], 0
v_mov_b64 v[46:47], 0
s_nop 0
s_nop 0
s_nop 0
buffer_load_dwordx4 v[84:87], v1, s[8:11], s25 offen offset:2048 sc1
s_nop 10
buffer_load_dwordx4 v[60:63], v1, s[8:11], s15 offen offset:0 sc1
s_nop 10
buffer_load_dwordx4 v[64:67], v1, s[8:11], s15 offen offset:1024 sc1
s_waitcnt vmcnt(4)
v_smfmac_f32_16x16x64_bf16 v[20:23], v[76:79], a[32:39], v9
buffer_load_dwordx4 v[68:71], v1, s[8:11], s15 offen offset:2048 sc1
v_smfmac_f32_16x16x64_bf16 v[24:27], v[76:79], a[88:95], v9
v_max_u32 v10, v76, v77
v_smfmac_f32_16x16x64_bf16 v[28:31], v[76:79], a[144:151], v9
v_max3_u32 v10, v10, v78, v79
v_smfmac_f32_16x16x64_bf16 v[32:35], v[76:79], a[200:207], v9
ds_write_b128 v1, v[76:79] offset:34304
s_waitcnt vmcnt(4)
v_smfmac_f32_16x16x64_bf16 v[20:23], v[80:83], a[40:47], v9
buffer_load_dwordx4 v[72:75], v1, s[8:11], s15 offen offset:3072 sc1
v_smfmac_f32_16x16x64_bf16 v[24:27], v[80:83], a[96:103], v9
v_max3_u32 v10, v10, v80, v81
v_smfmac_f32_16x16x64_bf16 v[28:31], v[80:83], a[152:159], v9
v_max3_u32 v10, v10, v82, v83
v_smfmac_f32_16x16x64_bf16 v[32:35], v[80:83], a[208:215], v9
ds_write_b128 v1, v[80:83] offset:35328
s_waitcnt vmcnt(4)
v_smfmac_f32_16x16x64_bf16 v[20:23], v[84:87], a[48:55], v9
v_max3_u32 v10, v10, v84, v85
v_smfmac_f32_16x16x64_bf16 v[24:27], v[84:87], a[104:111], v9
v_max3_u32 v10, v10, v86, v87
v_smfmac_f32_16x16x64_bf16 v[28:31], v[84:87], a[160:167], v9
v_smfmac_f32_16x16x64_bf16 v[32:35], v[84:87], a[216:223], v9
s_waitcnt vmcnt(3)
v_smfmac_f32_16x16x64_bf16 v[20:23], v[60:63], a[0:7], v9
v_max3_u32 v10, v10, v60, v61
v_smfmac_f32_16x16x64_bf16 v[24:27], v[60:63], a[56:63], v9
v_max3_u32 v10, v10, v62, v63
v_smfmac_f32_16x16x64_bf16 v[28:31], v[60:63], a[112:119], v9
v_smfmac_f32_16x16x64_bf16 v[32:35], v[60:63], a[168:175], v9
s_waitcnt vmcnt(2)
v_smfmac_f32_16x16x64_bf16 v[20:23], v[64:67], a[8:15], v9
v_max3_u32 v10, v10, v64, v65
v_smfmac_f32_16x16x64_bf16 v[24:27], v[64:67], a[64:71], v9
v_max3_u32 v10, v10, v66, v67
v_smfmac_f32_16x16x64_bf16 v[28:31], v[64:67], a[120:127], v9
v_smfmac_f32_16x16x64_bf16 v[32:35], v[64:67], a[176:183], v9
s_waitcnt vmcnt(1)
v_smfmac_f32_16x16x64_bf16 v[20:23], v[68:71], a[16:23], v9
v_max3_u32 v10, v10, v68, v69
v_smfmac_f32_16x16x64_bf16 v[24:27], v[68:71], a[72:79], v9
v_max3_u32 v10, v10, v70, v71
v_smfmac_f32_16x16x64_bf16 v[28:31], v[68:71], a[128:135], v9
v_smfmac_f32_16x16x64_bf16 v[32:35], v[68:71], a[184:191], v9
s_waitcnt vmcnt(0)
v_smfmac_f32_16x16x64_bf16 v[20:23], v[72:75], a[24:31], v9
v_max3_u32 v10, v10, v72, v73
v_smfmac_f32_16x16x64_bf16 v[24:27], v[72:75], a[80:87], v9
v_max3_u32 v10, v10, v74, v75
v_smfmac_f32_16x16x64_bf16 v[28:31], v[72:75], a[136:143], v9
v_cmp_eq_u32 vcc, -1, v10
v_smfmac_f32_16x16x64_bf16 v[32:35], v[72:75], a[192:199], v9
ds_write_b128 v1, v[72:75] offset:33280
v_cvt_pk_bf16_f32 v16, v20, v21
s_cbranch_vccnz A_retry_83
A_again_82:
v_smfmac_f32_16x16x64_bf16 v[36:39], v[60:63], v[88:95], v9
v_cvt_pk_bf16_f32 v17, v22, v23
v_smfmac_f32_16x16x64_bf16 v[36:39], v[64:67], v[96:103], v9
ds_write_b64 v3, v[16:17] offset:0
v_smfmac_f32_16x16x64_bf16 v[36:39], v[68:71], v[104:111], v9
ds_read_b64_tr_b16 v[48:49], v4 offset:0
v_smfmac_f32_16x16x64_bf16 v[36:39], v[72:75], v[112:119], v9
v_cvt_pk_bf16_f32 v18, v24, v25
v_smfmac_f32_16x16x64_bf16 v[36:39], v[76:79], v[120:127], v9
v_cvt_pk_bf16_f32 v19, v26, v27
v_smfmac_f32_16x16x64_bf16 v[36:39], v[80:83], v[128:135], v9
ds_write_b64 v3, v[18:19] offset:512
v_smfmac_f32_16x16x64_bf16 v[36:39], v[84:87], v[136:143], v9
ds_read_b64_tr_b16 v[50:51], v4 offset:512
v_smfmac_f32_16x16x64_bf16 v[40:43], v[60:63], v[144:151], v9
v_cvt_pk_bf16_f32 v16, v28, v29
v_smfmac_f32_16x16x64_bf16 v[40:43], v[64:67], v[152:159], v9
v_cvt_pk_bf16_f32 v17, v30, v31
v_smfmac_f32_16x16x64_bf16 v[40:43], v[68:71], v[160:167], v9
ds_write_b64 v3, v[16:17] offset:1024
v_smfmac_f32_16x16x64_bf16 v[40:43], v[72:75], v[168:175], v9
ds_read_b64_tr_b16 v[52:53], v4 offset:1024
v_smfmac_f32_16x16x64_bf16 v[40:43], v[76:79], v[176:183], v9
v_cvt_pk_bf16_f32 v18, v32, v33
v_smfmac_f32_16x16x64_bf16 v[40:43], v[80:83], v[184:191], v9
v_cvt_pk_bf16_f32 v19, v34, v35
v_smfmac_f32_16x16x64_bf16 v[40:43], v[84:87], v[192:199], v9
ds_write_b64 v3, v[18:19] offset:1536
v_smfmac_f32_16x16x64_bf16 v[44:47], v[60:63], v[200:207], v9
ds_read_b64_tr_b16 v[54:55], v4 offset:1536
v_smfmac_f32_16x16x64_bf16 v[44:47], v[64:67], v[208:215], v9
v_cvt_pk_bf16_f32 v16, v36, v37
v_smfmac_f32_16x16x64_bf16 v[44:47], v[68:71], v[216:223], v9
v_cvt_pk_bf16_f32 v17, v38, v39
v_smfmac_f32_16x16x64_bf16 v[44:47], v[72:75], v[224:231], v9
ds_write_b64 v3, v[16:17] offset:2048
v_smfmac_f32_16x16x64_bf16 v[44:47], v[76:79], v[232:239], v9
ds_read_b64_tr_b16 v[56:57], v4 offset:2048
v_smfmac_f32_16x16x64_bf16 v[44:47], v[80:83], v[240:247], v9
v_cvt_pk_bf16_f32 v18, v40, v41
v_smfmac_f32_16x16x64_bf16 v[44:47], v[84:87], v[248:255], v9
v_cvt_pk_bf16_f32 v19, v42, v43
ds_write_b64 v3, v[18:19] offset:2560
ds_read_b64_tr_b16 v[58:59], v4 offset:2560
s_waitcnt lgkmcnt(4)
v_mfma_f32_16x16x32_bf16 v[20:23], a[224:227], v[48:51], 0
ds_read_b64 v[60:61], v5 offset:33792
ds_read_b64 v[62:63], v5 offset:34048
v_mfma_f32_16x16x32_bf16 v[24:27], a[238:241], v[48:51], 0
ds_read_b64 v[64:65], v5 offset:34304
ds_read_b64 v[66:67], v5 offset:34560
v_mfma_f32_16x16x32_bf16 v[20:23], a[228:231], v[52:55], v[20:23]
v_cvt_pk_bf16_f32 v16, v44, v45
v_cvt_pk_bf16_f32 v17, v46, v47
v_mfma_f32_16x16x32_bf16 v[24:27], a[242:245], v[52:55], v[24:27]
ds_write_b64 v3, v[16:17] offset:3072
ds_read_b64_tr_b16 a[252:253], v4 offset:3072
s_waitcnt lgkmcnt(6)
v_mfma_f32_16x16x32_bf16 v[20:23], a[232:235], v[56:59], v[20:23]
ds_read_b64 v[68:69], v5 offset:34816
ds_read_b64 v[70:71], v5 offset:35072
v_mfma_f32_16x16x32_bf16 v[24:27], a[246:249], v[56:59], v[24:27]
ds_read_b64 v[72:73], v5 offset:35328
s_waitcnt lgkmcnt(5)
v_mfma_f32_16x16x32_bf16 v[28:31], v[60:63], v[48:51], 0
v_mfma_f32_16x16x32_bf16 v[28:31], v[64:67], v[52:55], v[28:31]
s_waitcnt lgkmcnt(1)
v_mfma_f32_16x16x32_bf16 v[28:31], v[68:71], v[56:59], v[28:31]
v_mfma_f32_16x16x16_bf16 v[20:23], a[236:237], a[252:253], v[20:23]
v_mfma_f32_16x16x16_bf16 v[24:27], a[250:251], a[252:253], v[24:27]
s_waitcnt lgkmcnt(0)
v_mfma_f32_16x16x16_bf16 v[28:31], v[72:73], a[252:253], v[28:31]
s_add_u32 s24, s24, 28672
s_nop 3
v_add_f32_dpp v20, v20, v20 row_ror:8 row_mask:0xf bank_mask:0x3
v_add_f32_dpp v21, v21, v21 row_ror:8 row_mask:0xf bank_mask:0x3
v_add_f32_dpp v22, v22, v22 row_ror:8 row_mask:0xf bank_mask:0x3
v_add_f32_dpp v23, v23, v23 row_ror:8 row_mask:0xf bank_mask:0x3
v_add_f32_dpp v20, v24, v24 row_ror:8 row_mask:0xf bank_mask:0xc
v_add_f32_dpp v21, v25, v25 row_ror:8 row_mask:0xf bank_mask:0xc
v_add_f32_dpp v22, v26, v26 row_ror:8 row_mask:0xf bank_mask:0xc
v_add_f32_dpp v23, v27, v27 row_ror:8 row_mask:0xf bank_mask:0xc
ds_write_b128 v13, v[20:23]
v_add_f32_dpp v28, v28, v28 row_ror:8 row_mask:0xf bank_mask:0xf
v_add_f32_dpp v29, v29, v29 row_ror:8 row_mask:0xf bank_mask:0xf
v_add_f32_dpp v30, v30, v30 row_ror:8 row_mask:0xf bank_mask:0xf
v_add_f32_dpp v31, v31, v31 row_ror:8 row_mask:0xf bank_mask:0xf
ds_write_b128 v14, v[28:31]
s_waitcnt lgkmcnt(0)
s_barrier
s_barrier
buffer_load_dwordx4 a[224:227], v1, s[8:11], s24 offen offset:0 sc1
buffer_load_dwordx4 a[228:231], v1, s[8:11], s24 offen offset:1024 sc1
buffer_load_dwordx4 a[232:235], v1, s[8:11], s24 offen offset:2048 sc1
buffer_load_dwordx2 a[236:237], v2, s[8:11], s24 offen offset:3072 sc1
buffer_load_dwordx4 a[238:241], v1, s[8:11], s24 offen offset:3584 sc1
s_add_u32 s18, s24, 4096
buffer_load_dwordx4 a[242:245], v1, s[8:11], s18 offen offset:512 sc1
buffer_load_dwordx4 a[246:249], v1, s[8:11], s18 offen offset:1536 sc1
buffer_load_dwordx2 a[250:251], v2, s[8:11], s18 offen offset:2560 sc1
s_add_u32 s14, s14, 1
s_and_b32 s17, s14, 3
s_mul_i32 s15, s17, 7168
s_add_u32 s15, s15, 44040192
s_mul_i32 s16, s17, 10240
s_add_u32 s16, s16, 44068864
s_waitcnt vmcnt(0)
s_cmp_lt_u32 s14, 63
s_cbranch_scc1 A_loop_79
s_endpgm
A_w_68:
A_loop_86:
s_barrier
s_add_u32 s25, s15, 4096
buffer_load_dwordx4 v[84:87], v1, s[8:11], s25 offen offset:2048 sc1
v_mov_b64 v[20:21], 0
v_mov_b64 v[22:23], 0
v_mov_b64 v[24:25], 0
v_mov_b64 v[26:27], 0
v_mov_b64 v[28:29], 0
v_mov_b64 v[30:31], 0
v_mov_b64 v[32:33], 0
s_nop 0
s_nop 0
s_nop 0
buffer_load_dwordx4 v[60:63], v1, s[8:11], s15 offen offset:0 sc1
v_mov_b64 v[34:35], 0
v_mov_b64 v[36:37], 0
v_mov_b64 v[38:39], 0
v_mov_b64 v[40:41], 0
v_mov_b64 v[42:43], 0
v_mov_b64 v[44:45], 0
v_mov_b64 v[46:47], 0
s_nop 0
s_nop 0
s_nop 0
buffer_load_dwordx4 v[64:67], v1, s[8:11], s15 offen offset:1024 sc1
s_nop 10
buffer_load_dwordx4 v[68:71], v1, s[8:11], s15 offen offset:2048 sc1
s_nop 10
buffer_load_dwordx4 v[72:75], v1, s[8:11], s15 offen offset:3072 sc1
s_waitcnt vmcnt(4)
v_smfmac_f32_16x16x64_bf16 v[20:23], v[84:87], a[48:55], v9
buffer_load_dwordx4 v[76:79], v1, s[8:11], s25 offen offset:0 sc1
v_smfmac_f32_16x16x64_bf16 v[24:27], v[84:87], a[104:111], v9
v_max_u32 v10, v84, v85
v_smfmac_f32_16x16x64_bf16 v[28:31], v[84:87], a[160:167], v9
v_max3_u32 v10, v10, v86, v87
v_smfmac_f32_16x16x64_bf16 v[32:35], v[84:87], a[216:223], v9
ds_write_b128 v1, v[84:87] offset:37376
s_waitcnt vmcnt(4)
v_smfmac_f32_16x16x64_bf16 v[20:23], v[60:63], a[0:7], v9
buffer_load_dwordx4 v[80:83], v1, s[8:11], s25 offen offset:1024 sc1
v_smfmac_f32_16x16x64_bf16 v[24:27], v[60:63], a[56:63], v9
v_max3_u32 v10, v10, v60, v61
v_smfmac_f32_16x16x64_bf16 v[28:31], v[60:63], a[112:119], v9
v_max3_u32 v10, v10, v62, v63
v_smfmac_f32_16x16x64_bf16 v[32:35], v[60:63], a[168:175], v9
s_waitcnt vmcnt(4)
v_smfmac_f32_16x16x64_bf16 v[20:23], v[64:67], a[8:15], v9
v_max3_u32 v10, v10, v64, v65
v_smfmac_f32_16x16x64_bf16 v[24:27], v[64:67], a[64:71], v9
v_max3_u32 v10, v10, v66, v67
v_smfmac_f32_16x16x64_bf16 v[28:31], v[64:67], a[120:127], v9
v_smfmac_f32_16x16x64_bf16 v[32:35], v[64:67], a[176:183], v9
s_waitcnt vmcnt(3)
v_smfmac_f32_16x16x64_bf16 v[20:23], v[68:71], a[16:23], v9
v_max3_u32 v10, v10, v68, v69
v_smfmac_f32_16x16x64_bf16 v[24:27], v[68:71], a[72:79], v9
v_max3_u32 v10, v10, v70, v71
v_smfmac_f32_16x16x64_bf16 v[28:31], v[68:71], a[128:135], v9
v_smfmac_f32_16x16x64_bf16 v[32:35], v[68:71], a[184:191], v9
s_waitcnt vmcnt(2)
v_smfmac_f32_16x16x64_bf16 v[20:23], v[72:75], a[24:31], v9
v_max3_u32 v10, v10, v72, v73
v_smfmac_f32_16x16x64_bf16 v[24:27], v[72:75], a[80:87], v9
v_max3_u32 v10, v10, v74, v75
v_smfmac_f32_16x16x64_bf16 v[28:31], v[72:75], a[136:143], v9
v_smfmac_f32_16x16x64_bf16 v[32:35], v[72:75], a[192:199], v9
s_waitcnt vmcnt(1)
v_smfmac_f32_16x16x64_bf16 v[20:23], v[76:79], a[32:39], v9
v_max3_u32 v10, v10, v76, v77
v_smfmac_f32_16x16x64_bf16 v[24:27], v[76:79], a[88:95], v9
v_max3_u32 v10, v10, v78, v79
v_smfmac_f32_16x16x64_bf16 v[28:31], v[76:79], a[144:151], v9
v_smfmac_f32_16x16x64_bf16 v[32:35], v[76:79], a[200:207], v9
s_waitcnt vmcnt(0)
v_smfmac_f32_16x16x64_bf16 v[20:23], v[80:83], a[40:47], v9
v_max3_u32 v10, v10, v80, v81
v_smfmac_f32_16x16x64_bf16 v[24:27], v[80:83], a[96:103], v9
v_max3_u32 v10, v10, v82, v83
v_smfmac_f32_16x16x64_bf16 v[28:31], v[80:83], a[152:159], v9
v_cmp_eq_u32 vcc, -1, v10
v_smfmac_f32_16x16x64_bf16 v[32:35], v[80:83], a[208:215], v9
ds_write_b128 v1, v[80:83] offset:36352
v_cvt_pk_bf16_f32 v16, v20, v21
s_cbranch_vccnz A_retry_88
A_again_87:
v_smfmac_f32_16x16x64_bf16 v[36:39], v[60:63], v[88:95], v9
v_cvt_pk_bf16_f32 v17, v22, v23
v_smfmac_f32_16x16x64_bf16 v[36:39], v[64:67], v[96:103], v9
ds_write_b64 v3, v[16:17] offset:0
v_smfmac_f32_16x16x64_bf16 v[36:39], v[68:71], v[104:111], v9
ds_read_b64_tr_b16 v[48:49], v4 offset:0
v_smfmac_f32_16x16x64_bf16 v[36:39], v[72:75], v[112:119], v9
v_cvt_pk_bf16_f32 v18, v24, v25
v_smfmac_f32_16x16x64_bf16 v[36:39], v[76:79], v[120:127], v9
v_cvt_pk_bf16_f32 v19, v26, v27
v_smfmac_f32_16x16x64_bf16 v[36:39], v[80:83], v[128:135], v9
ds_write_b64 v3, v[18:19] offset:512
v_smfmac_f32_16x16x64_bf16 v[36:39], v[84:87], v[136:143], v9
ds_read_b64_tr_b16 v[50:51], v4 offset:512
v_smfmac_f32_16x16x64_bf16 v[40:43], v[60:63], v[144:151], v9
v_cvt_pk_bf16_f32 v16, v28, v29
v_smfmac_f32_16x16x64_bf16 v[40:43], v[64:67], v[152:159], v9
v_cvt_pk_bf16_f32 v17, v30, v31
v_smfmac_f32_16x16x64_bf16 v[40:43], v[68:71], v[160:167], v9
ds_write_b64 v3, v[16:17] offset:1024
v_smfmac_f32_16x16x64_bf16 v[40:43], v[72:75], v[168:175], v9
ds_read_b64_tr_b16 v[52:53], v4 offset:1024
v_smfmac_f32_16x16x64_bf16 v[40:43], v[76:79], v[176:183], v9
v_cvt_pk_bf16_f32 v18, v32, v33
v_smfmac_f32_16x16x64_bf16 v[40:43], v[80:83], v[184:191], v9
v_cvt_pk_bf16_f32 v19, v34, v35
v_smfmac_f32_16x16x64_bf16 v[40:43], v[84:87], v[192:199], v9
ds_write_b64 v3, v[18:19] offset:1536
v_smfmac_f32_16x16x64_bf16 v[44:47], v[60:63], v[200:207], v9
ds_read_b64_tr_b16 v[54:55], v4 offset:1536
v_smfmac_f32_16x16x64_bf16 v[44:47], v[64:67], v[208:215], v9
v_cvt_pk_bf16_f32 v16, v36, v37
v_smfmac_f32_16x16x64_bf16 v[44:47], v[68:71], v[216:223], v9
v_cvt_pk_bf16_f32 v17, v38, v39
v_smfmac_f32_16x16x64_bf16 v[44:47], v[72:75], v[224:231], v9
ds_write_b64 v3, v[16:17] offset:2048
v_smfmac_f32_16x16x64_bf16 v[44:47], v[76:79], v[232:239], v9
ds_read_b64_tr_b16 v[56:57], v4 offset:2048
v_smfmac_f32_16x16x64_bf16 v[44:47], v[80:83], v[240:247], v9
v_cvt_pk_bf16_f32 v18, v40, v41
v_smfmac_f32_16x16x64_bf16 v[44:47], v[84:87], v[248:255], v9
v_cvt_pk_bf16_f32 v19, v42, v43
ds_write_b64 v3, v[18:19] offset:2560
ds_read_b64_tr_b16 v[58:59], v4 offset:2560
s_waitcnt lgkmcnt(4)
v_mfma_f32_16x16x32_bf16 v[20:23], a[224:227], v[48:51], 0
ds_read_b64 v[60:61], v5 offset:36608
ds_read_b64 v[62:63], v5 offset:36864
v_mfma_f32_16x16x32_bf16 v[24:27], a[238:241], v[48:51], 0
ds_read_b64 v[64:65], v5 offset:37120
ds_read_b64 v[66:67], v5 offset:37376
v_mfma_f32_16x16x32_bf16 v[20:23], a[228:231], v[52:55], v[20:23]
v_cvt_pk_bf16_f32 v16, v44, v45
v_cvt_pk_bf16_f32 v17, v46, v47
v_mfma_f32_16x16x32_bf16 v[24:27], a[242:245], v[52:55], v[24:27]
ds_write_b64 v3, v[16:17] offset:3072
ds_read_b64_tr_b16 a[252:253], v4 offset:3072
s_waitcnt lgkmcnt(6)
v_mfma_f32_16x16x32_bf16 v[20:23], a[232:235], v[56:59], v[20:23]
ds_read_b64 v[68:69], v5 offset:37632
ds_read_b64 v[70:71], v5 offset:37888
v_mfma_f32_16x16x32_bf16 v[24:27], a[246:249], v[56:59], v[24:27]
ds_read_b64 v[72:73], v5 offset:38144
s_waitcnt lgkmcnt(5)
v_mfma_f32_16x16x32_bf16 v[28:31], v[60:63], v[48:51], 0
v_mfma_f32_16x16x32_bf16 v[28:31], v[64:67], v[52:55], v[28:31]
s_waitcnt lgkmcnt(1)
v_mfma_f32_16x16x32_bf16 v[28:31], v[68:71], v[56:59], v[28:31]
v_mfma_f32_16x16x16_bf16 v[20:23], a[236:237], a[252:253], v[20:23]
v_mfma_f32_16x16x16_bf16 v[24:27], a[250:251], a[252:253], v[24:27]
s_waitcnt lgkmcnt(0)
v_mfma_f32_16x16x16_bf16 v[28:31], v[72:73], a[252:253], v[28:31]
s_add_u32 s24, s24, 28672
s_nop 3
v_add_f32_dpp v20, v20, v20 row_ror:8 row_mask:0xf bank_mask:0x3
v_add_f32_dpp v21, v21, v21 row_ror:8 row_mask:0xf bank_mask:0x3
v_add_f32_dpp v22, v22, v22 row_ror:8 row_mask:0xf bank_mask:0x3
v_add_f32_dpp v23, v23, v23 row_ror:8 row_mask:0xf bank_mask:0x3
v_add_f32_dpp v20, v24, v24 row_ror:8 row_mask:0xf bank_mask:0xc
v_add_f32_dpp v21, v25, v25 row_ror:8 row_mask:0xf bank_mask:0xc
v_add_f32_dpp v22, v26, v26 row_ror:8 row_mask:0xf bank_mask:0xc
v_add_f32_dpp v23, v27, v27 row_ror:8 row_mask:0xf bank_mask:0xc
ds_write_b128 v13, v[20:23]
v_add_f32_dpp v28, v28, v28 row_ror:8 row_mask:0xf bank_mask:0xf
v_add_f32_dpp v29, v29, v29 row_ror:8 row_mask:0xf bank_mask:0xf
v_add_f32_dpp v30, v30, v30 row_ror:8 row_mask:0xf bank_mask:0xf
v_add_f32_dpp v31, v31, v31 row_ror:8 row_mask:0xf bank_mask:0xf
ds_write_b128 v14, v[28:31]
s_waitcnt lgkmcnt(0)
s_barrier
s_barrier
s_add_u32 s26, s14, 2
s_and_b32 s26, s26, 3
s_mul_i32 s26, s26, 10240
s_add_u32 s26, s26, 44068864
v_mov_b32 v48, -1
v_mov_b32 v49, -1
v_mov_b32 v50, -1
v_mov_b32 v51, -1
s_mov_b64 exec, s[22:23]
buffer_store_dwordx4 v[48:51], v0, s[8:11], s26 offen sc1
s_mov_b64 exec, -1
buffer_load_dwordx4 a[224:227], v1, s[8:11], s24 offen offset:0 sc1
buffer_load_dwordx4 a[228:231], v1, s[8:11], s24 offen offset:1024 sc1
buffer_load_dwordx4 a[232:235], v1, s[8:11], s24 offen offset:2048 sc1
buffer_load_dwordx2 a[236:237], v2, s[8:11], s24 offen offset:3072 sc1
buffer_load_dwordx4 a[238:241], v1, s[8:11], s24 offen offset:3584 sc1
s_add_u32 s18, s24, 4096
buffer_load_dwordx4 a[242:245], v1, s[8:11], s18 offen offset:512 sc1
buffer_load_dwordx4 a[246:249], v1, s[8:11], s18 offen offset:1536 sc1
buffer_load_dwordx2 a[250:251], v2, s[8:11], s18 offen offset:2560 sc1
s_add_u32 s14, s14, 1
s_and_b32 s17, s14, 3
s_mul_i32 s15, s17, 7168
s_add_u32 s15, s15, 44040192
s_mul_i32 s16, s17, 10240
s_add_u32 s16, s16, 44068864
s_waitcnt vmcnt(0)
s_cmp_lt_u32 s14, 63
s_cbranch_scc1 A_loop_86
s_endpgm
M_chainB:
s_sub_u32 s12, s12, 16
v_and_b32 v0, 63, v0
v_lshlrev_b32 v1, 4, v0
s_mul_i32 s17, s13, 1792
v_add_u32 v2, s17, v1
v_min_u32 v12, 47, v0
v_lshlrev_b32 v12, 4, v12
s_add_u32 s18, s17, 1024
v_add_u32 v3, s18, v12
v_and_b32 v13, 7, v0
v_bfe_u32 v14, v0, 3, 1
v_lshrrev_b32 v15, 4, v0
v_and_b32 v16, 3, v0
v_lshlrev_b32 v11, 2, v16
s_lshl_b32 s17, s13, 7
v_add_u32 v11, s17, v11
s_mul_i32 s17, s13, 2560
v_add_u32 v4, s17, v1
v_lshrrev_b32 v16, 1, v15
v_lshlrev_b32 v5, 8, v16
v_lshl_add_u32 v5, v14, 7, v5
v_lshl_add_u32 v5, v13, 4, v5
s_add_u32 s17, s17, 2048
v_add_u32 v5, s17, v5
v_and_b32 v17, 3, v0
v_bfe_u32 v18, v0, 2, 2
v_lshrrev_b32 v16, 5, v0
v_lshl_add_u32 v18, v16, 2, v18
v_and_b32 v16, 1, v15
v_lshl_add_u32 v16, v18, 1, v16
v_lshlrev_b32 v6, 2, v17
v_xor_b32 v16, v16, v6
v_and_b32 v16, 15, v16
v_lshlrev_b32 v6, 8, v17
v_lshl_add_u32 v6, v16, 4, v6
s_lshl_b32 s17, s13, 10
s_add_u32 s17, s17, 7168
v_add_u32 v6, s17, v6
v_lshlrev_b32 v16, 2, v15
v_and_b32 v7, 15, v0
v_xor_b32 v7, v7, v16
v_and_b32 v7, 15, v7
v_lshlrev_b32 v7, 4, v7
v_lshl_add_u32 v7, v15, 8, v7
v_add_u32 v7, 7168, v7
v_and_b32 v16, 1, v0
v_lshl_add_u32 v16, v16, 2, v15
v_bfe_u32 v8, v0, 3, 1
v_lshl_add_u32 v16, v8, 4, v16
v_bfe_u32 v8, v0, 2, 1
v_lshl_add_u32 v16, v8, 3, v16
v_lshlrev_b32 v16, 4, v16
v_bfe_u32 v8, v0, 1, 1
v_lshl_add_u32 v8, v8, 3, v16
s_lshl_b32 s17, s12, 9
v_add_u32 v8, s17, v8
s_lshl_b32 s50, s12, 2
s_add_u32 s50, s50, 44109824
v_mov_b32 v9, 0x44444444
v_mov_b32 v16, 0xeeeeeeee
v_cmp_ne_u32 vcc, 0, v14
s_nop 1
v_cndmask_b32 v9, v9, v16, vcc
s_cmp_lg_u32 s12, 0
s_cbranch_scc1 B_warm_91
s_lshl_b32 s17, s13, 6
v_add_u32 v12, s17, v0
v_lshlrev_b32 v12, 7, v12
s_mov_b32 s17, 44040192
buffer_load_dword v13, v12, s[8:11], s17 offen sc1
s_mov_b32 s17, 44072960
buffer_load_dword v13, v12, s[8:11], s17 offen sc1
v_lshrrev_b32 v14, 7, v12
v_cmp_gt_u32 vcc, 37, v14
s_and_saveexec_b64 s[20:21], vcc
s_cbranch_execz B_w3_92
s_mov_b32 s17, 44105728
buffer_load_dword v13, v12, s[8:11], s17 offen sc1
B_w3_92:
s_mov_b64 exec, s[20:21]
s_waitcnt vmcnt(0)
B_warm_91:
v_and_b32 v12, 3, v0
v_lshlrev_b32 v12, 7, v12
s_lshl_b32 s17, s13, 9
s_add_u32 s17, s17, 44114560
B_wp_93:
buffer_load_dword v13, v12, s[8:11], s17 offen sc1
s_waitcnt vmcnt(0)
v_cmp_gt_u32 vcc, 7, v13
s_cbranch_vccz B_wpo_94
s_sleep 1
s_sub_u32 s19, s19, 1
s_cbranch_scc0 B_wp_93
s_branch M_abort
B_wpo_94:
s_mul_i32 s17, s12, 458752
s_mul_i32 s18, s13, 114688
s_add_u32 s17, s17, s18
s_add_u32 s17, s17, 6422528
s_mul_i32 s18, s13, 12288
s_add_u32 s18, s18, 12288
v_add_u32 v10, s18, v1
buffer_load_dwordx4 a[32:35], v1, s[8:11], s17 offen offset:0 sc1
buffer_load_dwordx4 a[36:39], v1, s[8:11], s17 offen offset:1024 sc1
buffer_load_dwordx4 a[40:43], v1, s[8:11], s17 offen offset:2048 sc1
buffer_load_dwordx4 a[44:47], v1, s[8:11], s17 offen offset:3072 sc1
s_add_u32 s17, s17, 4096
buffer_load_dwordx4 a[48:51], v1, s[8:11], s17 offen offset:0 sc1
buffer_load_dwordx4 a[52:55], v1, s[8:11], s17 offen offset:1024 sc1
buffer_load_dwordx4 a[56:59], v1, s[8:11], s17 offen offset:2048 sc1
buffer_load_dwordx4 a[60:63], v1, s[8:11], s17 offen offset:3072 sc1
s_add_u32 s17, s17, 4096
buffer_load_dwordx4 a[64:67], v1, s[8:11], s17 offen offset:0 sc1
buffer_load_dwordx4 a[68:71], v1, s[8:11], s17 offen offset:1024 sc1
buffer_load_dwordx4 a[72:75], v1, s[8:11], s17 offen offset:2048 sc1
buffer_load_dwordx4 a[76:79], v1, s[8:11], s17 offen offset:3072 sc1
s_add_u32 s17, s17, 4096
s_mul_i32 s18, s13, 12288
s_add_u32 m0, s18, 12288
s_nop 0
buffer_load_dwordx4 v1, s[8:11], s17 offen offset:0 sc1 lds
s_mul_i32 s18, s13, 12288
s_add_u32 m0, s18, 12288
s_nop 0
buffer_load_dwordx4 v1, s[8:11], s17 offen offset:1024 sc1 lds
buffer_load_dwordx4 a[80:83], v1, s[8:11], s17 offen offset:2048 sc1
buffer_load_dwordx4 a[84:87], v1, s[8:11], s17 offen offset:3072 sc1
s_add_u32 s17, s17, 4096
buffer_load_dwordx4 a[88:91], v1, s[8:11], s17 offen offset:0 sc1
buffer_load_dwordx4 a[92:95], v1, s[8:11], s17 offen offset:1024 sc1
buffer_load_dwordx4 a[96:99], v1, s[8:11], s17 offen offset:2048 sc1
buffer_load_dwordx4 a[100:103], v1, s[8:11], s17 offen offset:3072 sc1
s_add_u32 s17, s17, 4096
buffer_load_dwordx4 a[104:107], v1, s[8:11], s17 offen offset:0 sc1
buffer_load_dwordx4 a[108:111], v1, s[8:11], s17 offen offset:1024 sc1
buffer_load_dwordx4 a[112:115], v1, s[8:11], s17 offen offset:2048 sc1
buffer_load_dwordx4 a[116:119], v1, s[8:11], s17 offen offset:3072 sc1
s_add_u32 s17, s17, 4096
buffer_load_dwordx4 a[120:123], v1, s[8:11], s17 offen offset:0 sc1
buffer_load_dwordx4 a[124:127], v1, s[8:11], s17 offen offset:1024 sc1
s_mul_i32 s18, s13, 12288
s_add_u32 m0, s18, 12288
s_nop 0
buffer_load_dwordx4 v1, s[8:11], s17 offen offset:2048 sc1 lds
s_mul_i32 s18, s13, 12288
s_add_u32 m0, s18, 12288
s_nop 0
buffer_load_dwordx4 v1, s[8:11], s17 offen offset:3072 sc1 lds
s_add_u32 s17, s17, 4096
buffer_load_dwordx4 a[128:131], v1, s[8:11], s17 offen offset:0 sc1
buffer_load_dwordx4 a[132:135], v1, s[8:11], s17 offen offset:1024 sc1
buffer_load_dwordx4 a[136:139], v1, s[8:11], s17 offen offset:2048 sc1
buffer_load_dwordx4 a[140:143], v1, s[8:11], s17 offen offset:3072 sc1
s_add_u32 s17, s17, 4096
buffer_load_dwordx4 a[144:147], v1, s[8:11], s17 offen offset:0 sc1
buffer_load_dwordx4 a[148:151], v1, s[8:11], s17 offen offset:1024 sc1
buffer_load_dwordx4 a[152:155], v1, s[8:11], s17 offen offset:2048 sc1
buffer_load_dwordx4 a[156:159], v1, s[8:11], s17 offen offset:3072 sc1
s_add_u32 s17, s17, 4096
buffer_load_dwordx4 a[160:163], v1, s[8:11], s17 offen offset:0 sc1
buffer_load_dwordx4 a[164:167], v1, s[8:11], s17 offen offset:1024 sc1
buffer_load_dwordx4 a[168:171], v1, s[8:11], s17 offen offset:2048 sc1
buffer_load_dwordx4 a[172:175], v1, s[8:11], s17 offen offset:3072 sc1
s_add_u32 s17, s17, 4096
s_mul_i32 s18, s13, 12288
s_add_u32 m0, s18, 16384
s_nop 0
buffer_load_dwordx4 v1, s[8:11], s17 offen offset:0 sc1 lds
s_mul_i32 s18, s13, 12288
s_add_u32 m0, s18, 16384
s_nop 0
buffer_load_dwordx4 v1, s[8:11], s17 offen offset:1024 sc1 lds
buffer_load_dwordx4 a[176:179], v1, s[8:11], s17 offen offset:2048 sc1
buffer_load_dwordx4 a[180:183], v1, s[8:11], s17 offen offset:3072 sc1
s_add_u32 s17, s17, 4096
buffer_load_dwordx4 a[184:187], v1, s[8:11], s17 offen offset:0 sc1
buffer_load_dwordx4 a[188:191], v1, s[8:11], s17 offen offset:1024 sc1
buffer_load_dwordx4 a[192:195], v1, s[8:11], s17 offen offset:2048 sc1
buffer_load_dwordx4 a[196:199], v1, s[8:11], s17 offen offset:3072 sc1
s_add_u32 s17, s17, 4096
buffer_load_dwordx4 a[200:203], v1, s[8:11], s17 offen offset:0 sc1
buffer_load_dwordx4 a[204:207], v1, s[8:11], s17 offen offset:1024 sc1
buffer_load_dwordx4 a[208:211], v1, s[8:11], s17 offen offset:2048 sc1
buffer_load_dwordx4 a[212:215], v1, s[8:11], s17 offen offset:3072 sc1
s_add_u32 s17, s17, 4096
buffer_load_dwordx4 a[216:219], v1, s[8:11], s17 offen offset:0 sc1
buffer_load_dwordx4 a[220:223], v1, s[8:11], s17 offen offset:1024 sc1
s_mul_i32 s18, s13, 12288
s_add_u32 m0, s18, 16384
s_nop 0
buffer_load_dwordx4 v1, s[8:11], s17 offen offset:2048 sc1 lds
s_mul_i32 s18, s13, 12288
s_add_u32 m0, s18, 16384
s_nop 0
buffer_load_dwordx4 v1, s[8:11], s17 offen offset:3072 sc1 lds
s_add_u32 s17, s17, 4096
buffer_load_dwordx4 a[224:227], v1, s[8:11], s17 offen offset:0 sc1
buffer_load_dwordx4 a[228:231], v1, s[8:11], s17 offen offset:1024 sc1
buffer_load_dwordx4 a[232:235], v1, s[8:11], s17 offen offset:2048 sc1
buffer_load_dwordx4 a[236:239], v1, s[8:11], s17 offen offset:3072 sc1
s_add_u32 s17, s17, 4096
buffer_load_dwordx4 a[240:243], v1, s[8:11], s17 offen offset:0 sc1
buffer_load_dwordx4 a[244:247], v1, s[8:11], s17 offen offset:1024 sc1
buffer_load_dwordx4 a[248:251], v1, s[8:11], s17 offen offset:2048 sc1
buffer_load_dwordx4 a[252:255], v1, s[8:11], s17 offen offset:3072 sc1
s_add_u32 s17, s17, 4096
buffer_load_dwordx4 v[80:83], v1, s[8:11], s17 offen offset:0 sc1
buffer_load_dwordx4 v[84:87], v1, s[8:11], s17 offen offset:1024 sc1
buffer_load_dwordx4 v[88:91], v1, s[8:11], s17 offen offset:2048 sc1
buffer_load_dwordx4 v[92:95], v1, s[8:11], s17 offen offset:3072 sc1
s_add_u32 s17, s17, 4096
s_mul_i32 s18, s13, 12288
s_add_u32 m0, s18, 20480
s_nop 0
buffer_load_dwordx4 v1, s[8:11], s17 offen offset:0 sc1 lds
s_mul_i32 s18, s13, 12288
s_add_u32 m0, s18, 20480
s_nop 0
buffer_load_dwordx4 v1, s[8:11], s17 offen offset:1024 sc1 lds
buffer_load_dwordx4 v[96:99], v1, s[8:11], s17 offen offset:2048 sc1
buffer_load_dwordx4 v[100:103], v1, s[8:11], s17 offen offset:3072 sc1
s_add_u32 s17, s17, 4096
buffer_load_dwordx4 v[104:107], v1, s[8:11], s17 offen offset:0 sc1
buffer_load_dwordx4 v[108:111], v1, s[8:11], s17 offen offset:1024 sc1
buffer_load_dwordx4 v[112:115], v1, s[8:11], s17 offen offset:2048 sc1
buffer_load_dwordx4 v[116:119], v1, s[8:11], s17 offen offset:3072 sc1
s_add_u32 s17, s17, 4096
buffer_load_dwordx4 v[120:123], v1, s[8:11], s17 offen offset:0 sc1
buffer_load_dwordx4 v[124:127], v1, s[8:11], s17 offen offset:1024 sc1
buffer_load_dwordx4 v[128:131], v1, s[8:11], s17 offen offset:2048 sc1
buffer_load_dwordx4 v[132:135], v1, s[8:11], s17 offen offset:3072 sc1
s_add_u32 s17, s17, 4096
buffer_load_dwordx4 v[136:139], v1, s[8:11], s17 offen offset:0 sc1
buffer_load_dwordx4 v[140:143], v1, s[8:11], s17 offen offset:1024 sc1
s_mul_i32 s18, s13, 12288
s_add_u32 m0, s18, 20480
s_nop 0
buffer_load_dwordx4 v1, s[8:11], s17 offen offset:2048 sc1 lds
s_mul_i32 s18, s13, 12288
s_add_u32 m0, s18, 20480
s_nop 0
buffer_load_dwordx4 v1, s[8:11], s17 offen offset:3072 sc1 lds
s_add_u32 s17, s17, 4096
buffer_load_dwordx4 v[144:147], v1, s[8:11], s17 offen offset:0 sc1
buffer_load_dwordx4 v[148:151], v1, s[8:11], s17 offen offset:1024 sc1
buffer_load_dwordx4 v[152:155], v1, s[8:11], s17 offen offset:2048 sc1
buffer_load_dwordx4 v[156:159], v1, s[8:11], s17 offen offset:3072 sc1
s_add_u32 s17, s17, 4096
buffer_load_dwordx4 v[160:163], v1, s[8:11], s17 offen offset:0 sc1
buffer_load_dwordx4 v[164:167], v1, s[8:11], s17 offen offset:1024 sc1
buffer_load_dwordx4 v[168:171], v1, s[8:11], s17 offen offset:2048 sc1
buffer_load_dwordx4 v[172:175], v1, s[8:11], s17 offen offset:3072 sc1
s_add_u32 s17, s17, 4096
buffer_load_dwordx4 v[176:179], v1, s[8:11], s17 offen offset:0 sc1
buffer_load_dwordx4 v[180:183], v1, s[8:11], s17 offen offset:1024 sc1
buffer_load_dwordx4 v[184:187], v1, s[8:11], s17 offen offset:2048 sc1
buffer_load_dwordx4 v[188:191], v1, s[8:11], s17 offen offset:3072 sc1
s_add_u32 s17, s17, 4096
buffer_load_dwordx4 v[192:195], v1, s[8:11], s17 offen offset:0 sc1
buffer_load_dwordx4 v[196:199], v1, s[8:11], s17 offen offset:1024 sc1
buffer_load_dwordx4 v[200:203], v1, s[8:11], s17 offen offset:2048 sc1
buffer_load_dwordx4 v[204:207], v1, s[8:11], s17 offen offset:3072 sc1
s_add_u32 s17, s17, 4096
buffer_load_dwordx4 v[208:211], v1, s[8:11], s17 offen offset:0 sc1
buffer_load_dwordx4 v[212:215], v1, s[8:11], s17 offen offset:1024 sc1
buffer_load_dwordx4 v[216:219], v1, s[8:11], s17 offen offset:2048 sc1
buffer_load_dwordx4 v[220:223], v1, s[8:11], s17 offen offset:3072 sc1
s_add_u32 s17, s17, 4096
buffer_load_dwordx4 v[224:227], v1, s[8:11], s17 offen offset:0 sc1
buffer_load_dwordx4 v[228:231], v1, s[8:11], s17 offen offset:1024 sc1
buffer_load_dwordx4 v[232:235], v1, s[8:11], s17 offen offset:2048 sc1
buffer_load_dwordx4 v[236:239], v1, s[8:11], s17 offen offset:3072 sc1
s_add_u32 s17, s17, 4096
buffer_load_dwordx4 v[240:243], v1, s[8:11], s17 offen offset:0 sc1
buffer_load_dwordx4 v[244:247], v1, s[8:11], s17 offen offset:1024 sc1
buffer_load_dwordx4 v[248:251], v1, s[8:11], s17 offen offset:2048 sc1
buffer_load_dwordx4 v[252:255], v1, s[8:11], s17 offen offset:3072 sc1
v_mov_b32 v28, 0
v_mov_b32 v29, 0
v_mov_b32 v30, 0
v_mov_b32 v31, 0
v_mov_b32 v32, 0
v_mov_b32 v33, 0
v_mov_b32 v34, 0
v_mov_b32 v35, 0
s_waitcnt vmcnt(0) lgkmcnt(0)
s_mov_b32 s14, 0
s_mov_b32 s15, 44040192
s_mov_b32 s16, 44068864
s_mul_i32 s24, s12, 32768
s_lshl_b32 s17, s13, 13
s_add_u32 s24, s24, s17
s_add_u32 s24, s24, 12845056
s_mov_b32 s27, 44142208
s_mov_b32 s92, 44113536
M_md_95:
v_mbcnt_lo_u32_b32 v12, -1, 0
v_mbcnt_hi_u32_b32 v12, -1, v12
v_and_b32 v12, 7, v12
v_lshlrev_b32 v12, 5, v12
global_load_dword v13, v12, s[4:5] sc1
s_waitcnt vmcnt(0)
v_readlane_b32 s18, v13, 0
v_readlane_b32 s17, v13, 1
s_add_u32 s18, s18, s17
v_readlane_b32 s17, v13, 2
s_add_u32 s18, s18, s17
v_readlane_b32 s17, v13, 3
s_add_u32 s18, s18, s17
v_readlane_b32 s17, v13, 4
s_add_u32 s18, s18, s17
v_readlane_b32 s17, v13, 5
s_add_u32 s18, s18, s17
v_readlane_b32 s17, v13, 6
s_add_u32 s18, s18, s17
v_readlane_b32 s17, v13, 7
s_add_u32 s18, s18, s17
v_readlane_b32 s17, v13, 0
s_mov_b32 s51, 0
s_cmp_ge_u32 s17, 32
s_cbranch_scc1 M_mdd_96
s_mov_b32 s51, 1
s_cmp_ge_u32 s18, 256
s_cbranch_scc1 M_mdd_96
s_sleep 4
s_sub_u32 s19, s19, 1
s_cbranch_scc0 M_md_95
s_branch M_abort
M_mdd_96:
s_cmp_eq_u32 s51, 1
s_cbranch_scc1 B_m_98
B_m_97:
B_loop_99:
PM_100:
buffer_load_dwordx4 v[12:15], v2, s[8:11], s15 offen sc1
buffer_load_dwordx4 v[16:19], v3, s[8:11], s15 offen sc1
v_mov_b32 v21, 0
buffer_load_dword v20, v21, s[8:11], s92 offen sc1
s_waitcnt vmcnt(0)
v_max3_u32 v27, v12, v13, v14
v_max3_u32 v27, v27, v15, v16
v_max3_u32 v27, v27, v17, v18
v_max_u32 v27, v27, v19
v_cmp_eq_u32 vcc, -1, v27
s_cbranch_vccnz PMR_101
v_cmp_ge_u32 vcc, s14, v20
s_cbranch_vccnz PMR_101
ds_write_b128 v2, v[12:15] offset:0
ds_write_b128 v3, v[16:19] offset:0
s_waitcnt lgkmcnt(0)
s_barrier
ds_read_b128 v[52:55], v1 offset:0
ds_read_b128 v[56:59], v1 offset:1024
ds_read_b128 v[60:63], v1 offset:2048
ds_read_b128 v[64:67], v1 offset:3072
ds_read_b128 v[68:71], v1 offset:4096
ds_read_b128 v[72:75], v1 offset:5120
ds_read_b128 v[76:79], v1 offset:6144
s_add_u32 s18, s24, 4096
s_waitcnt lgkmcnt(6)
v_smfmac_f32_16x16x64_bf16 v[28:31], v[52:55], a[32:39], v9
ds_read_b128 v[12:15], v10 offset:0
s_waitcnt lgkmcnt(6)
v_smfmac_f32_16x16x64_bf16 v[28:31], v[56:59], a[40:47], v9
ds_read_b128 v[16:19], v10 offset:1024
s_waitcnt lgkmcnt(6)
v_smfmac_f32_16x16x64_bf16 v[28:31], v[60:63], a[48:55], v9
s_waitcnt lgkmcnt(5)
v_smfmac_f32_16x16x64_bf16 v[28:31], v[64:67], a[56:63], v9
s_waitcnt lgkmcnt(4)
v_smfmac_f32_16x16x64_bf16 v[28:31], v[68:71], a[64:71], v9
s_waitcnt lgkmcnt(3)
v_smfmac_f32_16x16x64_bf16 v[28:31], v[72:75], a[72:79], v9
buffer_load_dwordx4 a[0:3], v1, s[8:11], s24 offen offset:0 sc1
s_waitcnt lgkmcnt(2)
s_waitcnt lgkmcnt(0)
v_smfmac_f32_16x16x64_bf16 v[28:31], v[76:79], v[12:19], v9
buffer_load_dwordx4 a[4:7], v1, s[8:11], s24 offen offset:1024 sc1
v_smfmac_f32_16x16x64_bf16 v[32:35], v[52:55], a[80:87], v9
ds_read_b128 v[20:23], v10 offset:2048
v_smfmac_f32_16x16x64_bf16 v[32:35], v[56:59], a[88:95], v9
ds_read_b128 v[24:27], v10 offset:3072
v_smfmac_f32_16x16x64_bf16 v[32:35], v[60:63], a[96:103], v9
v_cvt_pk_bf16_f32 v36, v28, v29
v_smfmac_f32_16x16x64_bf16 v[32:35], v[64:67], a[104:111], v9
v_cvt_pk_bf16_f32 v38, v30, v31
v_smfmac_f32_16x16x64_bf16 v[32:35], v[68:71], a[112:119], v9
v_mov_b64 v[28:29], 0
v_smfmac_f32_16x16x64_bf16 v[32:35], v[72:75], a[120:127], v9
buffer_load_dwordx4 a[8:11], v1, s[8:11], s24 offen offset:2048 sc1
v_mov_b64 v[30:31], 0
s_waitcnt lgkmcnt(0)
v_smfmac_f32_16x16x64_bf16 v[32:35], v[76:79], v[20:27], v9
buffer_load_dwordx4 a[12:15], v1, s[8:11], s24 offen offset:3072 sc1
v_smfmac_f32_16x16x64_bf16 v[28:31], v[52:55], a[128:135], v9
ds_read_b128 v[12:15], v10 offset:4096
v_smfmac_f32_16x16x64_bf16 v[28:31], v[56:59], a[136:143], v9
ds_read_b128 v[16:19], v10 offset:5120
v_smfmac_f32_16x16x64_bf16 v[28:31], v[60:63], a[144:151], v9
v_cvt_pk_bf16_f32 v44, v32, v33
v_smfmac_f32_16x16x64_bf16 v[28:31], v[64:67], a[152:159], v9
v_cvt_pk_bf16_f32 v46, v34, v35
v_smfmac_f32_16x16x64_bf16 v[28:31], v[68:71], a[160:167], v9
v_mov_b64 v[32:33], 0
v_smfmac_f32_16x16x64_bf16 v[28:31], v[72:75], a[168:175], v9
buffer_load_dwordx4 a[16:19], v1, s[8:11], s18 offen offset:0 sc1
v_mov_b64 v[34:35], 0
s_waitcnt lgkmcnt(0)
v_smfmac_f32_16x16x64_bf16 v[28:31], v[76:79], v[12:19], v9
buffer_load_dwordx4 a[20:23], v1, s[8:11], s18 offen offset:1024 sc1
v_smfmac_f32_16x16x64_bf16 v[32:35], v[52:55], a[176:183], v9
ds_read_b128 v[20:23], v10 offset:6144
v_smfmac_f32_16x16x64_bf16 v[32:35], v[56:59], a[184:191], v9
ds_read_b128 v[24:27], v10 offset:7168
v_smfmac_f32_16x16x64_bf16 v[32:35], v[60:63], a[192:199], v9
v_cvt_pk_bf16_f32 v37, v28, v29
v_smfmac_f32_16x16x64_bf16 v[32:35], v[64:67], a[200:207], v9
v_cvt_pk_bf16_f32 v39, v30, v31
v_smfmac_f32_16x16x64_bf16 v[32:35], v[68:71], a[208:215], v9
v_mov_b64 v[28:29], 0
v_smfmac_f32_16x16x64_bf16 v[32:35], v[72:75], a[216:223], v9
buffer_load_dwordx4 a[24:27], v1, s[8:11], s18 offen offset:2048 sc1
v_mov_b64 v[30:31], 0
s_waitcnt lgkmcnt(0)
v_smfmac_f32_16x16x64_bf16 v[32:35], v[76:79], v[20:27], v9
buffer_load_dwordx4 a[28:31], v1, s[8:11], s18 offen offset:3072 sc1
v_smfmac_f32_16x16x64_bf16 v[28:31], v[52:55], a[224:231], v9
ds_read_b128 v[12:15], v10 offset:8192
v_smfmac_f32_16x16x64_bf16 v[28:31], v[56:59], a[232:239], v9
ds_read_b128 v[16:19], v10 offset:9216
v_smfmac_f32_16x16x64_bf16 v[28:31], v[60:63], a[240:247], v9
v_cvt_pk_bf16_f32 v45, v32, v33
v_smfmac_f32_16x16x64_bf16 v[28:31], v[64:67], a[248:255], v9
v_cvt_pk_bf16_f32 v47, v34, v35
v_smfmac_f32_16x16x64_bf16 v[28:31], v[68:71], v[80:87], v9
v_mov_b64 v[32:33], 0
v_smfmac_f32_16x16x64_bf16 v[28:31], v[72:75], v[88:95], v9
v_mov_b64 v[34:35], 0
s_waitcnt lgkmcnt(0)
v_smfmac_f32_16x16x64_bf16 v[28:31], v[76:79], v[12:19], v9
v_smfmac_f32_16x16x64_bf16 v[32:35], v[52:55], v[96:103], v9
ds_read_b128 v[20:23], v10 offset:10240
v_smfmac_f32_16x16x64_bf16 v[32:35], v[56:59], v[104:111], v9
ds_read_b128 v[24:27], v10 offset:11264
v_smfmac_f32_16x16x64_bf16 v[32:35], v[60:63], v[112:119], v9
v_cvt_pk_bf16_f32 v40, v28, v29
v_smfmac_f32_16x16x64_bf16 v[32:35], v[64:67], v[120:127], v9
v_cvt_pk_bf16_f32 v42, v30, v31
v_smfmac_f32_16x16x64_bf16 v[32:35], v[68:71], v[128:135], v9
v_mov_b64 v[28:29], 0
v_smfmac_f32_16x16x64_bf16 v[32:35], v[72:75], v[136:143], v9
v_mov_b64 v[30:31], 0
s_waitcnt lgkmcnt(0)
v_smfmac_f32_16x16x64_bf16 v[32:35], v[76:79], v[20:27], v9
v_smfmac_f32_16x16x64_bf16 v[28:31], v[52:55], v[144:151], v9
v_smfmac_f32_16x16x64_bf16 v[28:31], v[56:59], v[152:159], v9
v_smfmac_f32_16x16x64_bf16 v[28:31], v[60:63], v[160:167], v9
v_cvt_pk_bf16_f32 v48, v32, v33
v_smfmac_f32_16x16x64_bf16 v[28:31], v[64:67], v[168:175], v9
v_cvt_pk_bf16_f32 v50, v34, v35
v_smfmac_f32_16x16x64_bf16 v[28:31], v[68:71], v[176:183], v9
v_mov_b64 v[32:33], 0
v_smfmac_f32_16x16x64_bf16 v[28:31], v[72:75], v[184:191], v9
v_mov_b64 v[34:35], 0
v_smfmac_f32_16x16x64_bf16 v[28:31], v[76:79], v[192:199], v9
v_smfmac_f32_16x16x64_bf16 v[32:35], v[52:55], v[200:207], v9
v_smfmac_f32_16x16x64_bf16 v[32:35], v[56:59], v[208:215], v9
v_smfmac_f32_16x16x64_bf16 v[32:35], v[60:63], v[216:223], v9
v_cvt_pk_bf16_f32 v41, v28, v29
v_smfmac_f32_16x16x64_bf16 v[32:35], v[64:67], v[224:231], v9
v_cvt_pk_bf16_f32 v43, v30, v31
v_smfmac_f32_16x16x64_bf16 v[32:35], v[68:71], v[232:239], v9
v_mov_b64 v[28:29], 0
v_smfmac_f32_16x16x64_bf16 v[32:35], v[72:75], v[240:247], v9
v_mov_b64 v[30:31], 0
v_smfmac_f32_16x16x64_bf16 v[32:35], v[76:79], v[248:255], v9
s_add_u32 s24, s24, 458752
s_nop 6
v_cvt_pk_bf16_f32 v49, v32, v33
v_cvt_pk_bf16_f32 v51, v34, v35
v_mov_b64 v[32:33], 0
v_mov_b64 v[34:35], 0
s_waitcnt vmcnt(0)
s_add_u32 s25, s14, 1
s_mov_b32 s17, 44109952
buffer_load_dword v12, v11, s[8:11], s17 offen sc1
FP_102:
buffer_load_dword v13, v11, s[8:11], s17 offen sc1
s_waitcnt vmcnt(1)
v_cmp_gt_u32 vcc, s25, v12
s_cbranch_vccz FPD_103
buffer_load_dword v12, v11, s[8:11], s17 offen sc1
s_waitcnt vmcnt(1)
v_cmp_gt_u32 vcc, s25, v13
s_cbranch_vccz FPD_103
s_sub_u32 s19, s19, 1
s_cbranch_scc0 FP_102
s_branch M_abort
FPD_103:
buffer_load_dwordx4 v[52:55], v4, s[8:11], s16 offen sc1
buffer_load_dwordx4 v[56:59], v4, s[8:11], s16 offen offset:1024 sc1
buffer_load_dwordx4 v[60:63], v5, s[8:11], s16 offen sc1
B_again_104:
s_waitcnt vmcnt(2)
v_smfmac_f32_16x16x64_bf16 v[28:31], v[52:55], a[0:7], v9
v_max_u32 v27, v52, v53
v_smfmac_f32_16x16x64_bf16 v[32:35], v[52:55], a[8:15], v9
v_max3_u32 v27, v27, v54, v55
s_waitcnt vmcnt(1)
v_smfmac_f32_16x16x64_bf16 v[28:31], v[56:59], a[16:23], v9
v_max3_u32 v27, v27, v56, v57
v_smfmac_f32_16x16x64_bf16 v[32:35], v[56:59], a[24:31], v9
v_max3_u32 v27, v27, v58, v59
s_waitcnt vmcnt(0)
v_smfmac_f32_16x16x64_bf16 v[28:31], v[60:63], v[36:43], v9
v_max3_u32 v27, v27, v60, v61
v_smfmac_f32_16x16x64_bf16 v[32:35], v[60:63], v[44:51], v9
v_max3_u32 v27, v27, v62, v63
v_cmp_eq_u32 vcc, -1, v27
s_cbranch_vccnz B_retry_105
s_nop 5
v_permlane32_swap_b32 v28, v32
v_permlane32_swap_b32 v29, v33
v_permlane32_swap_b32 v30, v34
v_permlane32_swap_b32 v31, v35
v_pk_add_f32 v[28:29], v[28:29], v[32:33]
v_pk_add_f32 v[30:31], v[30:31], v[34:35]
ds_write_b128 v6, v[28:31]
s_waitcnt lgkmcnt(0)
s_barrier
s_cmp_lg_u32 s13, 0
s_cbranch_scc1 B_nofin_108
ds_read_b128 v[12:15], v7 offset:0
ds_read_b128 v[16:19], v7 offset:1024
ds_read_b128 v[20:23], v7 offset:2048
ds_read_b128 v[24:27], v7 offset:3072
s_add_u32 s17, s14, 1
v_mov_b32 v32, s17
v_mov_b32 v33, 0
s_mov_b64 exec, 1
buffer_store_dword v32, v33, s[8:11], s50 offen
s_mov_b64 exec, -1
s_add_u32 s17, s14, 1
s_and_b32 s17, s17, 3
s_mul_i32 s25, s17, 7168
s_add_u32 s25, s25, 44040192
s_waitcnt lgkmcnt(2)
v_pk_add_f32 v[12:13], v[12:13], v[16:17]
v_pk_add_f32 v[14:15], v[14:15], v[18:19]
s_waitcnt lgkmcnt(0)
v_pk_add_f32 v[20:21], v[20:21], v[24:25]
v_pk_add_f32 v[22:23], v[22:23], v[26:27]
v_pk_add_f32 v[12:13], v[12:13], v[20:21]
v_pk_add_f32 v[14:15], v[14:15], v[22:23]
s_nop 1
v_permlane32_swap_b32 v12, v14
v_permlane32_swap_b32 v13, v15
s_nop 1
v_permlane16_swap_b32 v12, v13
v_permlane16_swap_b32 v14, v15
v_cvt_pk_bf16_f32 v12, v12, v13
v_cvt_pk_bf16_f32 v13, v14, v15
v_min_u32 v12, -2, v12
v_min_u32 v13, -2, v13
buffer_store_dwordx2 v[12:13], v8, s[8:11], s25 offen
B_nofin_108:
s_cmp_lg_u32 s13, 1
s_cbranch_scc1 B_nr_110
s_cmp_eq_u32 s14, 0
s_cbranch_scc1 B_nr_110
s_sub_u32 s26, s14, 1
s_mov_b32 s17, 44113792
v_mov_b32 v21, 0
B_pe_111:
buffer_load_dword v20, v21, s[8:11], s17 offen sc1
s_waitcnt vmcnt(0)
v_cmp_gt_u32 vcc, s26, v20
s_cbranch_vccz B_oke_112
s_sub_u32 s19, s19, 1
s_cbranch_scc0 B_pe_111
s_branch M_abort
B_oke_112:
s_and_b32 s26, s26, 3
s_mul_i32 s26, s26, 7168
s_add_u32 s26, s26, 44040192
v_mov_b32 v20, -1
v_mov_b32 v21, -1
buffer_store_dwordx2 v[20:21], v8, s[8:11], s26 offen
B_nr_110:
s_barrier
B_join_109:
v_mov_b64 v[28:29], 0
v_mov_b64 v[30:31], 0
v_mov_b64 v[32:33], 0
v_mov_b64 v[34:35], 0
s_add_u32 s27, s27, 7168
s_add_u32 s14, s14, 1
s_and_b32 s17, s14, 3
s_mul_i32 s15, s17, 7168
s_add_u32 s15, s15, 44040192
s_mul_i32 s16, s17, 10240
s_add_u32 s16, s16, 44068864
s_cmp_lt_u32 s14, 63
s_cbranch_scc1 B_loop_99
s_add_u32 s12, s12, 16
s_endpgm
B_m_98:
B_loop_113:
PM_114:
buffer_load_dwordx4 v[12:15], v2, s[8:11], s15 offen sc1
buffer_load_dwordx4 v[16:19], v3, s[8:11], s15 offen sc1
v_mov_b32 v21, 0
buffer_load_dword v20, v21, s[8:11], s92 offen sc1
s_waitcnt vmcnt(0)
v_max3_u32 v27, v12, v13, v14
v_max3_u32 v27, v27, v15, v16
v_max3_u32 v27, v27, v17, v18
v_max_u32 v27, v27, v19
v_cmp_eq_u32 vcc, -1, v27
s_cbranch_vccnz PMR_115
v_cmp_ge_u32 vcc, s14, v20
s_cbranch_vccnz PMR_115
ds_write_b128 v2, v[12:15] offset:0
ds_write_b128 v3, v[16:19] offset:0
s_waitcnt lgkmcnt(0)
s_barrier
ds_read_b128 v[52:55], v1 offset:0
ds_read_b128 v[56:59], v1 offset:1024
ds_read_b128 v[60:63], v1 offset:2048
ds_read_b128 v[64:67], v1 offset:3072
ds_read_b128 v[68:71], v1 offset:4096
ds_read_b128 v[72:75], v1 offset:5120
ds_read_b128 v[76:79], v1 offset:6144
s_add_u32 s18, s24, 4096
s_waitcnt lgkmcnt(6)
v_smfmac_f32_16x16x64_bf16 v[28:31], v[52:55], a[32:39], v9
ds_read_b128 v[12:15], v10 offset:0
s_waitcnt lgkmcnt(6)
v_smfmac_f32_16x16x64_bf16 v[28:31], v[56:59], a[40:47], v9
ds_read_b128 v[16:19], v10 offset:1024
s_waitcnt lgkmcnt(6)
v_smfmac_f32_16x16x64_bf16 v[28:31], v[60:63], a[48:55], v9
s_waitcnt lgkmcnt(5)
v_smfmac_f32_16x16x64_bf16 v[28:31], v[64:67], a[56:63], v9
s_waitcnt lgkmcnt(4)
v_smfmac_f32_16x16x64_bf16 v[28:31], v[68:71], a[64:71], v9
s_waitcnt lgkmcnt(3)
v_smfmac_f32_16x16x64_bf16 v[28:31], v[72:75], a[72:79], v9
buffer_load_dwordx4 a[0:3], v1, s[8:11], s24 offen offset:0 sc1
s_waitcnt lgkmcnt(2)
s_waitcnt lgkmcnt(0)
v_smfmac_f32_16x16x64_bf16 v[28:31], v[76:79], v[12:19], v9
buffer_load_dwordx4 a[4:7], v1, s[8:11], s24 offen offset:1024 sc1
v_smfmac_f32_16x16x64_bf16 v[32:35], v[52:55], a[80:87], v9
ds_read_b128 v[20:23], v10 offset:2048
v_smfmac_f32_16x16x64_bf16 v[32:35], v[56:59], a[88:95], v9
ds_read_b128 v[24:27], v10 offset:3072
v_smfmac_f32_16x16x64_bf16 v[32:35], v[60:63], a[96:103], v9
v_cvt_pk_bf16_f32 v36, v28, v29
v_smfmac_f32_16x16x64_bf16 v[32:35], v[64:67], a[104:111], v9
v_cvt_pk_bf16_f32 v38, v30, v31
v_smfmac_f32_16x16x64_bf16 v[32:35], v[68:71], a[112:119], v9
v_mov_b64 v[28:29], 0
v_smfmac_f32_16x16x64_bf16 v[32:35], v[72:75], a[120:127], v9
buffer_load_dwordx4 a[8:11], v1, s[8:11], s24 offen offset:2048 sc1
v_mov_b64 v[30:31], 0
s_waitcnt lgkmcnt(0)
v_smfmac_f32_16x16x64_bf16 v[32:35], v[76:79], v[20:27], v9
buffer_load_dwordx4 a[12:15], v1, s[8:11], s24 offen offset:3072 sc1
v_smfmac_f32_16x16x64_bf16 v[28:31], v[52:55], a[128:135], v9
ds_read_b128 v[12:15], v10 offset:4096
v_smfmac_f32_16x16x64_bf16 v[28:31], v[56:59], a[136:143], v9
ds_read_b128 v[16:19], v10 offset:5120
v_smfmac_f32_16x16x64_bf16 v[28:31], v[60:63], a[144:151], v9
v_cvt_pk_bf16_f32 v44, v32, v33
v_smfmac_f32_16x16x64_bf16 v[28:31], v[64:67], a[152:159], v9
v_cvt_pk_bf16_f32 v46, v34, v35
v_smfmac_f32_16x16x64_bf16 v[28:31], v[68:71], a[160:167], v9
v_mov_b64 v[32:33], 0
v_smfmac_f32_16x16x64_bf16 v[28:31], v[72:75], a[168:175], v9
buffer_load_dwordx4 a[16:19], v1, s[8:11], s18 offen offset:0 sc1
v_mov_b64 v[34:35], 0
s_waitcnt lgkmcnt(0)
v_smfmac_f32_16x16x64_bf16 v[28:31], v[76:79], v[12:19], v9
buffer_load_dwordx4 a[20:23], v1, s[8:11], s18 offen offset:1024 sc1
v_smfmac_f32_16x16x64_bf16 v[32:35], v[52:55], a[176:183], v9
ds_read_b128 v[20:23], v10 offset:6144
v_smfmac_f32_16x16x64_bf16 v[32:35], v[56:59], a[184:191], v9
ds_read_b128 v[24:27], v10 offset:7168
v_smfmac_f32_16x16x64_bf16 v[32:35], v[60:63], a[192:199], v9
v_cvt_pk_bf16_f32 v37, v28, v29
v_smfmac_f32_16x16x64_bf16 v[32:35], v[64:67], a[200:207], v9
v_cvt_pk_bf16_f32 v39, v30, v31
v_smfmac_f32_16x16x64_bf16 v[32:35], v[68:71], a[208:215], v9
v_mov_b64 v[28:29], 0
v_smfmac_f32_16x16x64_bf16 v[32:35], v[72:75], a[216:223], v9
buffer_load_dwordx4 a[24:27], v1, s[8:11], s18 offen offset:2048 sc1
v_mov_b64 v[30:31], 0
s_waitcnt lgkmcnt(0)
v_smfmac_f32_16x16x64_bf16 v[32:35], v[76:79], v[20:27], v9
buffer_load_dwordx4 a[28:31], v1, s[8:11], s18 offen offset:3072 sc1
v_smfmac_f32_16x16x64_bf16 v[28:31], v[52:55], a[224:231], v9
ds_read_b128 v[12:15], v10 offset:8192
v_smfmac_f32_16x16x64_bf16 v[28:31], v[56:59], a[232:239], v9
ds_read_b128 v[16:19], v10 offset:9216
v_smfmac_f32_16x16x64_bf16 v[28:31], v[60:63], a[240:247], v9
v_cvt_pk_bf16_f32 v45, v32, v33
v_smfmac_f32_16x16x64_bf16 v[28:31], v[64:67], a[248:255], v9
v_cvt_pk_bf16_f32 v47, v34, v35
v_smfmac_f32_16x16x64_bf16 v[28:31], v[68:71], v[80:87], v9
v_mov_b64 v[32:33], 0
v_smfmac_f32_16x16x64_bf16 v[28:31], v[72:75], v[88:95], v9
v_mov_b64 v[34:35], 0
s_waitcnt lgkmcnt(0)
v_smfmac_f32_16x16x64_bf16 v[28:31], v[76:79], v[12:19], v9
v_smfmac_f32_16x16x64_bf16 v[32:35], v[52:55], v[96:103], v9
ds_read_b128 v[20:23], v10 offset:10240
v_smfmac_f32_16x16x64_bf16 v[32:35], v[56:59], v[104:111], v9
ds_read_b128 v[24:27], v10 offset:11264
v_smfmac_f32_16x16x64_bf16 v[32:35], v[60:63], v[112:119], v9
v_cvt_pk_bf16_f32 v40, v28, v29
v_smfmac_f32_16x16x64_bf16 v[32:35], v[64:67], v[120:127], v9
v_cvt_pk_bf16_f32 v42, v30, v31
v_smfmac_f32_16x16x64_bf16 v[32:35], v[68:71], v[128:135], v9
v_mov_b64 v[28:29], 0
v_smfmac_f32_16x16x64_bf16 v[32:35], v[72:75], v[136:143], v9
v_mov_b64 v[30:31], 0
s_waitcnt lgkmcnt(0)
v_smfmac_f32_16x16x64_bf16 v[32:35], v[76:79], v[20:27], v9
v_smfmac_f32_16x16x64_bf16 v[28:31], v[52:55], v[144:151], v9
v_smfmac_f32_16x16x64_bf16 v[28:31], v[56:59], v[152:159], v9
v_smfmac_f32_16x16x64_bf16 v[28:31], v[60:63], v[160:167], v9
v_cvt_pk_bf16_f32 v48, v32, v33
v_smfmac_f32_16x16x64_bf16 v[28:31], v[64:67], v[168:175], v9
v_cvt_pk_bf16_f32 v50, v34, v35
v_smfmac_f32_16x16x64_bf16 v[28:31], v[68:71], v[176:183], v9
v_mov_b64 v[32:33], 0
v_smfmac_f32_16x16x64_bf16 v[28:31], v[72:75], v[184:191], v9
v_mov_b64 v[34:35], 0
v_smfmac_f32_16x16x64_bf16 v[28:31], v[76:79], v[192:199], v9
v_smfmac_f32_16x16x64_bf16 v[32:35], v[52:55], v[200:207], v9
v_smfmac_f32_16x16x64_bf16 v[32:35], v[56:59], v[208:215], v9
v_smfmac_f32_16x16x64_bf16 v[32:35], v[60:63], v[216:223], v9
v_cvt_pk_bf16_f32 v41, v28, v29
v_smfmac_f32_16x16x64_bf16 v[32:35], v[64:67], v[224:231], v9
v_cvt_pk_bf16_f32 v43, v30, v31
v_smfmac_f32_16x16x64_bf16 v[32:35], v[68:71], v[232:239], v9
v_mov_b64 v[28:29], 0
v_smfmac_f32_16x16x64_bf16 v[32:35], v[72:75], v[240:247], v9
v_mov_b64 v[30:31], 0
v_smfmac_f32_16x16x64_bf16 v[32:35], v[76:79], v[248:255], v9
s_add_u32 s24, s24, 458752
s_nop 6
v_cvt_pk_bf16_f32 v49, v32, v33
v_cvt_pk_bf16_f32 v51, v34, v35
v_mov_b64 v[32:33], 0
v_mov_b64 v[34:35], 0
s_waitcnt vmcnt(0)
s_add_u32 s25, s14, 1
s_mov_b32 s17, 44109952
buffer_load_dword v12, v11, s[8:11], s17 offen sc1
FP_116:
buffer_load_dword v13, v11, s[8:11], s17 offen sc1
s_waitcnt vmcnt(1)
v_cmp_gt_u32 vcc, s25, v12
s_cbranch_vccz FPD_117
buffer_load_dword v12, v11, s[8:11], s17 offen sc1
s_waitcnt vmcnt(1)
v_cmp_gt_u32 vcc, s25, v13
s_cbranch_vccz FPD_117
s_sub_u32 s19, s19, 1
s_cbranch_scc0 FP_116
s_branch M_abort
FPD_117:
buffer_load_dwordx4 v[52:55], v4, s[8:11], s16 offen sc1
buffer_load_dwordx4 v[56:59], v4, s[8:11], s16 offen offset:1024 sc1
buffer_load_dwordx4 v[60:63], v5, s[8:11], s16 offen sc1
B_again_118:
s_waitcnt vmcnt(2)
v_smfmac_f32_16x16x64_bf16 v[28:31], v[52:55], a[0:7], v9
v_max_u32 v27, v52, v53
v_smfmac_f32_16x16x64_bf16 v[32:35], v[52:55], a[8:15], v9
v_max3_u32 v27, v27, v54, v55
s_waitcnt vmcnt(1)
v_smfmac_f32_16x16x64_bf16 v[28:31], v[56:59], a[16:23], v9
v_max3_u32 v27, v27, v56, v57
v_smfmac_f32_16x16x64_bf16 v[32:35], v[56:59], a[24:31], v9
v_max3_u32 v27, v27, v58, v59
s_waitcnt vmcnt(0)
v_smfmac_f32_16x16x64_bf16 v[28:31], v[60:63], v[36:43], v9
v_max3_u32 v27, v27, v60, v61
v_smfmac_f32_16x16x64_bf16 v[32:35], v[60:63], v[44:51], v9
v_max3_u32 v27, v27, v62, v63
v_cmp_eq_u32 vcc, -1, v27
s_cbranch_vccnz B_retry_119
s_nop 5
v_permlane32_swap_b32 v28, v32
v_permlane32_swap_b32 v29, v33
v_permlane32_swap_b32 v30, v34
v_permlane32_swap_b32 v31, v35
v_pk_add_f32 v[28:29], v[28:29], v[32:33]
v_pk_add_f32 v[30:31], v[30:31], v[34:35]
ds_write_b128 v6, v[28:31]
s_waitcnt lgkmcnt(0)
s_barrier
s_cmp_lg_u32 s13, 0
s_cbranch_scc1 B_nofin_122
ds_read_b128 v[12:15], v7 offset:0
ds_read_b128 v[16:19], v7 offset:1024
ds_read_b128 v[20:23], v7 offset:2048
ds_read_b128 v[24:27], v7 offset:3072
s_add_u32 s17, s14, 1
v_mov_b32 v32, s17
v_mov_b32 v33, 0
s_mov_b64 exec, 1
buffer_store_dword v32, v33, s[8:11], s50 offen sc1
s_mov_b64 exec, -1
s_add_u32 s17, s14, 1
s_and_b32 s17, s17, 3
s_mul_i32 s25, s17, 7168
s_add_u32 s25, s25, 44040192
s_waitcnt lgkmcnt(2)
v_pk_add_f32 v[12:13], v[12:13], v[16:17]
v_pk_add_f32 v[14:15], v[14:15], v[18:19]
s_waitcnt lgkmcnt(0)
v_pk_add_f32 v[20:21], v[20:21], v[24:25]
v_pk_add_f32 v[22:23], v[22:23], v[26:27]
v_pk_add_f32 v[12:13], v[12:13], v[20:21]
v_pk_add_f32 v[14:15], v[14:15], v[22:23]
s_nop 1
v_permlane32_swap_b32 v12, v14
v_permlane32_swap_b32 v13, v15
s_nop 1
v_permlane16_swap_b32 v12, v13
v_permlane16_swap_b32 v14, v15
v_cvt_pk_bf16_f32 v12, v12, v13
v_cvt_pk_bf16_f32 v13, v14, v15
v_min_u32 v12, -2, v12
v_min_u32 v13, -2, v13
buffer_store_dwordx2 v[12:13], v8, s[8:11], s25 offen sc1
B_nofin_122:
s_cmp_lg_u32 s13, 1
s_cbranch_scc1 B_nr_124
s_cmp_eq_u32 s14, 0
s_cbranch_scc1 B_nr_124
s_sub_u32 s26, s14, 1
s_mov_b32 s17, 44113792
v_mov_b32 v21, 0
B_pe_125:
buffer_load_dword v20, v21, s[8:11], s17 offen sc1
s_waitcnt vmcnt(0)
v_cmp_gt_u32 vcc, s26, v20
s_cbranch_vccz B_oke_126
s_sub_u32 s19, s19, 1
s_cbranch_scc0 B_pe_125
s_branch M_abort
B_oke_126:
s_and_b32 s26, s26, 3
s_mul_i32 s26, s26, 7168
s_add_u32 s26, s26, 44040192
v_mov_b32 v20, -1
v_mov_b32 v21, -1
buffer_store_dwordx2 v[20:21], v8, s[8:11], s26 offen sc1
B_nr_124:
s_barrier
B_join_123:
v_mov_b64 v[28:29], 0
v_mov_b64 v[30:31], 0
v_mov_b64 v[32:33], 0
v_mov_b64 v[34:35], 0
s_add_u32 s27, s27, 7168
s_add_u32 s14, s14, 1
s_and_b32 s17, s14, 3
s_mul_i32 s15, s17, 7168
s_add_u32 s15, s15, 44040192
s_mul_i32 s16, s17, 10240
s_add_u32 s16, s16, 44068864
s_cmp_lt_u32 s14, 63
s_cbranch_scc1 B_loop_113
s_add_u32 s12, s12, 16
s_endpgm
M_helper:
v_lshlrev_b32 v1, 7, v0
v_mov_b32 v2, 0
M_md_127:
v_mbcnt_lo_u32_b32 v40, -1, 0
v_mbcnt_hi_u32_b32 v40, -1, v40
v_and_b32 v40, 7, v40
v_lshlrev_b32 v40, 5, v40
global_load_dword v41, v40, s[4:5] sc1
s_waitcnt vmcnt(0)
v_readlane_b32 s18, v41, 0
v_readlane_b32 s17, v41, 1
s_add_u32 s18, s18, s17
v_readlane_b32 s17, v41, 2
s_add_u32 s18, s18, s17
v_readlane_b32 s17, v41, 3
s_add_u32 s18, s18, s17
v_readlane_b32 s17, v41, 4
s_add_u32 s18, s18, s17
v_readlane_b32 s17, v41, 5
s_add_u32 s18, s18, s17
v_readlane_b32 s17, v41, 6
s_add_u32 s18, s18, s17
v_readlane_b32 s17, v41, 7
s_add_u32 s18, s18, s17
v_readlane_b32 s17, v41, 0
s_mov_b32 s51, 0
s_cmp_ge_u32 s17, 32
s_cbranch_scc1 M_mdd_128
s_mov_b32 s51, 1
s_cmp_ge_u32 s18, 256
s_cbranch_scc1 M_mdd_128
s_sleep 4
s_sub_u32 s19, s19, 1
s_cbranch_scc0 M_md_127
s_branch M_abort
M_mdd_128:
s_cmp_eq_u32 s51, 1
s_cbranch_scc1 H_m_130
H_m_129:
s_mov_b32 s14, 0
s_mov_b32 s24, 12845056
s_mov_b32 s27, 42205184
s_mov_b32 s92, 44126848
s_cmp_lg_u32 s12, 31
s_cbranch_scc1 EX_no_135
v_and_b32 v7, 63, v0
v_lshlrev_b32 v4, 4, v7
s_mul_i32 s17, s13, 1792
v_add_u32 v4, s17, v4
v_min_u32 v7, 47, v7
v_lshlrev_b32 v7, 4, v7
s_add_u32 s17, s17, 1024
v_add_u32 v5, s17, v7
v_mov_b32 v6, 0
s_mov_b32 s14, 1
s_mov_b32 s27, 44142208
EX_loop_136:
s_and_b32 s17, s14, 3
s_mul_i32 s15, s17, 7168
s_add_u32 s15, s15, 44040192
EX_poll_137:
buffer_load_dwordx4 v[8:11], v4, s[8:11], s15 offen sc1
buffer_load_dwordx4 v[12:15], v5, s[8:11], s15 offen sc1
s_waitcnt vmcnt(0)
v_max3_u32 v16, v8, v9, v10
v_max3_u32 v16, v16, v11, v12
v_max3_u32 v16, v16, v13, v14
v_max_u32 v16, v16, v15
v_cmp_eq_u32 vcc, -1, v16
s_cbranch_vccz EX_ok_138
s_sleep 4
s_sub_u32 s19, s19, 1
s_cbranch_scc0 EX_poll_137
s_branch M_abort
EX_ok_138:
buffer_store_dwordx4 v[8:11], v4, s[8:11], s27 offen sc1
buffer_store_dwordx4 v[12:15], v5, s[8:11], s27 offen sc1
s_barrier
s_cmp_lg_u32 s13, 0
s_cbranch_scc1 EX_s_139
v_mov_b32 v16, s14
s_mov_b32 s17, 44113792
s_mov_b64 exec, 1
buffer_store_dword v16, v6, s[8:11], s17 offen
s_mov_b64 exec, -1
EX_s_139:
s_add_u32 s27, s27, 7168
s_add_u32 s14, s14, 1
s_cmp_le_u32 s14, 63
s_cbranch_scc1 EX_loop_136
s_waitcnt vmcnt(0)
s_endpgm
EX_no_135:
s_cmp_eq_u32 s12, 31
s_cbranch_scc1 PF_pf_134_b
s_cmp_eq_u32 s13, 0
s_cbranch_scc0 PF_pf_134_a
PF_loop_131:
PF_p2_132:
buffer_load_dword v3, v2, s[8:11], s92 offen sc1
s_waitcnt vmcnt(0)
v_cmp_gt_u32 vcc, 28, v3
s_cbranch_vccz PF_g2_133
s_sleep 1
s_sub_u32 s19, s19, 1
s_cbranch_scc0 PF_p2_132
s_branch M_abort
PF_g2_133:
s_add_u32 s17, s14, 1
v_mov_b32 v3, s17
s_mov_b32 s17, 44113536
s_mov_b64 exec, 1
buffer_store_dword v3, v2, s[8:11], s17 offen
s_mov_b32 s17, 44113664
buffer_store_dword v3, v2, s[8:11], s17 offen sc1
s_mov_b64 exec, -1
s_add_u32 s14, s14, 1
s_add_u32 s92, s92, 128
s_cmp_lt_u32 s14, 63
s_cbranch_scc1 PF_loop_131
s_branch PF_g2_133_end
PF_pf_134_a:
s_sub_u32 s26, s13, 1
s_branch PF_pf_134_c
PF_pf_134_b:
s_add_u32 s26, s13, 3
PF_pf_134_c:
PF_g2_133_end:
s_waitcnt vmcnt(0)
s_endpgm
H_m_130:
s_mov_b32 s14, 0
s_mov_b32 s24, 12845056
s_mov_b32 s27, 42205184
s_mov_b32 s92, 44126848
s_cmp_lg_u32 s12, 31
s_cbranch_scc1 EX_no_144
v_and_b32 v7, 63, v0
v_lshlrev_b32 v4, 4, v7
s_mul_i32 s17, s13, 1792
v_add_u32 v4, s17, v4
v_min_u32 v7, 47, v7
v_lshlrev_b32 v7, 4, v7
s_add_u32 s17, s17, 1024
v_add_u32 v5, s17, v7
v_mov_b32 v6, 0
s_mov_b32 s14, 1
s_mov_b32 s27, 44142208
EX_loop_145:
s_and_b32 s17, s14, 3
s_mul_i32 s15, s17, 7168
s_add_u32 s15, s15, 44040192
EX_poll_146:
buffer_load_dwordx4 v[8:11], v4, s[8:11], s15 offen sc1
buffer_load_dwordx4 v[12:15], v5, s[8:11], s15 offen sc1
s_waitcnt vmcnt(0)
v_max3_u32 v16, v8, v9, v10
v_max3_u32 v16, v16, v11, v12
v_max3_u32 v16, v16, v13, v14
v_max_u32 v16, v16, v15
v_cmp_eq_u32 vcc, -1, v16
s_cbranch_vccz EX_ok_147
s_sleep 4
s_sub_u32 s19, s19, 1
s_cbranch_scc0 EX_poll_146
s_branch M_abort
EX_ok_147:
buffer_store_dwordx4 v[8:11], v4, s[8:11], s27 offen sc1
buffer_store_dwordx4 v[12:15], v5, s[8:11], s27 offen sc1
s_barrier
s_cmp_lg_u32 s13, 0
s_cbranch_scc1 EX_s_148
v_mov_b32 v16, s14
s_mov_b32 s17, 44113792
s_mov_b64 exec, 1
buffer_store_dword v16, v6, s[8:11], s17 offen sc1
s_mov_b64 exec, -1
EX_s_148:
s_add_u32 s27, s27, 7168
s_add_u32 s14, s14, 1
s_cmp_le_u32 s14, 63
s_cbranch_scc1 EX_loop_145
s_waitcnt vmcnt(0)
s_endpgm
EX_no_144:
s_cmp_eq_u32 s12, 31
s_cbranch_scc1 PF_pf_143_b
s_cmp_eq_u32 s13, 0
s_cbranch_scc0 PF_pf_143_a
PF_loop_140:
PF_p2_141:
buffer_load_dword v3, v2, s[8:11], s92 offen sc1
s_waitcnt vmcnt(0)
v_cmp_gt_u32 vcc, 28, v3
s_cbranch_vccz PF_g2_142
s_sleep 1
s_sub_u32 s19, s19, 1
s_cbranch_scc0 PF_p2_141
s_branch M_abort
PF_g2_142:
s_add_u32 s17, s14, 1
v_mov_b32 v3, s17
s_mov_b32 s17, 44113536
s_mov_b64 exec, 1
buffer_store_dword v3, v2, s[8:11], s17 offen sc1
s_mov_b32 s17, 44113664
buffer_store_dword v3, v2, s[8:11], s17 offen sc1
s_mov_b64 exec, -1
s_add_u32 s14, s14, 1
s_add_u32 s92, s92, 128
s_cmp_lt_u32 s14, 63
s_cbranch_scc1 PF_loop_140
s_branch PF_g2_142_end
PF_pf_143_a:
s_sub_u32 s26, s13, 1
s_branch PF_pf_143_c
PF_pf_143_b:
s_add_u32 s26, s13, 3
PF_pf_143_c:
PF_g2_142_end:
s_waitcnt vmcnt(0)
s_endpgm
M_vx:
v_and_b32 v0, 63, v0
v_lshlrev_b32 v1, 4, v0
v_mov_b32 v2, 0
v_mov_b32 v3, 1
s_mul_i32 s22, s12, 2341
s_lshr_b32 s22, s22, 16
s_mul_i32 s17, s22, 28
s_sub_u32 s17, s12, s17
s_lshr_b32 s20, s17, 1
s_and_b32 s21, s17, 1
s_lshr_b32 s29, s13, 1
s_lshl_b32 s17, s21, 1
s_add_u32 s29, s29, s17
s_and_b32 s30, s13, 1
s_mul_i32 s24, s20, 458752
s_mul_i32 s17, s29, 114688
s_add_u32 s24, s24, s17
s_mul_i32 s17, s30, 57344
s_add_u32 s24, s24, s17
s_add_u32 s24, s24, 6422528
s_lshl_b32 s17, s29, 2
s_lshl_b32 s18, s30, 1
s_add_u32 s17, s17, s18
s_lshl_b32 s17, s17, 7
s_add_u32 s17, s17, 44114560
v_and_b32 v4, 1, v0
v_lshlrev_b32 v4, 7, v4
WC_149:
buffer_load_dword v6, v4, s[8:11], s17 offen sc1
s_waitcnt vmcnt(0)
v_cmp_gt_u32 vcc, 7, v6
s_cbranch_vccz WCD_150
s_sleep 1
s_sub_u32 s19, s19, 1
s_cbranch_scc0 WC_149
s_branch M_abort
WCD_150:
buffer_load_dwordx4 a[0:3], v1, s[8:11], s24 offen offset:0 sc1
buffer_load_dwordx4 a[4:7], v1, s[8:11], s24 offen offset:1024 sc1
buffer_load_dwordx4 a[8:11], v1, s[8:11], s24 offen offset:2048 sc1
buffer_load_dwordx4 a[12:15], v1, s[8:11], s24 offen offset:3072 sc1
s_add_u32 s24, s24, 4096
buffer_load_dwordx4 a[16:19], v1, s[8:11], s24 offen offset:0 sc1
buffer_load_dwordx4 a[20:23], v1, s[8:11], s24 offen offset:1024 sc1
buffer_load_dwordx4 a[24:27], v1, s[8:11], s24 offen offset:2048 sc1
buffer_load_dwordx4 a[28:31], v1, s[8:11], s24 offen offset:3072 sc1
s_add_u32 s24, s24, 4096
buffer_load_dwordx4 a[32:35], v1, s[8:11], s24 offen offset:0 sc1
buffer_load_dwordx4 a[36:39], v1, s[8:11], s24 offen offset:1024 sc1
buffer_load_dwordx4 a[40:43], v1, s[8:11], s24 offen offset:2048 sc1
buffer_load_dwordx4 a[44:47], v1, s[8:11], s24 offen offset:3072 sc1
s_add_u32 s24, s24, 4096
buffer_load_dwordx4 a[48:51], v1, s[8:11], s24 offen offset:0 sc1
buffer_load_dwordx4 a[52:55], v1, s[8:11], s24 offen offset:1024 sc1
buffer_load_dwordx4 a[56:59], v1, s[8:11], s24 offen offset:2048 sc1
buffer_load_dwordx4 a[60:63], v1, s[8:11], s24 offen offset:3072 sc1
s_add_u32 s24, s24, 4096
buffer_load_dwordx4 a[64:67], v1, s[8:11], s24 offen offset:0 sc1
buffer_load_dwordx4 a[68:71], v1, s[8:11], s24 offen offset:1024 sc1
buffer_load_dwordx4 a[72:75], v1, s[8:11], s24 offen offset:2048 sc1
buffer_load_dwordx4 a[76:79], v1, s[8:11], s24 offen offset:3072 sc1
s_add_u32 s24, s24, 4096
buffer_load_dwordx4 a[80:83], v1, s[8:11], s24 offen offset:0 sc1
buffer_load_dwordx4 a[84:87], v1, s[8:11], s24 offen offset:1024 sc1
buffer_load_dwordx4 a[88:91], v1, s[8:11], s24 offen offset:2048 sc1
buffer_load_dwordx4 a[92:95], v1, s[8:11], s24 offen offset:3072 sc1
s_add_u32 s24, s24, 4096
buffer_load_dwordx4 a[96:99], v1, s[8:11], s24 offen offset:0 sc1
buffer_load_dwordx4 a[100:103], v1, s[8:11], s24 offen offset:1024 sc1
buffer_load_dwordx4 a[104:107], v1, s[8:11], s24 offen offset:2048 sc1
buffer_load_dwordx4 a[108:111], v1, s[8:11], s24 offen offset:3072 sc1
s_add_u32 s24, s24, 4096
buffer_load_dwordx4 a[112:115], v1, s[8:11], s24 offen offset:0 sc1
buffer_load_dwordx4 a[116:119], v1, s[8:11], s24 offen offset:1024 sc1
buffer_load_dwordx4 a[120:123], v1, s[8:11], s24 offen offset:2048 sc1
buffer_load_dwordx4 a[124:127], v1, s[8:11], s24 offen offset:3072 sc1
s_add_u32 s24, s24, 4096
buffer_load_dwordx4 a[128:131], v1, s[8:11], s24 offen offset:0 sc1
buffer_load_dwordx4 a[132:135], v1, s[8:11], s24 offen offset:1024 sc1
buffer_load_dwordx4 a[136:139], v1, s[8:11], s24 offen offset:2048 sc1
buffer_load_dwordx4 a[140:143], v1, s[8:11], s24 offen offset:3072 sc1
s_add_u32 s24, s24, 4096
buffer_load_dwordx4 a[144:147], v1, s[8:11], s24 offen offset:0 sc1
buffer_load_dwordx4 a[148:151], v1, s[8:11], s24 offen offset:1024 sc1
buffer_load_dwordx4 a[152:155], v1, s[8:11], s24 offen offset:2048 sc1
buffer_load_dwordx4 a[156:159], v1, s[8:11], s24 offen offset:3072 sc1
s_add_u32 s24, s24, 4096
buffer_load_dwordx4 a[160:163], v1, s[8:11], s24 offen offset:0 sc1
buffer_load_dwordx4 a[164:167], v1, s[8:11], s24 offen offset:1024 sc1
buffer_load_dwordx4 a[168:171], v1, s[8:11], s24 offen offset:2048 sc1
buffer_load_dwordx4 a[172:175], v1, s[8:11], s24 offen offset:3072 sc1
s_add_u32 s24, s24, 4096
buffer_load_dwordx4 a[176:179], v1, s[8:11], s24 offen offset:0 sc1
buffer_load_dwordx4 a[180:183], v1, s[8:11], s24 offen offset:1024 sc1
buffer_load_dwordx4 a[184:187], v1, s[8:11], s24 offen offset:2048 sc1
buffer_load_dwordx4 a[188:191], v1, s[8:11], s24 offen offset:3072 sc1
s_add_u32 s24, s24, 4096
buffer_load_dwordx4 a[192:195], v1, s[8:11], s24 offen offset:0 sc1
buffer_load_dwordx4 a[196:199], v1, s[8:11], s24 offen offset:1024 sc1
buffer_load_dwordx4 a[200:203], v1, s[8:11], s24 offen offset:2048 sc1
buffer_load_dwordx4 a[204:207], v1, s[8:11], s24 offen offset:3072 sc1
s_add_u32 s24, s24, 4096
buffer_load_dwordx4 a[208:211], v1, s[8:11], s24 offen offset:0 sc1
buffer_load_dwordx4 a[212:215], v1, s[8:11], s24 offen offset:1024 sc1
buffer_load_dwordx4 a[216:219], v1, s[8:11], s24 offen offset:2048 sc1
buffer_load_dwordx4 a[220:223], v1, s[8:11], s24 offen offset:3072 sc1
s_mul_i32 s25, s20, 32768
s_lshl_b32 s17, s29, 13
s_add_u32 s25, s25, s17
s_lshl_b32 s17, s30, 12
s_add_u32 s25, s25, s17
s_add_u32 s25, s25, 12845056
s_mul_i32 s17, s22, 458752
s_add_u32 s25, s25, s17
s_mov_b32 s23, s22
s_lshl_b32 s26, s22, 7
s_add_u32 s26, s26, 44126848
s_mul_i32 s24, s22, 28672
s_mul_i32 s17, s13, 7168
s_add_u32 s24, s24, s17
s_add_u32 s24, s24, 46428800
s_mul_i32 s28, s13, 7168
s_mov_b32 s27, 0
s_mov_b32 s17, 44111616
WC_151:
buffer_load_dword v6, v2, s[8:11], s17 offen sc1
s_waitcnt vmcnt(0)
v_cmp_gt_u32 vcc, 64, v6
s_cbranch_vccz WCD_152
s_sleep 1
s_sub_u32 s19, s19, 1
s_cbranch_scc0 WC_151
s_branch M_abort
WCD_152:
s_add_u32 s18, s28, s27
s_mov_b32 m0, s18
s_nop 0
buffer_load_dwordx4 v1, s[8:11], s24 offen offset:0 sc1 lds
buffer_load_dwordx4 v1, s[8:11], s24 offen offset:1024 sc1 lds
buffer_load_dwordx4 v1, s[8:11], s24 offen offset:2048 sc1 lds
buffer_load_dwordx4 v1, s[8:11], s24 offen offset:3072 sc1 lds
s_add_u32 m0, s18, 4096
s_add_u32 s17, s24, 4096
buffer_load_dwordx4 v1, s[8:11], s17 offen offset:0 sc1 lds
buffer_load_dwordx4 v1, s[8:11], s17 offen offset:1024 sc1 lds
buffer_load_dwordx4 v1, s[8:11], s17 offen offset:2048 sc1 lds
VX_loop_153:
s_waitcnt vmcnt(0)
s_barrier
v_add_u32 v5, s27, v1
s_xor_b32 s27, s27, 28672
s_add_u32 s24, s24, 57344
s_add_u32 s17, s23, 2
s_cmp_ge_u32 s17, 64
s_cbranch_scc1 VX_nopf_154
s_add_u32 s18, s28, s27
s_mov_b32 m0, s18
s_nop 0
buffer_load_dwordx4 v1, s[8:11], s24 offen offset:0 sc1 lds
buffer_load_dwordx4 v1, s[8:11], s24 offen offset:1024 sc1 lds
buffer_load_dwordx4 v1, s[8:11], s24 offen offset:2048 sc1 lds
buffer_load_dwordx4 v1, s[8:11], s24 offen offset:3072 sc1 lds
s_add_u32 m0, s18, 4096
s_add_u32 s17, s24, 4096
buffer_load_dwordx4 v1, s[8:11], s17 offen offset:0 sc1 lds
buffer_load_dwordx4 v1, s[8:11], s17 offen offset:1024 sc1 lds
buffer_load_dwordx4 v1, s[8:11], s17 offen offset:2048 sc1 lds
VX_nopf_154:
ds_read_b128 v[8:11], v5 offset:0
ds_read_b128 v[12:15], v5 offset:14336
ds_read_b128 v[16:19], v5 offset:1024
ds_read_b128 v[20:23], v5 offset:15360
s_waitcnt lgkmcnt(2)
v_mfma_f32_16x16x32_bf16 v[32:35], v[8:11], a[0:3], 0
v_mfma_f32_16x16x32_bf16 v[36:39], v[12:15], a[0:3], 0
v_mfma_f32_16x16x32_bf16 v[48:51], v[8:11], a[56:59], 0
v_mfma_f32_16x16x32_bf16 v[52:55], v[12:15], a[56:59], 0
v_mfma_f32_16x16x32_bf16 v[40:43], v[8:11], a[112:115], 0
v_mfma_f32_16x16x32_bf16 v[44:47], v[12:15], a[112:115], 0
v_mfma_f32_16x16x32_bf16 v[56:59], v[8:11], a[168:171], 0
v_mfma_f32_16x16x32_bf16 v[60:63], v[12:15], a[168:171], 0
ds_read_b128 v[8:11], v5 offset:2048
ds_read_b128 v[12:15], v5 offset:16384
s_waitcnt lgkmcnt(2)
v_mfma_f32_16x16x32_bf16 v[32:35], v[16:19], a[4:7], v[32:35]
v_mfma_f32_16x16x32_bf16 v[36:39], v[20:23], a[4:7], v[36:39]
v_mfma_f32_16x16x32_bf16 v[48:51], v[16:19], a[60:63], v[48:51]
v_mfma_f32_16x16x32_bf16 v[52:55], v[20:23], a[60:63], v[52:55]
v_mfma_f32_16x16x32_bf16 v[40:43], v[16:19], a[116:119], v[40:43]
v_mfma_f32_16x16x32_bf16 v[44:47], v[20:23], a[116:119], v[44:47]
v_mfma_f32_16x16x32_bf16 v[56:59], v[16:19], a[172:175], v[56:59]
v_mfma_f32_16x16x32_bf16 v[60:63], v[20:23], a[172:175], v[60:63]
ds_read_b128 v[16:19], v5 offset:3072
ds_read_b128 v[20:23], v5 offset:17408
s_waitcnt lgkmcnt(2)
v_mfma_f32_16x16x32_bf16 v[32:35], v[8:11], a[8:11], v[32:35]
v_mfma_f32_16x16x32_bf16 v[36:39], v[12:15], a[8:11], v[36:39]
v_mfma_f32_16x16x32_bf16 v[48:51], v[8:11], a[64:67], v[48:51]
v_mfma_f32_16x16x32_bf16 v[52:55], v[12:15], a[64:67], v[52:55]
v_mfma_f32_16x16x32_bf16 v[40:43], v[8:11], a[120:123], v[40:43]
v_mfma_f32_16x16x32_bf16 v[44:47], v[12:15], a[120:123], v[44:47]
v_mfma_f32_16x16x32_bf16 v[56:59], v[8:11], a[176:179], v[56:59]
v_mfma_f32_16x16x32_bf16 v[60:63], v[12:15], a[176:179], v[60:63]
ds_read_b128 v[8:11], v5 offset:4096
ds_read_b128 v[12:15], v5 offset:18432
s_waitcnt lgkmcnt(2)
v_mfma_f32_16x16x32_bf16 v[32:35], v[16:19], a[12:15], v[32:35]
v_mfma_f32_16x16x32_bf16 v[36:39], v[20:23], a[12:15], v[36:39]
v_mfma_f32_16x16x32_bf16 v[48:51], v[16:19], a[68:71], v[48:51]
v_mfma_f32_16x16x32_bf16 v[52:55], v[20:23], a[68:71], v[52:55]
v_mfma_f32_16x16x32_bf16 v[40:43], v[16:19], a[124:127], v[40:43]
v_mfma_f32_16x16x32_bf16 v[44:47], v[20:23], a[124:127], v[44:47]
v_mfma_f32_16x16x32_bf16 v[56:59], v[16:19], a[180:183], v[56:59]
v_mfma_f32_16x16x32_bf16 v[60:63], v[20:23], a[180:183], v[60:63]
ds_read_b128 v[16:19], v5 offset:5120
ds_read_b128 v[20:23], v5 offset:19456
s_waitcnt lgkmcnt(2)
v_mfma_f32_16x16x32_bf16 v[32:35], v[8:11], a[16:19], v[32:35]
v_mfma_f32_16x16x32_bf16 v[36:39], v[12:15], a[16:19], v[36:39]
v_mfma_f32_16x16x32_bf16 v[48:51], v[8:11], a[72:75], v[48:51]
v_mfma_f32_16x16x32_bf16 v[52:55], v[12:15], a[72:75], v[52:55]
v_mfma_f32_16x16x32_bf16 v[40:43], v[8:11], a[128:131], v[40:43]
v_mfma_f32_16x16x32_bf16 v[44:47], v[12:15], a[128:131], v[44:47]
v_mfma_f32_16x16x32_bf16 v[56:59], v[8:11], a[184:187], v[56:59]
v_mfma_f32_16x16x32_bf16 v[60:63], v[12:15], a[184:187], v[60:63]
ds_read_b128 v[8:11], v5 offset:6144
ds_read_b128 v[12:15], v5 offset:20480
s_waitcnt lgkmcnt(2)
v_mfma_f32_16x16x32_bf16 v[32:35], v[16:19], a[20:23], v[32:35]
v_mfma_f32_16x16x32_bf16 v[36:39], v[20:23], a[20:23], v[36:39]
v_mfma_f32_16x16x32_bf16 v[48:51], v[16:19], a[76:79], v[48:51]
v_mfma_f32_16x16x32_bf16 v[52:55], v[20:23], a[76:79], v[52:55]
v_mfma_f32_16x16x32_bf16 v[40:43], v[16:19], a[132:135], v[40:43]
v_mfma_f32_16x16x32_bf16 v[44:47], v[20:23], a[132:135], v[44:47]
v_mfma_f32_16x16x32_bf16 v[56:59], v[16:19], a[188:191], v[56:59]
v_mfma_f32_16x16x32_bf16 v[60:63], v[20:23], a[188:191], v[60:63]
ds_read_b128 v[16:19], v5 offset:7168
ds_read_b128 v[20:23], v5 offset:21504
s_waitcnt lgkmcnt(2)
v_mfma_f32_16x16x32_bf16 v[32:35], v[8:11], a[24:27], v[32:35]
v_mfma_f32_16x16x32_bf16 v[36:39], v[12:15], a[24:27], v[36:39]
v_mfma_f32_16x16x32_bf16 v[48:51], v[8:11], a[80:83], v[48:51]
v_mfma_f32_16x16x32_bf16 v[52:55], v[12:15], a[80:83], v[52:55]
v_mfma_f32_16x16x32_bf16 v[40:43], v[8:11], a[136:139], v[40:43]
v_mfma_f32_16x16x32_bf16 v[44:47], v[12:15], a[136:139], v[44:47]
v_mfma_f32_16x16x32_bf16 v[56:59], v[8:11], a[192:195], v[56:59]
v_mfma_f32_16x16x32_bf16 v[60:63], v[12:15], a[192:195], v[60:63]
ds_read_b128 v[8:11], v5 offset:8192
ds_read_b128 v[12:15], v5 offset:22528
s_waitcnt lgkmcnt(2)
v_mfma_f32_16x16x32_bf16 v[32:35], v[16:19], a[28:31], v[32:35]
v_mfma_f32_16x16x32_bf16 v[36:39], v[20:23], a[28:31], v[36:39]
v_mfma_f32_16x16x32_bf16 v[48:51], v[16:19], a[84:87], v[48:51]
v_mfma_f32_16x16x32_bf16 v[52:55], v[20:23], a[84:87], v[52:55]
v_mfma_f32_16x16x32_bf16 v[40:43], v[16:19], a[140:143], v[40:43]
v_mfma_f32_16x16x32_bf16 v[44:47], v[20:23], a[140:143], v[44:47]
v_mfma_f32_16x16x32_bf16 v[56:59], v[16:19], a[196:199], v[56:59]
v_mfma_f32_16x16x32_bf16 v[60:63], v[20:23], a[196:199], v[60:63]
ds_read_b128 v[16:19], v5 offset:9216
ds_read_b128 v[20:23], v5 offset:23552
s_waitcnt lgkmcnt(2)
v_mfma_f32_16x16x32_bf16 v[32:35], v[8:11], a[32:35], v[32:35]
v_mfma_f32_16x16x32_bf16 v[36:39], v[12:15], a[32:35], v[36:39]
v_mfma_f32_16x16x32_bf16 v[48:51], v[8:11], a[88:91], v[48:51]
v_mfma_f32_16x16x32_bf16 v[52:55], v[12:15], a[88:91], v[52:55]
v_mfma_f32_16x16x32_bf16 v[40:43], v[8:11], a[144:147], v[40:43]
v_mfma_f32_16x16x32_bf16 v[44:47], v[12:15], a[144:147], v[44:47]
v_mfma_f32_16x16x32_bf16 v[56:59], v[8:11], a[200:203], v[56:59]
v_mfma_f32_16x16x32_bf16 v[60:63], v[12:15], a[200:203], v[60:63]
ds_read_b128 v[8:11], v5 offset:10240
ds_read_b128 v[12:15], v5 offset:24576
s_waitcnt lgkmcnt(2)
v_mfma_f32_16x16x32_bf16 v[32:35], v[16:19], a[36:39], v[32:35]
v_mfma_f32_16x16x32_bf16 v[36:39], v[20:23], a[36:39], v[36:39]
v_mfma_f32_16x16x32_bf16 v[48:51], v[16:19], a[92:95], v[48:51]
v_mfma_f32_16x16x32_bf16 v[52:55], v[20:23], a[92:95], v[52:55]
v_mfma_f32_16x16x32_bf16 v[40:43], v[16:19], a[148:151], v[40:43]
v_mfma_f32_16x16x32_bf16 v[44:47], v[20:23], a[148:151], v[44:47]
v_mfma_f32_16x16x32_bf16 v[56:59], v[16:19], a[204:207], v[56:59]
v_mfma_f32_16x16x32_bf16 v[60:63], v[20:23], a[204:207], v[60:63]
ds_read_b128 v[16:19], v5 offset:11264
ds_read_b128 v[20:23], v5 offset:25600
s_waitcnt lgkmcnt(2)
v_mfma_f32_16x16x32_bf16 v[32:35], v[8:11], a[40:43], v[32:35]
v_mfma_f32_16x16x32_bf16 v[36:39], v[12:15], a[40:43], v[36:39]
v_mfma_f32_16x16x32_bf16 v[48:51], v[8:11], a[96:99], v[48:51]
v_mfma_f32_16x16x32_bf16 v[52:55], v[12:15], a[96:99], v[52:55]
v_mfma_f32_16x16x32_bf16 v[40:43], v[8:11], a[152:155], v[40:43]
v_mfma_f32_16x16x32_bf16 v[44:47], v[12:15], a[152:155], v[44:47]
v_mfma_f32_16x16x32_bf16 v[56:59], v[8:11], a[208:211], v[56:59]
v_mfma_f32_16x16x32_bf16 v[60:63], v[12:15], a[208:211], v[60:63]
ds_read_b128 v[8:11], v5 offset:12288
ds_read_b128 v[12:15], v5 offset:26624
s_waitcnt lgkmcnt(2)
v_mfma_f32_16x16x32_bf16 v[32:35], v[16:19], a[44:47], v[32:35]
v_mfma_f32_16x16x32_bf16 v[36:39], v[20:23], a[44:47], v[36:39]
v_mfma_f32_16x16x32_bf16 v[48:51], v[16:19], a[100:103], v[48:51]
v_mfma_f32_16x16x32_bf16 v[52:55], v[20:23], a[100:103], v[52:55]
v_mfma_f32_16x16x32_bf16 v[40:43], v[16:19], a[156:159], v[40:43]
v_mfma_f32_16x16x32_bf16 v[44:47], v[20:23], a[156:159], v[44:47]
v_mfma_f32_16x16x32_bf16 v[56:59], v[16:19], a[212:215], v[56:59]
v_mfma_f32_16x16x32_bf16 v[60:63], v[20:23], a[212:215], v[60:63]
ds_read_b128 v[16:19], v5 offset:13312
ds_read_b128 v[20:23], v5 offset:27648
s_waitcnt lgkmcnt(2)
v_mfma_f32_16x16x32_bf16 v[32:35], v[8:11], a[48:51], v[32:35]
v_mfma_f32_16x16x32_bf16 v[36:39], v[12:15], a[48:51], v[36:39]
v_mfma_f32_16x16x32_bf16 v[48:51], v[8:11], a[104:107], v[48:51]
v_mfma_f32_16x16x32_bf16 v[52:55], v[12:15], a[104:107], v[52:55]
v_mfma_f32_16x16x32_bf16 v[40:43], v[8:11], a[160:163], v[40:43]
v_mfma_f32_16x16x32_bf16 v[44:47], v[12:15], a[160:163], v[44:47]
v_mfma_f32_16x16x32_bf16 v[56:59], v[8:11], a[216:219], v[56:59]
v_mfma_f32_16x16x32_bf16 v[60:63], v[12:15], a[216:219], v[60:63]
s_waitcnt lgkmcnt(0)
v_mfma_f32_16x16x32_bf16 v[32:35], v[16:19], a[52:55], v[32:35]
v_mfma_f32_16x16x32_bf16 v[36:39], v[20:23], a[52:55], v[36:39]
v_mfma_f32_16x16x32_bf16 v[48:51], v[16:19], a[108:111], v[48:51]
v_mfma_f32_16x16x32_bf16 v[52:55], v[20:23], a[108:111], v[52:55]
v_mfma_f32_16x16x32_bf16 v[40:43], v[16:19], a[164:167], v[40:43]
v_mfma_f32_16x16x32_bf16 v[44:47], v[20:23], a[164:167], v[44:47]
v_mfma_f32_16x16x32_bf16 v[56:59], v[16:19], a[220:223], v[56:59]
v_mfma_f32_16x16x32_bf16 v[60:63], v[20:23], a[220:223], v[60:63]
s_nop 7
v_cvt_pk_bf16_f32 v32, v32, v33
v_cvt_pk_bf16_f32 v33, v34, v35
v_cvt_pk_bf16_f32 v34, v36, v37
v_cvt_pk_bf16_f32 v35, v38, v39
buffer_store_dwordx4 v[32:35], v1, s[8:11], s25 offen offset:0 sc1
v_cvt_pk_bf16_f32 v40, v40, v41
v_cvt_pk_bf16_f32 v41, v42, v43
v_cvt_pk_bf16_f32 v42, v44, v45
v_cvt_pk_bf16_f32 v43, v46, v47
buffer_store_dwordx4 v[40:43], v1, s[8:11], s25 offen offset:1024 sc1
v_cvt_pk_bf16_f32 v48, v48, v49
v_cvt_pk_bf16_f32 v49, v50, v51
v_cvt_pk_bf16_f32 v50, v52, v53
v_cvt_pk_bf16_f32 v51, v54, v55
buffer_store_dwordx4 v[48:51], v1, s[8:11], s25 offen offset:2048 sc1
v_cvt_pk_bf16_f32 v56, v56, v57
v_cvt_pk_bf16_f32 v57, v58, v59
v_cvt_pk_bf16_f32 v58, v60, v61
v_cvt_pk_bf16_f32 v59, v62, v63
buffer_store_dwordx4 v[56:59], v1, s[8:11], s25 offen offset:3072 sc1
s_waitcnt vmcnt(0)
s_barrier
s_cmp_lg_u32 s13, 0
s_cbranch_scc1 VX_ns_155
s_mov_b64 exec, 1
buffer_atomic_add v3, v2, s[8:11], s26 offen sc1
s_mov_b64 exec, -1
VX_ns_155:
s_add_u32 s25, s25, 917504
s_add_u32 s26, s26, 256
s_add_u32 s23, s23, 2
s_cmp_lt_u32 s23, 64
s_cbranch_scc1 VX_loop_153
s_mul_i32 s17, s13, 1792
v_add_u32 v5, s17, v1
v_min_u32 v4, 47, v0
v_lshlrev_b32 v4, 4, v4
s_add_u32 s17, s17, 1024
v_add_u32 v6, s17, v4
v_lshrrev_b32 v4, 5, v0
v_lshlrev_b32 v7, 8, v4
v_and_b32 v4, 7, v0
v_lshl_add_u32 v7, v4, 4, v7
v_bfe_u32 v4, v0, 4, 1
v_lshl_add_u32 v7, v4, 3, v7
s_add_u32 s23, s22, 48
s_mul_i32 s24, s23, 7168
s_add_u32 s24, s24, 44135040
s_mul_i32 s25, s20, 16384
s_lshl_b32 s17, s29, 12
s_add_u32 s25, s25, s17
s_lshl_b32 s17, s30, 11
s_add_u32 s25, s25, s17
s_add_u32 s25, s25, 48263808
s_mul_i32 s17, s23, 229376
s_add_u32 s25, s25, s17
s_lshl_b32 s26, s23, 7
s_add_u32 s26, s26, 44126852
s_mov_b32 s40, 0
CP_159:
buffer_load_dword v64, v5, s[8:11], s24 offen sc1
s_waitcnt vmcnt(0)
v_cmp_eq_u32 vcc, -1, v64
s_cbranch_vccz CPD_160
s_sleep 32
s_sub_u32 s19, s19, 1
s_cbranch_scc0 CP_159
s_branch M_abort
CPD_160:
buffer_load_dwordx4 v[8:11], v5, s[8:11], s24 offen sc1
buffer_load_dwordx4 v[12:15], v6, s[8:11], s24 offen sc1
VM_loop_156:
VM_poll_157:
s_waitcnt vmcnt(0)
s_cmp_eq_u32 s40, 0
s_cbranch_scc1 VM_nsig_161
s_mov_b64 exec, 1
buffer_atomic_add v3, v2, s[8:11], s41 offen sc1
s_mov_b64 exec, -1
s_mov_b32 s40, 0
VM_nsig_161:
v_max3_u32 v64, v8, v9, v10
v_max3_u32 v64, v64, v11, v12
v_max3_u32 v64, v64, v13, v14
v_max_u32 v64, v64, v15
v_cmp_eq_u32 vcc, -1, v64
s_cbranch_vccz VM_ok_158
s_sleep 1
buffer_load_dwordx4 v[8:11], v5, s[8:11], s24 offen sc1
buffer_load_dwordx4 v[12:15], v6, s[8:11], s24 offen sc1
s_sub_u32 s19, s19, 1
s_cbranch_scc0 VM_poll_157
s_branch M_abort
VM_ok_158:
ds_write_b128 v5, v[8:11]
ds_write_b128 v6, v[12:15]
s_waitcnt lgkmcnt(0)
s_barrier
s_add_u32 s24, s24, 14336
s_add_u32 s17, s23, 2
s_cmp_ge_u32 s17, 64
s_cbranch_scc1 VM_nl_162
buffer_load_dwordx4 v[8:11], v5, s[8:11], s24 offen sc1
buffer_load_dwordx4 v[12:15], v6, s[8:11], s24 offen sc1
VM_nl_162:
ds_read2_b64 v[72:75], v7 offset0:0 offset1:16
ds_read2_b64 v[76:79], v7 offset0:64 offset1:80
v_add_u32 v64, 1024, v7
ds_read2_b64 v[80:83], v64 offset0:0 offset1:16
ds_read2_b64 v[84:87], v64 offset0:64 offset1:80
v_add_u32 v64, 2048, v7
ds_read2_b64 v[88:91], v64 offset0:0 offset1:16
ds_read2_b64 v[92:95], v64 offset0:64 offset1:80
v_add_u32 v64, 3072, v7
ds_read2_b64 v[96:99], v64 offset0:0 offset1:16
ds_read2_b64 v[100:103], v64 offset0:64 offset1:80
v_add_u32 v64, 4096, v7
ds_read2_b64 v[104:107], v64 offset0:0 offset1:16
ds_read2_b64 v[108:111], v64 offset0:64 offset1:80
v_add_u32 v64, 5120, v7
ds_read2_b64 v[112:115], v64 offset0:0 offset1:16
ds_read2_b64 v[116:119], v64 offset0:64 offset1:80
v_add_u32 v64, 6144, v7
ds_read2_b64 v[120:123], v64 offset0:0 offset1:16
ds_read2_b64 v[124:127], v64 offset0:64 offset1:80
s_waitcnt lgkmcnt(0)
v_swap_b32 v73, v74
v_swap_b32 v77, v78
v_swap_b32 v81, v82
v_swap_b32 v85, v86
v_swap_b32 v89, v90
v_swap_b32 v93, v94
v_swap_b32 v97, v98
v_swap_b32 v101, v102
v_swap_b32 v105, v106
v_swap_b32 v109, v110
v_swap_b32 v113, v114
v_swap_b32 v117, v118
v_swap_b32 v121, v122
v_swap_b32 v125, v126
s_nop 1
v_mfma_f32_16x16x32_bf16 v[32:35], v[72:75], a[0:3], 0
v_mfma_f32_16x16x32_bf16 v[36:39], v[72:75], a[112:115], 0
v_mfma_f32_16x16x32_bf16 v[40:43], v[72:75], a[56:59], 0
v_mfma_f32_16x16x32_bf16 v[44:47], v[72:75], a[168:171], 0
v_mfma_f32_16x16x32_bf16 v[32:35], v[76:79], a[4:7], v[32:35]
v_mfma_f32_16x16x32_bf16 v[36:39], v[76:79], a[116:119], v[36:39]
v_mfma_f32_16x16x32_bf16 v[40:43], v[76:79], a[60:63], v[40:43]
v_mfma_f32_16x16x32_bf16 v[44:47], v[76:79], a[172:175], v[44:47]
v_mfma_f32_16x16x32_bf16 v[32:35], v[80:83], a[8:11], v[32:35]
v_mfma_f32_16x16x32_bf16 v[36:39], v[80:83], a[120:123], v[36:39]
v_mfma_f32_16x16x32_bf16 v[40:43], v[80:83], a[64:67], v[40:43]
v_mfma_f32_16x16x32_bf16 v[44:47], v[80:83], a[176:179], v[44:47]
v_mfma_f32_16x16x32_bf16 v[32:35], v[84:87], a[12:15], v[32:35]
v_mfma_f32_16x16x32_bf16 v[36:39], v[84:87], a[124:127], v[36:39]
v_mfma_f32_16x16x32_bf16 v[40:43], v[84:87], a[68:71], v[40:43]
v_mfma_f32_16x16x32_bf16 v[44:47], v[84:87], a[180:183], v[44:47]
v_mfma_f32_16x16x32_bf16 v[32:35], v[88:91], a[16:19], v[32:35]
v_mfma_f32_16x16x32_bf16 v[36:39], v[88:91], a[128:131], v[36:39]
v_mfma_f32_16x16x32_bf16 v[40:43], v[88:91], a[72:75], v[40:43]
v_mfma_f32_16x16x32_bf16 v[44:47], v[88:91], a[184:187], v[44:47]
v_mfma_f32_16x16x32_bf16 v[32:35], v[92:95], a[20:23], v[32:35]
v_mfma_f32_16x16x32_bf16 v[36:39], v[92:95], a[132:135], v[36:39]
v_mfma_f32_16x16x32_bf16 v[40:43], v[92:95], a[76:79], v[40:43]
v_mfma_f32_16x16x32_bf16 v[44:47], v[92:95], a[188:191], v[44:47]
v_mfma_f32_16x16x32_bf16 v[32:35], v[96:99], a[24:27], v[32:35]
v_mfma_f32_16x16x32_bf16 v[36:39], v[96:99], a[136:139], v[36:39]
v_mfma_f32_16x16x32_bf16 v[40:43], v[96:99], a[80:83], v[40:43]
v_mfma_f32_16x16x32_bf16 v[44:47], v[96:99], a[192:195], v[44:47]
v_mfma_f32_16x16x32_bf16 v[32:35], v[100:103], a[28:31], v[32:35]
v_mfma_f32_16x16x32_bf16 v[36:39], v[100:103], a[140:143], v[36:39]
v_mfma_f32_16x16x32_bf16 v[40:43], v[100:103], a[84:87], v[40:43]
v_mfma_f32_16x16x32_bf16 v[44:47], v[100:103], a[196:199], v[44:47]
v_mfma_f32_16x16x32_bf16 v[32:35], v[104:107], a[32:35], v[32:35]
v_mfma_f32_16x16x32_bf16 v[36:39], v[104:107], a[144:147], v[36:39]
v_mfma_f32_16x16x32_bf16 v[40:43], v[104:107], a[88:91], v[40:43]
v_mfma_f32_16x16x32_bf16 v[44:47], v[104:107], a[200:203], v[44:47]
v_mfma_f32_16x16x32_bf16 v[32:35], v[108:111], a[36:39], v[32:35]
v_mfma_f32_16x16x32_bf16 v[36:39], v[108:111], a[148:151], v[36:39]
v_mfma_f32_16x16x32_bf16 v[40:43], v[108:111], a[92:95], v[40:43]
v_mfma_f32_16x16x32_bf16 v[44:47], v[108:111], a[204:207], v[44:47]
v_mfma_f32_16x16x32_bf16 v[32:35], v[112:115], a[40:43], v[32:35]
v_mfma_f32_16x16x32_bf16 v[36:39], v[112:115], a[152:155], v[36:39]
v_mfma_f32_16x16x32_bf16 v[40:43], v[112:115], a[96:99], v[40:43]
v_mfma_f32_16x16x32_bf16 v[44:47], v[112:115], a[208:211], v[44:47]
v_mfma_f32_16x16x32_bf16 v[32:35], v[116:119], a[44:47], v[32:35]
v_mfma_f32_16x16x32_bf16 v[36:39], v[116:119], a[156:159], v[36:39]
v_mfma_f32_16x16x32_bf16 v[40:43], v[116:119], a[100:103], v[40:43]
v_mfma_f32_16x16x32_bf16 v[44:47], v[116:119], a[212:215], v[44:47]
v_mfma_f32_16x16x32_bf16 v[32:35], v[120:123], a[48:51], v[32:35]
v_mfma_f32_16x16x32_bf16 v[36:39], v[120:123], a[160:163], v[36:39]
v_mfma_f32_16x16x32_bf16 v[40:43], v[120:123], a[104:107], v[40:43]
v_mfma_f32_16x16x32_bf16 v[44:47], v[120:123], a[216:219], v[44:47]
v_mfma_f32_16x16x32_bf16 v[32:35], v[124:127], a[52:55], v[32:35]
v_mfma_f32_16x16x32_bf16 v[36:39], v[124:127], a[164:167], v[36:39]
v_mfma_f32_16x16x32_bf16 v[40:43], v[124:127], a[108:111], v[40:43]
v_mfma_f32_16x16x32_bf16 v[44:47], v[124:127], a[220:223], v[44:47]
s_nop 7
v_cvt_pk_bf16_f32 v32, v32, v33
v_cvt_pk_bf16_f32 v33, v34, v35
v_cvt_pk_bf16_f32 v34, v36, v37
v_cvt_pk_bf16_f32 v35, v38, v39
buffer_store_dwordx4 v[32:35], v1, s[8:11], s25 offen offset:0 sc1
v_cvt_pk_bf16_f32 v40, v40, v41
v_cvt_pk_bf16_f32 v41, v42, v43
v_cvt_pk_bf16_f32 v42, v44, v45
v_cvt_pk_bf16_f32 v43, v46, v47
buffer_store_dwordx4 v[40:43], v1, s[8:11], s25 offen offset:1024 sc1
s_mov_b32 s41, s26
s_mov_b32 s40, 1
s_waitcnt vmcnt(0)
s_mov_b32 s40, 0
s_barrier
s_cmp_lg_u32 s13, 0
s_cbranch_scc1 VM_s4_163
v_mov_b32 v64, 4
s_mov_b64 exec, 1
buffer_atomic_add v64, v2, s[8:11], s41 offen sc1
s_mov_b64 exec, -1
VM_s4_163:
s_add_u32 s25, s25, 458752
s_add_u32 s26, s26, 256
s_add_u32 s23, s23, 2
s_cmp_lt_u32 s23, 64
s_cbranch_scc1 VM_loop_156
s_waitcnt vmcnt(0)
s_endpgm
M_vm:
s_sub_u32 s12, s12, 196
s_cmp_lg_u32 s13, 0
s_cbranch_scc1 M_dl_164
s_mov_b32 s17, 44113664
v_mov_b32 v8, 0
WC_165:
buffer_load_dword v9, v8, s[8:11], s17 offen sc1
s_waitcnt vmcnt(0)
v_cmp_gt_u32 vcc, 7, v9
s_cbranch_vccz WCD_166
s_sleep 16
s_sub_u32 s19, s19, 1
s_cbranch_scc0 WC_165
s_branch M_abort
WCD_166:
M_dl_164:
s_barrier
v_and_b32 v0, 63, v0
v_lshlrev_b32 v1, 4, v0
v_mov_b32 v2, 0
v_mov_b32 v3, 1
s_mul_i32 s22, s12, 2341
s_lshr_b32 s22, s22, 16
s_mul_i32 s17, s22, 28
s_sub_u32 s17, s12, s17
s_lshr_b32 s20, s17, 1
s_and_b32 s21, s17, 1
s_lshr_b32 s29, s13, 1
s_lshl_b32 s17, s21, 1
s_add_u32 s29, s29, s17
s_and_b32 s30, s13, 1
s_mul_i32 s24, s20, 458752
s_mul_i32 s17, s29, 114688
s_add_u32 s24, s24, s17
s_mul_i32 s17, s30, 57344
s_add_u32 s24, s24, s17
s_add_u32 s24, s24, 6422528
s_lshl_b32 s17, s29, 2
s_lshl_b32 s18, s30, 1
s_add_u32 s17, s17, s18
s_lshl_b32 s17, s17, 7
s_add_u32 s17, s17, 44114560
v_and_b32 v4, 1, v0
v_lshlrev_b32 v4, 7, v4
WC_167:
buffer_load_dword v6, v4, s[8:11], s17 offen sc1
s_waitcnt vmcnt(0)
v_cmp_gt_u32 vcc, 7, v6
s_cbranch_vccz WCD_168
s_sleep 1
s_sub_u32 s19, s19, 1
s_cbranch_scc0 WC_167
s_branch M_abort
WCD_168:
buffer_load_dwordx4 a[0:3], v1, s[8:11], s24 offen offset:0 sc1
buffer_load_dwordx4 a[4:7], v1, s[8:11], s24 offen offset:1024 sc1
buffer_load_dwordx4 a[8:11], v1, s[8:11], s24 offen offset:2048 sc1
buffer_load_dwordx4 a[12:15], v1, s[8:11], s24 offen offset:3072 sc1
s_add_u32 s24, s24, 4096
buffer_load_dwordx4 a[16:19], v1, s[8:11], s24 offen offset:0 sc1
buffer_load_dwordx4 a[20:23], v1, s[8:11], s24 offen offset:1024 sc1
buffer_load_dwordx4 a[24:27], v1, s[8:11], s24 offen offset:2048 sc1
buffer_load_dwordx4 a[28:31], v1, s[8:11], s24 offen offset:3072 sc1
s_add_u32 s24, s24, 4096
buffer_load_dwordx4 a[32:35], v1, s[8:11], s24 offen offset:0 sc1
buffer_load_dwordx4 a[36:39], v1, s[8:11], s24 offen offset:1024 sc1
buffer_load_dwordx4 a[40:43], v1, s[8:11], s24 offen offset:2048 sc1
buffer_load_dwordx4 a[44:47], v1, s[8:11], s24 offen offset:3072 sc1
s_add_u32 s24, s24, 4096
buffer_load_dwordx4 a[48:51], v1, s[8:11], s24 offen offset:0 sc1
buffer_load_dwordx4 a[52:55], v1, s[8:11], s24 offen offset:1024 sc1
buffer_load_dwordx4 a[56:59], v1, s[8:11], s24 offen offset:2048 sc1
buffer_load_dwordx4 a[60:63], v1, s[8:11], s24 offen offset:3072 sc1
s_add_u32 s24, s24, 4096
buffer_load_dwordx4 a[64:67], v1, s[8:11], s24 offen offset:0 sc1
buffer_load_dwordx4 a[68:71], v1, s[8:11], s24 offen offset:1024 sc1
buffer_load_dwordx4 a[72:75], v1, s[8:11], s24 offen offset:2048 sc1
buffer_load_dwordx4 a[76:79], v1, s[8:11], s24 offen offset:3072 sc1
s_add_u32 s24, s24, 4096
buffer_load_dwordx4 a[80:83], v1, s[8:11], s24 offen offset:0 sc1
buffer_load_dwordx4 a[84:87], v1, s[8:11], s24 offen offset:1024 sc1
buffer_load_dwordx4 a[88:91], v1, s[8:11], s24 offen offset:2048 sc1
buffer_load_dwordx4 a[92:95], v1, s[8:11], s24 offen offset:3072 sc1
s_add_u32 s24, s24, 4096
buffer_load_dwordx4 a[96:99], v1, s[8:11], s24 offen offset:0 sc1
buffer_load_dwordx4 a[100:103], v1, s[8:11], s24 offen offset:1024 sc1
buffer_load_dwordx4 a[104:107], v1, s[8:11], s24 offen offset:2048 sc1
buffer_load_dwordx4 a[108:111], v1, s[8:11], s24 offen offset:3072 sc1
s_add_u32 s24, s24, 4096
buffer_load_dwordx4 a[112:115], v1, s[8:11], s24 offen offset:0 sc1
buffer_load_dwordx4 a[116:119], v1, s[8:11], s24 offen offset:1024 sc1
buffer_load_dwordx4 a[120:123], v1, s[8:11], s24 offen offset:2048 sc1
buffer_load_dwordx4 a[124:127], v1, s[8:11], s24 offen offset:3072 sc1
s_add_u32 s24, s24, 4096
buffer_load_dwordx4 a[128:131], v1, s[8:11], s24 offen offset:0 sc1
buffer_load_dwordx4 a[132:135], v1, s[8:11], s24 offen offset:1024 sc1
buffer_load_dwordx4 a[136:139], v1, s[8:11], s24 offen offset:2048 sc1
buffer_load_dwordx4 a[140:143], v1, s[8:11], s24 offen offset:3072 sc1
s_add_u32 s24, s24, 4096
buffer_load_dwordx4 a[144:147], v1, s[8:11], s24 offen offset:0 sc1
buffer_load_dwordx4 a[148:151], v1, s[8:11], s24 offen offset:1024 sc1
buffer_load_dwordx4 a[152:155], v1, s[8:11], s24 offen offset:2048 sc1
buffer_load_dwordx4 a[156:159], v1, s[8:11], s24 offen offset:3072 sc1
s_add_u32 s24, s24, 4096
buffer_load_dwordx4 a[160:163], v1, s[8:11], s24 offen offset:0 sc1
buffer_load_dwordx4 a[164:167], v1, s[8:11], s24 offen offset:1024 sc1
buffer_load_dwordx4 a[168:171], v1, s[8:11], s24 offen offset:2048 sc1
buffer_load_dwordx4 a[172:175], v1, s[8:11], s24 offen offset:3072 sc1
s_add_u32 s24, s24, 4096
buffer_load_dwordx4 a[176:179], v1, s[8:11], s24 offen offset:0 sc1
buffer_load_dwordx4 a[180:183], v1, s[8:11], s24 offen offset:1024 sc1
buffer_load_dwordx4 a[184:187], v1, s[8:11], s24 offen offset:2048 sc1
buffer_load_dwordx4 a[188:191], v1, s[8:11], s24 offen offset:3072 sc1
s_add_u32 s24, s24, 4096
buffer_load_dwordx4 a[192:195], v1, s[8:11], s24 offen offset:0 sc1
buffer_load_dwordx4 a[196:199], v1, s[8:11], s24 offen offset:1024 sc1
buffer_load_dwordx4 a[200:203], v1, s[8:11], s24 offen offset:2048 sc1
buffer_load_dwordx4 a[204:207], v1, s[8:11], s24 offen offset:3072 sc1
s_add_u32 s24, s24, 4096
buffer_load_dwordx4 a[208:211], v1, s[8:11], s24 offen offset:0 sc1
buffer_load_dwordx4 a[212:215], v1, s[8:11], s24 offen offset:1024 sc1
buffer_load_dwordx4 a[216:219], v1, s[8:11], s24 offen offset:2048 sc1
buffer_load_dwordx4 a[220:223], v1, s[8:11], s24 offen offset:3072 sc1
s_waitcnt vmcnt(0)
s_mul_i32 s17, s13, 1792
v_add_u32 v5, s17, v1
v_min_u32 v4, 47, v0
v_lshlrev_b32 v4, 4, v4
s_add_u32 s17, s17, 1024
v_add_u32 v6, s17, v4
v_lshrrev_b32 v4, 5, v0
v_lshlrev_b32 v7, 8, v4
v_and_b32 v4, 7, v0
v_lshl_add_u32 v7, v4, 4, v7
v_bfe_u32 v4, v0, 4, 1
v_lshl_add_u32 v7, v4, 3, v7
s_add_u32 s23, s22, 0
s_mul_i32 s24, s23, 7168
s_add_u32 s24, s24, 44135040
s_mul_i32 s25, s20, 16384
s_lshl_b32 s17, s29, 12
s_add_u32 s25, s25, s17
s_lshl_b32 s17, s30, 11
s_add_u32 s25, s25, s17
s_add_u32 s25, s25, 48263808
s_mul_i32 s17, s23, 229376
s_add_u32 s25, s25, s17
s_lshl_b32 s26, s23, 7
s_add_u32 s26, s26, 44126852
s_mov_b32 s40, 0
buffer_load_dwordx4 v[8:11], v5, s[8:11], s24 offen sc1
buffer_load_dwordx4 v[12:15], v6, s[8:11], s24 offen sc1
VM_loop_169:
VM_poll_170:
s_waitcnt vmcnt(0)
s_cmp_eq_u32 s40, 0
s_cbranch_scc1 VM_nsig_172
s_mov_b64 exec, 1
buffer_atomic_add v3, v2, s[8:11], s41 offen sc1
s_mov_b64 exec, -1
s_mov_b32 s40, 0
VM_nsig_172:
v_max3_u32 v64, v8, v9, v10
v_max3_u32 v64, v64, v11, v12
v_max3_u32 v64, v64, v13, v14
v_max_u32 v64, v64, v15
v_cmp_eq_u32 vcc, -1, v64
s_cbranch_vccz VM_ok_171
s_sleep 1
buffer_load_dwordx4 v[8:11], v5, s[8:11], s24 offen sc1
buffer_load_dwordx4 v[12:15], v6, s[8:11], s24 offen sc1
s_sub_u32 s19, s19, 1
s_cbranch_scc0 VM_poll_170
s_branch M_abort
VM_ok_171:
ds_write_b128 v5, v[8:11]
ds_write_b128 v6, v[12:15]
s_waitcnt lgkmcnt(0)
s_barrier
s_add_u32 s24, s24, 7168
s_add_u32 s17, s23, 1
s_cmp_ge_u32 s17, 48
s_cbranch_scc1 VM_nl_173
buffer_load_dwordx4 v[8:11], v5, s[8:11], s24 offen sc1
buffer_load_dwordx4 v[12:15], v6, s[8:11], s24 offen sc1
VM_nl_173:
ds_read2_b64 v[72:75], v7 offset0:0 offset1:16
ds_read2_b64 v[76:79], v7 offset0:64 offset1:80
v_add_u32 v64, 1024, v7
ds_read2_b64 v[80:83], v64 offset0:0 offset1:16
ds_read2_b64 v[84:87], v64 offset0:64 offset1:80
v_add_u32 v64, 2048, v7
ds_read2_b64 v[88:91], v64 offset0:0 offset1:16
ds_read2_b64 v[92:95], v64 offset0:64 offset1:80
v_add_u32 v64, 3072, v7
ds_read2_b64 v[96:99], v64 offset0:0 offset1:16
ds_read2_b64 v[100:103], v64 offset0:64 offset1:80
v_add_u32 v64, 4096, v7
ds_read2_b64 v[104:107], v64 offset0:0 offset1:16
ds_read2_b64 v[108:111], v64 offset0:64 offset1:80
v_add_u32 v64, 5120, v7
ds_read2_b64 v[112:115], v64 offset0:0 offset1:16
ds_read2_b64 v[116:119], v64 offset0:64 offset1:80
v_add_u32 v64, 6144, v7
ds_read2_b64 v[120:123], v64 offset0:0 offset1:16
ds_read2_b64 v[124:127], v64 offset0:64 offset1:80
s_waitcnt lgkmcnt(0)
v_swap_b32 v73, v74
v_swap_b32 v77, v78
v_swap_b32 v81, v82
v_swap_b32 v85, v86
v_swap_b32 v89, v90
v_swap_b32 v93, v94
v_swap_b32 v97, v98
v_swap_b32 v101, v102
v_swap_b32 v105, v106
v_swap_b32 v109, v110
v_swap_b32 v113, v114
v_swap_b32 v117, v118
v_swap_b32 v121, v122
v_swap_b32 v125, v126
s_nop 1
v_mfma_f32_16x16x32_bf16 v[32:35], v[72:75], a[0:3], 0
v_mfma_f32_16x16x32_bf16 v[36:39], v[72:75], a[112:115], 0
v_mfma_f32_16x16x32_bf16 v[40:43], v[72:75], a[56:59], 0
v_mfma_f32_16x16x32_bf16 v[44:47], v[72:75], a[168:171], 0
v_mfma_f32_16x16x32_bf16 v[32:35], v[76:79], a[4:7], v[32:35]
v_mfma_f32_16x16x32_bf16 v[36:39], v[76:79], a[116:119], v[36:39]
v_mfma_f32_16x16x32_bf16 v[40:43], v[76:79], a[60:63], v[40:43]
v_mfma_f32_16x16x32_bf16 v[44:47], v[76:79], a[172:175], v[44:47]
v_mfma_f32_16x16x32_bf16 v[32:35], v[80:83], a[8:11], v[32:35]
v_mfma_f32_16x16x32_bf16 v[36:39], v[80:83], a[120:123], v[36:39]
v_mfma_f32_16x16x32_bf16 v[40:43], v[80:83], a[64:67], v[40:43]
v_mfma_f32_16x16x32_bf16 v[44:47], v[80:83], a[176:179], v[44:47]
v_mfma_f32_16x16x32_bf16 v[32:35], v[84:87], a[12:15], v[32:35]
v_mfma_f32_16x16x32_bf16 v[36:39], v[84:87], a[124:127], v[36:39]
v_mfma_f32_16x16x32_bf16 v[40:43], v[84:87], a[68:71], v[40:43]
v_mfma_f32_16x16x32_bf16 v[44:47], v[84:87], a[180:183], v[44:47]
v_mfma_f32_16x16x32_bf16 v[32:35], v[88:91], a[16:19], v[32:35]
v_mfma_f32_16x16x32_bf16 v[36:39], v[88:91], a[128:131], v[36:39]
v_mfma_f32_16x16x32_bf16 v[40:43], v[88:91], a[72:75], v[40:43]
v_mfma_f32_16x16x32_bf16 v[44:47], v[88:91], a[184:187], v[44:47]
v_mfma_f32_16x16x32_bf16 v[32:35], v[92:95], a[20:23], v[32:35]
v_mfma_f32_16x16x32_bf16 v[36:39], v[92:95], a[132:135], v[36:39]
v_mfma_f32_16x16x32_bf16 v[40:43], v[92:95], a[76:79], v[40:43]
v_mfma_f32_16x16x32_bf16 v[44:47], v[92:95], a[188:191], v[44:47]
v_mfma_f32_16x16x32_bf16 v[32:35], v[96:99], a[24:27], v[32:35]
v_mfma_f32_16x16x32_bf16 v[36:39], v[96:99], a[136:139], v[36:39]
v_mfma_f32_16x16x32_bf16 v[40:43], v[96:99], a[80:83], v[40:43]
v_mfma_f32_16x16x32_bf16 v[44:47], v[96:99], a[192:195], v[44:47]
v_mfma_f32_16x16x32_bf16 v[32:35], v[100:103], a[28:31], v[32:35]
v_mfma_f32_16x16x32_bf16 v[36:39], v[100:103], a[140:143], v[36:39]
v_mfma_f32_16x16x32_bf16 v[40:43], v[100:103], a[84:87], v[40:43]
v_mfma_f32_16x16x32_bf16 v[44:47], v[100:103], a[196:199], v[44:47]
v_mfma_f32_16x16x32_bf16 v[32:35], v[104:107], a[32:35], v[32:35]
v_mfma_f32_16x16x32_bf16 v[36:39], v[104:107], a[144:147], v[36:39]
v_mfma_f32_16x16x32_bf16 v[40:43], v[104:107], a[88:91], v[40:43]
v_mfma_f32_16x16x32_bf16 v[44:47], v[104:107], a[200:203], v[44:47]
v_mfma_f32_16x16x32_bf16 v[32:35], v[108:111], a[36:39], v[32:35]
v_mfma_f32_16x16x32_bf16 v[36:39], v[108:111], a[148:151], v[36:39]
v_mfma_f32_16x16x32_bf16 v[40:43], v[108:111], a[92:95], v[40:43]
v_mfma_f32_16x16x32_bf16 v[44:47], v[108:111], a[204:207], v[44:47]
v_mfma_f32_16x16x32_bf16 v[32:35], v[112:115], a[40:43], v[32:35]
v_mfma_f32_16x16x32_bf16 v[36:39], v[112:115], a[152:155], v[36:39]
v_mfma_f32_16x16x32_bf16 v[40:43], v[112:115], a[96:99], v[40:43]
v_mfma_f32_16x16x32_bf16 v[44:47], v[112:115], a[208:211], v[44:47]
v_mfma_f32_16x16x32_bf16 v[32:35], v[116:119], a[44:47], v[32:35]
v_mfma_f32_16x16x32_bf16 v[36:39], v[116:119], a[156:159], v[36:39]
v_mfma_f32_16x16x32_bf16 v[40:43], v[116:119], a[100:103], v[40:43]
v_mfma_f32_16x16x32_bf16 v[44:47], v[116:119], a[212:215], v[44:47]
v_mfma_f32_16x16x32_bf16 v[32:35], v[120:123], a[48:51], v[32:35]
v_mfma_f32_16x16x32_bf16 v[36:39], v[120:123], a[160:163], v[36:39]
v_mfma_f32_16x16x32_bf16 v[40:43], v[120:123], a[104:107], v[40:43]
v_mfma_f32_16x16x32_bf16 v[44:47], v[120:123], a[216:219], v[44:47]
v_mfma_f32_16x16x32_bf16 v[32:35], v[124:127], a[52:55], v[32:35]
v_mfma_f32_16x16x32_bf16 v[36:39], v[124:127], a[164:167], v[36:39]
v_mfma_f32_16x16x32_bf16 v[40:43], v[124:127], a[108:111], v[40:43]
v_mfma_f32_16x16x32_bf16 v[44:47], v[124:127], a[220:223], v[44:47]
s_nop 7
v_cvt_pk_bf16_f32 v32, v32, v33
v_cvt_pk_bf16_f32 v33, v34, v35
v_cvt_pk_bf16_f32 v34, v36, v37
v_cvt_pk_bf16_f32 v35, v38, v39
buffer_store_dwordx4 v[32:35], v1, s[8:11], s25 offen offset:0 sc1
v_cvt_pk_bf16_f32 v40, v40, v41
v_cvt_pk_bf16_f32 v41, v42, v43
v_cvt_pk_bf16_f32 v42, v44, v45
v_cvt_pk_bf16_f32 v43, v46, v47
buffer_store_dwordx4 v[40:43], v1, s[8:11], s25 offen offset:1024 sc1
s_mov_b32 s41, s26
s_mov_b32 s40, 1
s_barrier
s_add_u32 s25, s25, 229376
s_add_u32 s26, s26, 128
s_add_u32 s23, s23, 1
s_cmp_lt_u32 s23, 48
s_cbranch_scc1 VM_loop_169
s_waitcnt vmcnt(0)
s_mov_b64 exec, 1
buffer_atomic_add v3, v2, s[8:11], s41 offen sc1
s_mov_b64 exec, -1
s_waitcnt vmcnt(0)
s_endpgm
M_xa:
s_sub_u32 s12, s12, 56
s_cmp_lg_u32 s13, 0
s_cbranch_scc1 M_dl_174
s_mov_b32 s17, 44113664
v_mov_b32 v8, 0
WC_175:
buffer_load_dword v9, v8, s[8:11], s17 offen sc1
s_waitcnt vmcnt(0)
v_cmp_gt_u32 vcc, 7, v9
s_cbranch_vccz WCD_176
s_sleep 16
s_sub_u32 s19, s19, 1
s_cbranch_scc0 WC_175
s_branch M_abort
WCD_176:
M_dl_174:
s_barrier
v_and_b32 v0, 63, v0
v_lshlrev_b32 v1, 4, v0
v_lshlrev_b32 v2, 3, v0
v_mov_b32 v3, 0
v_mov_b32 v4, 1
v_mov_b32 v11, 0xff800000
s_and_b32 s20, s12, 15
s_lshr_b32 s21, s12, 4
v_and_b32 v12, 15, v0
v_lshrrev_b32 v13, 4, v0
s_mul_i32 s17, s13, 1792
v_lshrrev_b32 v10, 1, v13
v_lshlrev_b32 v6, 7, v10
v_and_b32 v10, 7, v0
v_lshl_add_u32 v6, v10, 4, v6
v_and_b32 v10, 1, v13
v_lshl_add_u32 v6, v10, 3, v6
s_lshl_b32 s18, s13, 11
s_add_u32 s18, s18, 81920
v_add_u32 v84, s18, v6
v_add_u32 v6, s17, v6
v_cmp_gt_u32 s[54:55], 48, v0
s_mul_i32 s17, s13, 6144
s_add_u32 s17, s17, 57344
v_add_u32 v7, s17, v1
s_and_b32 s17, s13, 1
s_lshl_b32 s17, s17, 10
s_add_u32 s17, s17, 57344
v_add_u32 v8, s17, v1
v_bfe_u32 v10, v12, 3, 1
v_lshlrev_b32 v9, 4, v10
v_bfe_u32 v10, v12, 1, 1
v_lshl_add_u32 v9, v10, 3, v9
v_bfe_u32 v10, v12, 2, 1
v_lshl_add_u32 v9, v10, 2, v9
v_and_b32 v10, 1, v12
v_add_u32 v9, v9, v10
s_and_b32 s17, s13, 1
s_lshl_b32 s17, s17, 1
v_add_u32 v9, s17, v9
v_lshrrev_b32 v10, 1, v13
v_lshlrev_b32 v10, 4, v10
v_sub_u32 v9, v9, v10
v_and_b32 v10, 1, v13
v_lshlrev_b32 v10, 2, v10
v_sub_u32 v9, v9, v10
v_cmp_le_i32 s[32:33], 0, v9
v_cmp_le_i32 s[34:35], 1, v9
v_cmp_le_i32 s[36:37], 8, v9
v_cmp_le_i32 s[38:39], 9, v9
v_cmp_le_i32 s[40:41], 2, v9
v_cmp_le_i32 s[42:43], 3, v9
v_cmp_le_i32 s[44:45], 10, v9
v_cmp_le_i32 s[46:47], 11, v9
v_cmp_gt_u32 s[48:49], 2, v13
s_lshl_b32 s17, s20, 2
s_add_u32 s17, s17, s13
s_lshl_b32 s17, s17, 7
s_add_u32 s17, s17, 44118656
v_and_b32 v10, 7, v0
v_min_u32 v10, 6, v10
v_lshlrev_b32 v10, 2, v10
WC_177:
buffer_load_dword v9, v10, s[8:11], s17 offen sc1
s_waitcnt vmcnt(0)
v_cmp_gt_u32 vcc, 7, v9
s_cbranch_vccz WCD_178
s_sleep 4
s_sub_u32 s19, s19, 1
s_cbranch_scc0 WC_177
s_branch M_abort
WCD_178:
s_mul_i32 s17, s20, 401408
s_mul_i32 s18, s13, 100352
s_add_u32 s17, s17, s18
buffer_load_dwordx4 a[0:3], v1, s[8:11], s17 offen offset:0 sc1
buffer_load_dwordx4 a[4:7], v1, s[8:11], s17 offen offset:1024 sc1
buffer_load_dwordx4 a[8:11], v1, s[8:11], s17 offen offset:2048 sc1
buffer_load_dwordx4 a[12:15], v1, s[8:11], s17 offen offset:3072 sc1
s_add_u32 s17, s17, 4096
buffer_load_dwordx4 a[16:19], v1, s[8:11], s17 offen offset:0 sc1
buffer_load_dwordx4 a[20:23], v1, s[8:11], s17 offen offset:1024 sc1
buffer_load_dwordx4 a[24:27], v1, s[8:11], s17 offen offset:2048 sc1
buffer_load_dwordx4 a[28:31], v1, s[8:11], s17 offen offset:3072 sc1
s_add_u32 s17, s17, 4096
buffer_load_dwordx4 a[32:35], v1, s[8:11], s17 offen offset:0 sc1
buffer_load_dwordx4 a[36:39], v1, s[8:11], s17 offen offset:1024 sc1
buffer_load_dwordx4 a[40:43], v1, s[8:11], s17 offen offset:2048 sc1
buffer_load_dwordx4 a[44:47], v1, s[8:11], s17 offen offset:3072 sc1
s_add_u32 s17, s17, 4096
buffer_load_dwordx4 a[48:51], v1, s[8:11], s17 offen offset:0 sc1
buffer_load_dwordx4 a[52:55], v1, s[8:11], s17 offen offset:1024 sc1
buffer_load_dwordx4 a[56:59], v1, s[8:11], s17 offen offset:2048 sc1
buffer_load_dwordx4 a[60:63], v1, s[8:11], s17 offen offset:3072 sc1
s_add_u32 s17, s17, 4096
buffer_load_dwordx4 a[64:67], v1, s[8:11], s17 offen offset:0 sc1
buffer_load_dwordx4 a[68:71], v1, s[8:11], s17 offen offset:1024 sc1
buffer_load_dwordx4 a[72:75], v1, s[8:11], s17 offen offset:2048 sc1
buffer_load_dwordx4 a[76:79], v1, s[8:11], s17 offen offset:3072 sc1
s_add_u32 s17, s17, 4096
buffer_load_dwordx4 a[80:83], v1, s[8:11], s17 offen offset:0 sc1
buffer_load_dwordx4 a[84:87], v1, s[8:11], s17 offen offset:1024 sc1
buffer_load_dwordx4 a[88:91], v1, s[8:11], s17 offen offset:2048 sc1
buffer_load_dwordx4 a[92:95], v1, s[8:11], s17 offen offset:3072 sc1
s_add_u32 s17, s17, 4096
buffer_load_dwordx4 a[96:99], v1, s[8:11], s17 offen offset:0 sc1
buffer_load_dwordx4 a[100:103], v1, s[8:11], s17 offen offset:1024 sc1
buffer_load_dwordx4 a[104:107], v1, s[8:11], s17 offen offset:2048 sc1
buffer_load_dwordx4 a[108:111], v1, s[8:11], s17 offen offset:3072 sc1
s_add_u32 s17, s17, 4096
buffer_load_dwordx4 a[112:115], v1, s[8:11], s17 offen offset:0 sc1
buffer_load_dwordx4 a[116:119], v1, s[8:11], s17 offen offset:1024 sc1
buffer_load_dwordx4 a[120:123], v1, s[8:11], s17 offen offset:2048 sc1
buffer_load_dwordx4 a[124:127], v1, s[8:11], s17 offen offset:3072 sc1
s_add_u32 s17, s17, 4096
buffer_load_dwordx4 a[128:131], v1, s[8:11], s17 offen offset:0 sc1
buffer_load_dwordx4 a[132:135], v1, s[8:11], s17 offen offset:1024 sc1
buffer_load_dwordx4 a[136:139], v1, s[8:11], s17 offen offset:2048 sc1
buffer_load_dwordx4 a[140:143], v1, s[8:11], s17 offen offset:3072 sc1
s_add_u32 s17, s17, 4096
buffer_load_dwordx4 a[144:147], v1, s[8:11], s17 offen offset:0 sc1
buffer_load_dwordx4 a[148:151], v1, s[8:11], s17 offen offset:1024 sc1
buffer_load_dwordx4 a[152:155], v1, s[8:11], s17 offen offset:2048 sc1
buffer_load_dwordx4 a[156:159], v1, s[8:11], s17 offen offset:3072 sc1
s_add_u32 s17, s17, 4096
buffer_load_dwordx4 a[160:163], v1, s[8:11], s17 offen offset:0 sc1
buffer_load_dwordx4 a[164:167], v1, s[8:11], s17 offen offset:1024 sc1
buffer_load_dwordx4 a[168:171], v1, s[8:11], s17 offen offset:2048 sc1
buffer_load_dwordx4 a[172:175], v1, s[8:11], s17 offen offset:3072 sc1
s_add_u32 s17, s17, 4096
buffer_load_dwordx4 a[176:179], v1, s[8:11], s17 offen offset:0 sc1
buffer_load_dwordx4 a[180:183], v1, s[8:11], s17 offen offset:1024 sc1
buffer_load_dwordx4 a[184:187], v1, s[8:11], s17 offen offset:2048 sc1
buffer_load_dwordx4 a[188:191], v1, s[8:11], s17 offen offset:3072 sc1
s_add_u32 s17, s17, 4096
buffer_load_dwordx4 a[192:195], v1, s[8:11], s17 offen offset:0 sc1
buffer_load_dwordx4 a[196:199], v1, s[8:11], s17 offen offset:1024 sc1
buffer_load_dwordx4 a[200:203], v1, s[8:11], s17 offen offset:2048 sc1
buffer_load_dwordx4 a[204:207], v1, s[8:11], s17 offen offset:3072 sc1
s_add_u32 s17, s17, 4096
buffer_load_dwordx4 a[208:211], v1, s[8:11], s17 offen offset:0 sc1
buffer_load_dwordx4 a[212:215], v1, s[8:11], s17 offen offset:1024 sc1
buffer_load_dwordx4 a[216:219], v1, s[8:11], s17 offen offset:2048 sc1
buffer_load_dwordx4 a[220:223], v1, s[8:11], s17 offen offset:3072 sc1
s_add_u32 s17, s17, 4096
buffer_load_dwordx4 v[88:91], v1, s[8:11], s17 offen offset:0 sc1
buffer_load_dwordx4 v[92:95], v1, s[8:11], s17 offen offset:1024 sc1
buffer_load_dwordx4 v[96:99], v1, s[8:11], s17 offen offset:2048 sc1
buffer_load_dwordx4 v[100:103], v1, s[8:11], s17 offen offset:3072 sc1
s_add_u32 s17, s17, 4096
buffer_load_dwordx4 v[104:107], v1, s[8:11], s17 offen offset:0 sc1
buffer_load_dwordx4 v[108:111], v1, s[8:11], s17 offen offset:1024 sc1
buffer_load_dwordx4 v[112:115], v1, s[8:11], s17 offen offset:2048 sc1
buffer_load_dwordx4 v[116:119], v1, s[8:11], s17 offen offset:3072 sc1
s_add_u32 s17, s17, 4096
buffer_load_dwordx4 v[120:123], v1, s[8:11], s17 offen offset:0 sc1
buffer_load_dwordx4 v[124:127], v1, s[8:11], s17 offen offset:1024 sc1
buffer_load_dwordx4 v[128:131], v1, s[8:11], s17 offen offset:2048 sc1
buffer_load_dwordx4 v[132:135], v1, s[8:11], s17 offen offset:3072 sc1
s_add_u32 s17, s17, 4096
buffer_load_dwordx4 v[136:139], v1, s[8:11], s17 offen offset:0 sc1
buffer_load_dwordx4 v[140:143], v1, s[8:11], s17 offen offset:1024 sc1
buffer_load_dwordx4 v[144:147], v1, s[8:11], s17 offen offset:2048 sc1
buffer_load_dwordx4 v[148:151], v1, s[8:11], s17 offen offset:3072 sc1
s_add_u32 s17, s17, 4096
buffer_load_dwordx4 v[152:155], v1, s[8:11], s17 offen offset:0 sc1
buffer_load_dwordx4 v[156:159], v1, s[8:11], s17 offen offset:1024 sc1
buffer_load_dwordx4 v[160:163], v1, s[8:11], s17 offen offset:2048 sc1
buffer_load_dwordx4 v[164:167], v1, s[8:11], s17 offen offset:3072 sc1
s_add_u32 s17, s17, 4096
buffer_load_dwordx4 v[168:171], v1, s[8:11], s17 offen offset:0 sc1
buffer_load_dwordx4 v[172:175], v1, s[8:11], s17 offen offset:1024 sc1
buffer_load_dwordx4 v[176:179], v1, s[8:11], s17 offen offset:2048 sc1
buffer_load_dwordx4 v[180:183], v1, s[8:11], s17 offen offset:3072 sc1
s_add_u32 s17, s17, 4096
buffer_load_dwordx4 v[184:187], v1, s[8:11], s17 offen offset:0 sc1
buffer_load_dwordx4 v[188:191], v1, s[8:11], s17 offen offset:1024 sc1
buffer_load_dwordx4 v[192:195], v1, s[8:11], s17 offen offset:2048 sc1
buffer_load_dwordx4 v[196:199], v1, s[8:11], s17 offen offset:3072 sc1
s_add_u32 s17, s17, 4096
buffer_load_dwordx4 v[200:203], v1, s[8:11], s17 offen offset:0 sc1
buffer_load_dwordx4 v[204:207], v1, s[8:11], s17 offen offset:1024 sc1
buffer_load_dwordx4 v[208:211], v1, s[8:11], s17 offen offset:2048 sc1
buffer_load_dwordx4 v[212:215], v1, s[8:11], s17 offen offset:3072 sc1
s_add_u32 s17, s17, 4096
buffer_load_dwordx4 v[216:219], v1, s[8:11], s17 offen offset:0 sc1
buffer_load_dwordx4 v[220:223], v1, s[8:11], s17 offen offset:1024 sc1
buffer_load_dwordx4 v[224:227], v1, s[8:11], s17 offen offset:2048 sc1
buffer_load_dwordx4 v[228:231], v1, s[8:11], s17 offen offset:3072 sc1
s_add_u32 s17, s17, 4096
buffer_load_dwordx4 v[232:235], v1, s[8:11], s17 offen offset:0 sc1
buffer_load_dwordx4 v[236:239], v1, s[8:11], s17 offen offset:1024 sc1
buffer_load_dwordx4 v[240:243], v1, s[8:11], s17 offen offset:2048 sc1
buffer_load_dwordx4 v[244:247], v1, s[8:11], s17 offen offset:3072 sc1
s_add_u32 s17, s17, 4096
buffer_load_dwordx4 v[248:251], v1, s[8:11], s17 offen offset:0 sc1
buffer_load_dwordx4 v[252:255], v1, s[8:11], s17 offen offset:1024 sc1
s_mov_b32 s22, s21
s_mul_i32 s23, s21, 28672
s_mul_i32 s17, s13, 7168
s_add_u32 s23, s23, s17
s_add_u32 s26, s23, 44593792
s_add_u32 s23, s23, 46428800
s_mul_i32 s27, s21, 7168
s_add_u32 s27, s27, 44135040
s_mul_i32 s28, s21, 49152
s_mul_i32 s17, s20, 3072
s_add_u32 s28, s28, s17
s_add_u32 s28, s28, 62943872
s_lshl_b32 s29, s21, 7
s_add_u32 s29, s29, 44126856
s_mul_i32 s25, s13, 7168
s_mov_b32 s24, 0
s_mov_b32 s17, 44111616
WC_179:
buffer_load_dword v9, v3, s[8:11], s17 offen sc1
s_waitcnt vmcnt(0)
v_cmp_gt_u32 vcc, 64, v9
s_cbranch_vccz WCD_180
s_sleep 4
s_sub_u32 s19, s19, 1
s_cbranch_scc0 WC_179
s_branch M_abort
WCD_180:
s_add_u32 s18, s25, s24
s_mov_b32 m0, s18
s_nop 0
buffer_load_dwordx4 v1, s[8:11], s23 offen offset:0 sc1 lds
buffer_load_dwordx4 v1, s[8:11], s23 offen offset:1024 sc1 lds
buffer_load_dwordx4 v1, s[8:11], s23 offen offset:2048 sc1 lds
buffer_load_dwordx4 v1, s[8:11], s23 offen offset:3072 sc1 lds
s_add_u32 m0, s18, 4096
s_add_u32 s17, s23, 4096
buffer_load_dwordx4 v1, s[8:11], s17 offen offset:0 sc1 lds
buffer_load_dwordx4 v1, s[8:11], s17 offen offset:1024 sc1 lds
buffer_load_dwordx4 v1, s[8:11], s17 offen offset:2048 sc1 lds
s_mov_b32 s52, 0
s_waitcnt vmcnt(0)
XA_loop_181:
s_barrier
v_add_u32 v5, s24, v1
s_xor_b32 s24, s24, 28672
buffer_load_dwordx4 a[224:227], v1, s[8:11], s26 offen offset:0 sc1
buffer_load_dwordx4 a[228:231], v1, s[8:11], s26 offen offset:1024 sc1
buffer_load_dwordx4 a[232:235], v1, s[8:11], s26 offen offset:2048 sc1
buffer_load_dwordx2 a[236:237], v2, s[8:11], s26 offen offset:3072 sc1
buffer_load_dwordx4 a[238:241], v1, s[8:11], s26 offen offset:3584 sc1
s_add_u32 s18, s26, 4096
buffer_load_dwordx4 a[242:245], v1, s[8:11], s18 offen offset:512 sc1
buffer_load_dwordx4 a[246:249], v1, s[8:11], s18 offen offset:1536 sc1
buffer_load_dwordx2 a[250:251], v2, s[8:11], s18 offen offset:2560 sc1
s_mul_i32 s17, s13, 1792
s_add_u32 s17, s17, s27
s_lshl_b32 s18, s13, 11
s_add_u32 m0, s18, 81920
s_nop 0
buffer_load_dwordx4 v1, s[8:11], s17 offen sc1 lds
s_mov_b64 exec, s[54:55]
buffer_load_dwordx4 v1, s[8:11], s17 offen offset:1024 sc1 lds
s_mov_b64 exec, -1
s_add_u32 s23, s23, 86016
s_add_u32 s26, s26, 86016
s_add_u32 s17, s22, 3
s_cmp_ge_u32 s17, 64
s_cbranch_scc1 XA_nopf_182
s_add_u32 s18, s25, s24
s_mov_b32 m0, s18
s_nop 0
buffer_load_dwordx4 v1, s[8:11], s23 offen offset:0 sc1 lds
buffer_load_dwordx4 v1, s[8:11], s23 offen offset:1024 sc1 lds
buffer_load_dwordx4 v1, s[8:11], s23 offen offset:2048 sc1 lds
buffer_load_dwordx4 v1, s[8:11], s23 offen offset:3072 sc1 lds
s_add_u32 m0, s18, 4096
s_add_u32 s17, s23, 4096
buffer_load_dwordx4 v1, s[8:11], s17 offen offset:0 sc1 lds
buffer_load_dwordx4 v1, s[8:11], s17 offen offset:1024 sc1 lds
buffer_load_dwordx4 v1, s[8:11], s17 offen offset:2048 sc1 lds
XA_nopf_182:
ds_read_b128 v[12:15], v5 offset:0
ds_read_b128 v[16:19], v5 offset:14336
ds_read_b128 v[20:23], v5 offset:1024
ds_read_b128 v[24:27], v5 offset:15360
s_waitcnt lgkmcnt(2)
v_mfma_f32_16x16x32_bf16 v[44:47], a[0:3], v[12:15], 0
v_mfma_f32_16x16x32_bf16 v[48:51], a[0:3], v[16:19], 0
v_mfma_f32_16x16x32_bf16 v[52:55], a[56:59], v[12:15], 0
v_mfma_f32_16x16x32_bf16 v[56:59], a[56:59], v[16:19], 0
v_mfma_f32_16x16x32_bf16 v[60:63], a[112:115], v[12:15], 0
v_mfma_f32_16x16x32_bf16 v[64:67], a[112:115], v[16:19], 0
v_mfma_f32_16x16x32_bf16 v[68:71], a[168:171], v[12:15], 0
v_mfma_f32_16x16x32_bf16 v[72:75], a[168:171], v[16:19], 0
ds_read_b128 v[12:15], v5 offset:2048
ds_read_b128 v[16:19], v5 offset:16384
s_waitcnt lgkmcnt(2)
v_mfma_f32_16x16x32_bf16 v[44:47], a[4:7], v[20:23], v[44:47]
v_mfma_f32_16x16x32_bf16 v[48:51], a[4:7], v[24:27], v[48:51]
v_mfma_f32_16x16x32_bf16 v[52:55], a[60:63], v[20:23], v[52:55]
v_mfma_f32_16x16x32_bf16 v[56:59], a[60:63], v[24:27], v[56:59]
v_mfma_f32_16x16x32_bf16 v[60:63], a[116:119], v[20:23], v[60:63]
v_mfma_f32_16x16x32_bf16 v[64:67], a[116:119], v[24:27], v[64:67]
v_mfma_f32_16x16x32_bf16 v[68:71], a[172:175], v[20:23], v[68:71]
v_mfma_f32_16x16x32_bf16 v[72:75], a[172:175], v[24:27], v[72:75]
ds_read_b128 v[20:23], v5 offset:3072
ds_read_b128 v[24:27], v5 offset:17408
s_waitcnt lgkmcnt(2)
v_mfma_f32_16x16x32_bf16 v[44:47], a[8:11], v[12:15], v[44:47]
v_mfma_f32_16x16x32_bf16 v[48:51], a[8:11], v[16:19], v[48:51]
v_mfma_f32_16x16x32_bf16 v[52:55], a[64:67], v[12:15], v[52:55]
v_mfma_f32_16x16x32_bf16 v[56:59], a[64:67], v[16:19], v[56:59]
v_mfma_f32_16x16x32_bf16 v[60:63], a[120:123], v[12:15], v[60:63]
v_mfma_f32_16x16x32_bf16 v[64:67], a[120:123], v[16:19], v[64:67]
v_mfma_f32_16x16x32_bf16 v[68:71], a[176:179], v[12:15], v[68:71]
v_mfma_f32_16x16x32_bf16 v[72:75], a[176:179], v[16:19], v[72:75]
ds_read_b128 v[12:15], v5 offset:4096
ds_read_b128 v[16:19], v5 offset:18432
s_waitcnt lgkmcnt(2)
v_mfma_f32_16x16x32_bf16 v[44:47], a[12:15], v[20:23], v[44:47]
v_mfma_f32_16x16x32_bf16 v[48:51], a[12:15], v[24:27], v[48:51]
v_mfma_f32_16x16x32_bf16 v[52:55], a[68:71], v[20:23], v[52:55]
v_mfma_f32_16x16x32_bf16 v[56:59], a[68:71], v[24:27], v[56:59]
v_mfma_f32_16x16x32_bf16 v[60:63], a[124:127], v[20:23], v[60:63]
v_mfma_f32_16x16x32_bf16 v[64:67], a[124:127], v[24:27], v[64:67]
v_mfma_f32_16x16x32_bf16 v[68:71], a[180:183], v[20:23], v[68:71]
v_mfma_f32_16x16x32_bf16 v[72:75], a[180:183], v[24:27], v[72:75]
ds_read_b128 v[20:23], v5 offset:5120
ds_read_b128 v[24:27], v5 offset:19456
s_waitcnt lgkmcnt(2)
v_mfma_f32_16x16x32_bf16 v[44:47], a[16:19], v[12:15], v[44:47]
v_mfma_f32_16x16x32_bf16 v[48:51], a[16:19], v[16:19], v[48:51]
v_mfma_f32_16x16x32_bf16 v[52:55], a[72:75], v[12:15], v[52:55]
v_mfma_f32_16x16x32_bf16 v[56:59], a[72:75], v[16:19], v[56:59]
v_mfma_f32_16x16x32_bf16 v[60:63], a[128:131], v[12:15], v[60:63]
v_mfma_f32_16x16x32_bf16 v[64:67], a[128:131], v[16:19], v[64:67]
v_mfma_f32_16x16x32_bf16 v[68:71], a[184:187], v[12:15], v[68:71]
v_mfma_f32_16x16x32_bf16 v[72:75], a[184:187], v[16:19], v[72:75]
ds_read_b128 v[12:15], v5 offset:6144
ds_read_b128 v[16:19], v5 offset:20480
s_waitcnt lgkmcnt(2)
v_mfma_f32_16x16x32_bf16 v[44:47], a[20:23], v[20:23], v[44:47]
v_mfma_f32_16x16x32_bf16 v[48:51], a[20:23], v[24:27], v[48:51]
v_mfma_f32_16x16x32_bf16 v[52:55], a[76:79], v[20:23], v[52:55]
v_mfma_f32_16x16x32_bf16 v[56:59], a[76:79], v[24:27], v[56:59]
v_mfma_f32_16x16x32_bf16 v[60:63], a[132:135], v[20:23], v[60:63]
v_mfma_f32_16x16x32_bf16 v[64:67], a[132:135], v[24:27], v[64:67]
v_mfma_f32_16x16x32_bf16 v[68:71], a[188:191], v[20:23], v[68:71]
v_mfma_f32_16x16x32_bf16 v[72:75], a[188:191], v[24:27], v[72:75]
ds_read_b128 v[20:23], v5 offset:7168
ds_read_b128 v[24:27], v5 offset:21504
s_waitcnt lgkmcnt(2)
v_mfma_f32_16x16x32_bf16 v[44:47], a[24:27], v[12:15], v[44:47]
v_mfma_f32_16x16x32_bf16 v[48:51], a[24:27], v[16:19], v[48:51]
v_mfma_f32_16x16x32_bf16 v[52:55], a[80:83], v[12:15], v[52:55]
v_mfma_f32_16x16x32_bf16 v[56:59], a[80:83], v[16:19], v[56:59]
v_mfma_f32_16x16x32_bf16 v[60:63], a[136:139], v[12:15], v[60:63]
v_mfma_f32_16x16x32_bf16 v[64:67], a[136:139], v[16:19], v[64:67]
v_mfma_f32_16x16x32_bf16 v[68:71], a[192:195], v[12:15], v[68:71]
v_mfma_f32_16x16x32_bf16 v[72:75], a[192:195], v[16:19], v[72:75]
ds_read_b128 v[12:15], v5 offset:8192
ds_read_b128 v[16:19], v5 offset:22528
s_waitcnt lgkmcnt(2)
v_mfma_f32_16x16x32_bf16 v[44:47], a[28:31], v[20:23], v[44:47]
v_mfma_f32_16x16x32_bf16 v[48:51], a[28:31], v[24:27], v[48:51]
v_mfma_f32_16x16x32_bf16 v[52:55], a[84:87], v[20:23], v[52:55]
v_mfma_f32_16x16x32_bf16 v[56:59], a[84:87], v[24:27], v[56:59]
v_mfma_f32_16x16x32_bf16 v[60:63], a[140:143], v[20:23], v[60:63]
v_mfma_f32_16x16x32_bf16 v[64:67], a[140:143], v[24:27], v[64:67]
v_mfma_f32_16x16x32_bf16 v[68:71], a[196:199], v[20:23], v[68:71]
v_mfma_f32_16x16x32_bf16 v[72:75], a[196:199], v[24:27], v[72:75]
ds_read_b128 v[20:23], v5 offset:9216
ds_read_b128 v[24:27], v5 offset:23552
s_waitcnt lgkmcnt(2)
v_mfma_f32_16x16x32_bf16 v[44:47], a[32:35], v[12:15], v[44:47]
v_mfma_f32_16x16x32_bf16 v[48:51], a[32:35], v[16:19], v[48:51]
v_mfma_f32_16x16x32_bf16 v[52:55], a[88:91], v[12:15], v[52:55]
v_mfma_f32_16x16x32_bf16 v[56:59], a[88:91], v[16:19], v[56:59]
v_mfma_f32_16x16x32_bf16 v[60:63], a[144:147], v[12:15], v[60:63]
v_mfma_f32_16x16x32_bf16 v[64:67], a[144:147], v[16:19], v[64:67]
v_mfma_f32_16x16x32_bf16 v[68:71], a[200:203], v[12:15], v[68:71]
v_mfma_f32_16x16x32_bf16 v[72:75], a[200:203], v[16:19], v[72:75]
ds_read_b128 v[12:15], v5 offset:10240
ds_read_b128 v[16:19], v5 offset:24576
s_waitcnt lgkmcnt(2)
v_mfma_f32_16x16x32_bf16 v[44:47], a[36:39], v[20:23], v[44:47]
v_mfma_f32_16x16x32_bf16 v[48:51], a[36:39], v[24:27], v[48:51]
v_mfma_f32_16x16x32_bf16 v[52:55], a[92:95], v[20:23], v[52:55]
v_mfma_f32_16x16x32_bf16 v[56:59], a[92:95], v[24:27], v[56:59]
v_mfma_f32_16x16x32_bf16 v[60:63], a[148:151], v[20:23], v[60:63]
v_mfma_f32_16x16x32_bf16 v[64:67], a[148:151], v[24:27], v[64:67]
v_mfma_f32_16x16x32_bf16 v[68:71], a[204:207], v[20:23], v[68:71]
v_mfma_f32_16x16x32_bf16 v[72:75], a[204:207], v[24:27], v[72:75]
ds_read_b128 v[20:23], v5 offset:11264
ds_read_b128 v[24:27], v5 offset:25600
s_waitcnt lgkmcnt(2)
v_mfma_f32_16x16x32_bf16 v[44:47], a[40:43], v[12:15], v[44:47]
v_mfma_f32_16x16x32_bf16 v[48:51], a[40:43], v[16:19], v[48:51]
v_mfma_f32_16x16x32_bf16 v[52:55], a[96:99], v[12:15], v[52:55]
v_mfma_f32_16x16x32_bf16 v[56:59], a[96:99], v[16:19], v[56:59]
v_mfma_f32_16x16x32_bf16 v[60:63], a[152:155], v[12:15], v[60:63]
v_mfma_f32_16x16x32_bf16 v[64:67], a[152:155], v[16:19], v[64:67]
v_mfma_f32_16x16x32_bf16 v[68:71], a[208:211], v[12:15], v[68:71]
v_mfma_f32_16x16x32_bf16 v[72:75], a[208:211], v[16:19], v[72:75]
ds_read_b128 v[12:15], v5 offset:12288
ds_read_b128 v[16:19], v5 offset:26624
s_waitcnt lgkmcnt(2)
v_mfma_f32_16x16x32_bf16 v[44:47], a[44:47], v[20:23], v[44:47]
v_mfma_f32_16x16x32_bf16 v[48:51], a[44:47], v[24:27], v[48:51]
v_mfma_f32_16x16x32_bf16 v[52:55], a[100:103], v[20:23], v[52:55]
v_mfma_f32_16x16x32_bf16 v[56:59], a[100:103], v[24:27], v[56:59]
v_mfma_f32_16x16x32_bf16 v[60:63], a[156:159], v[20:23], v[60:63]
v_mfma_f32_16x16x32_bf16 v[64:67], a[156:159], v[24:27], v[64:67]
v_mfma_f32_16x16x32_bf16 v[68:71], a[212:215], v[20:23], v[68:71]
v_mfma_f32_16x16x32_bf16 v[72:75], a[212:215], v[24:27], v[72:75]
ds_read_b128 v[20:23], v5 offset:13312
ds_read_b128 v[24:27], v5 offset:27648
s_waitcnt lgkmcnt(2)
v_mfma_f32_16x16x32_bf16 v[44:47], a[48:51], v[12:15], v[44:47]
v_mfma_f32_16x16x32_bf16 v[48:51], a[48:51], v[16:19], v[48:51]
v_mfma_f32_16x16x32_bf16 v[52:55], a[104:107], v[12:15], v[52:55]
v_mfma_f32_16x16x32_bf16 v[56:59], a[104:107], v[16:19], v[56:59]
v_mfma_f32_16x16x32_bf16 v[60:63], a[160:163], v[12:15], v[60:63]
v_mfma_f32_16x16x32_bf16 v[64:67], a[160:163], v[16:19], v[64:67]
v_mfma_f32_16x16x32_bf16 v[68:71], a[216:219], v[12:15], v[68:71]
v_mfma_f32_16x16x32_bf16 v[72:75], a[216:219], v[16:19], v[72:75]
s_waitcnt lgkmcnt(0)
v_mfma_f32_16x16x32_bf16 v[44:47], a[52:55], v[20:23], v[44:47]
v_mfma_f32_16x16x32_bf16 v[48:51], a[52:55], v[24:27], v[48:51]
v_mfma_f32_16x16x32_bf16 v[52:55], a[108:111], v[20:23], v[52:55]
v_mfma_f32_16x16x32_bf16 v[56:59], a[108:111], v[24:27], v[56:59]
v_mfma_f32_16x16x32_bf16 v[60:63], a[164:167], v[20:23], v[60:63]
v_mfma_f32_16x16x32_bf16 v[64:67], a[164:167], v[24:27], v[64:67]
v_mfma_f32_16x16x32_bf16 v[68:71], a[220:223], v[20:23], v[68:71]
v_mfma_f32_16x16x32_bf16 v[72:75], a[220:223], v[24:27], v[72:75]
s_nop 7
v_cvt_pk_bf16_f32 v28, v44, v45
v_cvt_pk_bf16_f32 v29, v46, v47
v_cvt_pk_bf16_f32 v36, v48, v49
v_cvt_pk_bf16_f32 v37, v50, v51
v_cvt_pk_bf16_f32 v30, v52, v53
v_cvt_pk_bf16_f32 v31, v54, v55
v_cvt_pk_bf16_f32 v38, v56, v57
v_cvt_pk_bf16_f32 v39, v58, v59
v_cvt_pk_bf16_f32 v32, v60, v61
v_cvt_pk_bf16_f32 v33, v62, v63
v_cvt_pk_bf16_f32 v40, v64, v65
v_cvt_pk_bf16_f32 v41, v66, v67
v_cvt_pk_bf16_f32 v34, v68, v69
v_cvt_pk_bf16_f32 v35, v70, v71
v_cvt_pk_bf16_f32 v42, v72, v73
v_cvt_pk_bf16_f32 v43, v74, v75
ds_read_b128 v[12:15], v5 offset:0
ds_read_b128 v[16:19], v5 offset:14336
ds_read_b128 v[20:23], v5 offset:1024
ds_read_b128 v[24:27], v5 offset:15360
s_waitcnt lgkmcnt(2)
v_mfma_f32_16x16x32_bf16 v[44:47], v[88:91], v[12:15], 0
v_mfma_f32_16x16x32_bf16 v[48:51], v[88:91], v[16:19], 0
v_mfma_f32_16x16x32_bf16 v[52:55], v[144:147], v[12:15], 0
v_mfma_f32_16x16x32_bf16 v[56:59], v[144:147], v[16:19], 0
v_mfma_f32_16x16x32_bf16 v[60:63], v[200:203], v[12:15], 0
v_mfma_f32_16x16x32_bf16 v[64:67], v[200:203], v[16:19], 0
ds_read_b128 v[12:15], v5 offset:2048
ds_read_b128 v[16:19], v5 offset:16384
s_waitcnt lgkmcnt(2)
v_mfma_f32_16x16x32_bf16 v[44:47], v[92:95], v[20:23], v[44:47]
v_mfma_f32_16x16x32_bf16 v[48:51], v[92:95], v[24:27], v[48:51]
v_mfma_f32_16x16x32_bf16 v[52:55], v[148:151], v[20:23], v[52:55]
v_mfma_f32_16x16x32_bf16 v[56:59], v[148:151], v[24:27], v[56:59]
v_mfma_f32_16x16x32_bf16 v[60:63], v[204:207], v[20:23], v[60:63]
v_mfma_f32_16x16x32_bf16 v[64:67], v[204:207], v[24:27], v[64:67]
ds_read_b128 v[20:23], v5 offset:3072
ds_read_b128 v[24:27], v5 offset:17408
s_waitcnt lgkmcnt(2)
v_mfma_f32_16x16x32_bf16 v[44:47], v[96:99], v[12:15], v[44:47]
v_mfma_f32_16x16x32_bf16 v[48:51], v[96:99], v[16:19], v[48:51]
v_mfma_f32_16x16x32_bf16 v[52:55], v[152:155], v[12:15], v[52:55]
v_mfma_f32_16x16x32_bf16 v[56:59], v[152:155], v[16:19], v[56:59]
v_mfma_f32_16x16x32_bf16 v[60:63], v[208:211], v[12:15], v[60:63]
v_mfma_f32_16x16x32_bf16 v[64:67], v[208:211], v[16:19], v[64:67]
ds_read_b128 v[12:15], v5 offset:4096
ds_read_b128 v[16:19], v5 offset:18432
s_waitcnt lgkmcnt(2)
v_mfma_f32_16x16x32_bf16 v[44:47], v[100:103], v[20:23], v[44:47]
v_mfma_f32_16x16x32_bf16 v[48:51], v[100:103], v[24:27], v[48:51]
v_mfma_f32_16x16x32_bf16 v[52:55], v[156:159], v[20:23], v[52:55]
v_mfma_f32_16x16x32_bf16 v[56:59], v[156:159], v[24:27], v[56:59]
v_mfma_f32_16x16x32_bf16 v[60:63], v[212:215], v[20:23], v[60:63]
v_mfma_f32_16x16x32_bf16 v[64:67], v[212:215], v[24:27], v[64:67]
ds_read_b128 v[20:23], v5 offset:5120
ds_read_b128 v[24:27], v5 offset:19456
s_waitcnt lgkmcnt(2)
v_mfma_f32_16x16x32_bf16 v[44:47], v[104:107], v[12:15], v[44:47]
v_mfma_f32_16x16x32_bf16 v[48:51], v[104:107], v[16:19], v[48:51]
v_mfma_f32_16x16x32_bf16 v[52:55], v[160:163], v[12:15], v[52:55]
v_mfma_f32_16x16x32_bf16 v[56:59], v[160:163], v[16:19], v[56:59]
v_mfma_f32_16x16x32_bf16 v[60:63], v[216:219], v[12:15], v[60:63]
v_mfma_f32_16x16x32_bf16 v[64:67], v[216:219], v[16:19], v[64:67]
ds_read_b128 v[12:15], v5 offset:6144
ds_read_b128 v[16:19], v5 offset:20480
s_waitcnt lgkmcnt(2)
v_mfma_f32_16x16x32_bf16 v[44:47], v[108:111], v[20:23], v[44:47]
v_mfma_f32_16x16x32_bf16 v[48:51], v[108:111], v[24:27], v[48:51]
v_mfma_f32_16x16x32_bf16 v[52:55], v[164:167], v[20:23], v[52:55]
v_mfma_f32_16x16x32_bf16 v[56:59], v[164:167], v[24:27], v[56:59]
v_mfma_f32_16x16x32_bf16 v[60:63], v[220:223], v[20:23], v[60:63]
v_mfma_f32_16x16x32_bf16 v[64:67], v[220:223], v[24:27], v[64:67]
ds_read_b128 v[20:23], v5 offset:7168
ds_read_b128 v[24:27], v5 offset:21504
s_waitcnt lgkmcnt(2)
v_mfma_f32_16x16x32_bf16 v[44:47], v[112:115], v[12:15], v[44:47]
v_mfma_f32_16x16x32_bf16 v[48:51], v[112:115], v[16:19], v[48:51]
v_mfma_f32_16x16x32_bf16 v[52:55], v[168:171], v[12:15], v[52:55]
v_mfma_f32_16x16x32_bf16 v[56:59], v[168:171], v[16:19], v[56:59]
v_mfma_f32_16x16x32_bf16 v[60:63], v[224:227], v[12:15], v[60:63]
v_mfma_f32_16x16x32_bf16 v[64:67], v[224:227], v[16:19], v[64:67]
ds_read_b128 v[12:15], v5 offset:8192
ds_read_b128 v[16:19], v5 offset:22528
s_waitcnt lgkmcnt(2)
v_mfma_f32_16x16x32_bf16 v[44:47], v[116:119], v[20:23], v[44:47]
v_mfma_f32_16x16x32_bf16 v[48:51], v[116:119], v[24:27], v[48:51]
v_mfma_f32_16x16x32_bf16 v[52:55], v[172:175], v[20:23], v[52:55]
v_mfma_f32_16x16x32_bf16 v[56:59], v[172:175], v[24:27], v[56:59]
v_mfma_f32_16x16x32_bf16 v[60:63], v[228:231], v[20:23], v[60:63]
v_mfma_f32_16x16x32_bf16 v[64:67], v[228:231], v[24:27], v[64:67]
ds_read_b128 v[20:23], v5 offset:9216
ds_read_b128 v[24:27], v5 offset:23552
s_waitcnt lgkmcnt(2)
v_mfma_f32_16x16x32_bf16 v[44:47], v[120:123], v[12:15], v[44:47]
v_mfma_f32_16x16x32_bf16 v[48:51], v[120:123], v[16:19], v[48:51]
v_mfma_f32_16x16x32_bf16 v[52:55], v[176:179], v[12:15], v[52:55]
v_mfma_f32_16x16x32_bf16 v[56:59], v[176:179], v[16:19], v[56:59]
v_mfma_f32_16x16x32_bf16 v[60:63], v[232:235], v[12:15], v[60:63]
v_mfma_f32_16x16x32_bf16 v[64:67], v[232:235], v[16:19], v[64:67]
ds_read_b128 v[12:15], v5 offset:10240
ds_read_b128 v[16:19], v5 offset:24576
s_waitcnt lgkmcnt(2)
v_mfma_f32_16x16x32_bf16 v[44:47], v[124:127], v[20:23], v[44:47]
v_mfma_f32_16x16x32_bf16 v[48:51], v[124:127], v[24:27], v[48:51]
v_mfma_f32_16x16x32_bf16 v[52:55], v[180:183], v[20:23], v[52:55]
v_mfma_f32_16x16x32_bf16 v[56:59], v[180:183], v[24:27], v[56:59]
v_mfma_f32_16x16x32_bf16 v[60:63], v[236:239], v[20:23], v[60:63]
v_mfma_f32_16x16x32_bf16 v[64:67], v[236:239], v[24:27], v[64:67]
ds_read_b128 v[20:23], v5 offset:11264
ds_read_b128 v[24:27], v5 offset:25600
s_waitcnt lgkmcnt(2)
v_mfma_f32_16x16x32_bf16 v[44:47], v[128:131], v[12:15], v[44:47]
v_mfma_f32_16x16x32_bf16 v[48:51], v[128:131], v[16:19], v[48:51]
v_mfma_f32_16x16x32_bf16 v[52:55], v[184:187], v[12:15], v[52:55]
v_mfma_f32_16x16x32_bf16 v[56:59], v[184:187], v[16:19], v[56:59]
v_mfma_f32_16x16x32_bf16 v[60:63], v[240:243], v[12:15], v[60:63]
v_mfma_f32_16x16x32_bf16 v[64:67], v[240:243], v[16:19], v[64:67]
ds_read_b128 v[12:15], v5 offset:12288
ds_read_b128 v[16:19], v5 offset:26624
s_waitcnt lgkmcnt(2)
v_mfma_f32_16x16x32_bf16 v[44:47], v[132:135], v[20:23], v[44:47]
v_mfma_f32_16x16x32_bf16 v[48:51], v[132:135], v[24:27], v[48:51]
v_mfma_f32_16x16x32_bf16 v[52:55], v[188:191], v[20:23], v[52:55]
v_mfma_f32_16x16x32_bf16 v[56:59], v[188:191], v[24:27], v[56:59]
v_mfma_f32_16x16x32_bf16 v[60:63], v[244:247], v[20:23], v[60:63]
v_mfma_f32_16x16x32_bf16 v[64:67], v[244:247], v[24:27], v[64:67]
ds_read_b128 v[20:23], v5 offset:13312
ds_read_b128 v[24:27], v5 offset:27648
s_waitcnt lgkmcnt(2)
v_mfma_f32_16x16x32_bf16 v[44:47], v[136:139], v[12:15], v[44:47]
v_mfma_f32_16x16x32_bf16 v[48:51], v[136:139], v[16:19], v[48:51]
v_mfma_f32_16x16x32_bf16 v[52:55], v[192:195], v[12:15], v[52:55]
v_mfma_f32_16x16x32_bf16 v[56:59], v[192:195], v[16:19], v[56:59]
v_mfma_f32_16x16x32_bf16 v[60:63], v[248:251], v[12:15], v[60:63]
v_mfma_f32_16x16x32_bf16 v[64:67], v[248:251], v[16:19], v[64:67]
s_waitcnt lgkmcnt(0)
v_mfma_f32_16x16x32_bf16 v[44:47], v[140:143], v[20:23], v[44:47]
v_mfma_f32_16x16x32_bf16 v[48:51], v[140:143], v[24:27], v[48:51]
v_mfma_f32_16x16x32_bf16 v[52:55], v[196:199], v[20:23], v[52:55]
v_mfma_f32_16x16x32_bf16 v[56:59], v[196:199], v[24:27], v[56:59]
v_mfma_f32_16x16x32_bf16 v[60:63], v[252:255], v[20:23], v[60:63]
v_mfma_f32_16x16x32_bf16 v[64:67], v[252:255], v[24:27], v[64:67]
s_nop 7
v_cvt_pk_bf16_f32 v44, v44, v45
v_cvt_pk_bf16_f32 v45, v46, v47
v_cvt_pk_bf16_f32 v46, v52, v53
v_cvt_pk_bf16_f32 v47, v54, v55
v_cvt_pk_bf16_f32 v48, v48, v49
v_cvt_pk_bf16_f32 v49, v50, v51
v_cvt_pk_bf16_f32 v50, v56, v57
v_cvt_pk_bf16_f32 v51, v58, v59
v_cvt_pk_bf16_f32 v52, v60, v61
v_cvt_pk_bf16_f32 v53, v62, v63
v_cvt_pk_bf16_f32 v54, v64, v65
v_cvt_pk_bf16_f32 v55, v66, v67
s_waitcnt vmcnt(0)
s_cmp_ge_u32 s13, 2
s_cbranch_scc1 XA_nsig_183
s_cmp_eq_u32 s52, 0
s_cbranch_scc1 XA_nsig_183
s_mov_b64 exec, 1
buffer_atomic_add v4, v3, s[8:11], s50 offen sc1
s_mov_b64 exec, -1
XA_nsig_183:
ds_read_b64 v[12:13], v84 offset:0
ds_read_b64 v[14:15], v84 offset:256
ds_read_b64 v[16:17], v84 offset:512
ds_read_b64 v[18:19], v84 offset:768
ds_read_b64 v[20:21], v84 offset:1024
ds_read_b64 v[22:23], v84 offset:1280
ds_read_b64 v[24:25], v84 offset:1536
v_mfma_f32_16x16x32_bf16 v[56:59], a[224:227], v[28:31], 0
v_mfma_f32_16x16x32_bf16 v[60:63], a[224:227], v[36:39], 0
v_mfma_f32_16x16x32_bf16 v[56:59], a[228:231], v[32:35], v[56:59]
v_mfma_f32_16x16x32_bf16 v[60:63], a[228:231], v[40:43], v[60:63]
v_mfma_f32_16x16x32_bf16 v[56:59], a[232:235], v[44:47], v[56:59]
v_mfma_f32_16x16x32_bf16 v[60:63], a[232:235], v[48:51], v[60:63]
v_mfma_f32_16x16x16_bf16 v[56:59], a[236:237], v[52:53], v[56:59]
v_mfma_f32_16x16x16_bf16 v[60:63], a[236:237], v[54:55], v[60:63]
v_mfma_f32_16x16x32_bf16 v[64:67], a[238:241], v[28:31], 0
v_mfma_f32_16x16x32_bf16 v[68:71], a[238:241], v[36:39], 0
v_mfma_f32_16x16x32_bf16 v[64:67], a[242:245], v[32:35], v[64:67]
v_mfma_f32_16x16x32_bf16 v[68:71], a[242:245], v[40:43], v[68:71]
v_mfma_f32_16x16x32_bf16 v[64:67], a[246:249], v[44:47], v[64:67]
v_mfma_f32_16x16x32_bf16 v[68:71], a[246:249], v[48:51], v[68:71]
v_mfma_f32_16x16x16_bf16 v[64:67], a[250:251], v[52:53], v[64:67]
v_mfma_f32_16x16x16_bf16 v[68:71], a[250:251], v[54:55], v[68:71]
s_waitcnt lgkmcnt(0)
v_max3_u32 v9, v12, v13, v14
v_max3_u32 v9, v9, v15, v16
v_max3_u32 v9, v9, v17, v18
v_max3_u32 v9, v9, v19, v20
v_max3_u32 v9, v9, v21, v22
v_max3_u32 v9, v9, v23, v24
v_max_u32 v9, v9, v25
v_cmp_eq_u32 vcc, -1, v9
s_cbranch_vccz XA_mkok_185
XA_mk_184:
s_sleep 1
buffer_load_dwordx2 v[12:13], v6, s[8:11], s27 offen offset:0 sc1
buffer_load_dwordx2 v[14:15], v6, s[8:11], s27 offen offset:256 sc1
buffer_load_dwordx2 v[16:17], v6, s[8:11], s27 offen offset:512 sc1
buffer_load_dwordx2 v[18:19], v6, s[8:11], s27 offen offset:768 sc1
buffer_load_dwordx2 v[20:21], v6, s[8:11], s27 offen offset:1024 sc1
buffer_load_dwordx2 v[22:23], v6, s[8:11], s27 offen offset:1280 sc1
buffer_load_dwordx2 v[24:25], v6, s[8:11], s27 offen offset:1536 sc1
s_waitcnt vmcnt(0)
v_max3_u32 v9, v12, v13, v14
v_max3_u32 v9, v9, v15, v16
v_max3_u32 v9, v9, v17, v18
v_max3_u32 v9, v9, v19, v20
v_max3_u32 v9, v9, v21, v22
v_max3_u32 v9, v9, v23, v24
v_max_u32 v9, v9, v25
v_cmp_eq_u32 vcc, -1, v9
s_cbranch_vccz XA_mkok_185
s_sub_u32 s19, s19, 1
s_cbranch_scc0 XA_mk_184
s_branch M_abort
XA_mkok_185:
v_mfma_f32_16x16x32_bf16 v[72:75], v[12:15], v[28:31], 0
v_mfma_f32_16x16x32_bf16 v[76:79], v[12:15], v[36:39], 0
v_mfma_f32_16x16x32_bf16 v[72:75], v[16:19], v[32:35], v[72:75]
v_mfma_f32_16x16x32_bf16 v[76:79], v[16:19], v[40:43], v[76:79]
v_mfma_f32_16x16x32_bf16 v[72:75], v[20:23], v[44:47], v[72:75]
v_mfma_f32_16x16x32_bf16 v[76:79], v[20:23], v[48:51], v[76:79]
v_mfma_f32_16x16x16_bf16 v[72:75], v[24:25], v[52:53], v[72:75]
v_mfma_f32_16x16x16_bf16 v[76:79], v[24:25], v[54:55], v[76:79]
s_nop 7
ds_write_b128 v7, v[56:59] offset:0
ds_write_b128 v7, v[60:63] offset:1024
ds_write_b128 v7, v[64:67] offset:2048
ds_write_b128 v7, v[68:71] offset:3072
ds_write_b128 v7, v[72:75] offset:4096
ds_write_b128 v7, v[76:79] offset:5120
s_waitcnt lgkmcnt(0)
s_barrier
s_cmp_ge_u32 s13, 2
s_cbranch_scc1 XA_fin_186
ds_read_b128 v[44:47], v8 offset:0
ds_read_b128 v[48:51], v8 offset:2048
ds_read_b128 v[52:55], v8 offset:4096
ds_read_b128 v[56:59], v8 offset:6144
ds_read_b128 v[60:63], v8 offset:8192
ds_read_b128 v[64:67], v8 offset:10240
ds_read_b128 v[68:71], v8 offset:12288
ds_read_b128 v[72:75], v8 offset:14336
ds_read_b128 v[76:79], v8 offset:16384
ds_read_b128 v[12:15], v8 offset:18432
ds_read_b128 v[16:19], v8 offset:20480
ds_read_b128 v[20:23], v8 offset:22528
s_waitcnt lgkmcnt(6)
v_pk_add_f32 v[44:45], v[44:45], v[56:57]
v_pk_add_f32 v[46:47], v[46:47], v[58:59]
v_pk_add_f32 v[48:49], v[48:49], v[60:61]
v_pk_add_f32 v[50:51], v[50:51], v[62:63]
v_pk_add_f32 v[52:53], v[52:53], v[64:65]
v_pk_add_f32 v[54:55], v[54:55], v[66:67]
s_waitcnt lgkmcnt(0)
v_pk_add_f32 v[68:69], v[68:69], v[12:13]
v_pk_add_f32 v[70:71], v[70:71], v[14:15]
v_pk_add_f32 v[72:73], v[72:73], v[16:17]
v_pk_add_f32 v[74:75], v[74:75], v[18:19]
v_pk_add_f32 v[76:77], v[76:77], v[20:21]
v_pk_add_f32 v[78:79], v[78:79], v[22:23]
v_pk_add_f32 v[44:45], v[44:45], v[68:69]
v_pk_add_f32 v[46:47], v[46:47], v[70:71]
v_pk_add_f32 v[48:49], v[48:49], v[72:73]
v_pk_add_f32 v[50:51], v[50:51], v[74:75]
v_pk_add_f32 v[52:53], v[52:53], v[76:77]
v_pk_add_f32 v[54:55], v[54:55], v[78:79]
v_cndmask_b32 v44, v11, v44, s[32:33]
v_cndmask_b32 v45, v11, v45, s[34:35]
v_cndmask_b32 v46, v11, v46, s[36:37]
v_cndmask_b32 v47, v11, v47, s[38:39]
v_cndmask_b32 v48, v11, v48, s[40:41]
v_cndmask_b32 v49, v11, v49, s[42:43]
v_cndmask_b32 v50, v11, v50, s[44:45]
v_cndmask_b32 v51, v11, v51, s[46:47]
v_max3_f32 v9, v44, v45, v46
v_max3_f32 v9, v9, v47, v48
v_max3_f32 v9, v9, v49, v50
v_max3_f32 v9, v9, v51, v52
v_max3_f32 v9, v9, v53, v54
v_max_f32 v9, v9, v55
v_mov_b32 v10, v9
s_nop 1
v_permlane32_swap_b32 v9, v10
v_max_f32 v9, v9, v10
v_mov_b32 v10, v9
s_nop 1
v_permlane16_swap_b32 v9, v10
v_max_f32 v9, v9, v10
v_sub_f32 v44, v44, v9
v_sub_f32 v45, v45, v9
v_sub_f32 v46, v46, v9
v_sub_f32 v47, v47, v9
v_sub_f32 v48, v48, v9
v_sub_f32 v49, v49, v9
v_sub_f32 v50, v50, v9
v_sub_f32 v51, v51, v9
v_sub_f32 v52, v52, v9
v_sub_f32 v53, v53, v9
v_sub_f32 v54, v54, v9
v_sub_f32 v55, v55, v9
v_exp_f32 v44, v44
v_exp_f32 v45, v45
v_exp_f32 v46, v46
v_exp_f32 v47, v47
v_exp_f32 v48, v48
v_exp_f32 v49, v49
v_exp_f32 v50, v50
v_exp_f32 v51, v51
v_exp_f32 v52, v52
v_exp_f32 v53, v53
v_exp_f32 v54, v54
v_exp_f32 v55, v55
s_nop 0
v_cndmask_b32 v52, 0, v52, s[48:49]
v_cndmask_b32 v53, 0, v53, s[48:49]
v_cndmask_b32 v54, 0, v54, s[48:49]
v_cndmask_b32 v55, 0, v55, s[48:49]
v_add_f32 v9, v44, v45
v_add_f32 v9, v9, v46
v_add_f32 v9, v9, v47
v_add_f32 v9, v9, v48
v_add_f32 v9, v9, v49
v_add_f32 v9, v9, v50
v_add_f32 v9, v9, v51
v_add_f32 v9, v9, v52
v_add_f32 v9, v9, v53
v_add_f32 v9, v9, v54
v_add_f32 v9, v9, v55
v_mov_b32 v10, v9
s_nop 1
v_permlane32_swap_b32 v9, v10
v_add_f32 v9, v9, v10
v_mov_b32 v10, v9
s_nop 1
v_permlane16_swap_b32 v9, v10
v_add_f32 v9, v9, v10
v_rcp_f32 v9, v9
s_nop 0
v_mul_f32 v44, v44, v9
v_mul_f32 v45, v45, v9
v_mul_f32 v46, v46, v9
v_mul_f32 v47, v47, v9
v_mul_f32 v48, v48, v9
v_mul_f32 v49, v49, v9
v_mul_f32 v50, v50, v9
v_mul_f32 v51, v51, v9
v_mul_f32 v52, v52, v9
v_mul_f32 v53, v53, v9
v_mul_f32 v54, v54, v9
v_mul_f32 v55, v55, v9
v_cvt_pk_bf16_f32 v44, v44, v45
v_cvt_pk_bf16_f32 v45, v46, v47
v_cvt_pk_bf16_f32 v46, v48, v49
v_cvt_pk_bf16_f32 v47, v50, v51
v_cvt_pk_bf16_f32 v48, v52, v53
v_cvt_pk_bf16_f32 v49, v54, v55
s_and_b32 s17, s13, 1
s_lshl_b32 s18, s17, 10
s_add_u32 s18, s18, s28
buffer_store_dwordx4 v[44:47], v1, s[8:11], s18 offen sc1
s_lshl_b32 s18, s17, 9
s_add_u32 s18, s18, s28
buffer_store_dwordx2 v[48:49], v2, s[8:11], s18 offen offset:2048 sc1
XA_fin_186:
s_mov_b32 s50, s29
s_mov_b32 s52, 1
s_cmp_lt_u32 s22, 30
s_cbranch_scc1 XA_dfr_187
s_mov_b32 s52, 0
s_cmp_ge_u32 s13, 2
s_cbranch_scc1 XA_dfr_187
s_waitcnt vmcnt(0)
s_mov_b64 exec, 1
buffer_atomic_add v4, v3, s[8:11], s50 offen sc1
s_mov_b64 exec, -1
XA_dfr_187:
s_add_u32 s27, s27, 21504
s_add_u32 s28, s28, 147456
s_add_u32 s29, s29, 384
s_add_u32 s22, s22, 3
s_cmp_lt_u32 s22, 64
s_cbranch_scc1 XA_loop_181
s_waitcnt vmcnt(0)
s_cmp_ge_u32 s13, 2
s_cbranch_scc1 XA_nsig2_188
s_cmp_eq_u32 s52, 0
s_cbranch_scc1 XA_nsig2_188
s_mov_b64 exec, 1
buffer_atomic_add v4, v3, s[8:11], s50 offen sc1
s_mov_b64 exec, -1
XA_nsig2_188:
s_waitcnt vmcnt(0)
s_endpgm
M_pv:
s_sub_u32 s12, s12, 104
s_load_dwordx2 s[36:37], s[0:1], 0
s_mov_b32 s38, 1835008
s_mov_b32 s39, 0x20000
s_load_dwordx2 s[40:41], s[0:1], 88
s_mov_b32 s42, 1835008
s_mov_b32 s43, 0x20000
v_and_b32 v0, 63, v0
v_lshlrev_b32 v1, 4, v0
v_lshlrev_b32 v2, 3, v0
v_mov_b32 v3, 0
s_mul_i32 s21, s12, 9363
s_lshr_b32 s21, s21, 16
s_mul_i32 s17, s21, 7
s_sub_u32 s20, s12, s17
v_and_b32 v4, 15, v0
v_bfe_u32 v5, v4, 3, 1
v_lshlrev_b32 v5, 4, v5
v_bfe_u32 v6, v4, 1, 1
v_lshl_add_u32 v5, v6, 3, v5
v_bfe_u32 v6, v4, 2, 1
v_lshl_add_u32 v5, v6, 2, v5
v_and_b32 v6, 1, v4
v_add_u32 v5, v5, v6
v_mul_u32_u24 v5, 896, v5
v_lshrrev_b32 v4, 4, v0
v_lshl_add_u32 v5, v4, 3, v5
s_lshl_b32 s17, s20, 2
s_add_u32 s17, s17, s13
s_lshl_b32 s18, s17, 5
v_add_u32 v5, s18, v5
v_add_u32 v6, 1792, v5
s_mul_i32 s26, s17, 2048
s_mul_i32 s18, s21, 57344
s_add_u32 s26, s26, s18
s_add_u32 s26, s26, 66089600
s_lshr_b32 s17, s17, 1
s_mul_i32 s23, s17, 32768
s_mul_i32 s24, s17, 16384
s_and_b32 s17, s13, 1
s_lshl_b32 s18, s17, 11
s_add_u32 s23, s23, s18
s_lshl_b32 s18, s17, 10
s_add_u32 s24, s24, s18
s_mul_i32 s18, s21, 458752
s_add_u32 s23, s23, s18
s_add_u32 s23, s23, 12845056
s_mul_i32 s18, s21, 229376
s_add_u32 s24, s24, s18
s_add_u32 s24, s24, 48263808
s_mul_i32 s25, s21, 49152
s_mul_i32 s18, s13, 12288
s_add_u32 s25, s25, s18
s_add_u32 s25, s25, 62943872
s_mul_i32 s27, s21, 28672
s_lshl_b32 s28, s21, 7
s_mov_b32 s22, s21
s_waitcnt lgkmcnt(0)
PV_loop_189:
s_cmp_ge_u32 s22, 32
s_cbranch_scc1 PV_late_190
s_cmp_lg_u32 s13, 0
s_cbranch_scc1 PV_ws_194
s_add_u32 s17, s28, 44126848
PV_w_192:
buffer_load_dwordx4 v[64:67], v3, s[8:11], s17 offen sc1
s_waitcnt vmcnt(0)
v_cmp_gt_u32 vcc, 28, v64
s_mov_b64 s[30:31], vcc
s_cmp_eq_u64 s[30:31], 0
s_cbranch_scc1 PV_wd_193
s_sleep 2
s_sub_u32 s19, s19, 1
s_cbranch_scc0 PV_w_192
s_branch M_abort
PV_wd_193:
PV_ws_194:
s_barrier
s_branch PV_go_191
PV_late_190:
s_cmp_lg_u32 s13, 0
s_cbranch_scc1 PV_ws_197
s_add_u32 s17, s28, 44126848
PV_w_195:
buffer_load_dwordx4 v[64:67], v3, s[8:11], s17 offen sc1
s_waitcnt vmcnt(0)
v_cmp_gt_u32 vcc, 28, v64
s_mov_b64 s[30:31], vcc
v_cmp_gt_u32 vcc, 1, v67
s_or_b64 s[30:31], s[30:31], vcc
s_cmp_eq_u64 s[30:31], 0
s_cbranch_scc1 PV_wd_196
s_sleep 2
s_sub_u32 s19, s19, 1
s_cbranch_scc0 PV_w_195
s_branch M_abort
PV_wd_196:
PV_ws_197:
s_barrier
PV_go_191:
s_add_u32 s17, s23, 0
buffer_load_dwordx4 a[0:3], v1, s[8:11], s17 offen offset:0 sc1
buffer_load_dwordx4 a[4:7], v1, s[8:11], s17 offen offset:1024 sc1
s_add_u32 s17, s23, 4096
buffer_load_dwordx4 a[8:11], v1, s[8:11], s17 offen offset:0 sc1
buffer_load_dwordx4 a[12:15], v1, s[8:11], s17 offen offset:1024 sc1
s_add_u32 s17, s23, 8192
buffer_load_dwordx4 a[16:19], v1, s[8:11], s17 offen offset:0 sc1
buffer_load_dwordx4 a[20:23], v1, s[8:11], s17 offen offset:1024 sc1
s_add_u32 s17, s23, 12288
buffer_load_dwordx4 a[24:27], v1, s[8:11], s17 offen offset:0 sc1
buffer_load_dwordx4 a[28:31], v1, s[8:11], s17 offen offset:1024 sc1
s_add_u32 s17, s23, 16384
buffer_load_dwordx4 a[32:35], v1, s[8:11], s17 offen offset:0 sc1
buffer_load_dwordx4 a[36:39], v1, s[8:11], s17 offen offset:1024 sc1
s_add_u32 s17, s23, 20480
buffer_load_dwordx4 a[40:43], v1, s[8:11], s17 offen offset:0 sc1
buffer_load_dwordx4 a[44:47], v1, s[8:11], s17 offen offset:1024 sc1
s_add_u32 s17, s23, 24576
buffer_load_dwordx4 a[48:51], v1, s[8:11], s17 offen offset:0 sc1
buffer_load_dwordx4 a[52:55], v1, s[8:11], s17 offen offset:1024 sc1
s_add_u32 s17, s23, 28672
buffer_load_dwordx4 a[56:59], v1, s[8:11], s17 offen offset:0 sc1
buffer_load_dwordx4 a[60:63], v1, s[8:11], s17 offen offset:1024 sc1
s_cmp_lt_u32 s22, 32
s_cbranch_scc1 PV_e1_198
buffer_load_dwordx2 v[60:61], v5, s[36:39], s27 offen
buffer_load_dwordx2 v[62:63], v6, s[36:39], s27 offen
buffer_load_dwordx4 v[52:55], v1, s[8:11], s26 offen offset:0 sc1
buffer_load_dwordx4 v[56:59], v1, s[8:11], s26 offen offset:1024 sc1
PV_e1_198:
s_cmp_lg_u32 s13, 0
s_cbranch_scc1 PV_ws_201
s_add_u32 s17, s28, 44126848
PV_w_199:
buffer_load_dwordx4 v[64:67], v3, s[8:11], s17 offen sc1
s_waitcnt vmcnt(0)
v_cmp_gt_u32 vcc, 112, v65
s_mov_b64 s[30:31], vcc
v_cmp_gt_u32 vcc, 32, v66
s_or_b64 s[30:31], s[30:31], vcc
s_cmp_eq_u64 s[30:31], 0
s_cbranch_scc1 PV_wd_200
s_sleep 2
s_sub_u32 s19, s19, 1
s_cbranch_scc0 PV_w_199
s_branch M_abort
PV_wd_200:
PV_ws_201:
s_barrier
s_add_u32 s17, s24, 0
buffer_load_dwordx4 a[64:67], v1, s[8:11], s17 offen offset:0 sc1
buffer_load_dwordx4 a[68:71], v1, s[8:11], s17 offen offset:2048 sc1
s_add_u32 s17, s24, 4096
buffer_load_dwordx4 a[72:75], v1, s[8:11], s17 offen offset:0 sc1
buffer_load_dwordx4 a[76:79], v1, s[8:11], s17 offen offset:2048 sc1
s_add_u32 s17, s24, 8192
buffer_load_dwordx4 a[80:83], v1, s[8:11], s17 offen offset:0 sc1
buffer_load_dwordx4 a[84:87], v1, s[8:11], s17 offen offset:2048 sc1
s_add_u32 s17, s24, 12288
buffer_load_dwordx4 a[88:91], v1, s[8:11], s17 offen offset:0 sc1
buffer_load_dwordx4 a[92:95], v1, s[8:11], s17 offen offset:2048 sc1
s_mul_i32 s18, s13, 12288
s_add_u32 m0, s18, 0
s_add_u32 s17, s25, 0
buffer_load_dwordx4 v1, s[8:11], s17 offen offset:0 sc1 lds
buffer_load_dwordx4 v1, s[8:11], s17 offen offset:1024 sc1 lds
buffer_load_dwordx4 v1, s[8:11], s17 offen offset:2048 sc1 lds
buffer_load_dwordx4 v1, s[8:11], s17 offen offset:3072 sc1 lds
s_add_u32 m0, s18, 4096
s_add_u32 s17, s25, 4096
buffer_load_dwordx4 v1, s[8:11], s17 offen offset:0 sc1 lds
buffer_load_dwordx4 v1, s[8:11], s17 offen offset:1024 sc1 lds
buffer_load_dwordx4 v1, s[8:11], s17 offen offset:2048 sc1 lds
buffer_load_dwordx4 v1, s[8:11], s17 offen offset:3072 sc1 lds
s_add_u32 m0, s18, 8192
s_add_u32 s17, s25, 8192
buffer_load_dwordx4 v1, s[8:11], s17 offen offset:0 sc1 lds
buffer_load_dwordx4 v1, s[8:11], s17 offen offset:1024 sc1 lds
buffer_load_dwordx4 v1, s[8:11], s17 offen offset:2048 sc1 lds
buffer_load_dwordx4 v1, s[8:11], s17 offen offset:3072 sc1 lds
s_waitcnt vmcnt(0)
s_barrier
ds_read_b128 v[12:15], v1 offset:0
ds_read_b128 v[16:19], v1 offset:1024
ds_read_b128 v[20:23], v1 offset:3072
ds_read_b128 v[24:27], v1 offset:4096
ds_read_b128 v[28:31], v1 offset:6144
ds_read_b128 v[32:35], v1 offset:7168
ds_read_b128 v[36:39], v1 offset:9216
s_waitcnt lgkmcnt(6)
v_mfma_f32_16x16x32_bf16 v[44:47], a[0:3], v[12:15], 0
ds_read_b128 v[40:43], v1 offset:10240
s_waitcnt lgkmcnt(6)
v_mfma_f32_16x16x32_bf16 v[48:51], a[0:3], v[16:19], 0
ds_read_b128 v[12:15], v1 offset:12288
s_waitcnt lgkmcnt(6)
v_mfma_f32_16x16x32_bf16 v[44:47], a[4:7], v[20:23], v[44:47]
ds_read_b128 v[16:19], v1 offset:13312
s_waitcnt lgkmcnt(6)
v_mfma_f32_16x16x32_bf16 v[48:51], a[4:7], v[24:27], v[48:51]
ds_read_b128 v[20:23], v1 offset:15360
s_waitcnt lgkmcnt(6)
v_mfma_f32_16x16x32_bf16 v[44:47], a[8:11], v[28:31], v[44:47]
ds_read_b128 v[24:27], v1 offset:16384
s_waitcnt lgkmcnt(6)
v_mfma_f32_16x16x32_bf16 v[48:51], a[8:11], v[32:35], v[48:51]
ds_read_b128 v[28:31], v1 offset:18432
s_waitcnt lgkmcnt(6)
v_mfma_f32_16x16x32_bf16 v[44:47], a[12:15], v[36:39], v[44:47]
ds_read_b128 v[32:35], v1 offset:19456
s_waitcnt lgkmcnt(6)
v_mfma_f32_16x16x32_bf16 v[48:51], a[12:15], v[40:43], v[48:51]
ds_read_b128 v[36:39], v1 offset:21504
s_waitcnt lgkmcnt(6)
v_mfma_f32_16x16x32_bf16 v[44:47], a[16:19], v[12:15], v[44:47]
ds_read_b128 v[40:43], v1 offset:22528
s_waitcnt lgkmcnt(6)
v_mfma_f32_16x16x32_bf16 v[48:51], a[16:19], v[16:19], v[48:51]
ds_read_b128 v[12:15], v1 offset:24576
s_waitcnt lgkmcnt(6)
v_mfma_f32_16x16x32_bf16 v[44:47], a[20:23], v[20:23], v[44:47]
ds_read_b128 v[16:19], v1 offset:25600
s_waitcnt lgkmcnt(6)
v_mfma_f32_16x16x32_bf16 v[48:51], a[20:23], v[24:27], v[48:51]
ds_read_b128 v[20:23], v1 offset:27648
s_waitcnt lgkmcnt(6)
v_mfma_f32_16x16x32_bf16 v[44:47], a[24:27], v[28:31], v[44:47]
ds_read_b128 v[24:27], v1 offset:28672
s_waitcnt lgkmcnt(6)
v_mfma_f32_16x16x32_bf16 v[48:51], a[24:27], v[32:35], v[48:51]
ds_read_b128 v[28:31], v1 offset:30720
s_waitcnt lgkmcnt(6)
v_mfma_f32_16x16x32_bf16 v[44:47], a[28:31], v[36:39], v[44:47]
ds_read_b128 v[32:35], v1 offset:31744
s_waitcnt lgkmcnt(6)
v_mfma_f32_16x16x32_bf16 v[48:51], a[28:31], v[40:43], v[48:51]
ds_read_b128 v[36:39], v1 offset:33792
s_waitcnt lgkmcnt(6)
v_mfma_f32_16x16x32_bf16 v[44:47], a[32:35], v[12:15], v[44:47]
ds_read_b128 v[40:43], v1 offset:34816
s_waitcnt lgkmcnt(6)
v_mfma_f32_16x16x32_bf16 v[48:51], a[32:35], v[16:19], v[48:51]
ds_read_b128 v[12:15], v1 offset:36864
s_waitcnt lgkmcnt(6)
v_mfma_f32_16x16x32_bf16 v[44:47], a[36:39], v[20:23], v[44:47]
ds_read_b128 v[16:19], v1 offset:37888
s_waitcnt lgkmcnt(6)
v_mfma_f32_16x16x32_bf16 v[48:51], a[36:39], v[24:27], v[48:51]
ds_read_b128 v[20:23], v1 offset:39936
s_waitcnt lgkmcnt(6)
v_mfma_f32_16x16x32_bf16 v[44:47], a[40:43], v[28:31], v[44:47]
ds_read_b128 v[24:27], v1 offset:40960
s_waitcnt lgkmcnt(6)
v_mfma_f32_16x16x32_bf16 v[48:51], a[40:43], v[32:35], v[48:51]
ds_read_b128 v[28:31], v1 offset:43008
s_waitcnt lgkmcnt(6)
v_mfma_f32_16x16x32_bf16 v[44:47], a[44:47], v[36:39], v[44:47]
ds_read_b128 v[32:35], v1 offset:44032
s_waitcnt lgkmcnt(6)
v_mfma_f32_16x16x32_bf16 v[48:51], a[44:47], v[40:43], v[48:51]
ds_read_b128 v[36:39], v1 offset:46080
s_waitcnt lgkmcnt(6)
v_mfma_f32_16x16x32_bf16 v[44:47], a[48:51], v[12:15], v[44:47]
ds_read_b128 v[40:43], v1 offset:47104
s_waitcnt lgkmcnt(6)
v_mfma_f32_16x16x32_bf16 v[48:51], a[48:51], v[16:19], v[48:51]
ds_read2st64_b64 v[12:15], v2 offset0:4 offset1:10
s_waitcnt lgkmcnt(6)
v_mfma_f32_16x16x32_bf16 v[44:47], a[52:55], v[20:23], v[44:47]
ds_read2st64_b64 v[16:19], v2 offset0:5 offset1:11
s_waitcnt lgkmcnt(6)
v_mfma_f32_16x16x32_bf16 v[48:51], a[52:55], v[24:27], v[48:51]
ds_read2st64_b64 v[20:23], v2 offset0:16 offset1:22
s_waitcnt lgkmcnt(6)
v_mfma_f32_16x16x32_bf16 v[44:47], a[56:59], v[28:31], v[44:47]
ds_read2st64_b64 v[24:27], v2 offset0:17 offset1:23
s_waitcnt lgkmcnt(6)
v_mfma_f32_16x16x32_bf16 v[48:51], a[56:59], v[32:35], v[48:51]
ds_read2st64_b64 v[28:31], v2 offset0:28 offset1:34
s_waitcnt lgkmcnt(6)
v_mfma_f32_16x16x32_bf16 v[44:47], a[60:63], v[36:39], v[44:47]
ds_read2st64_b64 v[32:35], v2 offset0:29 offset1:35
s_waitcnt lgkmcnt(6)
v_mfma_f32_16x16x32_bf16 v[48:51], a[60:63], v[40:43], v[48:51]
ds_read2st64_b64 v[36:39], v2 offset0:40 offset1:46
s_waitcnt lgkmcnt(6)
v_mfma_f32_16x16x32_bf16 v[44:47], a[64:67], v[12:15], v[44:47]
ds_read2st64_b64 v[40:43], v2 offset0:41 offset1:47
s_waitcnt lgkmcnt(6)
v_mfma_f32_16x16x32_bf16 v[48:51], a[64:67], v[16:19], v[48:51]
ds_read2st64_b64 v[12:15], v2 offset0:52 offset1:58
s_waitcnt lgkmcnt(6)
v_mfma_f32_16x16x32_bf16 v[44:47], a[68:71], v[20:23], v[44:47]
ds_read2st64_b64 v[16:19], v2 offset0:53 offset1:59
s_waitcnt lgkmcnt(6)
v_mfma_f32_16x16x32_bf16 v[48:51], a[68:71], v[24:27], v[48:51]
ds_read2st64_b64 v[20:23], v2 offset0:64 offset1:70
s_waitcnt lgkmcnt(6)
v_mfma_f32_16x16x32_bf16 v[44:47], a[72:75], v[28:31], v[44:47]
ds_read2st64_b64 v[24:27], v2 offset0:65 offset1:71
s_waitcnt lgkmcnt(6)
v_mfma_f32_16x16x32_bf16 v[48:51], a[72:75], v[32:35], v[48:51]
ds_read2st64_b64 v[28:31], v2 offset0:76 offset1:82
s_waitcnt lgkmcnt(6)
v_mfma_f32_16x16x32_bf16 v[44:47], a[76:79], v[36:39], v[44:47]
ds_read2st64_b64 v[32:35], v2 offset0:77 offset1:83
s_waitcnt lgkmcnt(6)
v_mfma_f32_16x16x32_bf16 v[48:51], a[76:79], v[40:43], v[48:51]
ds_read2st64_b64 v[36:39], v2 offset0:88 offset1:94
s_waitcnt lgkmcnt(6)
v_mfma_f32_16x16x32_bf16 v[44:47], a[80:83], v[12:15], v[44:47]
ds_read2st64_b64 v[40:43], v2 offset0:89 offset1:95
s_waitcnt lgkmcnt(6)
v_mfma_f32_16x16x32_bf16 v[48:51], a[80:83], v[16:19], v[48:51]
s_waitcnt lgkmcnt(5)
v_mfma_f32_16x16x32_bf16 v[44:47], a[84:87], v[20:23], v[44:47]
s_waitcnt lgkmcnt(4)
v_mfma_f32_16x16x32_bf16 v[48:51], a[84:87], v[24:27], v[48:51]
s_waitcnt lgkmcnt(3)
v_mfma_f32_16x16x32_bf16 v[44:47], a[88:91], v[28:31], v[44:47]
s_waitcnt lgkmcnt(2)
v_mfma_f32_16x16x32_bf16 v[48:51], a[88:91], v[32:35], v[48:51]
s_waitcnt lgkmcnt(1)
v_mfma_f32_16x16x32_bf16 v[44:47], a[92:95], v[36:39], v[44:47]
s_waitcnt lgkmcnt(0)
v_mfma_f32_16x16x32_bf16 v[48:51], a[92:95], v[40:43], v[48:51]
s_nop 7
s_cmp_ge_u32 s22, 32
s_cbranch_scc1 PV_fin_202
buffer_store_dwordx4 v[44:47], v1, s[8:11], s26 offen offset:0 sc1
buffer_store_dwordx4 v[48:51], v1, s[8:11], s26 offen offset:1024 sc1
s_waitcnt vmcnt(0)
s_barrier
s_cmp_lg_u32 s13, 0
s_cbranch_scc1 PV_nxt_203
s_add_u32 s17, s28, 44126860
v_mov_b32 v4, 1
s_mov_b64 exec, 1
buffer_atomic_add v4, v3, s[8:11], s17 offen sc1
s_mov_b64 exec, -1
s_branch PV_nxt_203
PV_fin_202:
v_lshlrev_b32 v12, 16, v60
v_and_b32 v13, 0xffff0000, v60
v_lshlrev_b32 v14, 16, v61
v_and_b32 v15, 0xffff0000, v61
v_fma_f32 v12, v44, v52, v12
v_fma_f32 v13, v45, v53, v13
v_fma_f32 v14, v46, v54, v14
v_fma_f32 v15, v47, v55, v15
v_cvt_pk_bf16_f32 v16, v12, v13
v_cvt_pk_bf16_f32 v17, v14, v15
buffer_store_dwordx2 v[16:17], v5, s[40:43], s27 offen
v_lshlrev_b32 v12, 16, v62
v_and_b32 v13, 0xffff0000, v62
v_lshlrev_b32 v14, 16, v63
v_and_b32 v15, 0xffff0000, v63
v_fma_f32 v12, v48, v56, v12
v_fma_f32 v13, v49, v57, v13
v_fma_f32 v14, v50, v58, v14
v_fma_f32 v15, v51, v59, v15
v_cvt_pk_bf16_f32 v18, v12, v13
v_cvt_pk_bf16_f32 v19, v14, v15
buffer_store_dwordx2 v[18:19], v6, s[40:43], s27 offen
PV_nxt_203:
s_add_u32 s23, s23, 1835008
s_add_u32 s24, s24, 917504
s_add_u32 s25, s25, 196608
s_add_u32 s26, s26, 229376
s_add_u32 s27, s27, 114688
s_add_u32 s28, s28, 512
s_add_u32 s22, s22, 4
s_cmp_lt_u32 s22, 64
s_cbranch_scc1 PV_loop_189
s_waitcnt vmcnt(0)
s_endpgm
M_ff:
s_sub_u32 s12, s12, 132
s_cmp_lg_u32 s13, 0
s_cbranch_scc1 M_dl_204
s_mov_b32 s17, 44113664
v_mov_b32 v8, 0
WC_205:
buffer_load_dword v9, v8, s[8:11], s17 offen sc1
s_waitcnt vmcnt(0)
v_cmp_gt_u32 vcc, 3, v9
s_cbranch_vccz WCD_206
s_sleep 16
s_sub_u32 s19, s19, 1
s_cbranch_scc0 WC_205
s_branch M_abort
WCD_206:
M_dl_204:
s_barrier
v_mov_b32 v9, v0
v_and_b32 v0, 63, v0
v_lshlrev_b32 v1, 4, v0
v_mov_b32 v2, 0
v_mov_b32 v3, 1
v_and_b32 v5, 15, v0
v_lshrrev_b32 v6, 4, v0
s_mov_b32 s20, s12
FF_u_207:
s_cmp_ge_u32 s20, 154
s_cbranch_scc1 FF_rd_210
s_cmp_ge_u32 s20, 98
s_cbranch_scc1 FF_d_208
s_cmp_ge_u32 s20, 49
s_cselect_b32 s21, 1, 0
s_mul_i32 s17, s21, 49
s_sub_u32 s17, s20, s17
s_mul_i32 s22, s17, 9363
s_lshr_b32 s22, s22, 16
s_mul_i32 s18, s22, 7
s_sub_u32 s23, s17, s18
s_cmp_eq_u32 s21, 1
s_cbranch_scc1 FF_g_211
s_load_dwordx2 s[36:37], s[0:1], 64
s_mov_b32 s38, 1605632
s_mov_b32 s39, 0x20000
s_branch FF_gu_212
FF_g_211:
s_load_dwordx2 s[36:37], s[0:1], 72
s_mov_b32 s38, 1605632
s_mov_b32 s39, 0x20000
FF_gu_212:
v_lshrrev_b32 v4, 5, v9
v_mul_u32_u24 v7, 3584, v4
v_mul_u32_u24 v8, 544, v4
v_and_b32 v4, 31, v9
v_lshl_add_u32 v7, v4, 4, v7
v_lshl_add_u32 v8, v4, 4, v8
s_mul_i32 s24, s22, 229376
s_lshl_b32 s17, s23, 9
s_add_u32 s24, s24, s17
s_waitcnt lgkmcnt(0)
buffer_load_dwordx4 v[16:19], v7, s[36:39], s24 offen
s_add_u32 s24, s24, 28672
buffer_load_dwordx4 v[20:23], v7, s[36:39], s24 offen
s_add_u32 s24, s24, 28672
buffer_load_dwordx4 v[24:27], v7, s[36:39], s24 offen
s_add_u32 s24, s24, 28672
buffer_load_dwordx4 v[28:31], v7, s[36:39], s24 offen
s_add_u32 s24, s24, 28672
buffer_load_dwordx4 v[32:35], v7, s[36:39], s24 offen
s_add_u32 s24, s24, 28672
buffer_load_dwordx4 v[36:39], v7, s[36:39], s24 offen
s_add_u32 s24, s24, 28672
buffer_load_dwordx4 v[40:43], v7, s[36:39], s24 offen
s_add_u32 s24, s24, 28672
buffer_load_dwordx4 v[44:47], v7, s[36:39], s24 offen
s_barrier
s_waitcnt vmcnt(0)
ds_write_b128 v8, v[16:19] offset:0
ds_write_b128 v8, v[20:23] offset:4352
ds_write_b128 v8, v[24:27] offset:8704
ds_write_b128 v8, v[28:31] offset:13056
ds_write_b128 v8, v[32:35] offset:17408
ds_write_b128 v8, v[36:39] offset:21760
ds_write_b128 v8, v[40:43] offset:26112
ds_write_b128 v8, v[44:47] offset:30464
v_lshrrev_b32 v4, 1, v6
v_lshlrev_b32 v8, 4, v4
v_and_b32 v4, 1, v6
v_lshl_add_u32 v8, v4, 2, v8
v_bfe_u32 v4, v0, 2, 1
v_add_u32 v8, v8, v4
v_bfe_u32 v4, v0, 3, 1
v_lshl_add_u32 v8, v4, 3, v8
v_mul_u32_u24 v8, 544, v8
v_and_b32 v4, 3, v0
v_lshl_add_u32 v8, v4, 3, v8
s_lshl_b32 s17, s13, 7
v_add_u32 v8, s17, v8
s_waitcnt lgkmcnt(0)
s_barrier
ds_read_b64_tr_b16 v[48:49], v8 offset:0
ds_read_b64_tr_b16 v[50:51], v8 offset:1088
ds_read_b64_tr_b16 v[52:53], v8 offset:17408
ds_read_b64_tr_b16 v[54:55], v8 offset:18496
ds_read_b64_tr_b16 v[56:57], v8 offset:32
ds_read_b64_tr_b16 v[58:59], v8 offset:1120
ds_read_b64_tr_b16 v[60:61], v8 offset:17440
ds_read_b64_tr_b16 v[62:63], v8 offset:18528
ds_read_b64_tr_b16 v[64:65], v8 offset:64
ds_read_b64_tr_b16 v[66:67], v8 offset:1152
ds_read_b64_tr_b16 v[68:69], v8 offset:17472
ds_read_b64_tr_b16 v[70:71], v8 offset:18560
ds_read_b64_tr_b16 v[72:73], v8 offset:96
ds_read_b64_tr_b16 v[74:75], v8 offset:1184
ds_read_b64_tr_b16 v[76:77], v8 offset:17504
ds_read_b64_tr_b16 v[78:79], v8 offset:18592
s_waitcnt lgkmcnt(0)
s_lshl_b32 s17, s23, 4
s_lshl_b32 s18, s13, 2
s_add_u32 s17, s17, s18
s_add_u32 s17, s17, 0
s_lshl_b32 s17, s17, 1
s_add_u32 s17, s17, s21
s_mul_i32 s17, s17, 14
s_lshl_b32 s18, s22, 1
s_add_u32 s17, s17, s18
s_lshl_b32 s25, s17, 10
s_add_u32 s25, s25, 69759616
buffer_store_dwordx4 v[48:51], v1, s[8:11], s25 offen offset:0 sc1
buffer_store_dwordx4 v[52:55], v1, s[8:11], s25 offen offset:1024 sc1
s_lshl_b32 s17, s23, 4
s_lshl_b32 s18, s13, 2
s_add_u32 s17, s17, s18
s_add_u32 s17, s17, 1
s_lshl_b32 s17, s17, 1
s_add_u32 s17, s17, s21
s_mul_i32 s17, s17, 14
s_lshl_b32 s18, s22, 1
s_add_u32 s17, s17, s18
s_lshl_b32 s25, s17, 10
s_add_u32 s25, s25, 69759616
buffer_store_dwordx4 v[56:59], v1, s[8:11], s25 offen offset:0 sc1
buffer_store_dwordx4 v[60:63], v1, s[8:11], s25 offen offset:1024 sc1
s_lshl_b32 s17, s23, 4
s_lshl_b32 s18, s13, 2
s_add_u32 s17, s17, s18
s_add_u32 s17, s17, 2
s_lshl_b32 s17, s17, 1
s_add_u32 s17, s17, s21
s_mul_i32 s17, s17, 14
s_lshl_b32 s18, s22, 1
s_add_u32 s17, s17, s18
s_lshl_b32 s25, s17, 10
s_add_u32 s25, s25, 69759616
buffer_store_dwordx4 v[64:67], v1, s[8:11], s25 offen offset:0 sc1
buffer_store_dwordx4 v[68:71], v1, s[8:11], s25 offen offset:1024 sc1
s_lshl_b32 s17, s23, 4
s_lshl_b32 s18, s13, 2
s_add_u32 s17, s17, s18
s_add_u32 s17, s17, 3
s_lshl_b32 s17, s17, 1
s_add_u32 s17, s17, s21
s_mul_i32 s17, s17, 14
s_lshl_b32 s18, s22, 1
s_add_u32 s17, s17, s18
s_lshl_b32 s25, s17, 10
s_add_u32 s25, s25, 69759616
buffer_store_dwordx4 v[72:75], v1, s[8:11], s25 offen offset:0 sc1
buffer_store_dwordx4 v[76:79], v1, s[8:11], s25 offen offset:1024 sc1
s_branch FF_n_209
FF_d_208:
s_load_dwordx2 s[36:37], s[0:1], 80
s_mov_b32 s38, 1605632
s_mov_b32 s39, 0x20000
s_sub_u32 s23, s20, 98
s_mul_i32 s24, s23, 28672
v_lshlrev_b32 v7, 4, v9
s_waitcnt lgkmcnt(0)
buffer_load_dwordx4 v[16:19], v7, s[36:39], s24 offen
s_add_u32 s24, s24, 4096
buffer_load_dwordx4 v[20:23], v7, s[36:39], s24 offen
s_add_u32 s24, s24, 4096
buffer_load_dwordx4 v[24:27], v7, s[36:39], s24 offen
s_add_u32 s24, s24, 4096
buffer_load_dwordx4 v[28:31], v7, s[36:39], s24 offen
s_add_u32 s24, s24, 4096
buffer_load_dwordx4 v[32:35], v7, s[36:39], s24 offen
s_add_u32 s24, s24, 4096
buffer_load_dwordx4 v[36:39], v7, s[36:39], s24 offen
s_add_u32 s24, s24, 4096
buffer_load_dwordx4 v[40:43], v7, s[36:39], s24 offen
s_barrier
v_add_u32 v4, 0, v9
v_mul_u32_u24 v8, 2341, v4
v_lshrrev_b32 v8, 17, v8
v_mul_u32_u24 v7, 56, v8
v_sub_u32 v7, v4, v7
v_lshlrev_b32 v7, 4, v7
v_mul_u32_u24 v8, 928, v8
v_add_u32 v7, v7, v8
s_waitcnt vmcnt(0)
ds_write_b128 v7, v[16:19]
v_add_u32 v4, 256, v9
v_mul_u32_u24 v8, 2341, v4
v_lshrrev_b32 v8, 17, v8
v_mul_u32_u24 v7, 56, v8
v_sub_u32 v7, v4, v7
v_lshlrev_b32 v7, 4, v7
v_mul_u32_u24 v8, 928, v8
v_add_u32 v7, v7, v8
ds_write_b128 v7, v[20:23]
v_add_u32 v4, 512, v9
v_mul_u32_u24 v8, 2341, v4
v_lshrrev_b32 v8, 17, v8
v_mul_u32_u24 v7, 56, v8
v_sub_u32 v7, v4, v7
v_lshlrev_b32 v7, 4, v7
v_mul_u32_u24 v8, 928, v8
v_add_u32 v7, v7, v8
ds_write_b128 v7, v[24:27]
v_add_u32 v4, 768, v9
v_mul_u32_u24 v8, 2341, v4
v_lshrrev_b32 v8, 17, v8
v_mul_u32_u24 v7, 56, v8
v_sub_u32 v7, v4, v7
v_lshlrev_b32 v7, 4, v7
v_mul_u32_u24 v8, 928, v8
v_add_u32 v7, v7, v8
ds_write_b128 v7, v[28:31]
v_add_u32 v4, 1024, v9
v_mul_u32_u24 v8, 2341, v4
v_lshrrev_b32 v8, 17, v8
v_mul_u32_u24 v7, 56, v8
v_sub_u32 v7, v4, v7
v_lshlrev_b32 v7, 4, v7
v_mul_u32_u24 v8, 928, v8
v_add_u32 v7, v7, v8
ds_write_b128 v7, v[32:35]
v_add_u32 v4, 1280, v9
v_mul_u32_u24 v8, 2341, v4
v_lshrrev_b32 v8, 17, v8
v_mul_u32_u24 v7, 56, v8
v_sub_u32 v7, v4, v7
v_lshlrev_b32 v7, 4, v7
v_mul_u32_u24 v8, 928, v8
v_add_u32 v7, v7, v8
ds_write_b128 v7, v[36:39]
v_add_u32 v4, 1536, v9
v_mul_u32_u24 v8, 2341, v4
v_lshrrev_b32 v8, 17, v8
v_mul_u32_u24 v7, 56, v8
v_sub_u32 v7, v4, v7
v_lshlrev_b32 v7, 4, v7
v_mul_u32_u24 v8, 928, v8
v_add_u32 v7, v7, v8
ds_write_b128 v7, v[40:43]
v_bfe_u32 v4, v0, 2, 2
v_lshl_add_u32 v4, v6, 2, v4
v_mul_u32_u24 v8, 928, v4
v_and_b32 v4, 3, v0
v_lshl_add_u32 v8, v4, 3, v8
s_mul_i32 s17, s13, 224
v_add_u32 v8, s17, v8
s_waitcnt lgkmcnt(0)
s_barrier
ds_read_b64_tr_b16 v[48:49], v8 offset:0
ds_read_b64_tr_b16 v[50:51], v8 offset:14848
ds_read_b64_tr_b16 v[52:53], v8 offset:32
ds_read_b64_tr_b16 v[54:55], v8 offset:14880
ds_read_b64_tr_b16 v[56:57], v8 offset:64
ds_read_b64_tr_b16 v[58:59], v8 offset:14912
ds_read_b64_tr_b16 v[60:61], v8 offset:96
ds_read_b64_tr_b16 v[62:63], v8 offset:14944
ds_read_b64_tr_b16 v[64:65], v8 offset:128
ds_read_b64_tr_b16 v[66:67], v8 offset:14976
ds_read_b64_tr_b16 v[68:69], v8 offset:160
ds_read_b64_tr_b16 v[70:71], v8 offset:15008
ds_read_b64_tr_b16 v[72:73], v8 offset:192
ds_read_b64_tr_b16 v[74:75], v8 offset:15040
s_mul_i32 s25, s23, 28
s_mul_i32 s17, s13, 7
s_add_u32 s25, s25, s17
s_lshl_b32 s25, s25, 10
s_add_u32 s25, s25, 72970880
s_waitcnt lgkmcnt(0)
buffer_store_dwordx4 v[48:51], v1, s[8:11], s25 offen offset:0 sc1
buffer_store_dwordx4 v[52:55], v1, s[8:11], s25 offen offset:1024 sc1
buffer_store_dwordx4 v[56:59], v1, s[8:11], s25 offen offset:2048 sc1
buffer_store_dwordx4 v[60:63], v1, s[8:11], s25 offen offset:3072 sc1
s_add_u32 s25, s25, 4096
buffer_store_dwordx4 v[64:67], v1, s[8:11], s25 offen offset:0 sc1
buffer_store_dwordx4 v[68:71], v1, s[8:11], s25 offen offset:1024 sc1
buffer_store_dwordx4 v[72:75], v1, s[8:11], s25 offen offset:2048 sc1
FF_n_209:
s_add_u32 s20, s20, 64
s_branch FF_u_207
FF_rd_210:
s_waitcnt vmcnt(0)
s_barrier
s_mov_b32 s26, 44111488
s_cmp_lg_u32 s13, 0
s_cbranch_scc1 FF_ns_213
s_mov_b64 exec, 1
buffer_atomic_add v3, v2, s[8:11], s26 offen sc1
s_mov_b64 exec, -1
FF_ns_213:
s_mov_b32 s26, 44111616
WC_214:
buffer_load_dword v4, v2, s[8:11], s26 offen sc1
s_waitcnt vmcnt(0)
v_cmp_gt_u32 vcc, 64, v4
s_cbranch_vccz WCD_215
s_sleep 4
s_sub_u32 s19, s19, 1
s_cbranch_scc0 WC_214
s_branch M_abort
WCD_215:
s_mul_i32 s24, s12, 28672
s_add_u32 s24, s24, 46428800
buffer_load_dwordx4 v[12:15], v1, s[8:11], s24 offen offset:0 sc1
buffer_load_dwordx4 v[16:19], v1, s[8:11], s24 offen offset:1024 sc1
buffer_load_dwordx4 v[20:23], v1, s[8:11], s24 offen offset:2048 sc1
buffer_load_dwordx4 v[24:27], v1, s[8:11], s24 offen offset:3072 sc1
s_add_u32 s24, s24, 4096
buffer_load_dwordx4 v[28:31], v1, s[8:11], s24 offen offset:0 sc1
buffer_load_dwordx4 v[32:35], v1, s[8:11], s24 offen offset:1024 sc1
buffer_load_dwordx4 v[36:39], v1, s[8:11], s24 offen offset:2048 sc1
buffer_load_dwordx4 v[40:43], v1, s[8:11], s24 offen offset:3072 sc1
s_add_u32 s24, s24, 4096
buffer_load_dwordx4 v[44:47], v1, s[8:11], s24 offen offset:0 sc1
buffer_load_dwordx4 v[48:51], v1, s[8:11], s24 offen offset:1024 sc1
buffer_load_dwordx4 v[52:55], v1, s[8:11], s24 offen offset:2048 sc1
buffer_load_dwordx4 v[56:59], v1, s[8:11], s24 offen offset:3072 sc1
s_add_u32 s24, s24, 4096
buffer_load_dwordx4 v[60:63], v1, s[8:11], s24 offen offset:0 sc1
buffer_load_dwordx4 v[64:67], v1, s[8:11], s24 offen offset:1024 sc1
buffer_load_dwordx4 v[68:71], v1, s[8:11], s24 offen offset:2048 sc1
buffer_load_dwordx4 v[72:75], v1, s[8:11], s24 offen offset:3072 sc1
s_add_u32 s24, s24, 4096
buffer_load_dwordx4 v[76:79], v1, s[8:11], s24 offen offset:0 sc1
buffer_load_dwordx4 v[80:83], v1, s[8:11], s24 offen offset:1024 sc1
buffer_load_dwordx4 v[84:87], v1, s[8:11], s24 offen offset:2048 sc1
buffer_load_dwordx4 v[88:91], v1, s[8:11], s24 offen offset:3072 sc1
s_add_u32 s24, s24, 4096
buffer_load_dwordx4 v[92:95], v1, s[8:11], s24 offen offset:0 sc1
buffer_load_dwordx4 v[96:99], v1, s[8:11], s24 offen offset:1024 sc1
buffer_load_dwordx4 v[100:103], v1, s[8:11], s24 offen offset:2048 sc1
buffer_load_dwordx4 v[104:107], v1, s[8:11], s24 offen offset:3072 sc1
s_add_u32 s24, s24, 4096
buffer_load_dwordx4 v[108:111], v1, s[8:11], s24 offen offset:0 sc1
buffer_load_dwordx4 v[112:115], v1, s[8:11], s24 offen offset:1024 sc1
buffer_load_dwordx4 v[116:119], v1, s[8:11], s24 offen offset:2048 sc1
buffer_load_dwordx4 v[120:123], v1, s[8:11], s24 offen offset:3072 sc1
v_accvgpr_write_b32 a0, 0
v_accvgpr_write_b32 a1, 0
v_accvgpr_write_b32 a2, 0
v_accvgpr_write_b32 a3, 0
v_accvgpr_write_b32 a4, 0
v_accvgpr_write_b32 a5, 0
v_accvgpr_write_b32 a6, 0
v_accvgpr_write_b32 a7, 0
v_accvgpr_write_b32 a8, 0
v_accvgpr_write_b32 a9, 0
v_accvgpr_write_b32 a10, 0
v_accvgpr_write_b32 a11, 0
v_accvgpr_write_b32 a12, 0
v_accvgpr_write_b32 a13, 0
v_accvgpr_write_b32 a14, 0
v_accvgpr_write_b32 a15, 0
v_accvgpr_write_b32 a16, 0
v_accvgpr_write_b32 a17, 0
v_accvgpr_write_b32 a18, 0
v_accvgpr_write_b32 a19, 0
v_accvgpr_write_b32 a20, 0
v_accvgpr_write_b32 a21, 0
v_accvgpr_write_b32 a22, 0
v_accvgpr_write_b32 a23, 0
v_accvgpr_write_b32 a24, 0
v_accvgpr_write_b32 a25, 0
v_accvgpr_write_b32 a26, 0
v_accvgpr_write_b32 a27, 0
v_accvgpr_write_b32 a28, 0
v_accvgpr_write_b32 a29, 0
v_accvgpr_write_b32 a30, 0
v_accvgpr_write_b32 a31, 0
v_accvgpr_write_b32 a32, 0
v_accvgpr_write_b32 a33, 0
v_accvgpr_write_b32 a34, 0
v_accvgpr_write_b32 a35, 0
v_accvgpr_write_b32 a36, 0
v_accvgpr_write_b32 a37, 0
v_accvgpr_write_b32 a38, 0
v_accvgpr_write_b32 a39, 0
v_accvgpr_write_b32 a40, 0
v_accvgpr_write_b32 a41, 0
v_accvgpr_write_b32 a42, 0
v_accvgpr_write_b32 a43, 0
v_accvgpr_write_b32 a44, 0
v_accvgpr_write_b32 a45, 0
v_accvgpr_write_b32 a46, 0
v_accvgpr_write_b32 a47, 0
v_accvgpr_write_b32 a48, 0
v_accvgpr_write_b32 a49, 0
v_accvgpr_write_b32 a50, 0
v_accvgpr_write_b32 a51, 0
v_accvgpr_write_b32 a52, 0
v_accvgpr_write_b32 a53, 0
v_accvgpr_write_b32 a54, 0
v_accvgpr_write_b32 a55, 0
v_accvgpr_write_b32 a56, 0
v_accvgpr_write_b32 a57, 0
v_accvgpr_write_b32 a58, 0
v_accvgpr_write_b32 a59, 0
v_accvgpr_write_b32 a60, 0
v_accvgpr_write_b32 a61, 0
v_accvgpr_write_b32 a62, 0
v_accvgpr_write_b32 a63, 0
v_accvgpr_write_b32 a64, 0
v_accvgpr_write_b32 a65, 0
v_accvgpr_write_b32 a66, 0
v_accvgpr_write_b32 a67, 0
v_accvgpr_write_b32 a68, 0
v_accvgpr_write_b32 a69, 0
v_accvgpr_write_b32 a70, 0
v_accvgpr_write_b32 a71, 0
v_accvgpr_write_b32 a72, 0
v_accvgpr_write_b32 a73, 0
v_accvgpr_write_b32 a74, 0
v_accvgpr_write_b32 a75, 0
v_accvgpr_write_b32 a76, 0
v_accvgpr_write_b32 a77, 0
v_accvgpr_write_b32 a78, 0
v_accvgpr_write_b32 a79, 0
v_accvgpr_write_b32 a80, 0
v_accvgpr_write_b32 a81, 0
v_accvgpr_write_b32 a82, 0
v_accvgpr_write_b32 a83, 0
v_accvgpr_write_b32 a84, 0
v_accvgpr_write_b32 a85, 0
v_accvgpr_write_b32 a86, 0
v_accvgpr_write_b32 a87, 0
v_accvgpr_write_b32 a88, 0
v_accvgpr_write_b32 a89, 0
v_accvgpr_write_b32 a90, 0
v_accvgpr_write_b32 a91, 0
v_accvgpr_write_b32 a92, 0
v_accvgpr_write_b32 a93, 0
v_accvgpr_write_b32 a94, 0
v_accvgpr_write_b32 a95, 0
v_accvgpr_write_b32 a96, 0
v_accvgpr_write_b32 a97, 0
v_accvgpr_write_b32 a98, 0
v_accvgpr_write_b32 a99, 0
v_accvgpr_write_b32 a100, 0
v_accvgpr_write_b32 a101, 0
v_accvgpr_write_b32 a102, 0
v_accvgpr_write_b32 a103, 0
v_accvgpr_write_b32 a104, 0
v_accvgpr_write_b32 a105, 0
v_accvgpr_write_b32 a106, 0
v_accvgpr_write_b32 a107, 0
v_accvgpr_write_b32 a108, 0
v_accvgpr_write_b32 a109, 0
v_accvgpr_write_b32 a110, 0
v_accvgpr_write_b32 a111, 0
v_accvgpr_write_b32 a112, 0
v_accvgpr_write_b32 a113, 0
v_accvgpr_write_b32 a114, 0
v_accvgpr_write_b32 a115, 0
v_accvgpr_write_b32 a116, 0
v_accvgpr_write_b32 a117, 0
v_accvgpr_write_b32 a118, 0
v_accvgpr_write_b32 a119, 0
v_accvgpr_write_b32 a120, 0
v_accvgpr_write_b32 a121, 0
v_accvgpr_write_b32 a122, 0
v_accvgpr_write_b32 a123, 0
v_accvgpr_write_b32 a124, 0
v_accvgpr_write_b32 a125, 0
v_accvgpr_write_b32 a126, 0
v_accvgpr_write_b32 a127, 0
v_accvgpr_write_b32 a128, 0
v_accvgpr_write_b32 a129, 0
v_accvgpr_write_b32 a130, 0
v_accvgpr_write_b32 a131, 0
v_accvgpr_write_b32 a132, 0
v_accvgpr_write_b32 a133, 0
v_accvgpr_write_b32 a134, 0
v_accvgpr_write_b32 a135, 0
v_accvgpr_write_b32 a136, 0
v_accvgpr_write_b32 a137, 0
v_accvgpr_write_b32 a138, 0
v_accvgpr_write_b32 a139, 0
v_accvgpr_write_b32 a140, 0
v_accvgpr_write_b32 a141, 0
v_accvgpr_write_b32 a142, 0
v_accvgpr_write_b32 a143, 0
v_accvgpr_write_b32 a144, 0
v_accvgpr_write_b32 a145, 0
v_accvgpr_write_b32 a146, 0
v_accvgpr_write_b32 a147, 0
v_accvgpr_write_b32 a148, 0
v_accvgpr_write_b32 a149, 0
v_accvgpr_write_b32 a150, 0
v_accvgpr_write_b32 a151, 0
v_accvgpr_write_b32 a152, 0
v_accvgpr_write_b32 a153, 0
v_accvgpr_write_b32 a154, 0
v_accvgpr_write_b32 a155, 0
v_accvgpr_write_b32 a156, 0
v_accvgpr_write_b32 a157, 0
v_accvgpr_write_b32 a158, 0
v_accvgpr_write_b32 a159, 0
v_accvgpr_write_b32 a160, 0
v_accvgpr_write_b32 a161, 0
v_accvgpr_write_b32 a162, 0
v_accvgpr_write_b32 a163, 0
v_accvgpr_write_b32 a164, 0
v_accvgpr_write_b32 a165, 0
v_accvgpr_write_b32 a166, 0
v_accvgpr_write_b32 a167, 0
v_accvgpr_write_b32 a168, 0
v_accvgpr_write_b32 a169, 0
v_accvgpr_write_b32 a170, 0
v_accvgpr_write_b32 a171, 0
v_accvgpr_write_b32 a172, 0
v_accvgpr_write_b32 a173, 0
v_accvgpr_write_b32 a174, 0
v_accvgpr_write_b32 a175, 0
v_accvgpr_write_b32 a176, 0
v_accvgpr_write_b32 a177, 0
v_accvgpr_write_b32 a178, 0
v_accvgpr_write_b32 a179, 0
v_accvgpr_write_b32 a180, 0
v_accvgpr_write_b32 a181, 0
v_accvgpr_write_b32 a182, 0
v_accvgpr_write_b32 a183, 0
v_accvgpr_write_b32 a184, 0
v_accvgpr_write_b32 a185, 0
v_accvgpr_write_b32 a186, 0
v_accvgpr_write_b32 a187, 0
v_accvgpr_write_b32 a188, 0
v_accvgpr_write_b32 a189, 0
v_accvgpr_write_b32 a190, 0
v_accvgpr_write_b32 a191, 0
v_accvgpr_write_b32 a192, 0
v_accvgpr_write_b32 a193, 0
v_accvgpr_write_b32 a194, 0
v_accvgpr_write_b32 a195, 0
v_accvgpr_write_b32 a196, 0
v_accvgpr_write_b32 a197, 0
v_accvgpr_write_b32 a198, 0
v_accvgpr_write_b32 a199, 0
v_accvgpr_write_b32 a200, 0
v_accvgpr_write_b32 a201, 0
v_accvgpr_write_b32 a202, 0
v_accvgpr_write_b32 a203, 0
v_accvgpr_write_b32 a204, 0
v_accvgpr_write_b32 a205, 0
v_accvgpr_write_b32 a206, 0
v_accvgpr_write_b32 a207, 0
v_accvgpr_write_b32 a208, 0
v_accvgpr_write_b32 a209, 0
v_accvgpr_write_b32 a210, 0
v_accvgpr_write_b32 a211, 0
v_accvgpr_write_b32 a212, 0
v_accvgpr_write_b32 a213, 0
v_accvgpr_write_b32 a214, 0
v_accvgpr_write_b32 a215, 0
v_accvgpr_write_b32 a216, 0
v_accvgpr_write_b32 a217, 0
v_accvgpr_write_b32 a218, 0
v_accvgpr_write_b32 a219, 0
v_accvgpr_write_b32 a220, 0
v_accvgpr_write_b32 a221, 0
v_accvgpr_write_b32 a222, 0
v_accvgpr_write_b32 a223, 0
s_mov_b32 s26, 44111488
WC_216:
buffer_load_dword v4, v2, s[8:11], s26 offen sc1
s_waitcnt vmcnt(0)
v_cmp_gt_u32 vcc, 64, v4
s_cbranch_vccz WCD_217
s_sleep 2
s_sub_u32 s19, s19, 1
s_cbranch_scc0 WC_216
s_branch M_abort
WCD_217:
s_mul_i32 s27, s13, 802816
s_add_u32 s27, s27, 69759616
s_mul_i32 s28, s13, 401408
s_add_u32 s28, s28, 72970880
buffer_load_dwordx4 v[164:167], v1, s[8:11], s27 offen offset:0 sc1
s_add_u32 s32, s27, 28672
buffer_load_dwordx4 v[168:171], v1, s[8:11], s32 offen offset:0 sc1
s_add_u32 s32, s27, 12288
buffer_load_dwordx4 v[172:175], v1, s[8:11], s32 offen offset:2048 sc1
s_add_u32 s32, s27, 40960
buffer_load_dwordx4 v[176:179], v1, s[8:11], s32 offen offset:2048 sc1
buffer_load_dwordx4 v[180:183], v1, s[8:11], s27 offen offset:1024 sc1
s_add_u32 s32, s27, 28672
buffer_load_dwordx4 v[184:187], v1, s[8:11], s32 offen offset:1024 sc1
s_add_u32 s32, s27, 12288
buffer_load_dwordx4 v[188:191], v1, s[8:11], s32 offen offset:3072 sc1
s_add_u32 s32, s27, 40960
buffer_load_dwordx4 v[192:195], v1, s[8:11], s32 offen offset:3072 sc1
buffer_load_dwordx4 v[196:199], v1, s[8:11], s27 offen offset:2048 sc1
s_add_u32 s32, s27, 28672
buffer_load_dwordx4 v[200:203], v1, s[8:11], s32 offen offset:2048 sc1
s_add_u32 s32, s27, 16384
buffer_load_dwordx4 v[204:207], v1, s[8:11], s32 offen offset:0 sc1
s_add_u32 s32, s27, 45056
buffer_load_dwordx4 v[208:211], v1, s[8:11], s32 offen offset:0 sc1
buffer_load_dwordx4 v[212:215], v1, s[8:11], s27 offen offset:3072 sc1
s_add_u32 s32, s27, 28672
buffer_load_dwordx4 v[216:219], v1, s[8:11], s32 offen offset:3072 sc1
s_add_u32 s32, s27, 16384
buffer_load_dwordx4 v[220:223], v1, s[8:11], s32 offen offset:1024 sc1
s_add_u32 s32, s27, 45056
buffer_load_dwordx4 v[224:227], v1, s[8:11], s32 offen offset:1024 sc1
s_add_u32 s32, s27, 4096
buffer_load_dwordx4 v[228:231], v1, s[8:11], s32 offen offset:0 sc1
s_add_u32 s32, s27, 32768
buffer_load_dwordx4 v[232:235], v1, s[8:11], s32 offen offset:0 sc1
s_add_u32 s32, s27, 16384
buffer_load_dwordx4 v[236:239], v1, s[8:11], s32 offen offset:2048 sc1
s_add_u32 s32, s27, 45056
buffer_load_dwordx4 v[240:243], v1, s[8:11], s32 offen offset:2048 sc1
s_add_u32 s32, s27, 4096
buffer_load_dwordx4 v[244:247], v1, s[8:11], s32 offen offset:1024 sc1
s_add_u32 s32, s27, 32768
buffer_load_dwordx4 a[224:227], v1, s[8:11], s32 offen offset:1024 sc1
s_add_u32 s32, s27, 16384
buffer_load_dwordx4 a[228:231], v1, s[8:11], s32 offen offset:3072 sc1
s_add_u32 s32, s27, 45056
buffer_load_dwordx4 a[232:235], v1, s[8:11], s32 offen offset:3072 sc1
s_add_u32 s32, s27, 4096
buffer_load_dwordx4 a[236:239], v1, s[8:11], s32 offen offset:2048 sc1
s_add_u32 s32, s27, 32768
buffer_load_dwordx4 a[240:243], v1, s[8:11], s32 offen offset:2048 sc1
s_add_u32 s32, s27, 20480
buffer_load_dwordx4 a[244:247], v1, s[8:11], s32 offen offset:0 sc1
s_mov_b32 s29, 0
FF_loop_218:
s_cmp_lt_u32 s29, 13
s_cselect_b32 s17, 57344, 0
s_add_u32 s30, s27, s17
s_cselect_b32 s17, 0, 0
s_cmp_lt_u32 s29, 13
s_cselect_b32 s17, 28672, 0
s_add_u32 s31, s28, s17
s_waitcnt vmcnt(26)
v_mfma_f32_16x16x32_bf16 v[124:127], v[164:167], v[12:15], 0
v_mfma_f32_16x16x32_bf16 v[128:131], v[164:167], v[68:71], 0
s_add_u32 s32, s27, 49152
buffer_load_dwordx4 a[248:251], v1, s[8:11], s32 offen offset:0 sc1
s_waitcnt vmcnt(26)
v_mfma_f32_16x16x32_bf16 v[132:135], v[168:171], v[12:15], 0
v_mfma_f32_16x16x32_bf16 v[136:139], v[168:171], v[68:71], 0
s_add_u32 s32, s27, 4096
buffer_load_dwordx4 v[164:167], v1, s[8:11], s32 offen offset:3072 sc1
s_waitcnt vmcnt(26)
v_mfma_f32_16x16x32_bf16 v[140:143], v[172:175], v[12:15], 0
v_mfma_f32_16x16x32_bf16 v[144:147], v[172:175], v[68:71], 0
s_add_u32 s32, s27, 32768
buffer_load_dwordx4 v[168:171], v1, s[8:11], s32 offen offset:3072 sc1
s_waitcnt vmcnt(26)
v_mfma_f32_16x16x32_bf16 v[148:151], v[176:179], v[12:15], 0
v_mfma_f32_16x16x32_bf16 v[152:155], v[176:179], v[68:71], 0
s_add_u32 s32, s27, 20480
buffer_load_dwordx4 v[172:175], v1, s[8:11], s32 offen offset:1024 sc1
s_waitcnt vmcnt(26)
v_mfma_f32_16x16x32_bf16 v[124:127], v[180:183], v[16:19], v[124:127]
v_mfma_f32_16x16x32_bf16 v[128:131], v[180:183], v[72:75], v[128:131]
s_add_u32 s32, s27, 49152
buffer_load_dwordx4 v[176:179], v1, s[8:11], s32 offen offset:1024 sc1
s_waitcnt vmcnt(26)
v_mfma_f32_16x16x32_bf16 v[132:135], v[184:187], v[16:19], v[132:135]
v_mfma_f32_16x16x32_bf16 v[136:139], v[184:187], v[72:75], v[136:139]
s_add_u32 s32, s27, 8192
buffer_load_dwordx4 v[180:183], v1, s[8:11], s32 offen offset:0 sc1
s_waitcnt vmcnt(26)
v_mfma_f32_16x16x32_bf16 v[140:143], v[188:191], v[16:19], v[140:143]
v_mfma_f32_16x16x32_bf16 v[144:147], v[188:191], v[72:75], v[144:147]
s_add_u32 s32, s27, 36864
buffer_load_dwordx4 v[184:187], v1, s[8:11], s32 offen offset:0 sc1
s_waitcnt vmcnt(26)
v_mfma_f32_16x16x32_bf16 v[148:151], v[192:195], v[16:19], v[148:151]
v_mfma_f32_16x16x32_bf16 v[152:155], v[192:195], v[72:75], v[152:155]
s_add_u32 s32, s27, 20480
buffer_load_dwordx4 v[188:191], v1, s[8:11], s32 offen offset:2048 sc1
s_waitcnt vmcnt(26)
v_mfma_f32_16x16x32_bf16 v[124:127], v[196:199], v[20:23], v[124:127]
v_mfma_f32_16x16x32_bf16 v[128:131], v[196:199], v[76:79], v[128:131]
s_add_u32 s32, s27, 49152
buffer_load_dwordx4 v[192:195], v1, s[8:11], s32 offen offset:2048 sc1
s_waitcnt vmcnt(26)
v_mfma_f32_16x16x32_bf16 v[132:135], v[200:203], v[20:23], v[132:135]
v_mfma_f32_16x16x32_bf16 v[136:139], v[200:203], v[76:79], v[136:139]
s_add_u32 s32, s27, 8192
buffer_load_dwordx4 v[196:199], v1, s[8:11], s32 offen offset:1024 sc1
s_waitcnt vmcnt(26)
v_mfma_f32_16x16x32_bf16 v[140:143], v[204:207], v[20:23], v[140:143]
v_mfma_f32_16x16x32_bf16 v[144:147], v[204:207], v[76:79], v[144:147]
s_add_u32 s32, s27, 36864
buffer_load_dwordx4 v[200:203], v1, s[8:11], s32 offen offset:1024 sc1
s_waitcnt vmcnt(26)
v_mfma_f32_16x16x32_bf16 v[148:151], v[208:211], v[20:23], v[148:151]
v_mfma_f32_16x16x32_bf16 v[152:155], v[208:211], v[76:79], v[152:155]
s_add_u32 s32, s27, 20480
buffer_load_dwordx4 v[204:207], v1, s[8:11], s32 offen offset:3072 sc1
s_waitcnt vmcnt(26)
v_mfma_f32_16x16x32_bf16 v[124:127], v[212:215], v[24:27], v[124:127]
v_mfma_f32_16x16x32_bf16 v[128:131], v[212:215], v[80:83], v[128:131]
s_add_u32 s32, s27, 49152
buffer_load_dwordx4 v[208:211], v1, s[8:11], s32 offen offset:3072 sc1
s_waitcnt vmcnt(26)
v_mfma_f32_16x16x32_bf16 v[132:135], v[216:219], v[24:27], v[132:135]
v_mfma_f32_16x16x32_bf16 v[136:139], v[216:219], v[80:83], v[136:139]
s_add_u32 s32, s27, 8192
buffer_load_dwordx4 v[212:215], v1, s[8:11], s32 offen offset:2048 sc1
s_waitcnt vmcnt(26)
v_mfma_f32_16x16x32_bf16 v[140:143], v[220:223], v[24:27], v[140:143]
v_mfma_f32_16x16x32_bf16 v[144:147], v[220:223], v[80:83], v[144:147]
s_add_u32 s32, s27, 36864
buffer_load_dwordx4 v[216:219], v1, s[8:11], s32 offen offset:2048 sc1
s_waitcnt vmcnt(26)
v_mfma_f32_16x16x32_bf16 v[148:151], v[224:227], v[24:27], v[148:151]
v_mfma_f32_16x16x32_bf16 v[152:155], v[224:227], v[80:83], v[152:155]
s_add_u32 s32, s27, 24576
buffer_load_dwordx4 v[220:223], v1, s[8:11], s32 offen offset:0 sc1
s_waitcnt vmcnt(26)
v_mfma_f32_16x16x32_bf16 v[124:127], v[228:231], v[28:31], v[124:127]
v_mfma_f32_16x16x32_bf16 v[128:131], v[228:231], v[84:87], v[128:131]
s_add_u32 s32, s27, 53248
buffer_load_dwordx4 v[224:227], v1, s[8:11], s32 offen offset:0 sc1
s_waitcnt vmcnt(26)
v_mfma_f32_16x16x32_bf16 v[132:135], v[232:235], v[28:31], v[132:135]
v_mfma_f32_16x16x32_bf16 v[136:139], v[232:235], v[84:87], v[136:139]
s_add_u32 s32, s27, 8192
buffer_load_dwordx4 v[228:231], v1, s[8:11], s32 offen offset:3072 sc1
s_waitcnt vmcnt(26)
v_mfma_f32_16x16x32_bf16 v[140:143], v[236:239], v[28:31], v[140:143]
v_mfma_f32_16x16x32_bf16 v[144:147], v[236:239], v[84:87], v[144:147]
s_add_u32 s32, s27, 36864
buffer_load_dwordx4 v[232:235], v1, s[8:11], s32 offen offset:3072 sc1
s_waitcnt vmcnt(26)
v_mfma_f32_16x16x32_bf16 v[148:151], v[240:243], v[28:31], v[148:151]
v_mfma_f32_16x16x32_bf16 v[152:155], v[240:243], v[84:87], v[152:155]
s_add_u32 s32, s27, 24576
buffer_load_dwordx4 v[236:239], v1, s[8:11], s32 offen offset:1024 sc1
s_waitcnt vmcnt(26)
v_mfma_f32_16x16x32_bf16 v[124:127], v[244:247], v[32:35], v[124:127]
v_mfma_f32_16x16x32_bf16 v[128:131], v[244:247], v[88:91], v[128:131]
s_add_u32 s32, s27, 53248
buffer_load_dwordx4 v[240:243], v1, s[8:11], s32 offen offset:1024 sc1
s_waitcnt vmcnt(26)
v_mfma_f32_16x16x32_bf16 v[132:135], a[224:227], v[32:35], v[132:135]
v_mfma_f32_16x16x32_bf16 v[136:139], a[224:227], v[88:91], v[136:139]
s_add_u32 s32, s27, 12288
buffer_load_dwordx4 v[244:247], v1, s[8:11], s32 offen offset:0 sc1
s_waitcnt vmcnt(26)
v_mfma_f32_16x16x32_bf16 v[140:143], a[228:231], v[32:35], v[140:143]
v_mfma_f32_16x16x32_bf16 v[144:147], a[228:231], v[88:91], v[144:147]
s_add_u32 s32, s27, 40960
buffer_load_dwordx4 a[224:227], v1, s[8:11], s32 offen offset:0 sc1
s_waitcnt vmcnt(26)
v_mfma_f32_16x16x32_bf16 v[148:151], a[232:235], v[32:35], v[148:151]
v_mfma_f32_16x16x32_bf16 v[152:155], a[232:235], v[88:91], v[152:155]
s_add_u32 s32, s27, 24576
buffer_load_dwordx4 a[228:231], v1, s[8:11], s32 offen offset:2048 sc1
s_waitcnt vmcnt(26)
v_mfma_f32_16x16x32_bf16 v[124:127], a[236:239], v[36:39], v[124:127]
v_mfma_f32_16x16x32_bf16 v[128:131], a[236:239], v[92:95], v[128:131]
s_add_u32 s32, s27, 53248
buffer_load_dwordx4 a[232:235], v1, s[8:11], s32 offen offset:2048 sc1
s_waitcnt vmcnt(26)
v_mfma_f32_16x16x32_bf16 v[132:135], a[240:243], v[36:39], v[132:135]
v_mfma_f32_16x16x32_bf16 v[136:139], a[240:243], v[92:95], v[136:139]
s_add_u32 s32, s27, 12288
buffer_load_dwordx4 a[236:239], v1, s[8:11], s32 offen offset:1024 sc1
s_waitcnt vmcnt(26)
v_mfma_f32_16x16x32_bf16 v[140:143], a[244:247], v[36:39], v[140:143]
v_mfma_f32_16x16x32_bf16 v[144:147], a[244:247], v[92:95], v[144:147]
s_add_u32 s32, s27, 40960
buffer_load_dwordx4 a[240:243], v1, s[8:11], s32 offen offset:1024 sc1
s_waitcnt vmcnt(26)
v_mfma_f32_16x16x32_bf16 v[148:151], a[248:251], v[36:39], v[148:151]
v_mfma_f32_16x16x32_bf16 v[152:155], a[248:251], v[92:95], v[152:155]
s_add_u32 s32, s27, 24576
buffer_load_dwordx4 a[244:247], v1, s[8:11], s32 offen offset:3072 sc1
s_waitcnt vmcnt(26)
v_mfma_f32_16x16x32_bf16 v[124:127], v[164:167], v[40:43], v[124:127]
v_mfma_f32_16x16x32_bf16 v[128:131], v[164:167], v[96:99], v[128:131]
s_add_u32 s32, s27, 53248
buffer_load_dwordx4 a[248:251], v1, s[8:11], s32 offen offset:3072 sc1
s_waitcnt vmcnt(26)
v_mfma_f32_16x16x32_bf16 v[132:135], v[168:171], v[40:43], v[132:135]
v_mfma_f32_16x16x32_bf16 v[136:139], v[168:171], v[96:99], v[136:139]
buffer_load_dwordx4 v[164:167], v1, s[8:11], s28 offen offset:0 sc1
s_waitcnt vmcnt(26)
v_mfma_f32_16x16x32_bf16 v[140:143], v[172:175], v[40:43], v[140:143]
v_mfma_f32_16x16x32_bf16 v[144:147], v[172:175], v[96:99], v[144:147]
buffer_load_dwordx4 v[168:171], v1, s[8:11], s28 offen offset:1024 sc1
s_waitcnt vmcnt(26)
v_mfma_f32_16x16x32_bf16 v[148:151], v[176:179], v[40:43], v[148:151]
v_mfma_f32_16x16x32_bf16 v[152:155], v[176:179], v[96:99], v[152:155]
buffer_load_dwordx4 v[172:175], v1, s[8:11], s28 offen offset:2048 sc1
s_waitcnt vmcnt(26)
v_mfma_f32_16x16x32_bf16 v[124:127], v[180:183], v[44:47], v[124:127]
v_mfma_f32_16x16x32_bf16 v[128:131], v[180:183], v[100:103], v[128:131]
buffer_load_dwordx4 v[176:179], v1, s[8:11], s28 offen offset:3072 sc1
s_waitcnt vmcnt(26)
v_mfma_f32_16x16x32_bf16 v[132:135], v[184:187], v[44:47], v[132:135]
v_mfma_f32_16x16x32_bf16 v[136:139], v[184:187], v[100:103], v[136:139]
s_add_u32 s32, s28, 4096
buffer_load_dwordx4 v[180:183], v1, s[8:11], s32 offen offset:0 sc1
s_waitcnt vmcnt(26)
v_mfma_f32_16x16x32_bf16 v[140:143], v[188:191], v[44:47], v[140:143]
v_mfma_f32_16x16x32_bf16 v[144:147], v[188:191], v[100:103], v[144:147]
s_add_u32 s32, s28, 4096
buffer_load_dwordx4 v[184:187], v1, s[8:11], s32 offen offset:1024 sc1
s_waitcnt vmcnt(26)
v_mfma_f32_16x16x32_bf16 v[148:151], v[192:195], v[44:47], v[148:151]
v_mfma_f32_16x16x32_bf16 v[152:155], v[192:195], v[100:103], v[152:155]
s_add_u32 s32, s28, 4096
buffer_load_dwordx4 v[188:191], v1, s[8:11], s32 offen offset:2048 sc1
s_waitcnt vmcnt(26)
v_mfma_f32_16x16x32_bf16 v[124:127], v[196:199], v[48:51], v[124:127]
v_mfma_f32_16x16x32_bf16 v[128:131], v[196:199], v[104:107], v[128:131]
s_add_u32 s32, s28, 4096
buffer_load_dwordx4 v[192:195], v1, s[8:11], s32 offen offset:3072 sc1
s_waitcnt vmcnt(26)
v_mfma_f32_16x16x32_bf16 v[132:135], v[200:203], v[48:51], v[132:135]
v_mfma_f32_16x16x32_bf16 v[136:139], v[200:203], v[104:107], v[136:139]
s_add_u32 s32, s28, 8192
buffer_load_dwordx4 v[196:199], v1, s[8:11], s32 offen offset:0 sc1
s_waitcnt vmcnt(26)
v_mfma_f32_16x16x32_bf16 v[140:143], v[204:207], v[48:51], v[140:143]
v_mfma_f32_16x16x32_bf16 v[144:147], v[204:207], v[104:107], v[144:147]
s_add_u32 s32, s28, 8192
buffer_load_dwordx4 v[200:203], v1, s[8:11], s32 offen offset:1024 sc1
s_waitcnt vmcnt(26)
v_mfma_f32_16x16x32_bf16 v[148:151], v[208:211], v[48:51], v[148:151]
v_mfma_f32_16x16x32_bf16 v[152:155], v[208:211], v[104:107], v[152:155]
s_add_u32 s32, s28, 8192
buffer_load_dwordx4 v[204:207], v1, s[8:11], s32 offen offset:2048 sc1
s_waitcnt vmcnt(26)
v_mfma_f32_16x16x32_bf16 v[124:127], v[212:215], v[52:55], v[124:127]
v_mfma_f32_16x16x32_bf16 v[128:131], v[212:215], v[108:111], v[128:131]
s_add_u32 s32, s28, 8192
buffer_load_dwordx4 v[208:211], v1, s[8:11], s32 offen offset:3072 sc1
s_waitcnt vmcnt(26)
v_mfma_f32_16x16x32_bf16 v[132:135], v[216:219], v[52:55], v[132:135]
v_mfma_f32_16x16x32_bf16 v[136:139], v[216:219], v[108:111], v[136:139]
s_add_u32 s32, s28, 12288
buffer_load_dwordx4 v[212:215], v1, s[8:11], s32 offen offset:0 sc1
s_waitcnt vmcnt(26)
v_mfma_f32_16x16x32_bf16 v[140:143], v[220:223], v[52:55], v[140:143]
v_mfma_f32_16x16x32_bf16 v[144:147], v[220:223], v[108:111], v[144:147]
s_add_u32 s32, s28, 12288
buffer_load_dwordx4 v[216:219], v1, s[8:11], s32 offen offset:1024 sc1
s_waitcnt vmcnt(26)
v_mfma_f32_16x16x32_bf16 v[148:151], v[224:227], v[52:55], v[148:151]
v_mfma_f32_16x16x32_bf16 v[152:155], v[224:227], v[108:111], v[152:155]
s_add_u32 s32, s28, 12288
buffer_load_dwordx4 v[220:223], v1, s[8:11], s32 offen offset:2048 sc1
s_waitcnt vmcnt(26)
v_mfma_f32_16x16x32_bf16 v[124:127], v[228:231], v[56:59], v[124:127]
v_mfma_f32_16x16x32_bf16 v[128:131], v[228:231], v[112:115], v[128:131]
s_add_u32 s32, s28, 12288
buffer_load_dwordx4 v[224:227], v1, s[8:11], s32 offen offset:3072 sc1
s_waitcnt vmcnt(26)
v_mfma_f32_16x16x32_bf16 v[132:135], v[232:235], v[56:59], v[132:135]
v_mfma_f32_16x16x32_bf16 v[136:139], v[232:235], v[112:115], v[136:139]
s_add_u32 s32, s28, 16384
buffer_load_dwordx4 v[228:231], v1, s[8:11], s32 offen offset:0 sc1
s_waitcnt vmcnt(26)
v_mfma_f32_16x16x32_bf16 v[140:143], v[236:239], v[56:59], v[140:143]
v_mfma_f32_16x16x32_bf16 v[144:147], v[236:239], v[112:115], v[144:147]
s_add_u32 s32, s28, 16384
buffer_load_dwordx4 v[232:235], v1, s[8:11], s32 offen offset:1024 sc1
s_waitcnt vmcnt(26)
v_mfma_f32_16x16x32_bf16 v[148:151], v[240:243], v[56:59], v[148:151]
v_mfma_f32_16x16x32_bf16 v[152:155], v[240:243], v[112:115], v[152:155]
s_add_u32 s32, s28, 16384
buffer_load_dwordx4 v[236:239], v1, s[8:11], s32 offen offset:2048 sc1
s_waitcnt vmcnt(26)
v_mfma_f32_16x16x32_bf16 v[124:127], v[244:247], v[60:63], v[124:127]
v_mfma_f32_16x16x32_bf16 v[128:131], v[244:247], v[116:119], v[128:131]
s_add_u32 s32, s28, 16384
buffer_load_dwordx4 v[240:243], v1, s[8:11], s32 offen offset:3072 sc1
s_waitcnt vmcnt(26)
v_mfma_f32_16x16x32_bf16 v[132:135], a[224:227], v[60:63], v[132:135]
v_mfma_f32_16x16x32_bf16 v[136:139], a[224:227], v[116:119], v[136:139]
s_add_u32 s32, s28, 20480
buffer_load_dwordx4 v[244:247], v1, s[8:11], s32 offen offset:0 sc1
s_waitcnt vmcnt(26)
v_mfma_f32_16x16x32_bf16 v[140:143], a[228:231], v[60:63], v[140:143]
v_mfma_f32_16x16x32_bf16 v[144:147], a[228:231], v[116:119], v[144:147]
s_add_u32 s32, s28, 20480
buffer_load_dwordx4 a[224:227], v1, s[8:11], s32 offen offset:1024 sc1
s_waitcnt vmcnt(26)
v_mfma_f32_16x16x32_bf16 v[148:151], a[232:235], v[60:63], v[148:151]
v_mfma_f32_16x16x32_bf16 v[152:155], a[232:235], v[116:119], v[152:155]
s_add_u32 s32, s28, 20480
buffer_load_dwordx4 a[228:231], v1, s[8:11], s32 offen offset:2048 sc1
s_waitcnt vmcnt(26)
v_mfma_f32_16x16x32_bf16 v[124:127], a[236:239], v[64:67], v[124:127]
v_mfma_f32_16x16x32_bf16 v[128:131], a[236:239], v[120:123], v[128:131]
s_add_u32 s32, s28, 20480
buffer_load_dwordx4 a[232:235], v1, s[8:11], s32 offen offset:3072 sc1
s_waitcnt vmcnt(26)
v_mfma_f32_16x16x32_bf16 v[132:135], a[240:243], v[64:67], v[132:135]
v_mfma_f32_16x16x32_bf16 v[136:139], a[240:243], v[120:123], v[136:139]
s_add_u32 s32, s28, 24576
buffer_load_dwordx4 a[236:239], v1, s[8:11], s32 offen offset:0 sc1
s_waitcnt vmcnt(26)
v_mfma_f32_16x16x32_bf16 v[140:143], a[244:247], v[64:67], v[140:143]
v_mfma_f32_16x16x32_bf16 v[144:147], a[244:247], v[120:123], v[144:147]
s_add_u32 s32, s28, 24576
buffer_load_dwordx4 a[240:243], v1, s[8:11], s32 offen offset:1024 sc1
s_waitcnt vmcnt(26)
v_mfma_f32_16x16x32_bf16 v[148:151], a[248:251], v[64:67], v[148:151]
v_mfma_f32_16x16x32_bf16 v[152:155], a[248:251], v[120:123], v[152:155]
s_add_u32 s32, s28, 24576
buffer_load_dwordx4 a[244:247], v1, s[8:11], s32 offen offset:2048 sc1
s_waitcnt vmcnt(26)
s_nop 7
v_max_f32 v124, 0, v124
v_max_f32 v125, 0, v125
v_max_f32 v126, 0, v126
v_max_f32 v127, 0, v127
v_mul_f32 v124, v124, v140
v_mul_f32 v125, v125, v141
v_mul_f32 v126, v126, v142
v_mul_f32 v127, v127, v143
v_cvt_pk_bf16_f32 v156, v124, v125
v_cvt_pk_bf16_f32 v157, v126, v127
v_max_f32 v128, 0, v128
v_max_f32 v129, 0, v129
v_max_f32 v130, 0, v130
v_max_f32 v131, 0, v131
v_mul_f32 v128, v128, v144
v_mul_f32 v129, v129, v145
v_mul_f32 v130, v130, v146
v_mul_f32 v131, v131, v147
v_cvt_pk_bf16_f32 v160, v128, v129
v_cvt_pk_bf16_f32 v161, v130, v131
v_max_f32 v132, 0, v132
v_max_f32 v133, 0, v133
v_max_f32 v134, 0, v134
v_max_f32 v135, 0, v135
v_mul_f32 v132, v132, v148
v_mul_f32 v133, v133, v149
v_mul_f32 v134, v134, v150
v_mul_f32 v135, v135, v151
v_cvt_pk_bf16_f32 v158, v132, v133
v_cvt_pk_bf16_f32 v159, v134, v135
v_max_f32 v136, 0, v136
v_max_f32 v137, 0, v137
v_max_f32 v138, 0, v138
v_max_f32 v139, 0, v139
v_mul_f32 v136, v136, v152
v_mul_f32 v137, v137, v153
v_mul_f32 v138, v138, v154
v_mul_f32 v139, v139, v155
v_cvt_pk_bf16_f32 v162, v136, v137
v_cvt_pk_bf16_f32 v163, v138, v139
s_nop 1
v_mfma_f32_16x16x32_bf16 a[0:3], v[164:167], v[156:159], a[0:3]
v_mfma_f32_16x16x32_bf16 a[4:7], v[164:167], v[160:163], a[4:7]
s_add_u32 s32, s28, 24576
buffer_load_dwordx4 a[248:251], v1, s[8:11], s32 offen offset:3072 sc1
s_waitcnt vmcnt(26)
v_mfma_f32_16x16x32_bf16 a[8:11], v[168:171], v[156:159], a[8:11]
v_mfma_f32_16x16x32_bf16 a[12:15], v[168:171], v[160:163], a[12:15]
buffer_load_dwordx4 v[164:167], v1, s[8:11], s30 offen offset:0 sc1
s_waitcnt vmcnt(26)
v_mfma_f32_16x16x32_bf16 a[16:19], v[172:175], v[156:159], a[16:19]
v_mfma_f32_16x16x32_bf16 a[20:23], v[172:175], v[160:163], a[20:23]
s_add_u32 s32, s30, 28672
buffer_load_dwordx4 v[168:171], v1, s[8:11], s32 offen offset:0 sc1
s_waitcnt vmcnt(26)
v_mfma_f32_16x16x32_bf16 a[24:27], v[176:179], v[156:159], a[24:27]
v_mfma_f32_16x16x32_bf16 a[28:31], v[176:179], v[160:163], a[28:31]
s_add_u32 s32, s30, 12288
buffer_load_dwordx4 v[172:175], v1, s[8:11], s32 offen offset:2048 sc1
s_waitcnt vmcnt(26)
v_mfma_f32_16x16x32_bf16 a[32:35], v[180:183], v[156:159], a[32:35]
v_mfma_f32_16x16x32_bf16 a[36:39], v[180:183], v[160:163], a[36:39]
s_add_u32 s32, s30, 40960
buffer_load_dwordx4 v[176:179], v1, s[8:11], s32 offen offset:2048 sc1
s_waitcnt vmcnt(26)
v_mfma_f32_16x16x32_bf16 a[40:43], v[184:187], v[156:159], a[40:43]
v_mfma_f32_16x16x32_bf16 a[44:47], v[184:187], v[160:163], a[44:47]
buffer_load_dwordx4 v[180:183], v1, s[8:11], s30 offen offset:1024 sc1
s_waitcnt vmcnt(26)
v_mfma_f32_16x16x32_bf16 a[48:51], v[188:191], v[156:159], a[48:51]
v_mfma_f32_16x16x32_bf16 a[52:55], v[188:191], v[160:163], a[52:55]
s_add_u32 s32, s30, 28672
buffer_load_dwordx4 v[184:187], v1, s[8:11], s32 offen offset:1024 sc1
s_waitcnt vmcnt(26)
v_mfma_f32_16x16x32_bf16 a[56:59], v[192:195], v[156:159], a[56:59]
v_mfma_f32_16x16x32_bf16 a[60:63], v[192:195], v[160:163], a[60:63]
s_add_u32 s32, s30, 12288
buffer_load_dwordx4 v[188:191], v1, s[8:11], s32 offen offset:3072 sc1
s_waitcnt vmcnt(26)
v_mfma_f32_16x16x32_bf16 a[64:67], v[196:199], v[156:159], a[64:67]
v_mfma_f32_16x16x32_bf16 a[68:71], v[196:199], v[160:163], a[68:71]
s_add_u32 s32, s30, 40960
buffer_load_dwordx4 v[192:195], v1, s[8:11], s32 offen offset:3072 sc1
s_waitcnt vmcnt(26)
v_mfma_f32_16x16x32_bf16 a[72:75], v[200:203], v[156:159], a[72:75]
v_mfma_f32_16x16x32_bf16 a[76:79], v[200:203], v[160:163], a[76:79]
buffer_load_dwordx4 v[196:199], v1, s[8:11], s30 offen offset:2048 sc1
s_waitcnt vmcnt(26)
v_mfma_f32_16x16x32_bf16 a[80:83], v[204:207], v[156:159], a[80:83]
v_mfma_f32_16x16x32_bf16 a[84:87], v[204:207], v[160:163], a[84:87]
s_add_u32 s32, s30, 28672
buffer_load_dwordx4 v[200:203], v1, s[8:11], s32 offen offset:2048 sc1
s_waitcnt vmcnt(26)
v_mfma_f32_16x16x32_bf16 a[88:91], v[208:211], v[156:159], a[88:91]
v_mfma_f32_16x16x32_bf16 a[92:95], v[208:211], v[160:163], a[92:95]
s_add_u32 s32, s30, 16384
buffer_load_dwordx4 v[204:207], v1, s[8:11], s32 offen offset:0 sc1
s_waitcnt vmcnt(26)
v_mfma_f32_16x16x32_bf16 a[96:99], v[212:215], v[156:159], a[96:99]
v_mfma_f32_16x16x32_bf16 a[100:103], v[212:215], v[160:163], a[100:103]
s_add_u32 s32, s30, 45056
buffer_load_dwordx4 v[208:211], v1, s[8:11], s32 offen offset:0 sc1
s_waitcnt vmcnt(26)
v_mfma_f32_16x16x32_bf16 a[104:107], v[216:219], v[156:159], a[104:107]
v_mfma_f32_16x16x32_bf16 a[108:111], v[216:219], v[160:163], a[108:111]
buffer_load_dwordx4 v[212:215], v1, s[8:11], s30 offen offset:3072 sc1
s_waitcnt vmcnt(26)
v_mfma_f32_16x16x32_bf16 a[112:115], v[220:223], v[156:159], a[112:115]
v_mfma_f32_16x16x32_bf16 a[116:119], v[220:223], v[160:163], a[116:119]
s_add_u32 s32, s30, 28672
buffer_load_dwordx4 v[216:219], v1, s[8:11], s32 offen offset:3072 sc1
s_waitcnt vmcnt(26)
v_mfma_f32_16x16x32_bf16 a[120:123], v[224:227], v[156:159], a[120:123]
v_mfma_f32_16x16x32_bf16 a[124:127], v[224:227], v[160:163], a[124:127]
s_add_u32 s32, s30, 16384
buffer_load_dwordx4 v[220:223], v1, s[8:11], s32 offen offset:1024 sc1
s_waitcnt vmcnt(26)
v_mfma_f32_16x16x32_bf16 a[128:131], v[228:231], v[156:159], a[128:131]
v_mfma_f32_16x16x32_bf16 a[132:135], v[228:231], v[160:163], a[132:135]
s_add_u32 s32, s30, 45056
buffer_load_dwordx4 v[224:227], v1, s[8:11], s32 offen offset:1024 sc1
s_waitcnt vmcnt(26)
v_mfma_f32_16x16x32_bf16 a[136:139], v[232:235], v[156:159], a[136:139]
v_mfma_f32_16x16x32_bf16 a[140:143], v[232:235], v[160:163], a[140:143]
s_add_u32 s32, s30, 4096
buffer_load_dwordx4 v[228:231], v1, s[8:11], s32 offen offset:0 sc1
s_waitcnt vmcnt(26)
v_mfma_f32_16x16x32_bf16 a[144:147], v[236:239], v[156:159], a[144:147]
v_mfma_f32_16x16x32_bf16 a[148:151], v[236:239], v[160:163], a[148:151]
s_add_u32 s32, s30, 32768
buffer_load_dwordx4 v[232:235], v1, s[8:11], s32 offen offset:0 sc1
s_waitcnt vmcnt(26)
v_mfma_f32_16x16x32_bf16 a[152:155], v[240:243], v[156:159], a[152:155]
v_mfma_f32_16x16x32_bf16 a[156:159], v[240:243], v[160:163], a[156:159]
s_add_u32 s32, s30, 16384
buffer_load_dwordx4 v[236:239], v1, s[8:11], s32 offen offset:2048 sc1
s_waitcnt vmcnt(26)
v_mfma_f32_16x16x32_bf16 a[160:163], v[244:247], v[156:159], a[160:163]
v_mfma_f32_16x16x32_bf16 a[164:167], v[244:247], v[160:163], a[164:167]
s_add_u32 s32, s30, 45056
buffer_load_dwordx4 v[240:243], v1, s[8:11], s32 offen offset:2048 sc1
s_waitcnt vmcnt(26)
v_mfma_f32_16x16x32_bf16 a[168:171], a[224:227], v[156:159], a[168:171]
v_mfma_f32_16x16x32_bf16 a[172:175], a[224:227], v[160:163], a[172:175]
s_add_u32 s32, s30, 4096
buffer_load_dwordx4 v[244:247], v1, s[8:11], s32 offen offset:1024 sc1
s_waitcnt vmcnt(26)
v_mfma_f32_16x16x32_bf16 a[176:179], a[228:231], v[156:159], a[176:179]
v_mfma_f32_16x16x32_bf16 a[180:183], a[228:231], v[160:163], a[180:183]
s_add_u32 s32, s30, 32768
buffer_load_dwordx4 a[224:227], v1, s[8:11], s32 offen offset:1024 sc1
s_waitcnt vmcnt(26)
v_mfma_f32_16x16x32_bf16 a[184:187], a[232:235], v[156:159], a[184:187]
v_mfma_f32_16x16x32_bf16 a[188:191], a[232:235], v[160:163], a[188:191]
s_add_u32 s32, s30, 16384
buffer_load_dwordx4 a[228:231], v1, s[8:11], s32 offen offset:3072 sc1
s_waitcnt vmcnt(26)
v_mfma_f32_16x16x32_bf16 a[192:195], a[236:239], v[156:159], a[192:195]
v_mfma_f32_16x16x32_bf16 a[196:199], a[236:239], v[160:163], a[196:199]
s_add_u32 s32, s30, 45056
buffer_load_dwordx4 a[232:235], v1, s[8:11], s32 offen offset:3072 sc1
s_waitcnt vmcnt(26)
v_mfma_f32_16x16x32_bf16 a[200:203], a[240:243], v[156:159], a[200:203]
v_mfma_f32_16x16x32_bf16 a[204:207], a[240:243], v[160:163], a[204:207]
s_add_u32 s32, s30, 4096
buffer_load_dwordx4 a[236:239], v1, s[8:11], s32 offen offset:2048 sc1
s_waitcnt vmcnt(26)
v_mfma_f32_16x16x32_bf16 a[208:211], a[244:247], v[156:159], a[208:211]
v_mfma_f32_16x16x32_bf16 a[212:215], a[244:247], v[160:163], a[212:215]
s_add_u32 s32, s30, 32768
buffer_load_dwordx4 a[240:243], v1, s[8:11], s32 offen offset:2048 sc1
s_waitcnt vmcnt(26)
v_mfma_f32_16x16x32_bf16 a[216:219], a[248:251], v[156:159], a[216:219]
v_mfma_f32_16x16x32_bf16 a[220:223], a[248:251], v[160:163], a[220:223]
s_add_u32 s32, s30, 20480
buffer_load_dwordx4 a[244:247], v1, s[8:11], s32 offen offset:0 sc1
s_mov_b32 s27, s30
s_mov_b32 s28, s31
s_add_u32 s29, s29, 1
s_cmp_lt_u32 s29, 14
s_cbranch_scc1 FF_loop_218
s_waitcnt vmcnt(0)
s_nop 7
s_mul_i32 s17, s13, 28672
v_add_u32 v7, s17, v1
s_mul_i32 s17, s13, 7168
v_add_u32 v8, s17, v1
v_add_u32 v10, 57344, v8
s_mul_i32 s25, s12, 57344
s_mul_i32 s17, s13, 7168
s_add_u32 s25, s25, s17
s_add_u32 s25, s25, 66089600
s_mov_b32 s33, 0xbfb8aa3b
s_lshl_b32 s26, s12, 7
s_add_u32 s26, s26, 44126860
v_bfe_u32 v11, v5, 3, 1
v_lshlrev_b32 v11, 4, v11
v_bfe_u32 v4, v5, 1, 1
v_lshl_add_u32 v11, v4, 3, v11
v_bfe_u32 v4, v5, 2, 1
v_lshl_add_u32 v11, v4, 2, v11
v_and_b32 v4, 1, v5
v_add_u32 v11, v11, v4
v_mul_u32_u24 v11, 896, v11
v_lshl_add_u32 v11, v6, 3, v11
s_load_dwordx2 s[36:37], s[0:1], 0
s_mov_b32 s38, 1835008
s_mov_b32 s39, 0x20000
s_load_dwordx2 s[40:41], s[0:1], 88
s_mov_b32 s42, 1835008
s_mov_b32 s43, 0x20000
s_mul_i32 s34, s12, 28672
s_waitcnt lgkmcnt(0)
s_cmp_ge_u32 s12, 32
s_cbranch_scc1 FF_late_219
WC_221:
buffer_load_dword v4, v2, s[8:11], s26 offen sc1
s_waitcnt vmcnt(0)
v_cmp_gt_u32 vcc, 7, v4
s_cbranch_vccz WCD_222
s_sleep 4
s_sub_u32 s19, s19, 1
s_cbranch_scc0 WC_221
s_branch M_abort
WCD_222:
s_barrier
ds_write_b128 v7, a[0:3] offset:0
ds_write_b128 v7, a[4:7] offset:1024
ds_write_b128 v7, a[8:11] offset:2048
ds_write_b128 v7, a[12:15] offset:3072
ds_write_b128 v7, a[16:19] offset:4096
ds_write_b128 v7, a[20:23] offset:5120
ds_write_b128 v7, a[24:27] offset:6144
ds_write_b128 v7, a[28:31] offset:7168
ds_write_b128 v7, a[32:35] offset:8192
ds_write_b128 v7, a[36:39] offset:9216
ds_write_b128 v7, a[40:43] offset:10240
ds_write_b128 v7, a[44:47] offset:11264
ds_write_b128 v7, a[48:51] offset:12288
ds_write_b128 v7, a[52:55] offset:13312
ds_write_b128 v7, a[56:59] offset:14336
ds_write_b128 v7, a[60:63] offset:15360
ds_write_b128 v7, a[64:67] offset:16384
ds_write_b128 v7, a[68:71] offset:17408
ds_write_b128 v7, a[72:75] offset:18432
ds_write_b128 v7, a[76:79] offset:19456
ds_write_b128 v7, a[80:83] offset:20480
ds_write_b128 v7, a[84:87] offset:21504
ds_write_b128 v7, a[88:91] offset:22528
ds_write_b128 v7, a[92:95] offset:23552
ds_write_b128 v7, a[96:99] offset:24576
ds_write_b128 v7, a[100:103] offset:25600
ds_write_b128 v7, a[104:107] offset:26624
ds_write_b128 v7, a[108:111] offset:27648
s_add_u32 s17, s25, 0
buffer_load_dwordx4 v[48:51], v1, s[8:11], s17 offen offset:0 sc1
s_mul_i32 s17, s13, 7
s_add_u32 s17, s17, 0
s_and_b32 s18, s17, 1
s_mul_i32 s18, s18, 1792
s_lshr_b32 s17, s17, 1
s_lshl_b32 s17, s17, 5
s_add_u32 s17, s17, s18
s_add_u32 s60, s17, s34
buffer_load_dwordx2 v[80:81], v11, s[36:39], s60 offen
s_add_u32 s17, s25, 0
buffer_load_dwordx4 v[52:55], v1, s[8:11], s17 offen offset:1024 sc1
s_mul_i32 s17, s13, 7
s_add_u32 s17, s17, 1
s_and_b32 s18, s17, 1
s_mul_i32 s18, s18, 1792
s_lshr_b32 s17, s17, 1
s_lshl_b32 s17, s17, 5
s_add_u32 s17, s17, s18
s_add_u32 s61, s17, s34
buffer_load_dwordx2 v[82:83], v11, s[36:39], s61 offen
s_add_u32 s17, s25, 0
buffer_load_dwordx4 v[56:59], v1, s[8:11], s17 offen offset:2048 sc1
s_mul_i32 s17, s13, 7
s_add_u32 s17, s17, 2
s_and_b32 s18, s17, 1
s_mul_i32 s18, s18, 1792
s_lshr_b32 s17, s17, 1
s_lshl_b32 s17, s17, 5
s_add_u32 s17, s17, s18
s_add_u32 s62, s17, s34
buffer_load_dwordx2 v[84:85], v11, s[36:39], s62 offen
s_add_u32 s17, s25, 0
buffer_load_dwordx4 v[60:63], v1, s[8:11], s17 offen offset:3072 sc1
s_mul_i32 s17, s13, 7
s_add_u32 s17, s17, 3
s_and_b32 s18, s17, 1
s_mul_i32 s18, s18, 1792
s_lshr_b32 s17, s17, 1
s_lshl_b32 s17, s17, 5
s_add_u32 s17, s17, s18
s_add_u32 s63, s17, s34
buffer_load_dwordx2 v[86:87], v11, s[36:39], s63 offen
s_add_u32 s17, s25, 4096
buffer_load_dwordx4 v[64:67], v1, s[8:11], s17 offen offset:0 sc1
s_mul_i32 s17, s13, 7
s_add_u32 s17, s17, 4
s_and_b32 s18, s17, 1
s_mul_i32 s18, s18, 1792
s_lshr_b32 s17, s17, 1
s_lshl_b32 s17, s17, 5
s_add_u32 s17, s17, s18
s_add_u32 s64, s17, s34
buffer_load_dwordx2 v[88:89], v11, s[36:39], s64 offen
s_add_u32 s17, s25, 4096
buffer_load_dwordx4 v[68:71], v1, s[8:11], s17 offen offset:1024 sc1
s_mul_i32 s17, s13, 7
s_add_u32 s17, s17, 5
s_and_b32 s18, s17, 1
s_mul_i32 s18, s18, 1792
s_lshr_b32 s17, s17, 1
s_lshl_b32 s17, s17, 5
s_add_u32 s17, s17, s18
s_add_u32 s65, s17, s34
buffer_load_dwordx2 v[90:91], v11, s[36:39], s65 offen
s_add_u32 s17, s25, 4096
buffer_load_dwordx4 v[72:75], v1, s[8:11], s17 offen offset:2048 sc1
s_mul_i32 s17, s13, 7
s_add_u32 s17, s17, 6
s_and_b32 s18, s17, 1
s_mul_i32 s18, s18, 1792
s_lshr_b32 s17, s17, 1
s_lshl_b32 s17, s17, 5
s_add_u32 s17, s17, s18
s_add_u32 s66, s17, s34
buffer_load_dwordx2 v[92:93], v11, s[36:39], s66 offen
s_waitcnt lgkmcnt(0)
s_barrier
s_waitcnt vmcnt(0)
ds_read_b128 v[16:19], v8 offset:0
ds_read_b128 v[20:23], v8 offset:28672
ds_read_b128 v[24:27], v10 offset:0
ds_read_b128 v[28:31], v10 offset:28672
s_waitcnt lgkmcnt(0)
v_pk_add_f32 v[16:17], v[16:17], v[20:21]
v_pk_add_f32 v[24:25], v[24:25], v[28:29]
v_pk_add_f32 v[16:17], v[16:17], v[24:25]
v_pk_add_f32 v[18:19], v[18:19], v[22:23]
v_pk_add_f32 v[26:27], v[26:27], v[30:31]
v_pk_add_f32 v[18:19], v[18:19], v[26:27]
v_mul_f32 v20, s33, v16
v_mul_f32 v21, s33, v17
v_mul_f32 v22, s33, v18
v_mul_f32 v23, s33, v19
v_exp_f32 v20, v20
v_exp_f32 v21, v21
v_exp_f32 v22, v22
v_exp_f32 v23, v23
s_nop 0
v_add_f32 v20, 1.0, v20
v_add_f32 v21, 1.0, v21
v_add_f32 v22, 1.0, v22
v_add_f32 v23, 1.0, v23
v_rcp_f32 v20, v20
v_rcp_f32 v21, v21
v_rcp_f32 v22, v22
v_rcp_f32 v23, v23
s_nop 0
v_mul_f32 v36, v16, v20
v_mul_f32 v37, v17, v21
v_mul_f32 v38, v18, v22
v_mul_f32 v39, v19, v23
v_lshlrev_b32 v16, 16, v80
v_and_b32 v17, 0xffff0000, v80
v_lshlrev_b32 v18, 16, v81
v_and_b32 v19, 0xffff0000, v81
v_fma_f32 v16, v48, v36, v16
v_fma_f32 v17, v49, v37, v17
v_fma_f32 v18, v50, v38, v18
v_fma_f32 v19, v51, v39, v19
v_cvt_pk_bf16_f32 v40, v16, v17
v_cvt_pk_bf16_f32 v41, v18, v19
buffer_store_dwordx2 v[40:41], v11, s[40:43], s60 offen
ds_read_b128 v[16:19], v8 offset:1024
ds_read_b128 v[20:23], v8 offset:29696
ds_read_b128 v[24:27], v10 offset:1024
ds_read_b128 v[28:31], v10 offset:29696
s_waitcnt lgkmcnt(0)
v_pk_add_f32 v[16:17], v[16:17], v[20:21]
v_pk_add_f32 v[24:25], v[24:25], v[28:29]
v_pk_add_f32 v[16:17], v[16:17], v[24:25]
v_pk_add_f32 v[18:19], v[18:19], v[22:23]
v_pk_add_f32 v[26:27], v[26:27], v[30:31]
v_pk_add_f32 v[18:19], v[18:19], v[26:27]
v_mul_f32 v20, s33, v16
v_mul_f32 v21, s33, v17
v_mul_f32 v22, s33, v18
v_mul_f32 v23, s33, v19
v_exp_f32 v20, v20
v_exp_f32 v21, v21
v_exp_f32 v22, v22
v_exp_f32 v23, v23
s_nop 0
v_add_f32 v20, 1.0, v20
v_add_f32 v21, 1.0, v21
v_add_f32 v22, 1.0, v22
v_add_f32 v23, 1.0, v23
v_rcp_f32 v20, v20
v_rcp_f32 v21, v21
v_rcp_f32 v22, v22
v_rcp_f32 v23, v23
s_nop 0
v_mul_f32 v36, v16, v20
v_mul_f32 v37, v17, v21
v_mul_f32 v38, v18, v22
v_mul_f32 v39, v19, v23
v_lshlrev_b32 v16, 16, v82
v_and_b32 v17, 0xffff0000, v82
v_lshlrev_b32 v18, 16, v83
v_and_b32 v19, 0xffff0000, v83
v_fma_f32 v16, v52, v36, v16
v_fma_f32 v17, v53, v37, v17
v_fma_f32 v18, v54, v38, v18
v_fma_f32 v19, v55, v39, v19
v_cvt_pk_bf16_f32 v40, v16, v17
v_cvt_pk_bf16_f32 v41, v18, v19
buffer_store_dwordx2 v[40:41], v11, s[40:43], s61 offen
ds_read_b128 v[16:19], v8 offset:2048
ds_read_b128 v[20:23], v8 offset:30720
ds_read_b128 v[24:27], v10 offset:2048
ds_read_b128 v[28:31], v10 offset:30720
s_waitcnt lgkmcnt(0)
v_pk_add_f32 v[16:17], v[16:17], v[20:21]
v_pk_add_f32 v[24:25], v[24:25], v[28:29]
v_pk_add_f32 v[16:17], v[16:17], v[24:25]
v_pk_add_f32 v[18:19], v[18:19], v[22:23]
v_pk_add_f32 v[26:27], v[26:27], v[30:31]
v_pk_add_f32 v[18:19], v[18:19], v[26:27]
v_mul_f32 v20, s33, v16
v_mul_f32 v21, s33, v17
v_mul_f32 v22, s33, v18
v_mul_f32 v23, s33, v19
v_exp_f32 v20, v20
v_exp_f32 v21, v21
v_exp_f32 v22, v22
v_exp_f32 v23, v23
s_nop 0
v_add_f32 v20, 1.0, v20
v_add_f32 v21, 1.0, v21
v_add_f32 v22, 1.0, v22
v_add_f32 v23, 1.0, v23
v_rcp_f32 v20, v20
v_rcp_f32 v21, v21
v_rcp_f32 v22, v22
v_rcp_f32 v23, v23
s_nop 0
v_mul_f32 v36, v16, v20
v_mul_f32 v37, v17, v21
v_mul_f32 v38, v18, v22
v_mul_f32 v39, v19, v23
v_lshlrev_b32 v16, 16, v84
v_and_b32 v17, 0xffff0000, v84
v_lshlrev_b32 v18, 16, v85
v_and_b32 v19, 0xffff0000, v85
v_fma_f32 v16, v56, v36, v16
v_fma_f32 v17, v57, v37, v17
v_fma_f32 v18, v58, v38, v18
v_fma_f32 v19, v59, v39, v19
v_cvt_pk_bf16_f32 v40, v16, v17
v_cvt_pk_bf16_f32 v41, v18, v19
buffer_store_dwordx2 v[40:41], v11, s[40:43], s62 offen
ds_read_b128 v[16:19], v8 offset:3072
ds_read_b128 v[20:23], v8 offset:31744
ds_read_b128 v[24:27], v10 offset:3072
ds_read_b128 v[28:31], v10 offset:31744
s_waitcnt lgkmcnt(0)
v_pk_add_f32 v[16:17], v[16:17], v[20:21]
v_pk_add_f32 v[24:25], v[24:25], v[28:29]
v_pk_add_f32 v[16:17], v[16:17], v[24:25]
v_pk_add_f32 v[18:19], v[18:19], v[22:23]
v_pk_add_f32 v[26:27], v[26:27], v[30:31]
v_pk_add_f32 v[18:19], v[18:19], v[26:27]
v_mul_f32 v20, s33, v16
v_mul_f32 v21, s33, v17
v_mul_f32 v22, s33, v18
v_mul_f32 v23, s33, v19
v_exp_f32 v20, v20
v_exp_f32 v21, v21
v_exp_f32 v22, v22
v_exp_f32 v23, v23
s_nop 0
v_add_f32 v20, 1.0, v20
v_add_f32 v21, 1.0, v21
v_add_f32 v22, 1.0, v22
v_add_f32 v23, 1.0, v23
v_rcp_f32 v20, v20
v_rcp_f32 v21, v21
v_rcp_f32 v22, v22
v_rcp_f32 v23, v23
s_nop 0
v_mul_f32 v36, v16, v20
v_mul_f32 v37, v17, v21
v_mul_f32 v38, v18, v22
v_mul_f32 v39, v19, v23
v_lshlrev_b32 v16, 16, v86
v_and_b32 v17, 0xffff0000, v86
v_lshlrev_b32 v18, 16, v87
v_and_b32 v19, 0xffff0000, v87
v_fma_f32 v16, v60, v36, v16
v_fma_f32 v17, v61, v37, v17
v_fma_f32 v18, v62, v38, v18
v_fma_f32 v19, v63, v39, v19
v_cvt_pk_bf16_f32 v40, v16, v17
v_cvt_pk_bf16_f32 v41, v18, v19
buffer_store_dwordx2 v[40:41], v11, s[40:43], s63 offen
ds_read_b128 v[16:19], v8 offset:4096
ds_read_b128 v[20:23], v8 offset:32768
ds_read_b128 v[24:27], v10 offset:4096
ds_read_b128 v[28:31], v10 offset:32768
s_waitcnt lgkmcnt(0)
v_pk_add_f32 v[16:17], v[16:17], v[20:21]
v_pk_add_f32 v[24:25], v[24:25], v[28:29]
v_pk_add_f32 v[16:17], v[16:17], v[24:25]
v_pk_add_f32 v[18:19], v[18:19], v[22:23]
v_pk_add_f32 v[26:27], v[26:27], v[30:31]
v_pk_add_f32 v[18:19], v[18:19], v[26:27]
v_mul_f32 v20, s33, v16
v_mul_f32 v21, s33, v17
v_mul_f32 v22, s33, v18
v_mul_f32 v23, s33, v19
v_exp_f32 v20, v20
v_exp_f32 v21, v21
v_exp_f32 v22, v22
v_exp_f32 v23, v23
s_nop 0
v_add_f32 v20, 1.0, v20
v_add_f32 v21, 1.0, v21
v_add_f32 v22, 1.0, v22
v_add_f32 v23, 1.0, v23
v_rcp_f32 v20, v20
v_rcp_f32 v21, v21
v_rcp_f32 v22, v22
v_rcp_f32 v23, v23
s_nop 0
v_mul_f32 v36, v16, v20
v_mul_f32 v37, v17, v21
v_mul_f32 v38, v18, v22
v_mul_f32 v39, v19, v23
v_lshlrev_b32 v16, 16, v88
v_and_b32 v17, 0xffff0000, v88
v_lshlrev_b32 v18, 16, v89
v_and_b32 v19, 0xffff0000, v89
v_fma_f32 v16, v64, v36, v16
v_fma_f32 v17, v65, v37, v17
v_fma_f32 v18, v66, v38, v18
v_fma_f32 v19, v67, v39, v19
v_cvt_pk_bf16_f32 v40, v16, v17
v_cvt_pk_bf16_f32 v41, v18, v19
buffer_store_dwordx2 v[40:41], v11, s[40:43], s64 offen
ds_read_b128 v[16:19], v8 offset:5120
ds_read_b128 v[20:23], v8 offset:33792
ds_read_b128 v[24:27], v10 offset:5120
ds_read_b128 v[28:31], v10 offset:33792
s_waitcnt lgkmcnt(0)
v_pk_add_f32 v[16:17], v[16:17], v[20:21]
v_pk_add_f32 v[24:25], v[24:25], v[28:29]
v_pk_add_f32 v[16:17], v[16:17], v[24:25]
v_pk_add_f32 v[18:19], v[18:19], v[22:23]
v_pk_add_f32 v[26:27], v[26:27], v[30:31]
v_pk_add_f32 v[18:19], v[18:19], v[26:27]
v_mul_f32 v20, s33, v16
v_mul_f32 v21, s33, v17
v_mul_f32 v22, s33, v18
v_mul_f32 v23, s33, v19
v_exp_f32 v20, v20
v_exp_f32 v21, v21
v_exp_f32 v22, v22
v_exp_f32 v23, v23
s_nop 0
v_add_f32 v20, 1.0, v20
v_add_f32 v21, 1.0, v21
v_add_f32 v22, 1.0, v22
v_add_f32 v23, 1.0, v23
v_rcp_f32 v20, v20
v_rcp_f32 v21, v21
v_rcp_f32 v22, v22
v_rcp_f32 v23, v23
s_nop 0
v_mul_f32 v36, v16, v20
v_mul_f32 v37, v17, v21
v_mul_f32 v38, v18, v22
v_mul_f32 v39, v19, v23
v_lshlrev_b32 v16, 16, v90
v_and_b32 v17, 0xffff0000, v90
v_lshlrev_b32 v18, 16, v91
v_and_b32 v19, 0xffff0000, v91
v_fma_f32 v16, v68, v36, v16
v_fma_f32 v17, v69, v37, v17
v_fma_f32 v18, v70, v38, v18
v_fma_f32 v19, v71, v39, v19
v_cvt_pk_bf16_f32 v40, v16, v17
v_cvt_pk_bf16_f32 v41, v18, v19
buffer_store_dwordx2 v[40:41], v11, s[40:43], s65 offen
ds_read_b128 v[16:19], v8 offset:6144
ds_read_b128 v[20:23], v8 offset:34816
ds_read_b128 v[24:27], v10 offset:6144
ds_read_b128 v[28:31], v10 offset:34816
s_waitcnt lgkmcnt(0)
v_pk_add_f32 v[16:17], v[16:17], v[20:21]
v_pk_add_f32 v[24:25], v[24:25], v[28:29]
v_pk_add_f32 v[16:17], v[16:17], v[24:25]
v_pk_add_f32 v[18:19], v[18:19], v[22:23]
v_pk_add_f32 v[26:27], v[26:27], v[30:31]
v_pk_add_f32 v[18:19], v[18:19], v[26:27]
v_mul_f32 v20, s33, v16
v_mul_f32 v21, s33, v17
v_mul_f32 v22, s33, v18
v_mul_f32 v23, s33, v19
v_exp_f32 v20, v20
v_exp_f32 v21, v21
v_exp_f32 v22, v22
v_exp_f32 v23, v23
s_nop 0
v_add_f32 v20, 1.0, v20
v_add_f32 v21, 1.0, v21
v_add_f32 v22, 1.0, v22
v_add_f32 v23, 1.0, v23
v_rcp_f32 v20, v20
v_rcp_f32 v21, v21
v_rcp_f32 v22, v22
v_rcp_f32 v23, v23
s_nop 0
v_mul_f32 v36, v16, v20
v_mul_f32 v37, v17, v21
v_mul_f32 v38, v18, v22
v_mul_f32 v39, v19, v23
v_lshlrev_b32 v16, 16, v92
v_and_b32 v17, 0xffff0000, v92
v_lshlrev_b32 v18, 16, v93
v_and_b32 v19, 0xffff0000, v93
v_fma_f32 v16, v72, v36, v16
v_fma_f32 v17, v73, v37, v17
v_fma_f32 v18, v74, v38, v18
v_fma_f32 v19, v75, v39, v19
v_cvt_pk_bf16_f32 v40, v16, v17
v_cvt_pk_bf16_f32 v41, v18, v19
buffer_store_dwordx2 v[40:41], v11, s[40:43], s66 offen
s_barrier
ds_write_b128 v7, a[112:115] offset:0
ds_write_b128 v7, a[116:119] offset:1024
ds_write_b128 v7, a[120:123] offset:2048
ds_write_b128 v7, a[124:127] offset:3072
ds_write_b128 v7, a[128:131] offset:4096
ds_write_b128 v7, a[132:135] offset:5120
ds_write_b128 v7, a[136:139] offset:6144
ds_write_b128 v7, a[140:143] offset:7168
ds_write_b128 v7, a[144:147] offset:8192
ds_write_b128 v7, a[148:151] offset:9216
ds_write_b128 v7, a[152:155] offset:10240
ds_write_b128 v7, a[156:159] offset:11264
ds_write_b128 v7, a[160:163] offset:12288
ds_write_b128 v7, a[164:167] offset:13312
ds_write_b128 v7, a[168:171] offset:14336
ds_write_b128 v7, a[172:175] offset:15360
ds_write_b128 v7, a[176:179] offset:16384
ds_write_b128 v7, a[180:183] offset:17408
ds_write_b128 v7, a[184:187] offset:18432
ds_write_b128 v7, a[188:191] offset:19456
ds_write_b128 v7, a[192:195] offset:20480
ds_write_b128 v7, a[196:199] offset:21504
ds_write_b128 v7, a[200:203] offset:22528
ds_write_b128 v7, a[204:207] offset:23552
ds_write_b128 v7, a[208:211] offset:24576
ds_write_b128 v7, a[212:215] offset:25600
ds_write_b128 v7, a[216:219] offset:26624
ds_write_b128 v7, a[220:223] offset:27648
s_add_u32 s17, s25, 28672
buffer_load_dwordx4 v[48:51], v1, s[8:11], s17 offen offset:0 sc1
s_mul_i32 s17, s13, 7
s_add_u32 s17, s17, 28
s_and_b32 s18, s17, 1
s_mul_i32 s18, s18, 1792
s_lshr_b32 s17, s17, 1
s_lshl_b32 s17, s17, 5
s_add_u32 s17, s17, s18
s_add_u32 s60, s17, s34
buffer_load_dwordx2 v[80:81], v11, s[36:39], s60 offen
s_add_u32 s17, s25, 28672
buffer_load_dwordx4 v[52:55], v1, s[8:11], s17 offen offset:1024 sc1
s_mul_i32 s17, s13, 7
s_add_u32 s17, s17, 29
s_and_b32 s18, s17, 1
s_mul_i32 s18, s18, 1792
s_lshr_b32 s17, s17, 1
s_lshl_b32 s17, s17, 5
s_add_u32 s17, s17, s18
s_add_u32 s61, s17, s34
buffer_load_dwordx2 v[82:83], v11, s[36:39], s61 offen
s_add_u32 s17, s25, 28672
buffer_load_dwordx4 v[56:59], v1, s[8:11], s17 offen offset:2048 sc1
s_mul_i32 s17, s13, 7
s_add_u32 s17, s17, 30
s_and_b32 s18, s17, 1
s_mul_i32 s18, s18, 1792
s_lshr_b32 s17, s17, 1
s_lshl_b32 s17, s17, 5
s_add_u32 s17, s17, s18
s_add_u32 s62, s17, s34
buffer_load_dwordx2 v[84:85], v11, s[36:39], s62 offen
s_add_u32 s17, s25, 28672
buffer_load_dwordx4 v[60:63], v1, s[8:11], s17 offen offset:3072 sc1
s_mul_i32 s17, s13, 7
s_add_u32 s17, s17, 31
s_and_b32 s18, s17, 1
s_mul_i32 s18, s18, 1792
s_lshr_b32 s17, s17, 1
s_lshl_b32 s17, s17, 5
s_add_u32 s17, s17, s18
s_add_u32 s63, s17, s34
buffer_load_dwordx2 v[86:87], v11, s[36:39], s63 offen
s_add_u32 s17, s25, 32768
buffer_load_dwordx4 v[64:67], v1, s[8:11], s17 offen offset:0 sc1
s_mul_i32 s17, s13, 7
s_add_u32 s17, s17, 32
s_and_b32 s18, s17, 1
s_mul_i32 s18, s18, 1792
s_lshr_b32 s17, s17, 1
s_lshl_b32 s17, s17, 5
s_add_u32 s17, s17, s18
s_add_u32 s64, s17, s34
buffer_load_dwordx2 v[88:89], v11, s[36:39], s64 offen
s_add_u32 s17, s25, 32768
buffer_load_dwordx4 v[68:71], v1, s[8:11], s17 offen offset:1024 sc1
s_mul_i32 s17, s13, 7
s_add_u32 s17, s17, 33
s_and_b32 s18, s17, 1
s_mul_i32 s18, s18, 1792
s_lshr_b32 s17, s17, 1
s_lshl_b32 s17, s17, 5
s_add_u32 s17, s17, s18
s_add_u32 s65, s17, s34
buffer_load_dwordx2 v[90:91], v11, s[36:39], s65 offen
s_add_u32 s17, s25, 32768
buffer_load_dwordx4 v[72:75], v1, s[8:11], s17 offen offset:2048 sc1
s_mul_i32 s17, s13, 7
s_add_u32 s17, s17, 34
s_and_b32 s18, s17, 1
s_mul_i32 s18, s18, 1792
s_lshr_b32 s17, s17, 1
s_lshl_b32 s17, s17, 5
s_add_u32 s17, s17, s18
s_add_u32 s66, s17, s34
buffer_load_dwordx2 v[92:93], v11, s[36:39], s66 offen
s_waitcnt lgkmcnt(0)
s_barrier
s_waitcnt vmcnt(0)
ds_read_b128 v[16:19], v8 offset:0
ds_read_b128 v[20:23], v8 offset:28672
ds_read_b128 v[24:27], v10 offset:0
ds_read_b128 v[28:31], v10 offset:28672
s_waitcnt lgkmcnt(0)
v_pk_add_f32 v[16:17], v[16:17], v[20:21]
v_pk_add_f32 v[24:25], v[24:25], v[28:29]
v_pk_add_f32 v[16:17], v[16:17], v[24:25]
v_pk_add_f32 v[18:19], v[18:19], v[22:23]
v_pk_add_f32 v[26:27], v[26:27], v[30:31]
v_pk_add_f32 v[18:19], v[18:19], v[26:27]
v_mul_f32 v20, s33, v16
v_mul_f32 v21, s33, v17
v_mul_f32 v22, s33, v18
v_mul_f32 v23, s33, v19
v_exp_f32 v20, v20
v_exp_f32 v21, v21
v_exp_f32 v22, v22
v_exp_f32 v23, v23
s_nop 0
v_add_f32 v20, 1.0, v20
v_add_f32 v21, 1.0, v21
v_add_f32 v22, 1.0, v22
v_add_f32 v23, 1.0, v23
v_rcp_f32 v20, v20
v_rcp_f32 v21, v21
v_rcp_f32 v22, v22
v_rcp_f32 v23, v23
s_nop 0
v_mul_f32 v36, v16, v20
v_mul_f32 v37, v17, v21
v_mul_f32 v38, v18, v22
v_mul_f32 v39, v19, v23
v_lshlrev_b32 v16, 16, v80
v_and_b32 v17, 0xffff0000, v80
v_lshlrev_b32 v18, 16, v81
v_and_b32 v19, 0xffff0000, v81
v_fma_f32 v16, v48, v36, v16
v_fma_f32 v17, v49, v37, v17
v_fma_f32 v18, v50, v38, v18
v_fma_f32 v19, v51, v39, v19
v_cvt_pk_bf16_f32 v40, v16, v17
v_cvt_pk_bf16_f32 v41, v18, v19
buffer_store_dwordx2 v[40:41], v11, s[40:43], s60 offen
ds_read_b128 v[16:19], v8 offset:1024
ds_read_b128 v[20:23], v8 offset:29696
ds_read_b128 v[24:27], v10 offset:1024
ds_read_b128 v[28:31], v10 offset:29696
s_waitcnt lgkmcnt(0)
v_pk_add_f32 v[16:17], v[16:17], v[20:21]
v_pk_add_f32 v[24:25], v[24:25], v[28:29]
v_pk_add_f32 v[16:17], v[16:17], v[24:25]
v_pk_add_f32 v[18:19], v[18:19], v[22:23]
v_pk_add_f32 v[26:27], v[26:27], v[30:31]
v_pk_add_f32 v[18:19], v[18:19], v[26:27]
v_mul_f32 v20, s33, v16
v_mul_f32 v21, s33, v17
v_mul_f32 v22, s33, v18
v_mul_f32 v23, s33, v19
v_exp_f32 v20, v20
v_exp_f32 v21, v21
v_exp_f32 v22, v22
v_exp_f32 v23, v23
s_nop 0
v_add_f32 v20, 1.0, v20
v_add_f32 v21, 1.0, v21
v_add_f32 v22, 1.0, v22
v_add_f32 v23, 1.0, v23
v_rcp_f32 v20, v20
v_rcp_f32 v21, v21
v_rcp_f32 v22, v22
v_rcp_f32 v23, v23
s_nop 0
v_mul_f32 v36, v16, v20
v_mul_f32 v37, v17, v21
v_mul_f32 v38, v18, v22
v_mul_f32 v39, v19, v23
v_lshlrev_b32 v16, 16, v82
v_and_b32 v17, 0xffff0000, v82
v_lshlrev_b32 v18, 16, v83
v_and_b32 v19, 0xffff0000, v83
v_fma_f32 v16, v52, v36, v16
v_fma_f32 v17, v53, v37, v17
v_fma_f32 v18, v54, v38, v18
v_fma_f32 v19, v55, v39, v19
v_cvt_pk_bf16_f32 v40, v16, v17
v_cvt_pk_bf16_f32 v41, v18, v19
buffer_store_dwordx2 v[40:41], v11, s[40:43], s61 offen
ds_read_b128 v[16:19], v8 offset:2048
ds_read_b128 v[20:23], v8 offset:30720
ds_read_b128 v[24:27], v10 offset:2048
ds_read_b128 v[28:31], v10 offset:30720
s_waitcnt lgkmcnt(0)
v_pk_add_f32 v[16:17], v[16:17], v[20:21]
v_pk_add_f32 v[24:25], v[24:25], v[28:29]
v_pk_add_f32 v[16:17], v[16:17], v[24:25]
v_pk_add_f32 v[18:19], v[18:19], v[22:23]
v_pk_add_f32 v[26:27], v[26:27], v[30:31]
v_pk_add_f32 v[18:19], v[18:19], v[26:27]
v_mul_f32 v20, s33, v16
v_mul_f32 v21, s33, v17
v_mul_f32 v22, s33, v18
v_mul_f32 v23, s33, v19
v_exp_f32 v20, v20
v_exp_f32 v21, v21
v_exp_f32 v22, v22
v_exp_f32 v23, v23
s_nop 0
v_add_f32 v20, 1.0, v20
v_add_f32 v21, 1.0, v21
v_add_f32 v22, 1.0, v22
v_add_f32 v23, 1.0, v23
v_rcp_f32 v20, v20
v_rcp_f32 v21, v21
v_rcp_f32 v22, v22
v_rcp_f32 v23, v23
s_nop 0
v_mul_f32 v36, v16, v20
v_mul_f32 v37, v17, v21
v_mul_f32 v38, v18, v22
v_mul_f32 v39, v19, v23
v_lshlrev_b32 v16, 16, v84
v_and_b32 v17, 0xffff0000, v84
v_lshlrev_b32 v18, 16, v85
v_and_b32 v19, 0xffff0000, v85
v_fma_f32 v16, v56, v36, v16
v_fma_f32 v17, v57, v37, v17
v_fma_f32 v18, v58, v38, v18
v_fma_f32 v19, v59, v39, v19
v_cvt_pk_bf16_f32 v40, v16, v17
v_cvt_pk_bf16_f32 v41, v18, v19
buffer_store_dwordx2 v[40:41], v11, s[40:43], s62 offen
ds_read_b128 v[16:19], v8 offset:3072
ds_read_b128 v[20:23], v8 offset:31744
ds_read_b128 v[24:27], v10 offset:3072
ds_read_b128 v[28:31], v10 offset:31744
s_waitcnt lgkmcnt(0)
v_pk_add_f32 v[16:17], v[16:17], v[20:21]
v_pk_add_f32 v[24:25], v[24:25], v[28:29]
v_pk_add_f32 v[16:17], v[16:17], v[24:25]
v_pk_add_f32 v[18:19], v[18:19], v[22:23]
v_pk_add_f32 v[26:27], v[26:27], v[30:31]
v_pk_add_f32 v[18:19], v[18:19], v[26:27]
v_mul_f32 v20, s33, v16
v_mul_f32 v21, s33, v17
v_mul_f32 v22, s33, v18
v_mul_f32 v23, s33, v19
v_exp_f32 v20, v20
v_exp_f32 v21, v21
v_exp_f32 v22, v22
v_exp_f32 v23, v23
s_nop 0
v_add_f32 v20, 1.0, v20
v_add_f32 v21, 1.0, v21
v_add_f32 v22, 1.0, v22
v_add_f32 v23, 1.0, v23
v_rcp_f32 v20, v20
v_rcp_f32 v21, v21
v_rcp_f32 v22, v22
v_rcp_f32 v23, v23
s_nop 0
v_mul_f32 v36, v16, v20
v_mul_f32 v37, v17, v21
v_mul_f32 v38, v18, v22
v_mul_f32 v39, v19, v23
v_lshlrev_b32 v16, 16, v86
v_and_b32 v17, 0xffff0000, v86
v_lshlrev_b32 v18, 16, v87
v_and_b32 v19, 0xffff0000, v87
v_fma_f32 v16, v60, v36, v16
v_fma_f32 v17, v61, v37, v17
v_fma_f32 v18, v62, v38, v18
v_fma_f32 v19, v63, v39, v19
v_cvt_pk_bf16_f32 v40, v16, v17
v_cvt_pk_bf16_f32 v41, v18, v19
buffer_store_dwordx2 v[40:41], v11, s[40:43], s63 offen
ds_read_b128 v[16:19], v8 offset:4096
ds_read_b128 v[20:23], v8 offset:32768
ds_read_b128 v[24:27], v10 offset:4096
ds_read_b128 v[28:31], v10 offset:32768
s_waitcnt lgkmcnt(0)
v_pk_add_f32 v[16:17], v[16:17], v[20:21]
v_pk_add_f32 v[24:25], v[24:25], v[28:29]
v_pk_add_f32 v[16:17], v[16:17], v[24:25]
v_pk_add_f32 v[18:19], v[18:19], v[22:23]
v_pk_add_f32 v[26:27], v[26:27], v[30:31]
v_pk_add_f32 v[18:19], v[18:19], v[26:27]
v_mul_f32 v20, s33, v16
v_mul_f32 v21, s33, v17
v_mul_f32 v22, s33, v18
v_mul_f32 v23, s33, v19
v_exp_f32 v20, v20
v_exp_f32 v21, v21
v_exp_f32 v22, v22
v_exp_f32 v23, v23
s_nop 0
v_add_f32 v20, 1.0, v20
v_add_f32 v21, 1.0, v21
v_add_f32 v22, 1.0, v22
v_add_f32 v23, 1.0, v23
v_rcp_f32 v20, v20
v_rcp_f32 v21, v21
v_rcp_f32 v22, v22
v_rcp_f32 v23, v23
s_nop 0
v_mul_f32 v36, v16, v20
v_mul_f32 v37, v17, v21
v_mul_f32 v38, v18, v22
v_mul_f32 v39, v19, v23
v_lshlrev_b32 v16, 16, v88
v_and_b32 v17, 0xffff0000, v88
v_lshlrev_b32 v18, 16, v89
v_and_b32 v19, 0xffff0000, v89
v_fma_f32 v16, v64, v36, v16
v_fma_f32 v17, v65, v37, v17
v_fma_f32 v18, v66, v38, v18
v_fma_f32 v19, v67, v39, v19
v_cvt_pk_bf16_f32 v40, v16, v17
v_cvt_pk_bf16_f32 v41, v18, v19
buffer_store_dwordx2 v[40:41], v11, s[40:43], s64 offen
ds_read_b128 v[16:19], v8 offset:5120
ds_read_b128 v[20:23], v8 offset:33792
ds_read_b128 v[24:27], v10 offset:5120
ds_read_b128 v[28:31], v10 offset:33792
s_waitcnt lgkmcnt(0)
v_pk_add_f32 v[16:17], v[16:17], v[20:21]
v_pk_add_f32 v[24:25], v[24:25], v[28:29]
v_pk_add_f32 v[16:17], v[16:17], v[24:25]
v_pk_add_f32 v[18:19], v[18:19], v[22:23]
v_pk_add_f32 v[26:27], v[26:27], v[30:31]
v_pk_add_f32 v[18:19], v[18:19], v[26:27]
v_mul_f32 v20, s33, v16
v_mul_f32 v21, s33, v17
v_mul_f32 v22, s33, v18
v_mul_f32 v23, s33, v19
v_exp_f32 v20, v20
v_exp_f32 v21, v21
v_exp_f32 v22, v22
v_exp_f32 v23, v23
s_nop 0
v_add_f32 v20, 1.0, v20
v_add_f32 v21, 1.0, v21
v_add_f32 v22, 1.0, v22
v_add_f32 v23, 1.0, v23
v_rcp_f32 v20, v20
v_rcp_f32 v21, v21
v_rcp_f32 v22, v22
v_rcp_f32 v23, v23
s_nop 0
v_mul_f32 v36, v16, v20
v_mul_f32 v37, v17, v21
v_mul_f32 v38, v18, v22
v_mul_f32 v39, v19, v23
v_lshlrev_b32 v16, 16, v90
v_and_b32 v17, 0xffff0000, v90
v_lshlrev_b32 v18, 16, v91
v_and_b32 v19, 0xffff0000, v91
v_fma_f32 v16, v68, v36, v16
v_fma_f32 v17, v69, v37, v17
v_fma_f32 v18, v70, v38, v18
v_fma_f32 v19, v71, v39, v19
v_cvt_pk_bf16_f32 v40, v16, v17
v_cvt_pk_bf16_f32 v41, v18, v19
buffer_store_dwordx2 v[40:41], v11, s[40:43], s65 offen
ds_read_b128 v[16:19], v8 offset:6144
ds_read_b128 v[20:23], v8 offset:34816
ds_read_b128 v[24:27], v10 offset:6144
ds_read_b128 v[28:31], v10 offset:34816
s_waitcnt lgkmcnt(0)
v_pk_add_f32 v[16:17], v[16:17], v[20:21]
v_pk_add_f32 v[24:25], v[24:25], v[28:29]
v_pk_add_f32 v[16:17], v[16:17], v[24:25]
v_pk_add_f32 v[18:19], v[18:19], v[22:23]
v_pk_add_f32 v[26:27], v[26:27], v[30:31]
v_pk_add_f32 v[18:19], v[18:19], v[26:27]
v_mul_f32 v20, s33, v16
v_mul_f32 v21, s33, v17
v_mul_f32 v22, s33, v18
v_mul_f32 v23, s33, v19
v_exp_f32 v20, v20
v_exp_f32 v21, v21
v_exp_f32 v22, v22
v_exp_f32 v23, v23
s_nop 0
v_add_f32 v20, 1.0, v20
v_add_f32 v21, 1.0, v21
v_add_f32 v22, 1.0, v22
v_add_f32 v23, 1.0, v23
v_rcp_f32 v20, v20
v_rcp_f32 v21, v21
v_rcp_f32 v22, v22
v_rcp_f32 v23, v23
s_nop 0
v_mul_f32 v36, v16, v20
v_mul_f32 v37, v17, v21
v_mul_f32 v38, v18, v22
v_mul_f32 v39, v19, v23
v_lshlrev_b32 v16, 16, v92
v_and_b32 v17, 0xffff0000, v92
v_lshlrev_b32 v18, 16, v93
v_and_b32 v19, 0xffff0000, v93
v_fma_f32 v16, v72, v36, v16
v_fma_f32 v17, v73, v37, v17
v_fma_f32 v18, v74, v38, v18
v_fma_f32 v19, v75, v39, v19
v_cvt_pk_bf16_f32 v40, v16, v17
v_cvt_pk_bf16_f32 v41, v18, v19
buffer_store_dwordx2 v[40:41], v11, s[40:43], s66 offen
s_branch FF_end_220
FF_late_219:
s_barrier
ds_write_b128 v7, a[0:3] offset:0
ds_write_b128 v7, a[4:7] offset:1024
ds_write_b128 v7, a[8:11] offset:2048
ds_write_b128 v7, a[12:15] offset:3072
ds_write_b128 v7, a[16:19] offset:4096
ds_write_b128 v7, a[20:23] offset:5120
ds_write_b128 v7, a[24:27] offset:6144
ds_write_b128 v7, a[28:31] offset:7168
ds_write_b128 v7, a[32:35] offset:8192
ds_write_b128 v7, a[36:39] offset:9216
ds_write_b128 v7, a[40:43] offset:10240
ds_write_b128 v7, a[44:47] offset:11264
ds_write_b128 v7, a[48:51] offset:12288
ds_write_b128 v7, a[52:55] offset:13312
ds_write_b128 v7, a[56:59] offset:14336
ds_write_b128 v7, a[60:63] offset:15360
ds_write_b128 v7, a[64:67] offset:16384
ds_write_b128 v7, a[68:71] offset:17408
ds_write_b128 v7, a[72:75] offset:18432
ds_write_b128 v7, a[76:79] offset:19456
ds_write_b128 v7, a[80:83] offset:20480
ds_write_b128 v7, a[84:87] offset:21504
ds_write_b128 v7, a[88:91] offset:22528
ds_write_b128 v7, a[92:95] offset:23552
ds_write_b128 v7, a[96:99] offset:24576
ds_write_b128 v7, a[100:103] offset:25600
ds_write_b128 v7, a[104:107] offset:26624
ds_write_b128 v7, a[108:111] offset:27648
s_waitcnt lgkmcnt(0)
s_barrier
ds_read_b128 v[16:19], v8 offset:0
ds_read_b128 v[20:23], v8 offset:28672
ds_read_b128 v[24:27], v10 offset:0
ds_read_b128 v[28:31], v10 offset:28672
s_waitcnt lgkmcnt(0)
v_pk_add_f32 v[16:17], v[16:17], v[20:21]
v_pk_add_f32 v[24:25], v[24:25], v[28:29]
v_pk_add_f32 v[16:17], v[16:17], v[24:25]
v_pk_add_f32 v[18:19], v[18:19], v[22:23]
v_pk_add_f32 v[26:27], v[26:27], v[30:31]
v_pk_add_f32 v[18:19], v[18:19], v[26:27]
v_mul_f32 v20, s33, v16
v_mul_f32 v21, s33, v17
v_mul_f32 v22, s33, v18
v_mul_f32 v23, s33, v19
v_exp_f32 v20, v20
v_exp_f32 v21, v21
v_exp_f32 v22, v22
v_exp_f32 v23, v23
s_nop 0
v_add_f32 v20, 1.0, v20
v_add_f32 v21, 1.0, v21
v_add_f32 v22, 1.0, v22
v_add_f32 v23, 1.0, v23
v_rcp_f32 v20, v20
v_rcp_f32 v21, v21
v_rcp_f32 v22, v22
v_rcp_f32 v23, v23
s_nop 0
v_mul_f32 v36, v16, v20
v_mul_f32 v37, v17, v21
v_mul_f32 v38, v18, v22
v_mul_f32 v39, v19, v23
s_add_u32 s17, s25, 0
buffer_store_dwordx4 v[36:39], v1, s[8:11], s17 offen offset:0 sc1
s_nop 1
ds_read_b128 v[16:19], v8 offset:1024
ds_read_b128 v[20:23], v8 offset:29696
ds_read_b128 v[24:27], v10 offset:1024
ds_read_b128 v[28:31], v10 offset:29696
s_waitcnt lgkmcnt(0)
v_pk_add_f32 v[16:17], v[16:17], v[20:21]
v_pk_add_f32 v[24:25], v[24:25], v[28:29]
v_pk_add_f32 v[16:17], v[16:17], v[24:25]
v_pk_add_f32 v[18:19], v[18:19], v[22:23]
v_pk_add_f32 v[26:27], v[26:27], v[30:31]
v_pk_add_f32 v[18:19], v[18:19], v[26:27]
v_mul_f32 v20, s33, v16
v_mul_f32 v21, s33, v17
v_mul_f32 v22, s33, v18
v_mul_f32 v23, s33, v19
v_exp_f32 v20, v20
v_exp_f32 v21, v21
v_exp_f32 v22, v22
v_exp_f32 v23, v23
s_nop 0
v_add_f32 v20, 1.0, v20
v_add_f32 v21, 1.0, v21
v_add_f32 v22, 1.0, v22
v_add_f32 v23, 1.0, v23
v_rcp_f32 v20, v20
v_rcp_f32 v21, v21
v_rcp_f32 v22, v22
v_rcp_f32 v23, v23
s_nop 0
v_mul_f32 v36, v16, v20
v_mul_f32 v37, v17, v21
v_mul_f32 v38, v18, v22
v_mul_f32 v39, v19, v23
s_add_u32 s17, s25, 0
buffer_store_dwordx4 v[36:39], v1, s[8:11], s17 offen offset:1024 sc1
s_nop 1
ds_read_b128 v[16:19], v8 offset:2048
ds_read_b128 v[20:23], v8 offset:30720
ds_read_b128 v[24:27], v10 offset:2048
ds_read_b128 v[28:31], v10 offset:30720
s_waitcnt lgkmcnt(0)
v_pk_add_f32 v[16:17], v[16:17], v[20:21]
v_pk_add_f32 v[24:25], v[24:25], v[28:29]
v_pk_add_f32 v[16:17], v[16:17], v[24:25]
v_pk_add_f32 v[18:19], v[18:19], v[22:23]
v_pk_add_f32 v[26:27], v[26:27], v[30:31]
v_pk_add_f32 v[18:19], v[18:19], v[26:27]
v_mul_f32 v20, s33, v16
v_mul_f32 v21, s33, v17
v_mul_f32 v22, s33, v18
v_mul_f32 v23, s33, v19
v_exp_f32 v20, v20
v_exp_f32 v21, v21
v_exp_f32 v22, v22
v_exp_f32 v23, v23
s_nop 0
v_add_f32 v20, 1.0, v20
v_add_f32 v21, 1.0, v21
v_add_f32 v22, 1.0, v22
v_add_f32 v23, 1.0, v23
v_rcp_f32 v20, v20
v_rcp_f32 v21, v21
v_rcp_f32 v22, v22
v_rcp_f32 v23, v23
s_nop 0
v_mul_f32 v36, v16, v20
v_mul_f32 v37, v17, v21
v_mul_f32 v38, v18, v22
v_mul_f32 v39, v19, v23
s_add_u32 s17, s25, 0
buffer_store_dwordx4 v[36:39], v1, s[8:11], s17 offen offset:2048 sc1
s_nop 1
ds_read_b128 v[16:19], v8 offset:3072
ds_read_b128 v[20:23], v8 offset:31744
ds_read_b128 v[24:27], v10 offset:3072
ds_read_b128 v[28:31], v10 offset:31744
s_waitcnt lgkmcnt(0)
v_pk_add_f32 v[16:17], v[16:17], v[20:21]
v_pk_add_f32 v[24:25], v[24:25], v[28:29]
v_pk_add_f32 v[16:17], v[16:17], v[24:25]
v_pk_add_f32 v[18:19], v[18:19], v[22:23]
v_pk_add_f32 v[26:27], v[26:27], v[30:31]
v_pk_add_f32 v[18:19], v[18:19], v[26:27]
v_mul_f32 v20, s33, v16
v_mul_f32 v21, s33, v17
v_mul_f32 v22, s33, v18
v_mul_f32 v23, s33, v19
v_exp_f32 v20, v20
v_exp_f32 v21, v21
v_exp_f32 v22, v22
v_exp_f32 v23, v23
s_nop 0
v_add_f32 v20, 1.0, v20
v_add_f32 v21, 1.0, v21
v_add_f32 v22, 1.0, v22
v_add_f32 v23, 1.0, v23
v_rcp_f32 v20, v20
v_rcp_f32 v21, v21
v_rcp_f32 v22, v22
v_rcp_f32 v23, v23
s_nop 0
v_mul_f32 v36, v16, v20
v_mul_f32 v37, v17, v21
v_mul_f32 v38, v18, v22
v_mul_f32 v39, v19, v23
s_add_u32 s17, s25, 0
buffer_store_dwordx4 v[36:39], v1, s[8:11], s17 offen offset:3072 sc1
s_nop 1
ds_read_b128 v[16:19], v8 offset:4096
ds_read_b128 v[20:23], v8 offset:32768
ds_read_b128 v[24:27], v10 offset:4096
ds_read_b128 v[28:31], v10 offset:32768
s_waitcnt lgkmcnt(0)
v_pk_add_f32 v[16:17], v[16:17], v[20:21]
v_pk_add_f32 v[24:25], v[24:25], v[28:29]
v_pk_add_f32 v[16:17], v[16:17], v[24:25]
v_pk_add_f32 v[18:19], v[18:19], v[22:23]
v_pk_add_f32 v[26:27], v[26:27], v[30:31]
v_pk_add_f32 v[18:19], v[18:19], v[26:27]
v_mul_f32 v20, s33, v16
v_mul_f32 v21, s33, v17
v_mul_f32 v22, s33, v18
v_mul_f32 v23, s33, v19
v_exp_f32 v20, v20
v_exp_f32 v21, v21
v_exp_f32 v22, v22
v_exp_f32 v23, v23
s_nop 0
v_add_f32 v20, 1.0, v20
v_add_f32 v21, 1.0, v21
v_add_f32 v22, 1.0, v22
v_add_f32 v23, 1.0, v23
v_rcp_f32 v20, v20
v_rcp_f32 v21, v21
v_rcp_f32 v22, v22
v_rcp_f32 v23, v23
s_nop 0
v_mul_f32 v36, v16, v20
v_mul_f32 v37, v17, v21
v_mul_f32 v38, v18, v22
v_mul_f32 v39, v19, v23
s_add_u32 s17, s25, 4096
buffer_store_dwordx4 v[36:39], v1, s[8:11], s17 offen offset:0 sc1
s_nop 1
ds_read_b128 v[16:19], v8 offset:5120
ds_read_b128 v[20:23], v8 offset:33792
ds_read_b128 v[24:27], v10 offset:5120
ds_read_b128 v[28:31], v10 offset:33792
s_waitcnt lgkmcnt(0)
v_pk_add_f32 v[16:17], v[16:17], v[20:21]
v_pk_add_f32 v[24:25], v[24:25], v[28:29]
v_pk_add_f32 v[16:17], v[16:17], v[24:25]
v_pk_add_f32 v[18:19], v[18:19], v[22:23]
v_pk_add_f32 v[26:27], v[26:27], v[30:31]
v_pk_add_f32 v[18:19], v[18:19], v[26:27]
v_mul_f32 v20, s33, v16
v_mul_f32 v21, s33, v17
v_mul_f32 v22, s33, v18
v_mul_f32 v23, s33, v19
v_exp_f32 v20, v20
v_exp_f32 v21, v21
v_exp_f32 v22, v22
v_exp_f32 v23, v23
s_nop 0
v_add_f32 v20, 1.0, v20
v_add_f32 v21, 1.0, v21
v_add_f32 v22, 1.0, v22
v_add_f32 v23, 1.0, v23
v_rcp_f32 v20, v20
v_rcp_f32 v21, v21
v_rcp_f32 v22, v22
v_rcp_f32 v23, v23
s_nop 0
v_mul_f32 v36, v16, v20
v_mul_f32 v37, v17, v21
v_mul_f32 v38, v18, v22
v_mul_f32 v39, v19, v23
s_add_u32 s17, s25, 4096
buffer_store_dwordx4 v[36:39], v1, s[8:11], s17 offen offset:1024 sc1
s_nop 1
ds_read_b128 v[16:19], v8 offset:6144
ds_read_b128 v[20:23], v8 offset:34816
ds_read_b128 v[24:27], v10 offset:6144
ds_read_b128 v[28:31], v10 offset:34816
s_waitcnt lgkmcnt(0)
v_pk_add_f32 v[16:17], v[16:17], v[20:21]
v_pk_add_f32 v[24:25], v[24:25], v[28:29]
v_pk_add_f32 v[16:17], v[16:17], v[24:25]
v_pk_add_f32 v[18:19], v[18:19], v[22:23]
v_pk_add_f32 v[26:27], v[26:27], v[30:31]
v_pk_add_f32 v[18:19], v[18:19], v[26:27]
v_mul_f32 v20, s33, v16
v_mul_f32 v21, s33, v17
v_mul_f32 v22, s33, v18
v_mul_f32 v23, s33, v19
v_exp_f32 v20, v20
v_exp_f32 v21, v21
v_exp_f32 v22, v22
v_exp_f32 v23, v23
s_nop 0
v_add_f32 v20, 1.0, v20
v_add_f32 v21, 1.0, v21
v_add_f32 v22, 1.0, v22
v_add_f32 v23, 1.0, v23
v_rcp_f32 v20, v20
v_rcp_f32 v21, v21
v_rcp_f32 v22, v22
v_rcp_f32 v23, v23
s_nop 0
v_mul_f32 v36, v16, v20
v_mul_f32 v37, v17, v21
v_mul_f32 v38, v18, v22
v_mul_f32 v39, v19, v23
s_add_u32 s17, s25, 4096
buffer_store_dwordx4 v[36:39], v1, s[8:11], s17 offen offset:2048 sc1
s_nop 1
s_barrier
ds_write_b128 v7, a[112:115] offset:0
ds_write_b128 v7, a[116:119] offset:1024
ds_write_b128 v7, a[120:123] offset:2048
ds_write_b128 v7, a[124:127] offset:3072
ds_write_b128 v7, a[128:131] offset:4096
ds_write_b128 v7, a[132:135] offset:5120
ds_write_b128 v7, a[136:139] offset:6144
ds_write_b128 v7, a[140:143] offset:7168
ds_write_b128 v7, a[144:147] offset:8192
ds_write_b128 v7, a[148:151] offset:9216
ds_write_b128 v7, a[152:155] offset:10240
ds_write_b128 v7, a[156:159] offset:11264
ds_write_b128 v7, a[160:163] offset:12288
ds_write_b128 v7, a[164:167] offset:13312
ds_write_b128 v7, a[168:171] offset:14336
ds_write_b128 v7, a[172:175] offset:15360
ds_write_b128 v7, a[176:179] offset:16384
ds_write_b128 v7, a[180:183] offset:17408
ds_write_b128 v7, a[184:187] offset:18432
ds_write_b128 v7, a[188:191] offset:19456
ds_write_b128 v7, a[192:195] offset:20480
ds_write_b128 v7, a[196:199] offset:21504
ds_write_b128 v7, a[200:203] offset:22528
ds_write_b128 v7, a[204:207] offset:23552
ds_write_b128 v7, a[208:211] offset:24576
ds_write_b128 v7, a[212:215] offset:25600
ds_write_b128 v7, a[216:219] offset:26624
ds_write_b128 v7, a[220:223] offset:27648
s_waitcnt lgkmcnt(0)
s_barrier
ds_read_b128 v[16:19], v8 offset:0
ds_read_b128 v[20:23], v8 offset:28672
ds_read_b128 v[24:27], v10 offset:0
ds_read_b128 v[28:31], v10 offset:28672
s_waitcnt lgkmcnt(0)
v_pk_add_f32 v[16:17], v[16:17], v[20:21]
v_pk_add_f32 v[24:25], v[24:25], v[28:29]
v_pk_add_f32 v[16:17], v[16:17], v[24:25]
v_pk_add_f32 v[18:19], v[18:19], v[22:23]
v_pk_add_f32 v[26:27], v[26:27], v[30:31]
v_pk_add_f32 v[18:19], v[18:19], v[26:27]
v_mul_f32 v20, s33, v16
v_mul_f32 v21, s33, v17
v_mul_f32 v22, s33, v18
v_mul_f32 v23, s33, v19
v_exp_f32 v20, v20
v_exp_f32 v21, v21
v_exp_f32 v22, v22
v_exp_f32 v23, v23
s_nop 0
v_add_f32 v20, 1.0, v20
v_add_f32 v21, 1.0, v21
v_add_f32 v22, 1.0, v22
v_add_f32 v23, 1.0, v23
v_rcp_f32 v20, v20
v_rcp_f32 v21, v21
v_rcp_f32 v22, v22
v_rcp_f32 v23, v23
s_nop 0
v_mul_f32 v36, v16, v20
v_mul_f32 v37, v17, v21
v_mul_f32 v38, v18, v22
v_mul_f32 v39, v19, v23
s_add_u32 s17, s25, 28672
buffer_store_dwordx4 v[36:39], v1, s[8:11], s17 offen offset:0 sc1
s_nop 1
ds_read_b128 v[16:19], v8 offset:1024
ds_read_b128 v[20:23], v8 offset:29696
ds_read_b128 v[24:27], v10 offset:1024
ds_read_b128 v[28:31], v10 offset:29696
s_waitcnt lgkmcnt(0)
v_pk_add_f32 v[16:17], v[16:17], v[20:21]
v_pk_add_f32 v[24:25], v[24:25], v[28:29]
v_pk_add_f32 v[16:17], v[16:17], v[24:25]
v_pk_add_f32 v[18:19], v[18:19], v[22:23]
v_pk_add_f32 v[26:27], v[26:27], v[30:31]
v_pk_add_f32 v[18:19], v[18:19], v[26:27]
v_mul_f32 v20, s33, v16
v_mul_f32 v21, s33, v17
v_mul_f32 v22, s33, v18
v_mul_f32 v23, s33, v19
v_exp_f32 v20, v20
v_exp_f32 v21, v21
v_exp_f32 v22, v22
v_exp_f32 v23, v23
s_nop 0
v_add_f32 v20, 1.0, v20
v_add_f32 v21, 1.0, v21
v_add_f32 v22, 1.0, v22
v_add_f32 v23, 1.0, v23
v_rcp_f32 v20, v20
v_rcp_f32 v21, v21
v_rcp_f32 v22, v22
v_rcp_f32 v23, v23
s_nop 0
v_mul_f32 v36, v16, v20
v_mul_f32 v37, v17, v21
v_mul_f32 v38, v18, v22
v_mul_f32 v39, v19, v23
s_add_u32 s17, s25, 28672
buffer_store_dwordx4 v[36:39], v1, s[8:11], s17 offen offset:1024 sc1
s_nop 1
ds_read_b128 v[16:19], v8 offset:2048
ds_read_b128 v[20:23], v8 offset:30720
ds_read_b128 v[24:27], v10 offset:2048
ds_read_b128 v[28:31], v10 offset:30720
s_waitcnt lgkmcnt(0)
v_pk_add_f32 v[16:17], v[16:17], v[20:21]
v_pk_add_f32 v[24:25], v[24:25], v[28:29]
v_pk_add_f32 v[16:17], v[16:17], v[24:25]
v_pk_add_f32 v[18:19], v[18:19], v[22:23]
v_pk_add_f32 v[26:27], v[26:27], v[30:31]
v_pk_add_f32 v[18:19], v[18:19], v[26:27]
v_mul_f32 v20, s33, v16
v_mul_f32 v21, s33, v17
v_mul_f32 v22, s33, v18
v_mul_f32 v23, s33, v19
v_exp_f32 v20, v20
v_exp_f32 v21, v21
v_exp_f32 v22, v22
v_exp_f32 v23, v23
s_nop 0
v_add_f32 v20, 1.0, v20
v_add_f32 v21, 1.0, v21
v_add_f32 v22, 1.0, v22
v_add_f32 v23, 1.0, v23
v_rcp_f32 v20, v20
v_rcp_f32 v21, v21
v_rcp_f32 v22, v22
v_rcp_f32 v23, v23
s_nop 0
v_mul_f32 v36, v16, v20
v_mul_f32 v37, v17, v21
v_mul_f32 v38, v18, v22
v_mul_f32 v39, v19, v23
s_add_u32 s17, s25, 28672
buffer_store_dwordx4 v[36:39], v1, s[8:11], s17 offen offset:2048 sc1
s_nop 1
ds_read_b128 v[16:19], v8 offset:3072
ds_read_b128 v[20:23], v8 offset:31744
ds_read_b128 v[24:27], v10 offset:3072
ds_read_b128 v[28:31], v10 offset:31744
s_waitcnt lgkmcnt(0)
v_pk_add_f32 v[16:17], v[16:17], v[20:21]
v_pk_add_f32 v[24:25], v[24:25], v[28:29]
v_pk_add_f32 v[16:17], v[16:17], v[24:25]
v_pk_add_f32 v[18:19], v[18:19], v[22:23]
v_pk_add_f32 v[26:27], v[26:27], v[30:31]
v_pk_add_f32 v[18:19], v[18:19], v[26:27]
v_mul_f32 v20, s33, v16
v_mul_f32 v21, s33, v17
v_mul_f32 v22, s33, v18
v_mul_f32 v23, s33, v19
v_exp_f32 v20, v20
v_exp_f32 v21, v21
v_exp_f32 v22, v22
v_exp_f32 v23, v23
s_nop 0
v_add_f32 v20, 1.0, v20
v_add_f32 v21, 1.0, v21
v_add_f32 v22, 1.0, v22
v_add_f32 v23, 1.0, v23
v_rcp_f32 v20, v20
v_rcp_f32 v21, v21
v_rcp_f32 v22, v22
v_rcp_f32 v23, v23
s_nop 0
v_mul_f32 v36, v16, v20
v_mul_f32 v37, v17, v21
v_mul_f32 v38, v18, v22
v_mul_f32 v39, v19, v23
s_add_u32 s17, s25, 28672
buffer_store_dwordx4 v[36:39], v1, s[8:11], s17 offen offset:3072 sc1
s_nop 1
ds_read_b128 v[16:19], v8 offset:4096
ds_read_b128 v[20:23], v8 offset:32768
ds_read_b128 v[24:27], v10 offset:4096
ds_read_b128 v[28:31], v10 offset:32768
s_waitcnt lgkmcnt(0)
v_pk_add_f32 v[16:17], v[16:17], v[20:21]
v_pk_add_f32 v[24:25], v[24:25], v[28:29]
v_pk_add_f32 v[16:17], v[16:17], v[24:25]
v_pk_add_f32 v[18:19], v[18:19], v[22:23]
v_pk_add_f32 v[26:27], v[26:27], v[30:31]
v_pk_add_f32 v[18:19], v[18:19], v[26:27]
v_mul_f32 v20, s33, v16
v_mul_f32 v21, s33, v17
v_mul_f32 v22, s33, v18
v_mul_f32 v23, s33, v19
v_exp_f32 v20, v20
v_exp_f32 v21, v21
v_exp_f32 v22, v22
v_exp_f32 v23, v23
s_nop 0
v_add_f32 v20, 1.0, v20
v_add_f32 v21, 1.0, v21
v_add_f32 v22, 1.0, v22
v_add_f32 v23, 1.0, v23
v_rcp_f32 v20, v20
v_rcp_f32 v21, v21
v_rcp_f32 v22, v22
v_rcp_f32 v23, v23
s_nop 0
v_mul_f32 v36, v16, v20
v_mul_f32 v37, v17, v21
v_mul_f32 v38, v18, v22
v_mul_f32 v39, v19, v23
s_add_u32 s17, s25, 32768
buffer_store_dwordx4 v[36:39], v1, s[8:11], s17 offen offset:0 sc1
s_nop 1
ds_read_b128 v[16:19], v8 offset:5120
ds_read_b128 v[20:23], v8 offset:33792
ds_read_b128 v[24:27], v10 offset:5120
ds_read_b128 v[28:31], v10 offset:33792
s_waitcnt lgkmcnt(0)
v_pk_add_f32 v[16:17], v[16:17], v[20:21]
v_pk_add_f32 v[24:25], v[24:25], v[28:29]
v_pk_add_f32 v[16:17], v[16:17], v[24:25]
v_pk_add_f32 v[18:19], v[18:19], v[22:23]
v_pk_add_f32 v[26:27], v[26:27], v[30:31]
v_pk_add_f32 v[18:19], v[18:19], v[26:27]
v_mul_f32 v20, s33, v16
v_mul_f32 v21, s33, v17
v_mul_f32 v22, s33, v18
v_mul_f32 v23, s33, v19
v_exp_f32 v20, v20
v_exp_f32 v21, v21
v_exp_f32 v22, v22
v_exp_f32 v23, v23
s_nop 0
v_add_f32 v20, 1.0, v20
v_add_f32 v21, 1.0, v21
v_add_f32 v22, 1.0, v22
v_add_f32 v23, 1.0, v23
v_rcp_f32 v20, v20
v_rcp_f32 v21, v21
v_rcp_f32 v22, v22
v_rcp_f32 v23, v23
s_nop 0
v_mul_f32 v36, v16, v20
v_mul_f32 v37, v17, v21
v_mul_f32 v38, v18, v22
v_mul_f32 v39, v19, v23
s_add_u32 s17, s25, 32768
buffer_store_dwordx4 v[36:39], v1, s[8:11], s17 offen offset:1024 sc1
s_nop 1
ds_read_b128 v[16:19], v8 offset:6144
ds_read_b128 v[20:23], v8 offset:34816
ds_read_b128 v[24:27], v10 offset:6144
ds_read_b128 v[28:31], v10 offset:34816
s_waitcnt lgkmcnt(0)
v_pk_add_f32 v[16:17], v[16:17], v[20:21]
v_pk_add_f32 v[24:25], v[24:25], v[28:29]
v_pk_add_f32 v[16:17], v[16:17], v[24:25]
v_pk_add_f32 v[18:19], v[18:19], v[22:23]
v_pk_add_f32 v[26:27], v[26:27], v[30:31]
v_pk_add_f32 v[18:19], v[18:19], v[26:27]
v_mul_f32 v20, s33, v16
v_mul_f32 v21, s33, v17
v_mul_f32 v22, s33, v18
v_mul_f32 v23, s33, v19
v_exp_f32 v20, v20
v_exp_f32 v21, v21
v_exp_f32 v22, v22
v_exp_f32 v23, v23
s_nop 0
v_add_f32 v20, 1.0, v20
v_add_f32 v21, 1.0, v21
v_add_f32 v22, 1.0, v22
v_add_f32 v23, 1.0, v23
v_rcp_f32 v20, v20
v_rcp_f32 v21, v21
v_rcp_f32 v22, v22
v_rcp_f32 v23, v23
s_nop 0
v_mul_f32 v36, v16, v20
v_mul_f32 v37, v17, v21
v_mul_f32 v38, v18, v22
v_mul_f32 v39, v19, v23
s_add_u32 s17, s25, 32768
buffer_store_dwordx4 v[36:39], v1, s[8:11], s17 offen offset:2048 sc1
s_nop 1
s_waitcnt vmcnt(0)
s_barrier
s_cmp_lg_u32 s13, 0
s_cbranch_scc1 FF_gs_223
s_mov_b64 exec, 1
buffer_atomic_add v3, v2, s[8:11], s26 offen sc1
s_mov_b64 exec, -1
FF_gs_223:
FF_end_220:
s_waitcnt vmcnt(0)
s_endpgm
A_retry_45:
s_nop 7
A_rl_46:
s_add_u32 s25, s15, 4096
buffer_load_dwordx4 v[60:63], v1, s[8:11], s15 offen offset:0 sc1
buffer_load_dwordx4 v[64:67], v1, s[8:11], s15 offen offset:1024 sc1
buffer_load_dwordx4 v[68:71], v1, s[8:11], s15 offen offset:2048 sc1
buffer_load_dwordx4 v[72:75], v1, s[8:11], s15 offen offset:3072 sc1
buffer_load_dwordx4 v[76:79], v1, s[8:11], s25 offen offset:0 sc1
buffer_load_dwordx4 v[80:83], v1, s[8:11], s25 offen offset:1024 sc1
buffer_load_dwordx4 v[84:87], v1, s[8:11], s25 offen offset:2048 sc1
s_waitcnt vmcnt(0)
v_max3_u32 v10, v60, v61, v62
v_max3_u32 v10, v10, v63, v64
v_max3_u32 v10, v10, v65, v66
v_max3_u32 v10, v10, v67, v68
v_max3_u32 v10, v10, v69, v70
v_max3_u32 v10, v10, v71, v72
v_max3_u32 v10, v10, v73, v74
v_max3_u32 v10, v10, v75, v76
v_max3_u32 v10, v10, v77, v78
v_max3_u32 v10, v10, v79, v80
v_max3_u32 v10, v10, v81, v82
v_max3_u32 v10, v10, v83, v84
v_max3_u32 v10, v10, v85, v86
v_max_u32 v10, v10, v87
v_cmp_eq_u32 vcc, -1, v10
s_cbranch_vccz A_rok_47
s_sub_u32 s19, s19, 1
s_cbranch_scc0 A_rl_46
s_branch M_abort
A_rok_47:
v_mov_b64 v[20:21], 0
v_mov_b64 v[22:23], 0
v_mov_b64 v[24:25], 0
v_mov_b64 v[26:27], 0
v_mov_b64 v[28:29], 0
v_mov_b64 v[30:31], 0
v_mov_b64 v[32:33], 0
v_mov_b64 v[34:35], 0
ds_write_b128 v1, v[60:63] offset:27136
ds_write_b128 v1, v[64:67] offset:28160
s_nop 1
v_smfmac_f32_16x16x64_bf16 v[20:23], v[60:63], a[0:7], v9
v_smfmac_f32_16x16x64_bf16 v[24:27], v[60:63], a[56:63], v9
v_smfmac_f32_16x16x64_bf16 v[28:31], v[60:63], a[112:119], v9
v_smfmac_f32_16x16x64_bf16 v[32:35], v[60:63], a[168:175], v9
v_smfmac_f32_16x16x64_bf16 v[20:23], v[64:67], a[8:15], v9
v_smfmac_f32_16x16x64_bf16 v[24:27], v[64:67], a[64:71], v9
v_smfmac_f32_16x16x64_bf16 v[28:31], v[64:67], a[120:127], v9
v_smfmac_f32_16x16x64_bf16 v[32:35], v[64:67], a[176:183], v9
v_smfmac_f32_16x16x64_bf16 v[20:23], v[68:71], a[16:23], v9
v_smfmac_f32_16x16x64_bf16 v[24:27], v[68:71], a[72:79], v9
v_smfmac_f32_16x16x64_bf16 v[28:31], v[68:71], a[128:135], v9
v_smfmac_f32_16x16x64_bf16 v[32:35], v[68:71], a[184:191], v9
v_smfmac_f32_16x16x64_bf16 v[20:23], v[72:75], a[24:31], v9
v_smfmac_f32_16x16x64_bf16 v[24:27], v[72:75], a[80:87], v9
v_smfmac_f32_16x16x64_bf16 v[28:31], v[72:75], a[136:143], v9
v_smfmac_f32_16x16x64_bf16 v[32:35], v[72:75], a[192:199], v9
v_smfmac_f32_16x16x64_bf16 v[20:23], v[76:79], a[32:39], v9
v_smfmac_f32_16x16x64_bf16 v[24:27], v[76:79], a[88:95], v9
v_smfmac_f32_16x16x64_bf16 v[28:31], v[76:79], a[144:151], v9
v_smfmac_f32_16x16x64_bf16 v[32:35], v[76:79], a[200:207], v9
v_smfmac_f32_16x16x64_bf16 v[20:23], v[80:83], a[40:47], v9
v_smfmac_f32_16x16x64_bf16 v[24:27], v[80:83], a[96:103], v9
v_smfmac_f32_16x16x64_bf16 v[28:31], v[80:83], a[152:159], v9
v_smfmac_f32_16x16x64_bf16 v[32:35], v[80:83], a[208:215], v9
v_smfmac_f32_16x16x64_bf16 v[20:23], v[84:87], a[48:55], v9
v_smfmac_f32_16x16x64_bf16 v[24:27], v[84:87], a[104:111], v9
v_smfmac_f32_16x16x64_bf16 v[28:31], v[84:87], a[160:167], v9
v_smfmac_f32_16x16x64_bf16 v[32:35], v[84:87], a[216:223], v9
v_cvt_pk_bf16_f32 v16, v20, v21
s_branch A_again_44

A_retry_50:
s_nop 7
A_rl_51:
s_add_u32 s25, s15, 4096
buffer_load_dwordx4 v[60:63], v1, s[8:11], s15 offen offset:0 sc1
buffer_load_dwordx4 v[64:67], v1, s[8:11], s15 offen offset:1024 sc1
buffer_load_dwordx4 v[68:71], v1, s[8:11], s15 offen offset:2048 sc1
buffer_load_dwordx4 v[72:75], v1, s[8:11], s15 offen offset:3072 sc1
buffer_load_dwordx4 v[76:79], v1, s[8:11], s25 offen offset:0 sc1
buffer_load_dwordx4 v[80:83], v1, s[8:11], s25 offen offset:1024 sc1
buffer_load_dwordx4 v[84:87], v1, s[8:11], s25 offen offset:2048 sc1
s_waitcnt vmcnt(0)
v_max3_u32 v10, v60, v61, v62
v_max3_u32 v10, v10, v63, v64
v_max3_u32 v10, v10, v65, v66
v_max3_u32 v10, v10, v67, v68
v_max3_u32 v10, v10, v69, v70
v_max3_u32 v10, v10, v71, v72
v_max3_u32 v10, v10, v73, v74
v_max3_u32 v10, v10, v75, v76
v_max3_u32 v10, v10, v77, v78
v_max3_u32 v10, v10, v79, v80
v_max3_u32 v10, v10, v81, v82
v_max3_u32 v10, v10, v83, v84
v_max3_u32 v10, v10, v85, v86
v_max_u32 v10, v10, v87
v_cmp_eq_u32 vcc, -1, v10
s_cbranch_vccz A_rok_52
s_sub_u32 s19, s19, 1
s_cbranch_scc0 A_rl_51
s_branch M_abort
A_rok_52:
v_mov_b64 v[20:21], 0
v_mov_b64 v[22:23], 0
v_mov_b64 v[24:25], 0
v_mov_b64 v[26:27], 0
v_mov_b64 v[28:29], 0
v_mov_b64 v[30:31], 0
v_mov_b64 v[32:33], 0
v_mov_b64 v[34:35], 0
ds_write_b128 v1, v[64:67] offset:30208
ds_write_b128 v1, v[68:71] offset:31232
ds_write_b128 v1, v[72:75] offset:32256
s_nop 1
v_smfmac_f32_16x16x64_bf16 v[20:23], v[60:63], a[0:7], v9
v_smfmac_f32_16x16x64_bf16 v[24:27], v[60:63], a[56:63], v9
v_smfmac_f32_16x16x64_bf16 v[28:31], v[60:63], a[112:119], v9
v_smfmac_f32_16x16x64_bf16 v[32:35], v[60:63], a[168:175], v9
v_smfmac_f32_16x16x64_bf16 v[20:23], v[64:67], a[8:15], v9
v_smfmac_f32_16x16x64_bf16 v[24:27], v[64:67], a[64:71], v9
v_smfmac_f32_16x16x64_bf16 v[28:31], v[64:67], a[120:127], v9
v_smfmac_f32_16x16x64_bf16 v[32:35], v[64:67], a[176:183], v9
v_smfmac_f32_16x16x64_bf16 v[20:23], v[68:71], a[16:23], v9
v_smfmac_f32_16x16x64_bf16 v[24:27], v[68:71], a[72:79], v9
v_smfmac_f32_16x16x64_bf16 v[28:31], v[68:71], a[128:135], v9
v_smfmac_f32_16x16x64_bf16 v[32:35], v[68:71], a[184:191], v9
v_smfmac_f32_16x16x64_bf16 v[20:23], v[72:75], a[24:31], v9
v_smfmac_f32_16x16x64_bf16 v[24:27], v[72:75], a[80:87], v9
v_smfmac_f32_16x16x64_bf16 v[28:31], v[72:75], a[136:143], v9
v_smfmac_f32_16x16x64_bf16 v[32:35], v[72:75], a[192:199], v9
v_smfmac_f32_16x16x64_bf16 v[20:23], v[76:79], a[32:39], v9
v_smfmac_f32_16x16x64_bf16 v[24:27], v[76:79], a[88:95], v9
v_smfmac_f32_16x16x64_bf16 v[28:31], v[76:79], a[144:151], v9
v_smfmac_f32_16x16x64_bf16 v[32:35], v[76:79], a[200:207], v9
v_smfmac_f32_16x16x64_bf16 v[20:23], v[80:83], a[40:47], v9
v_smfmac_f32_16x16x64_bf16 v[24:27], v[80:83], a[96:103], v9
v_smfmac_f32_16x16x64_bf16 v[28:31], v[80:83], a[152:159], v9
v_smfmac_f32_16x16x64_bf16 v[32:35], v[80:83], a[208:215], v9
v_smfmac_f32_16x16x64_bf16 v[20:23], v[84:87], a[48:55], v9
v_smfmac_f32_16x16x64_bf16 v[24:27], v[84:87], a[104:111], v9
v_smfmac_f32_16x16x64_bf16 v[28:31], v[84:87], a[160:167], v9
v_smfmac_f32_16x16x64_bf16 v[32:35], v[84:87], a[216:223], v9
v_cvt_pk_bf16_f32 v16, v20, v21
s_branch A_again_49

A_retry_57:
s_nop 7
A_rl_58:
s_add_u32 s25, s15, 4096
buffer_load_dwordx4 v[60:63], v1, s[8:11], s15 offen offset:0 sc1
buffer_load_dwordx4 v[64:67], v1, s[8:11], s15 offen offset:1024 sc1
buffer_load_dwordx4 v[68:71], v1, s[8:11], s15 offen offset:2048 sc1
buffer_load_dwordx4 v[72:75], v1, s[8:11], s15 offen offset:3072 sc1
buffer_load_dwordx4 v[76:79], v1, s[8:11], s25 offen offset:0 sc1
buffer_load_dwordx4 v[80:83], v1, s[8:11], s25 offen offset:1024 sc1
buffer_load_dwordx4 v[84:87], v1, s[8:11], s25 offen offset:2048 sc1
s_waitcnt vmcnt(0)
v_max3_u32 v10, v60, v61, v62
v_max3_u32 v10, v10, v63, v64
v_max3_u32 v10, v10, v65, v66
v_max3_u32 v10, v10, v67, v68
v_max3_u32 v10, v10, v69, v70
v_max3_u32 v10, v10, v71, v72
v_max3_u32 v10, v10, v73, v74
v_max3_u32 v10, v10, v75, v76
v_max3_u32 v10, v10, v77, v78
v_max3_u32 v10, v10, v79, v80
v_max3_u32 v10, v10, v81, v82
v_max3_u32 v10, v10, v83, v84
v_max3_u32 v10, v10, v85, v86
v_max_u32 v10, v10, v87
v_cmp_eq_u32 vcc, -1, v10
s_cbranch_vccz A_rok_59
s_sub_u32 s19, s19, 1
s_cbranch_scc0 A_rl_58
s_branch M_abort
A_rok_59:
v_mov_b64 v[20:21], 0
v_mov_b64 v[22:23], 0
v_mov_b64 v[24:25], 0
v_mov_b64 v[26:27], 0
v_mov_b64 v[28:29], 0
v_mov_b64 v[30:31], 0
v_mov_b64 v[32:33], 0
v_mov_b64 v[34:35], 0
ds_write_b128 v1, v[72:75] offset:33280
ds_write_b128 v1, v[76:79] offset:34304
ds_write_b128 v1, v[80:83] offset:35328
s_nop 1
v_smfmac_f32_16x16x64_bf16 v[20:23], v[60:63], a[0:7], v9
v_smfmac_f32_16x16x64_bf16 v[24:27], v[60:63], a[56:63], v9
v_smfmac_f32_16x16x64_bf16 v[28:31], v[60:63], a[112:119], v9
v_smfmac_f32_16x16x64_bf16 v[32:35], v[60:63], a[168:175], v9
v_smfmac_f32_16x16x64_bf16 v[20:23], v[64:67], a[8:15], v9
v_smfmac_f32_16x16x64_bf16 v[24:27], v[64:67], a[64:71], v9
v_smfmac_f32_16x16x64_bf16 v[28:31], v[64:67], a[120:127], v9
v_smfmac_f32_16x16x64_bf16 v[32:35], v[64:67], a[176:183], v9
v_smfmac_f32_16x16x64_bf16 v[20:23], v[68:71], a[16:23], v9
v_smfmac_f32_16x16x64_bf16 v[24:27], v[68:71], a[72:79], v9
v_smfmac_f32_16x16x64_bf16 v[28:31], v[68:71], a[128:135], v9
v_smfmac_f32_16x16x64_bf16 v[32:35], v[68:71], a[184:191], v9
v_smfmac_f32_16x16x64_bf16 v[20:23], v[72:75], a[24:31], v9
v_smfmac_f32_16x16x64_bf16 v[24:27], v[72:75], a[80:87], v9
v_smfmac_f32_16x16x64_bf16 v[28:31], v[72:75], a[136:143], v9
v_smfmac_f32_16x16x64_bf16 v[32:35], v[72:75], a[192:199], v9
v_smfmac_f32_16x16x64_bf16 v[20:23], v[76:79], a[32:39], v9
v_smfmac_f32_16x16x64_bf16 v[24:27], v[76:79], a[88:95], v9
v_smfmac_f32_16x16x64_bf16 v[28:31], v[76:79], a[144:151], v9
v_smfmac_f32_16x16x64_bf16 v[32:35], v[76:79], a[200:207], v9
v_smfmac_f32_16x16x64_bf16 v[20:23], v[80:83], a[40:47], v9
v_smfmac_f32_16x16x64_bf16 v[24:27], v[80:83], a[96:103], v9
v_smfmac_f32_16x16x64_bf16 v[28:31], v[80:83], a[152:159], v9
v_smfmac_f32_16x16x64_bf16 v[32:35], v[80:83], a[208:215], v9
v_smfmac_f32_16x16x64_bf16 v[20:23], v[84:87], a[48:55], v9
v_smfmac_f32_16x16x64_bf16 v[24:27], v[84:87], a[104:111], v9
v_smfmac_f32_16x16x64_bf16 v[28:31], v[84:87], a[160:167], v9
v_smfmac_f32_16x16x64_bf16 v[32:35], v[84:87], a[216:223], v9
v_cvt_pk_bf16_f32 v16, v20, v21
s_branch A_again_56

A_retry_62:
s_nop 7
A_rl_63:
s_add_u32 s25, s15, 4096
buffer_load_dwordx4 v[60:63], v1, s[8:11], s15 offen offset:0 sc1
buffer_load_dwordx4 v[64:67], v1, s[8:11], s15 offen offset:1024 sc1
buffer_load_dwordx4 v[68:71], v1, s[8:11], s15 offen offset:2048 sc1
buffer_load_dwordx4 v[72:75], v1, s[8:11], s15 offen offset:3072 sc1
buffer_load_dwordx4 v[76:79], v1, s[8:11], s25 offen offset:0 sc1
buffer_load_dwordx4 v[80:83], v1, s[8:11], s25 offen offset:1024 sc1
buffer_load_dwordx4 v[84:87], v1, s[8:11], s25 offen offset:2048 sc1
s_waitcnt vmcnt(0)
v_max3_u32 v10, v60, v61, v62
v_max3_u32 v10, v10, v63, v64
v_max3_u32 v10, v10, v65, v66
v_max3_u32 v10, v10, v67, v68
v_max3_u32 v10, v10, v69, v70
v_max3_u32 v10, v10, v71, v72
v_max3_u32 v10, v10, v73, v74
v_max3_u32 v10, v10, v75, v76
v_max3_u32 v10, v10, v77, v78
v_max3_u32 v10, v10, v79, v80
v_max3_u32 v10, v10, v81, v82
v_max3_u32 v10, v10, v83, v84
v_max3_u32 v10, v10, v85, v86
v_max_u32 v10, v10, v87
v_cmp_eq_u32 vcc, -1, v10
s_cbranch_vccz A_rok_64
s_sub_u32 s19, s19, 1
s_cbranch_scc0 A_rl_63
s_branch M_abort
A_rok_64:
v_mov_b64 v[20:21], 0
v_mov_b64 v[22:23], 0
v_mov_b64 v[24:25], 0
v_mov_b64 v[26:27], 0
v_mov_b64 v[28:29], 0
v_mov_b64 v[30:31], 0
v_mov_b64 v[32:33], 0
v_mov_b64 v[34:35], 0
ds_write_b128 v1, v[80:83] offset:36352
ds_write_b128 v1, v[84:87] offset:37376
s_nop 1
v_smfmac_f32_16x16x64_bf16 v[20:23], v[60:63], a[0:7], v9
v_smfmac_f32_16x16x64_bf16 v[24:27], v[60:63], a[56:63], v9
v_smfmac_f32_16x16x64_bf16 v[28:31], v[60:63], a[112:119], v9
v_smfmac_f32_16x16x64_bf16 v[32:35], v[60:63], a[168:175], v9
v_smfmac_f32_16x16x64_bf16 v[20:23], v[64:67], a[8:15], v9
v_smfmac_f32_16x16x64_bf16 v[24:27], v[64:67], a[64:71], v9
v_smfmac_f32_16x16x64_bf16 v[28:31], v[64:67], a[120:127], v9
v_smfmac_f32_16x16x64_bf16 v[32:35], v[64:67], a[176:183], v9
v_smfmac_f32_16x16x64_bf16 v[20:23], v[68:71], a[16:23], v9
v_smfmac_f32_16x16x64_bf16 v[24:27], v[68:71], a[72:79], v9
v_smfmac_f32_16x16x64_bf16 v[28:31], v[68:71], a[128:135], v9
v_smfmac_f32_16x16x64_bf16 v[32:35], v[68:71], a[184:191], v9
v_smfmac_f32_16x16x64_bf16 v[20:23], v[72:75], a[24:31], v9
v_smfmac_f32_16x16x64_bf16 v[24:27], v[72:75], a[80:87], v9
v_smfmac_f32_16x16x64_bf16 v[28:31], v[72:75], a[136:143], v9
v_smfmac_f32_16x16x64_bf16 v[32:35], v[72:75], a[192:199], v9
v_smfmac_f32_16x16x64_bf16 v[20:23], v[76:79], a[32:39], v9
v_smfmac_f32_16x16x64_bf16 v[24:27], v[76:79], a[88:95], v9
v_smfmac_f32_16x16x64_bf16 v[28:31], v[76:79], a[144:151], v9
v_smfmac_f32_16x16x64_bf16 v[32:35], v[76:79], a[200:207], v9
v_smfmac_f32_16x16x64_bf16 v[20:23], v[80:83], a[40:47], v9
v_smfmac_f32_16x16x64_bf16 v[24:27], v[80:83], a[96:103], v9
v_smfmac_f32_16x16x64_bf16 v[28:31], v[80:83], a[152:159], v9
v_smfmac_f32_16x16x64_bf16 v[32:35], v[80:83], a[208:215], v9
v_smfmac_f32_16x16x64_bf16 v[20:23], v[84:87], a[48:55], v9
v_smfmac_f32_16x16x64_bf16 v[24:27], v[84:87], a[104:111], v9
v_smfmac_f32_16x16x64_bf16 v[28:31], v[84:87], a[160:167], v9
v_smfmac_f32_16x16x64_bf16 v[32:35], v[84:87], a[216:223], v9
v_cvt_pk_bf16_f32 v16, v20, v21
s_branch A_again_61

A_retry_71:
s_nop 7
A_rl_72:
s_add_u32 s25, s15, 4096
buffer_load_dwordx4 v[60:63], v1, s[8:11], s15 offen offset:0 sc1
buffer_load_dwordx4 v[64:67], v1, s[8:11], s15 offen offset:1024 sc1
buffer_load_dwordx4 v[68:71], v1, s[8:11], s15 offen offset:2048 sc1
buffer_load_dwordx4 v[72:75], v1, s[8:11], s15 offen offset:3072 sc1
buffer_load_dwordx4 v[76:79], v1, s[8:11], s25 offen offset:0 sc1
buffer_load_dwordx4 v[80:83], v1, s[8:11], s25 offen offset:1024 sc1
buffer_load_dwordx4 v[84:87], v1, s[8:11], s25 offen offset:2048 sc1
s_waitcnt vmcnt(0)
v_max3_u32 v10, v60, v61, v62
v_max3_u32 v10, v10, v63, v64
v_max3_u32 v10, v10, v65, v66
v_max3_u32 v10, v10, v67, v68
v_max3_u32 v10, v10, v69, v70
v_max3_u32 v10, v10, v71, v72
v_max3_u32 v10, v10, v73, v74
v_max3_u32 v10, v10, v75, v76
v_max3_u32 v10, v10, v77, v78
v_max3_u32 v10, v10, v79, v80
v_max3_u32 v10, v10, v81, v82
v_max3_u32 v10, v10, v83, v84
v_max3_u32 v10, v10, v85, v86
v_max_u32 v10, v10, v87
v_cmp_eq_u32 vcc, -1, v10
s_cbranch_vccz A_rok_73
s_sub_u32 s19, s19, 1
s_cbranch_scc0 A_rl_72
s_branch M_abort
A_rok_73:
v_mov_b64 v[20:21], 0
v_mov_b64 v[22:23], 0
v_mov_b64 v[24:25], 0
v_mov_b64 v[26:27], 0
v_mov_b64 v[28:29], 0
v_mov_b64 v[30:31], 0
v_mov_b64 v[32:33], 0
v_mov_b64 v[34:35], 0
ds_write_b128 v1, v[60:63] offset:27136
ds_write_b128 v1, v[64:67] offset:28160
s_nop 1
v_smfmac_f32_16x16x64_bf16 v[20:23], v[60:63], a[0:7], v9
v_smfmac_f32_16x16x64_bf16 v[24:27], v[60:63], a[56:63], v9
v_smfmac_f32_16x16x64_bf16 v[28:31], v[60:63], a[112:119], v9
v_smfmac_f32_16x16x64_bf16 v[32:35], v[60:63], a[168:175], v9
v_smfmac_f32_16x16x64_bf16 v[20:23], v[64:67], a[8:15], v9
v_smfmac_f32_16x16x64_bf16 v[24:27], v[64:67], a[64:71], v9
v_smfmac_f32_16x16x64_bf16 v[28:31], v[64:67], a[120:127], v9
v_smfmac_f32_16x16x64_bf16 v[32:35], v[64:67], a[176:183], v9
v_smfmac_f32_16x16x64_bf16 v[20:23], v[68:71], a[16:23], v9
v_smfmac_f32_16x16x64_bf16 v[24:27], v[68:71], a[72:79], v9
v_smfmac_f32_16x16x64_bf16 v[28:31], v[68:71], a[128:135], v9
v_smfmac_f32_16x16x64_bf16 v[32:35], v[68:71], a[184:191], v9
v_smfmac_f32_16x16x64_bf16 v[20:23], v[72:75], a[24:31], v9
v_smfmac_f32_16x16x64_bf16 v[24:27], v[72:75], a[80:87], v9
v_smfmac_f32_16x16x64_bf16 v[28:31], v[72:75], a[136:143], v9
v_smfmac_f32_16x16x64_bf16 v[32:35], v[72:75], a[192:199], v9
v_smfmac_f32_16x16x64_bf16 v[20:23], v[76:79], a[32:39], v9
v_smfmac_f32_16x16x64_bf16 v[24:27], v[76:79], a[88:95], v9
v_smfmac_f32_16x16x64_bf16 v[28:31], v[76:79], a[144:151], v9
v_smfmac_f32_16x16x64_bf16 v[32:35], v[76:79], a[200:207], v9
v_smfmac_f32_16x16x64_bf16 v[20:23], v[80:83], a[40:47], v9
v_smfmac_f32_16x16x64_bf16 v[24:27], v[80:83], a[96:103], v9
v_smfmac_f32_16x16x64_bf16 v[28:31], v[80:83], a[152:159], v9
v_smfmac_f32_16x16x64_bf16 v[32:35], v[80:83], a[208:215], v9
v_smfmac_f32_16x16x64_bf16 v[20:23], v[84:87], a[48:55], v9
v_smfmac_f32_16x16x64_bf16 v[24:27], v[84:87], a[104:111], v9
v_smfmac_f32_16x16x64_bf16 v[28:31], v[84:87], a[160:167], v9
v_smfmac_f32_16x16x64_bf16 v[32:35], v[84:87], a[216:223], v9
v_cvt_pk_bf16_f32 v16, v20, v21
s_branch A_again_70

A_retry_76:
s_nop 7
A_rl_77:
s_add_u32 s25, s15, 4096
buffer_load_dwordx4 v[60:63], v1, s[8:11], s15 offen offset:0 sc1
buffer_load_dwordx4 v[64:67], v1, s[8:11], s15 offen offset:1024 sc1
buffer_load_dwordx4 v[68:71], v1, s[8:11], s15 offen offset:2048 sc1
buffer_load_dwordx4 v[72:75], v1, s[8:11], s15 offen offset:3072 sc1
buffer_load_dwordx4 v[76:79], v1, s[8:11], s25 offen offset:0 sc1
buffer_load_dwordx4 v[80:83], v1, s[8:11], s25 offen offset:1024 sc1
buffer_load_dwordx4 v[84:87], v1, s[8:11], s25 offen offset:2048 sc1
s_waitcnt vmcnt(0)
v_max3_u32 v10, v60, v61, v62
v_max3_u32 v10, v10, v63, v64
v_max3_u32 v10, v10, v65, v66
v_max3_u32 v10, v10, v67, v68
v_max3_u32 v10, v10, v69, v70
v_max3_u32 v10, v10, v71, v72
v_max3_u32 v10, v10, v73, v74
v_max3_u32 v10, v10, v75, v76
v_max3_u32 v10, v10, v77, v78
v_max3_u32 v10, v10, v79, v80
v_max3_u32 v10, v10, v81, v82
v_max3_u32 v10, v10, v83, v84
v_max3_u32 v10, v10, v85, v86
v_max_u32 v10, v10, v87
v_cmp_eq_u32 vcc, -1, v10
s_cbranch_vccz A_rok_78
s_sub_u32 s19, s19, 1
s_cbranch_scc0 A_rl_77
s_branch M_abort
A_rok_78:
v_mov_b64 v[20:21], 0
v_mov_b64 v[22:23], 0
v_mov_b64 v[24:25], 0
v_mov_b64 v[26:27], 0
v_mov_b64 v[28:29], 0
v_mov_b64 v[30:31], 0
v_mov_b64 v[32:33], 0
v_mov_b64 v[34:35], 0
ds_write_b128 v1, v[64:67] offset:30208
ds_write_b128 v1, v[68:71] offset:31232
ds_write_b128 v1, v[72:75] offset:32256
s_nop 1
v_smfmac_f32_16x16x64_bf16 v[20:23], v[60:63], a[0:7], v9
v_smfmac_f32_16x16x64_bf16 v[24:27], v[60:63], a[56:63], v9
v_smfmac_f32_16x16x64_bf16 v[28:31], v[60:63], a[112:119], v9
v_smfmac_f32_16x16x64_bf16 v[32:35], v[60:63], a[168:175], v9
v_smfmac_f32_16x16x64_bf16 v[20:23], v[64:67], a[8:15], v9
v_smfmac_f32_16x16x64_bf16 v[24:27], v[64:67], a[64:71], v9
v_smfmac_f32_16x16x64_bf16 v[28:31], v[64:67], a[120:127], v9
v_smfmac_f32_16x16x64_bf16 v[32:35], v[64:67], a[176:183], v9
v_smfmac_f32_16x16x64_bf16 v[20:23], v[68:71], a[16:23], v9
v_smfmac_f32_16x16x64_bf16 v[24:27], v[68:71], a[72:79], v9
v_smfmac_f32_16x16x64_bf16 v[28:31], v[68:71], a[128:135], v9
v_smfmac_f32_16x16x64_bf16 v[32:35], v[68:71], a[184:191], v9
v_smfmac_f32_16x16x64_bf16 v[20:23], v[72:75], a[24:31], v9
v_smfmac_f32_16x16x64_bf16 v[24:27], v[72:75], a[80:87], v9
v_smfmac_f32_16x16x64_bf16 v[28:31], v[72:75], a[136:143], v9
v_smfmac_f32_16x16x64_bf16 v[32:35], v[72:75], a[192:199], v9
v_smfmac_f32_16x16x64_bf16 v[20:23], v[76:79], a[32:39], v9
v_smfmac_f32_16x16x64_bf16 v[24:27], v[76:79], a[88:95], v9
v_smfmac_f32_16x16x64_bf16 v[28:31], v[76:79], a[144:151], v9
v_smfmac_f32_16x16x64_bf16 v[32:35], v[76:79], a[200:207], v9
v_smfmac_f32_16x16x64_bf16 v[20:23], v[80:83], a[40:47], v9
v_smfmac_f32_16x16x64_bf16 v[24:27], v[80:83], a[96:103], v9
v_smfmac_f32_16x16x64_bf16 v[28:31], v[80:83], a[152:159], v9
v_smfmac_f32_16x16x64_bf16 v[32:35], v[80:83], a[208:215], v9
v_smfmac_f32_16x16x64_bf16 v[20:23], v[84:87], a[48:55], v9
v_smfmac_f32_16x16x64_bf16 v[24:27], v[84:87], a[104:111], v9
v_smfmac_f32_16x16x64_bf16 v[28:31], v[84:87], a[160:167], v9
v_smfmac_f32_16x16x64_bf16 v[32:35], v[84:87], a[216:223], v9
v_cvt_pk_bf16_f32 v16, v20, v21
s_branch A_again_75

A_retry_83:
s_nop 7
A_rl_84:
s_add_u32 s25, s15, 4096
buffer_load_dwordx4 v[60:63], v1, s[8:11], s15 offen offset:0 sc1
buffer_load_dwordx4 v[64:67], v1, s[8:11], s15 offen offset:1024 sc1
buffer_load_dwordx4 v[68:71], v1, s[8:11], s15 offen offset:2048 sc1
buffer_load_dwordx4 v[72:75], v1, s[8:11], s15 offen offset:3072 sc1
buffer_load_dwordx4 v[76:79], v1, s[8:11], s25 offen offset:0 sc1
buffer_load_dwordx4 v[80:83], v1, s[8:11], s25 offen offset:1024 sc1
buffer_load_dwordx4 v[84:87], v1, s[8:11], s25 offen offset:2048 sc1
s_waitcnt vmcnt(0)
v_max3_u32 v10, v60, v61, v62
v_max3_u32 v10, v10, v63, v64
v_max3_u32 v10, v10, v65, v66
v_max3_u32 v10, v10, v67, v68
v_max3_u32 v10, v10, v69, v70
v_max3_u32 v10, v10, v71, v72
v_max3_u32 v10, v10, v73, v74
v_max3_u32 v10, v10, v75, v76
v_max3_u32 v10, v10, v77, v78
v_max3_u32 v10, v10, v79, v80
v_max3_u32 v10, v10, v81, v82
v_max3_u32 v10, v10, v83, v84
v_max3_u32 v10, v10, v85, v86
v_max_u32 v10, v10, v87
v_cmp_eq_u32 vcc, -1, v10
s_cbranch_vccz A_rok_85
s_sub_u32 s19, s19, 1
s_cbranch_scc0 A_rl_84
s_branch M_abort
A_rok_85:
v_mov_b64 v[20:21], 0
v_mov_b64 v[22:23], 0
v_mov_b64 v[24:25], 0
v_mov_b64 v[26:27], 0
v_mov_b64 v[28:29], 0
v_mov_b64 v[30:31], 0
v_mov_b64 v[32:33], 0
v_mov_b64 v[34:35], 0
ds_write_b128 v1, v[72:75] offset:33280
ds_write_b128 v1, v[76:79] offset:34304
ds_write_b128 v1, v[80:83] offset:35328
s_nop 1
v_smfmac_f32_16x16x64_bf16 v[20:23], v[60:63], a[0:7], v9
v_smfmac_f32_16x16x64_bf16 v[24:27], v[60:63], a[56:63], v9
v_smfmac_f32_16x16x64_bf16 v[28:31], v[60:63], a[112:119], v9
v_smfmac_f32_16x16x64_bf16 v[32:35], v[60:63], a[168:175], v9
v_smfmac_f32_16x16x64_bf16 v[20:23], v[64:67], a[8:15], v9
v_smfmac_f32_16x16x64_bf16 v[24:27], v[64:67], a[64:71], v9
v_smfmac_f32_16x16x64_bf16 v[28:31], v[64:67], a[120:127], v9
v_smfmac_f32_16x16x64_bf16 v[32:35], v[64:67], a[176:183], v9
v_smfmac_f32_16x16x64_bf16 v[20:23], v[68:71], a[16:23], v9
v_smfmac_f32_16x16x64_bf16 v[24:27], v[68:71], a[72:79], v9
v_smfmac_f32_16x16x64_bf16 v[28:31], v[68:71], a[128:135], v9
v_smfmac_f32_16x16x64_bf16 v[32:35], v[68:71], a[184:191], v9
v_smfmac_f32_16x16x64_bf16 v[20:23], v[72:75], a[24:31], v9
v_smfmac_f32_16x16x64_bf16 v[24:27], v[72:75], a[80:87], v9
v_smfmac_f32_16x16x64_bf16 v[28:31], v[72:75], a[136:143], v9
v_smfmac_f32_16x16x64_bf16 v[32:35], v[72:75], a[192:199], v9
v_smfmac_f32_16x16x64_bf16 v[20:23], v[76:79], a[32:39], v9
v_smfmac_f32_16x16x64_bf16 v[24:27], v[76:79], a[88:95], v9
v_smfmac_f32_16x16x64_bf16 v[28:31], v[76:79], a[144:151], v9
v_smfmac_f32_16x16x64_bf16 v[32:35], v[76:79], a[200:207], v9
v_smfmac_f32_16x16x64_bf16 v[20:23], v[80:83], a[40:47], v9
v_smfmac_f32_16x16x64_bf16 v[24:27], v[80:83], a[96:103], v9
v_smfmac_f32_16x16x64_bf16 v[28:31], v[80:83], a[152:159], v9
v_smfmac_f32_16x16x64_bf16 v[32:35], v[80:83], a[208:215], v9
v_smfmac_f32_16x16x64_bf16 v[20:23], v[84:87], a[48:55], v9
v_smfmac_f32_16x16x64_bf16 v[24:27], v[84:87], a[104:111], v9
v_smfmac_f32_16x16x64_bf16 v[28:31], v[84:87], a[160:167], v9
v_smfmac_f32_16x16x64_bf16 v[32:35], v[84:87], a[216:223], v9
v_cvt_pk_bf16_f32 v16, v20, v21
s_branch A_again_82

A_retry_88:
s_nop 7
A_rl_89:
s_add_u32 s25, s15, 4096
buffer_load_dwordx4 v[60:63], v1, s[8:11], s15 offen offset:0 sc1
buffer_load_dwordx4 v[64:67], v1, s[8:11], s15 offen offset:1024 sc1
buffer_load_dwordx4 v[68:71], v1, s[8:11], s15 offen offset:2048 sc1
buffer_load_dwordx4 v[72:75], v1, s[8:11], s15 offen offset:3072 sc1
buffer_load_dwordx4 v[76:79], v1, s[8:11], s25 offen offset:0 sc1
buffer_load_dwordx4 v[80:83], v1, s[8:11], s25 offen offset:1024 sc1
buffer_load_dwordx4 v[84:87], v1, s[8:11], s25 offen offset:2048 sc1
s_waitcnt vmcnt(0)
v_max3_u32 v10, v60, v61, v62
v_max3_u32 v10, v10, v63, v64
v_max3_u32 v10, v10, v65, v66
v_max3_u32 v10, v10, v67, v68
v_max3_u32 v10, v10, v69, v70
v_max3_u32 v10, v10, v71, v72
v_max3_u32 v10, v10, v73, v74
v_max3_u32 v10, v10, v75, v76
v_max3_u32 v10, v10, v77, v78
v_max3_u32 v10, v10, v79, v80
v_max3_u32 v10, v10, v81, v82
v_max3_u32 v10, v10, v83, v84
v_max3_u32 v10, v10, v85, v86
v_max_u32 v10, v10, v87
v_cmp_eq_u32 vcc, -1, v10
s_cbranch_vccz A_rok_90
s_sub_u32 s19, s19, 1
s_cbranch_scc0 A_rl_89
s_branch M_abort
A_rok_90:
v_mov_b64 v[20:21], 0
v_mov_b64 v[22:23], 0
v_mov_b64 v[24:25], 0
v_mov_b64 v[26:27], 0
v_mov_b64 v[28:29], 0
v_mov_b64 v[30:31], 0
v_mov_b64 v[32:33], 0
v_mov_b64 v[34:35], 0
ds_write_b128 v1, v[80:83] offset:36352
ds_write_b128 v1, v[84:87] offset:37376
s_nop 1
v_smfmac_f32_16x16x64_bf16 v[20:23], v[60:63], a[0:7], v9
v_smfmac_f32_16x16x64_bf16 v[24:27], v[60:63], a[56:63], v9
v_smfmac_f32_16x16x64_bf16 v[28:31], v[60:63], a[112:119], v9
v_smfmac_f32_16x16x64_bf16 v[32:35], v[60:63], a[168:175], v9
v_smfmac_f32_16x16x64_bf16 v[20:23], v[64:67], a[8:15], v9
v_smfmac_f32_16x16x64_bf16 v[24:27], v[64:67], a[64:71], v9
v_smfmac_f32_16x16x64_bf16 v[28:31], v[64:67], a[120:127], v9
v_smfmac_f32_16x16x64_bf16 v[32:35], v[64:67], a[176:183], v9
v_smfmac_f32_16x16x64_bf16 v[20:23], v[68:71], a[16:23], v9
v_smfmac_f32_16x16x64_bf16 v[24:27], v[68:71], a[72:79], v9
v_smfmac_f32_16x16x64_bf16 v[28:31], v[68:71], a[128:135], v9
v_smfmac_f32_16x16x64_bf16 v[32:35], v[68:71], a[184:191], v9
v_smfmac_f32_16x16x64_bf16 v[20:23], v[72:75], a[24:31], v9
v_smfmac_f32_16x16x64_bf16 v[24:27], v[72:75], a[80:87], v9
v_smfmac_f32_16x16x64_bf16 v[28:31], v[72:75], a[136:143], v9
v_smfmac_f32_16x16x64_bf16 v[32:35], v[72:75], a[192:199], v9
v_smfmac_f32_16x16x64_bf16 v[20:23], v[76:79], a[32:39], v9
v_smfmac_f32_16x16x64_bf16 v[24:27], v[76:79], a[88:95], v9
v_smfmac_f32_16x16x64_bf16 v[28:31], v[76:79], a[144:151], v9
v_smfmac_f32_16x16x64_bf16 v[32:35], v[76:79], a[200:207], v9
v_smfmac_f32_16x16x64_bf16 v[20:23], v[80:83], a[40:47], v9
v_smfmac_f32_16x16x64_bf16 v[24:27], v[80:83], a[96:103], v9
v_smfmac_f32_16x16x64_bf16 v[28:31], v[80:83], a[152:159], v9
v_smfmac_f32_16x16x64_bf16 v[32:35], v[80:83], a[208:215], v9
v_smfmac_f32_16x16x64_bf16 v[20:23], v[84:87], a[48:55], v9
v_smfmac_f32_16x16x64_bf16 v[24:27], v[84:87], a[104:111], v9
v_smfmac_f32_16x16x64_bf16 v[28:31], v[84:87], a[160:167], v9
v_smfmac_f32_16x16x64_bf16 v[32:35], v[84:87], a[216:223], v9
v_cvt_pk_bf16_f32 v16, v20, v21
s_branch A_again_87

PMR_101:
s_sub_u32 s19, s19, 1
s_cbranch_scc1 M_abort
s_branch PM_100
B_retry_105:
s_nop 7
B_rl_106:
buffer_load_dwordx4 v[52:55], v4, s[8:11], s16 offen sc1
buffer_load_dwordx4 v[56:59], v4, s[8:11], s16 offen offset:1024 sc1
buffer_load_dwordx4 v[60:63], v5, s[8:11], s16 offen sc1
s_waitcnt vmcnt(0)
v_max3_u32 v27, v52, v53, v54
v_max3_u32 v27, v27, v55, v56
v_max3_u32 v27, v27, v57, v58
v_max3_u32 v27, v27, v59, v60
v_max3_u32 v27, v27, v61, v62
v_max_u32 v27, v27, v63
v_cmp_eq_u32 vcc, -1, v27
s_cbranch_vccz B_rok_107
s_sub_u32 s19, s19, 1
s_cbranch_scc0 B_rl_106
s_branch M_abort
B_rok_107:
v_mov_b64 v[28:29], 0
v_mov_b64 v[30:31], 0
v_mov_b64 v[32:33], 0
v_mov_b64 v[34:35], 0
s_nop 1
s_branch B_again_104

PMR_115:
s_sub_u32 s19, s19, 1
s_cbranch_scc1 M_abort
s_branch PM_114
B_retry_119:
s_nop 7
B_rl_120:
buffer_load_dwordx4 v[52:55], v4, s[8:11], s16 offen sc1
buffer_load_dwordx4 v[56:59], v4, s[8:11], s16 offen offset:1024 sc1
buffer_load_dwordx4 v[60:63], v5, s[8:11], s16 offen sc1
s_waitcnt vmcnt(0)
v_max3_u32 v27, v52, v53, v54
v_max3_u32 v27, v27, v55, v56
v_max3_u32 v27, v27, v57, v58
v_max3_u32 v27, v27, v59, v60
v_max3_u32 v27, v27, v61, v62
v_max_u32 v27, v27, v63
v_cmp_eq_u32 vcc, -1, v27
s_cbranch_vccz B_rok_121
s_sub_u32 s19, s19, 1
s_cbranch_scc0 B_rl_120
s_branch M_abort
B_rok_121:
v_mov_b64 v[28:29], 0
v_mov_b64 v[30:31], 0
v_mov_b64 v[32:33], 0
v_mov_b64 v[34:35], 0
s_nop 1
s_branch B_again_118

M_abort:
v_mov_b32 v1, 0
v_mov_b32 v2, 1
global_atomic_add v1, v2, s[4:5] offset:20 sc1
s_waitcnt vmcnt(0)
M_exit:
s_endpgm
M_code_end:
.fill 1100, 4, 0xbf800000
.section .rodata,"a"
.p2align 6
.amdhsa_kernel recurrent_scan__memory_aug_recurrent_mem_tr__glu_gated_reglu__prompt_kernel
  .amdhsa_next_free_vgpr 512
  .amdhsa_next_free_sgpr 102
  .amdhsa_accum_offset 256
  .amdhsa_group_segment_fixed_size 0
  .amdhsa_kernarg_size 112
  .amdhsa_user_sgpr_count 2
  .amdhsa_user_sgpr_kernarg_segment_ptr 1
  .amdhsa_system_sgpr_workgroup_id_x 1
.end_amdhsa_kernel
```
